```python
import torch

def _softmax(x, axis=-1):
    return torch.softmax(x, dim=axis)

def _gelu(x):
    return torch.nn.functional.gelu(x, approximate='tanh')

def _silu(x):
    return torch.nn.functional.silu(x)

def _sigmoid(x):
    return torch.sigmoid(x)

def _layernorm(x, axis=-1, eps=1e-05):
    m = x.mean(dim=axis, keepdim=True)
    v = x.var(dim=axis, keepdim=True, unbiased=False)
    return (x - m) / torch.sqrt(v + eps)

def _scatter_add(tgt, idx, src, axis=0):
    return tgt.clone().index_add_(axis, idx, src)

def _segment_sum(src, seg, n):
    out = torch.zeros((n,) + src.shape[1:], dtype=src.dtype)
    return out.index_add_(0, seg, src)

def _pad(x, pw):
    flat = tuple((v for pair in reversed(pw) for v in pair))
    return torch.nn.functional.pad(x, flat)
kernel_name = 'concat_heads__memory_aug_recurrent_mem_tr__sliding_block__prompt'

def setup_inputs():

    _w = lambda a: (lambda t: t.to(torch.bfloat16) if t.is_floating_point() else t)(torch.as_tensor(a))

    def _A_setup():
        B, S, Dm = (1, 2048, 1024)
        H, Dh = (32, 128)
        M, seg = (8, 32)
        seg = min(seg, S)
        S = S // seg * seg
        return {'x': _w((lambda *s: torch.randn(*s, dtype=torch.bfloat16) * 0.05)(B, S, Dm)), 'mem0': _w((lambda *s: torch.randn(*s, dtype=torch.bfloat16) * 1.6)(B, M, Dm)), 'Wq': _w((lambda *s: torch.randn(*s, dtype=torch.bfloat16) * 0.8)(Dm, H, Dh) * Dm ** (-0.5)), 'Wk': _w((lambda *s: torch.randn(*s, dtype=torch.bfloat16) * 0.8)(Dm, H, Dh) * Dm ** (-0.5)), 'Wv': _w((lambda *s: torch.randn(*s, dtype=torch.bfloat16) * 1.6)(Dm, H, Dh) * Dm ** (-0.5)), 'Wo': _w((lambda *s: torch.randn(*s, dtype=torch.bfloat16) * 1.6)(H, Dh, Dm) * (H * Dh) ** (-0.5)), 'seg_len': seg}
    _A_in = _A_setup()

    def _B_setup():
        B, S, D = (1, 2048, 1024)
        return {'x': _w((lambda *s: torch.randn(*s, dtype=torch.bfloat16) * 0.2)(B, S, D)), 'wqkv': _w((lambda *s: torch.randn(*s, dtype=torch.bfloat16) * 0.2)(D, 3 * D)), 'wo': _w((lambda *s: torch.randn(*s, dtype=torch.bfloat16) * 0.05)(D, D))}
    _B_in = _B_setup()
    return {'A_x': _A_in['x'], 'A_mem0': _A_in['mem0'], 'A_Wq': _A_in['Wq'], 'A_Wk': _A_in['Wk'], 'A_Wv': _A_in['Wv'], 'A_Wo': _A_in['Wo'], 'A_seg_len': _A_in['seg_len'], 'B_x': _B_in['x'], 'B_wqkv': _B_in['wqkv'], 'B_wo': _B_in['wo']}

def reference(A_x, A_mem0, A_Wq, A_Wk, A_Wv, A_Wo, A_seg_len, B_x, B_wqkv, B_wo):

    def _A_ref(x, mem0, Wq, Wk, Wv, Wo, seg_len):
        B, S, Dm = x.shape
        H, Dh = (Wq.shape[1], Wq.shape[2])
        M = mem0.shape[1]
        scale = Dh ** (-0.5)
        n_seg = S // seg_len
        L = M + seg_len
        idx = torch.arange(L)
        mask = (idx[:, None] < M) | (idx[:, None] >= idx[None, :])
        mem = mem0
        outs = []
        for s in range(n_seg):
            xs = x[:, s * seg_len:(s + 1) * seg_len, :].clone()
            h = torch.concatenate([mem, xs], axis=1)
            q = torch.einsum('btd,dhe->bhte', h, Wq)
            k = torch.einsum('btd,dhe->bhte', h, Wk)
            v = torch.einsum('btd,dhe->bhte', h, Wv)
            scores = torch.einsum('bhqe,bhke->bhqk', q, k) * scale
            scores = torch.where(mask[None, None], scores, -1000000000.0)
            p = _softmax(scores, axis=-1)
            o = torch.einsum('bhqk,bhke->bhqe', p, v)
            o = torch.einsum('bhte,hed->btd', o, Wo)
            mem = o[:, :M, :].clone()
            outs.append(o[:, M:, :])
        return torch.concatenate(outs, axis=1)

    def _B_ref(x, wqkv, wo):
        B, S, D = x.shape
        H = 32
        Dh = D // H
        W = 256
        qkv = (lambda x, *d: x.permute(*d))((x @ wqkv).reshape(B, S, 3, H, Dh), 2, 0, 3, 1, 4)
        q, k, v = (qkv[0], qkv[1], qkv[2])
        scores = torch.einsum('bhqd,bhkd->bhqk', q, k) * Dh ** (-0.5)
        idx = torch.arange(S)
        mask = (idx[:, None] - idx[None, :] >= 0) & (idx[:, None] - idx[None, :] < W)
        scores = torch.where(mask[None, None], scores, -1000000000.0)
        p = _softmax(scores, axis=-1)
        o = torch.einsum('bhqk,bhkd->bhqd', p, v)
        return (lambda x, *d: x.permute(*d))(o, 0, 2, 1, 3).reshape(B, S, D) @ wo
    a = _A_ref(A_x, A_mem0, A_Wq, A_Wk, A_Wv, A_Wo, A_seg_len)
    b = _B_ref(B_x, B_wqkv, B_wo)
    return torch.concatenate([a, b], axis=-1)
```

```asm
; @launch kernel=mega_kernel grid=(256,1,1) block=(256,1,1) lds=163840
.amdgcn_target "amdgcn-amd-amdhsa--gfx950"
.text
.globl mega_kernel
.type mega_kernel,@function
.p2align 8
mega_kernel:
    s_cmp_ge_u32 s2, 256
    s_cbranch_scc1 mega_kernel_exit
    s_mov_b32 s100, 0
    s_getpc_b64 s[4:5]
mega_kernel_pc:
    s_lshr_b32 s6, s2, 3
    s_lshl_b32 s6, s6, 13
    v_and_b32 v250, 63, v0
    v_lshl_add_u32 v250, v250, 7, s6
    v_min_u32 v250, mega_kernel_end-mega_kernel_pc-4, v250
    v_mov_b32 v253, s5
    v_add_co_u32 v252, vcc, s4, v250
    s_nop 1
    v_addc_co_u32 v253, vcc, 0, v253, vcc
    v_readfirstlane_b32 s4, v0
    s_nop 0
    s_lshr_b32 s4, s4, 6
    s_cmp_lg_u32 s4, 1
    s_cbranch_scc1 nopf_1
    global_load_dword v251, v[252:253], off
nopf_1:
mega_kernel_restart:
    s_load_dwordx2 s[16:17], s[0:1], 8
    s_load_dwordx4 s[20:23], s[0:1], 16
    s_load_dwordx4 s[24:27], s[0:1], 32
    s_load_dwordx4 s[28:31], s[0:1], 88
    v_and_b32 v1, 63, v0
    v_lshrrev_b32 v4, 6, v0
    s_nop 0
    v_readfirstlane_b32 s32, v4
    v_and_b32 v2, 15, v1
    v_lshrrev_b32 v3, 4, v1
    s_waitcnt lgkmcnt(0)
    s_lshl_b32 s35, s100, 27
    s_add_u32 s30, s30, s35
    s_addc_u32 s31, s31, 0
    s_lshl_b32 s35, s100, 7
    s_add_u32 s28, s28, s35
    s_addc_u32 s29, s29, 0
    s_mov_b32 s8, s30
    s_and_b32 s9, s31, 0xffff
    s_mov_b32 s10, 0x8000000
    s_mov_b32 s11, 0x00020000
    s_mov_b32 s12, s28
    s_and_b32 s13, s29, 0xffff
    s_mov_b32 s14, 0x80
    s_mov_b32 s15, 0x00020000
    s_lshr_b32 s33, s2, 5
    s_and_b32 s34, s2, 31
    s_cmp_lg_u32 s100, 0
    s_cbranch_scc1 role_2
    s_getreg_b32 s33, hwreg(HW_REG_XCC_ID)
    s_and_b32 s33, s33, 7
    s_cmp_lg_u32 s32, 0
    s_cbranch_scc1 norole_3
    s_lshl_b32 s35, s33, 2
    v_mov_b32 v4, s35
    v_mov_b32 v5, 1
    s_mov_b64 exec, 1
    buffer_atomic_add v5, v4, s[12:15], 0 offen sc0 sc1
    s_waitcnt vmcnt(0)
    v_mov_b32 v4, 155648
    ds_write_b32 v4, v5
    s_waitcnt lgkmcnt(0)
    s_mov_b64 exec, -1
norole_3:
    s_barrier
    v_mov_b32 v4, 155648
    ds_read_b32 v5, v4
    s_waitcnt lgkmcnt(0)
    v_readfirstlane_b32 s34, v5
role_2:
    s_mov_b32 s101, s33
    s_mov_b32 s3, s34
    s_cmp_ge_u32 s33, 4
    s_cbranch_scc1 mega_kernel_worker
    s_cmp_ge_u32 s34, 32
    s_cbranch_scc1 mega_kernel_worker
    s_mov_b32 s3, -1
    s_lshl_b32 s33, s33, 1
    s_lshr_b32 s35, s34, 4
    s_add_u32 s33, s33, s35
    s_and_b32 s34, s34, 15
    s_xor_b32 s55, s33, s34
    s_and_b32 s55, s55, 1
    s_lshr_b32 s56, s33, 1
    s_lshl_b32 s56, s56, 4
    s_add_u32 s56, s56, s34
    s_lshl_b32 s56, s56, 10
    s_or_b32 s35, s33, s34
    s_xor_b32 s36, s32, 1
    s_or_b32 s35, s35, s36
    s_cmp_lg_u32 s35, 0
    s_cbranch_scc1 noz_4
    v_lshlrev_b32 v4, 7, v1
    v_mov_b32 v5, 0
    s_mov_b32 s35, 0x6400000
    buffer_store_dword v5, v4, s[8:11], s35 offen sc1
    s_mov_b32 s35, 0x6402000
    buffer_store_dword v5, v4, s[8:11], s35 offen sc1
    s_mov_b32 s35, 0x6404000
    buffer_store_dword v5, v4, s[8:11], s35 offen sc1
    s_mov_b32 s35, 0x6406000
    buffer_store_dword v5, v4, s[8:11], s35 offen sc1
    s_waitcnt vmcnt(0)
    v_mov_b32 v4, 52
    v_mov_b32 v5, 1
    s_mov_b64 exec, 1
    buffer_store_dword v5, v4, s[12:15], 0 offen sc1
    s_mov_b64 exec, -1
noz_4:
    v_mov_b32 v44, -1
    v_mov_b32 v45, -1
    v_mov_b32 v46, -1
    v_mov_b32 v47, -1
    v_lshlrev_b32 v6, 4, v1
    s_lshl_b32 s38, s33, 4
    s_add_u32 s38, s38, s34
    s_lshl_b32 s38, s38, 10
    s_lshl_b32 s35, s32, 17
    s_add_u32 s37, s35, s38
    s_add_u32 s35, s35, s56
    s_cmp_lg_u32 s100, 0
    s_cbranch_scc1 f1_5
    s_add_u32 s36, s37, 0x6000000
    buffer_store_dwordx4 v[44:47], v6, s[8:11], s36 offen
    s_add_u32 s36, s37, 0x6080000
    buffer_store_dwordx4 v[44:47], v6, s[8:11], s36 offen
    s_add_u32 s36, s35, 0x6100000
    buffer_store_dwordx4 v[44:47], v6, s[8:11], s36 offen
    s_branch f2_6
f1_5:
    s_add_u32 s36, s37, 0x6000000
    buffer_store_dwordx4 v[44:47], v6, s[8:11], s36 offen sc1
    s_add_u32 s36, s37, 0x6080000
    buffer_store_dwordx4 v[44:47], v6, s[8:11], s36 offen sc1
    s_add_u32 s36, s35, 0x6100000
    buffer_store_dwordx4 v[44:47], v6, s[8:11], s36 offen sc1
f2_6:
    s_lshl_b32 s35, s34, 14
    s_lshl_b32 s36, s32, 11
    s_add_u32 s35, s35, s36
    s_add_u32 s35, s35, 0x6200000
    v_add_u32 v28, s35, v6
    s_lshl_b32 s36, s33, 8
    v_add_u32 v27, s36, v28
    v_add_u32 v29, 8192, v27
    s_mov_b64 exec, 0xffff
    s_mov_b32 s36, 0x0
    buffer_store_dwordx4 v[44:47], v27, s[8:11], s36 offen sc1
    buffer_store_dwordx4 v[44:47], v29, s[8:11], s36 offen sc1
    s_mov_b32 s36, 0x40000
    buffer_store_dwordx4 v[44:47], v27, s[8:11], s36 offen sc1
    buffer_store_dwordx4 v[44:47], v29, s[8:11], s36 offen sc1
    s_mov_b32 s36, 0x80000
    buffer_store_dwordx4 v[44:47], v27, s[8:11], s36 offen sc1
    buffer_store_dwordx4 v[44:47], v29, s[8:11], s36 offen sc1
    s_mov_b32 s36, 0xc0000
    buffer_store_dwordx4 v[44:47], v27, s[8:11], s36 offen sc1
    buffer_store_dwordx4 v[44:47], v29, s[8:11], s36 offen sc1
    s_mov_b64 exec, -1
    s_lshr_b32 s35, s33, 1
    s_lshl_b32 s35, s35, 8
    s_add_u32 s35, s35, 0x6180000
    v_lshl_add_u32 v38, v2, 2, s35
    s_cmp_eq_u32 s55, 0
    s_cbranch_scc1 fr_7
    s_and_b32 s36, s33, 1
    s_lshl_b32 s36, s36, 5
    s_add_u32 s35, s35, s36
    s_lshr_b32 s36, s34, 1
    s_lshl_b32 s36, s36, 2
    s_add_u32 s35, s35, s36
    v_min_u32 v38, 1, v0
    v_lshl_add_u32 v38, v38, 28, s35
    buffer_store_dword v44, v38, s[8:11], 0 offen sc1
fr_7:
    s_mov_b32 s52, 1
    s_cmp_lt_u32 s34, 8
    s_cbranch_scc1 nocal2_9
    s_bitcmp1_b32 s33, 0
    s_cbranch_scc1 nocal2_9
    s_waitcnt vmcnt(0)
    s_barrier
    s_cmp_lg_u32 s32, 0
    s_cbranch_scc1 nocal_8
    s_mov_b32 s60, -1
    s_mov_b32 s61, -1
    s_mov_b64 exec, 0xffff
    s_mov_b32 s36, 262144
    s_memtime s[66:67]
    s_waitcnt lgkmcnt(0)
    buffer_store_dwordx4 v[44:47], v27, s[8:11], s36 offen sc1
    s_waitcnt vmcnt(0)
    s_memtime s[64:65]
    s_waitcnt lgkmcnt(0)
    s_sub_u32 s37, s64, s66
    s_min_u32 s60, s60, s37
    s_mov_b32 s36, 262144
    s_memtime s[66:67]
    s_waitcnt lgkmcnt(0)
    buffer_store_dwordx4 v[44:47], v29, s[8:11], s36 offen sc1
    s_waitcnt vmcnt(0)
    s_memtime s[64:65]
    s_waitcnt lgkmcnt(0)
    s_sub_u32 s37, s64, s66
    s_min_u32 s61, s61, s37
    s_mov_b32 s36, 524288
    s_memtime s[66:67]
    s_waitcnt lgkmcnt(0)
    buffer_store_dwordx4 v[44:47], v27, s[8:11], s36 offen sc1
    s_waitcnt vmcnt(0)
    s_memtime s[64:65]
    s_waitcnt lgkmcnt(0)
    s_sub_u32 s37, s64, s66
    s_min_u32 s60, s60, s37
    s_mov_b32 s36, 524288
    s_memtime s[66:67]
    s_waitcnt lgkmcnt(0)
    buffer_store_dwordx4 v[44:47], v29, s[8:11], s36 offen sc1
    s_waitcnt vmcnt(0)
    s_memtime s[64:65]
    s_waitcnt lgkmcnt(0)
    s_sub_u32 s37, s64, s66
    s_min_u32 s61, s61, s37
    s_mov_b32 s36, 786432
    s_memtime s[66:67]
    s_waitcnt lgkmcnt(0)
    buffer_store_dwordx4 v[44:47], v27, s[8:11], s36 offen sc1
    s_waitcnt vmcnt(0)
    s_memtime s[64:65]
    s_waitcnt lgkmcnt(0)
    s_sub_u32 s37, s64, s66
    s_min_u32 s60, s60, s37
    s_mov_b32 s36, 786432
    s_memtime s[66:67]
    s_waitcnt lgkmcnt(0)
    buffer_store_dwordx4 v[44:47], v29, s[8:11], s36 offen sc1
    s_waitcnt vmcnt(0)
    s_memtime s[64:65]
    s_waitcnt lgkmcnt(0)
    s_sub_u32 s37, s64, s66
    s_min_u32 s61, s61, s37
    s_cmp_lt_u32 s61, s60
    s_cselect_b32 s52, 0x10001, 1
    s_mov_b64 exec, -1
nocal_8:
    s_barrier
nocal2_9:
    s_lshr_b32 s37, s38, 4
    v_lshrrev_b32 v8, 2, v1
    v_lshlrev_b32 v8, 13, v8
    v_and_b32 v9, 3, v1
    v_lshl_add_u32 v8, v9, 4, v8
    s_lshl_b32 s35, s32, 17
    s_add_u32 s37, s37, s35
    s_lshl_b32 s35, s32, 10
    s_mov_b32 s72, s20
    s_and_b32 s73, s21, 0xffff
    s_mov_b32 s74, 0x800000
    s_mov_b32 s75, 0x00020000
    s_add_u32 m0, s35, 0
    s_add_u32 s36, s37, 0
    buffer_load_dwordx4 v8, s[72:75], s36 offen lds
    s_add_u32 m0, s35, 4096
    s_add_u32 s36, s37, 524288
    buffer_load_dwordx4 v8, s[72:75], s36 offen lds
    s_add_u32 m0, s35, 8192
    s_add_u32 s36, s37, 1048576
    buffer_load_dwordx4 v8, s[72:75], s36 offen lds
    s_add_u32 m0, s35, 12288
    s_add_u32 s36, s37, 1572864
    buffer_load_dwordx4 v8, s[72:75], s36 offen lds
    s_add_u32 m0, s35, 16384
    s_add_u32 s36, s37, 2097152
    buffer_load_dwordx4 v8, s[72:75], s36 offen lds
    s_add_u32 m0, s35, 20480
    s_add_u32 s36, s37, 2621440
    buffer_load_dwordx4 v8, s[72:75], s36 offen lds
    s_add_u32 m0, s35, 24576
    s_add_u32 s36, s37, 3145728
    buffer_load_dwordx4 v8, s[72:75], s36 offen lds
    s_add_u32 m0, s35, 28672
    s_add_u32 s36, s37, 3670016
    buffer_load_dwordx4 v8, s[72:75], s36 offen lds
    s_add_u32 m0, s35, 32768
    s_add_u32 s36, s37, 4194304
    buffer_load_dwordx4 v8, s[72:75], s36 offen lds
    s_add_u32 m0, s35, 36864
    s_add_u32 s36, s37, 4718592
    buffer_load_dwordx4 v8, s[72:75], s36 offen lds
    s_add_u32 m0, s35, 40960
    s_add_u32 s36, s37, 5242880
    buffer_load_dwordx4 v8, s[72:75], s36 offen lds
    s_add_u32 m0, s35, 45056
    s_add_u32 s36, s37, 5767168
    buffer_load_dwordx4 v8, s[72:75], s36 offen lds
    s_add_u32 m0, s35, 49152
    s_add_u32 s36, s37, 6291456
    buffer_load_dwordx4 v8, s[72:75], s36 offen lds
    s_add_u32 m0, s35, 53248
    s_add_u32 s36, s37, 6815744
    buffer_load_dwordx4 v8, s[72:75], s36 offen lds
    s_add_u32 m0, s35, 57344
    s_add_u32 s36, s37, 7340032
    buffer_load_dwordx4 v8, s[72:75], s36 offen lds
    s_add_u32 m0, s35, 61440
    s_add_u32 s36, s37, 7864320
    buffer_load_dwordx4 v8, s[72:75], s36 offen lds
    s_waitcnt vmcnt(16)
    s_barrier
    s_cmp_lg_u32 s32, 0
    s_cbranch_scc1 nord_10
    v_mov_b32 v68, 32
    v_mov_b32 v69, s52
    s_mov_b64 exec, 1
    buffer_atomic_add v69, v68, s[12:15], 0 offen sc1
    s_mov_b64 exec, -1
nord_10:
    s_nop 4
    s_mov_b32 s72, s22
    s_and_b32 s73, s23, 0xffff
    s_mov_b32 s74, 0x800000
    s_mov_b32 s75, 0x00020000
    s_add_u32 m0, s35, 65536
    s_add_u32 s36, s37, 0
    buffer_load_dwordx4 v8, s[72:75], s36 offen lds
    s_add_u32 m0, s35, 69632
    s_add_u32 s36, s37, 524288
    buffer_load_dwordx4 v8, s[72:75], s36 offen lds
    s_add_u32 m0, s35, 73728
    s_add_u32 s36, s37, 1048576
    buffer_load_dwordx4 v8, s[72:75], s36 offen lds
    s_add_u32 m0, s35, 77824
    s_add_u32 s36, s37, 1572864
    buffer_load_dwordx4 v8, s[72:75], s36 offen lds
    s_add_u32 m0, s35, 81920
    s_add_u32 s36, s37, 2097152
    buffer_load_dwordx4 v8, s[72:75], s36 offen lds
    s_add_u32 m0, s35, 86016
    s_add_u32 s36, s37, 2621440
    buffer_load_dwordx4 v8, s[72:75], s36 offen lds
    s_add_u32 m0, s35, 90112
    s_add_u32 s36, s37, 3145728
    buffer_load_dwordx4 v8, s[72:75], s36 offen lds
    s_add_u32 m0, s35, 94208
    s_add_u32 s36, s37, 3670016
    buffer_load_dwordx4 v8, s[72:75], s36 offen lds
    s_add_u32 m0, s35, 98304
    s_add_u32 s36, s37, 4194304
    buffer_load_dwordx4 v8, s[72:75], s36 offen lds
    s_add_u32 m0, s35, 102400
    s_add_u32 s36, s37, 4718592
    buffer_load_dwordx4 v8, s[72:75], s36 offen lds
    s_add_u32 m0, s35, 106496
    s_add_u32 s36, s37, 5242880
    buffer_load_dwordx4 v8, s[72:75], s36 offen lds
    s_add_u32 m0, s35, 110592
    s_add_u32 s36, s37, 5767168
    buffer_load_dwordx4 v8, s[72:75], s36 offen lds
    s_add_u32 m0, s35, 114688
    s_add_u32 s36, s37, 6291456
    buffer_load_dwordx4 v8, s[72:75], s36 offen lds
    s_add_u32 m0, s35, 118784
    s_add_u32 s36, s37, 6815744
    buffer_load_dwordx4 v8, s[72:75], s36 offen lds
    s_add_u32 m0, s35, 122880
    s_add_u32 s36, s37, 7340032
    buffer_load_dwordx4 v8, s[72:75], s36 offen lds
    s_add_u32 m0, s35, 126976
    s_add_u32 s36, s37, 7864320
    buffer_load_dwordx4 v8, s[72:75], s36 offen lds
    s_mov_b32 s80, s16
    s_and_b32 s81, s17, 0xffff
    s_mov_b32 s82, 0x4000
    s_mov_b32 s83, 0x00020000
    v_and_b32 v10, 7, v2
    v_lshlrev_b32 v10, 11, v10
    v_lshl_add_u32 v10, v3, 5, v10
    v_lshrrev_b32 v11, 3, v2
    v_lshl_add_u32 v10, v11, 2, v10
    s_lshl_b32 s36, s32, 9
    buffer_load_dword v224, v10, s[80:83], s36 offen offset:0
    buffer_load_dword v225, v10, s[80:83], s36 offen offset:8
    buffer_load_dword v226, v10, s[80:83], s36 offen offset:16
    buffer_load_dword v227, v10, s[80:83], s36 offen offset:24
    buffer_load_dword v228, v10, s[80:83], s36 offen offset:128
    buffer_load_dword v229, v10, s[80:83], s36 offen offset:136
    buffer_load_dword v230, v10, s[80:83], s36 offen offset:144
    buffer_load_dword v231, v10, s[80:83], s36 offen offset:152
    buffer_load_dword v232, v10, s[80:83], s36 offen offset:256
    buffer_load_dword v233, v10, s[80:83], s36 offen offset:264
    buffer_load_dword v234, v10, s[80:83], s36 offen offset:272
    buffer_load_dword v235, v10, s[80:83], s36 offen offset:280
    buffer_load_dword v236, v10, s[80:83], s36 offen offset:384
    buffer_load_dword v237, v10, s[80:83], s36 offen offset:392
    buffer_load_dword v238, v10, s[80:83], s36 offen offset:400
    buffer_load_dword v239, v10, s[80:83], s36 offen offset:408
    s_cmp_lg_u32 s55, 0
    s_cbranch_scc1 wN_11
    s_mov_b32 s76, s24
    s_and_b32 s77, s25, 0xffff
    s_mov_b32 s78, 0x800000
    s_mov_b32 s79, 0x00020000
    v_lshrrev_b32 v9, 3, v1
    v_lshlrev_b32 v9, 13, v9
    v_and_b32 v10, 7, v1
    v_lshl_add_u32 v9, v10, 4, v9
    s_lshr_b32 s37, s38, 4
    s_andn2_b32 s37, s37, 64
    s_lshl_b32 s36, s32, 16
    s_add_u32 s37, s37, s36
    s_mov_b32 s35, 262144
    s_branch wJ_12
wN_11:
    s_mov_b32 s76, s26
    s_and_b32 s77, s27, 0xffff
    s_mov_b32 s78, 0x800000
    s_mov_b32 s79, 0x00020000
    v_lshlrev_b32 v9, 11, v3
    v_lshl_add_u32 v9, v2, 4, v9
    s_lshl_b32 s37, s33, 20
    s_lshr_b32 s36, s34, 1
    s_lshl_b32 s36, s36, 8
    s_add_u32 s37, s37, s36
    s_lshl_b32 s36, s32, 13
    s_add_u32 s37, s37, s36
    s_mov_b32 s35, 32768
wJ_12:
    s_mov_b32 s60, s37
    s_mov_b32 s61, s35
    s_mov_b32 s48, 0xfffefffe
    s_mov_b32 s49, 0x3e0293ee
    s_mov_b32 s50, 400000
    v_mov_b32 v40, s49
    v_mov_b32 v41, s49
    s_mov_b32 s62, 0xff00ff00
    s_mov_b32 s63, 0xff00ff00
    v_mov_b32 v4, 0xf149f2ca
    v_cndmask_b32 v56, 0, v4, s[62:63]
    v_cndmask_b32 v57, 0, v4, s[62:63]
    v_cndmask_b32 v58, 0, v4, s[62:63]
    v_cndmask_b32 v59, 0, v4, s[62:63]
    v_cmp_gt_u32 vcc, 32, v1
    s_nop 1
    v_cndmask_b32 v48, v56, v4, vcc
    v_cndmask_b32 v49, v56, v4, vcc
    v_cndmask_b32 v50, v56, v4, vcc
    v_cndmask_b32 v51, v56, v4, vcc
    v_mov_b32 v4, 0xff61b1e6
    v_cndmask_b32 v33, v4, 0, s[62:63]
    v_mov_b32 v60, 0x3f803f80
    v_mov_b32 v61, 0x3f803f80
    v_mov_b32 v62, 0x3f803f80
    v_mov_b32 v63, 0x3f803f80
    v_mov_b32 v4, 0x4444
    v_mov_b32 v5, 0xeeee
    v_cndmask_b32 v32, v4, v5, s[62:63]
    v_bfe_u32 v4, v2, 2, 1
    v_bfe_u32 v5, v2, 1, 1
    v_lshl_add_u32 v4, v5, 1, v4
    v_and_b32 v5, 1, v2
    v_lshlrev_b32 v5, 4, v5
    v_mov_b32 v11, 0x3f80
    v_lshlrev_b32 v5, v5, v11
    v_cmp_eq_u32 vcc, 0, v4
    s_nop 1
    v_cndmask_b32 v52, 0, v5, vcc
    v_cmp_eq_u32 vcc, 1, v4
    s_nop 1
    v_cndmask_b32 v53, 0, v5, vcc
    v_cmp_eq_u32 vcc, 2, v4
    s_nop 1
    v_cndmask_b32 v54, 0, v5, vcc
    v_cmp_eq_u32 vcc, 3, v4
    s_nop 1
    v_cndmask_b32 v55, 0, v5, vcc
    s_and_b32 s35, s32, 1
    s_lshr_b32 s36, s32, 1
    s_lshl_b32 s37, s32, 12
    v_add_u32 v4, s37, v6
    s_lshr_b32 s37, s33, 1
    s_lshl_b32 s37, s37, 14
    s_add_u32 s37, s37, 0x6100000
    v_add_u32 v12, s37, v4
    s_lshl_b32 s37, s33, 14
    s_add_u32 s37, s37, 0x6000000
    v_add_u32 v21, s37, v4
    s_lshl_b32 s51, s32, 12
    s_add_u32 s37, s37, s51
    s_add_u32 s37, s37, 0x80000
    v_and_b32 v22, 31, v1
    v_lshlrev_b32 v22, 4, v22
    v_lshrrev_b32 v4, 5, v1
    v_xor_b32 v4, 1, v4
    v_lshl_add_u32 v22, v4, 11, v22
    v_add_u32 v22, s37, v22
    s_lshl_b32 s37, s32, 12
    s_add_u32 s37, s37, 131072
    v_lshl_add_u32 v14, v1, 3, s37
    v_lshrrev_b32 v4, 5, v1
    v_lshlrev_b32 v4, 13, v4
    v_and_b32 v5, 31, v1
    v_lshl_add_u32 v4, v5, 4, v4
    s_lshl_b32 s37, s32, 9
    s_add_u32 s37, s37, 131072
    v_add_u32 v15, s37, v4
    v_bfe_u32 v4, v1, 3, 1
    v_bfe_u32 v5, v1, 4, 1
    v_lshlrev_b32 v11, 2, v4
    v_lshl_add_u32 v11, v5, 1, v11
    v_and_b32 v64, 7, v1
    v_lshrrev_b32 v65, 5, v1
    v_lshlrev_b32 v18, 8, v4
    v_lshl_add_u32 v18, v64, 5, v18
    v_lshl_add_u32 v18, v65, 4, v18
    v_lshl_add_u32 v18, v5, 2, v18
    s_andn2_b32 s37, s38, 1024
    s_lshl_b32 s51, s36, 10
    s_add_u32 s37, s37, s51
    s_lshl_b32 s51, s35, 3
    s_add_u32 s37, s37, s51
    s_add_u32 s37, s37, 0x6080000
    v_add_u32 v18, s37, v18
    v_bfe_u32 v4, v64, 1, 1
    v_lshlrev_b32 v16, 8, v4
    v_add_u32 v11, v11, v65
    v_lshl_add_u32 v16, v11, 4, v16
    v_lshrrev_b32 v4, 2, v64
    v_lshl_add_u32 v16, v4, 3, v16
    v_and_b32 v4, 1, v64
    v_lshl_add_u32 v16, v4, 2, v16
    s_lshl_b32 s37, s35, 9
    v_add_u32 v16, s37, v16
    s_lshl_b32 s37, s36, 7
    s_add_u32 s37, s37, s38
    s_add_u32 s37, s37, 0x6000000
    v_add_u32 v16, s37, v16
    v_lshlrev_b32 v13, 4, v2
    v_lshl_add_u32 v13, v3, 2, v13
    s_lshl_b32 s37, s32, 8
    s_add_u32 s37, s37, s56
    s_add_u32 s37, s37, 0x6100000
    v_add_u32 v13, s37, v13
    s_lshl_b32 s37, s36, 10
    s_xor_b32 s57, s37, s38
    s_lshl_b32 s37, s35, 19
    s_add_u32 s37, s37, s57
    s_add_u32 s37, s37, 0x6000000
    s_lshl_b32 s51, s35, 23
    s_add_u32 s51, s51, s57
    s_add_u32 s51, s51, 0x5000000
    v_add_u32 v17, s37, v6
    v_add_u32 v19, s51, v6
    s_or_b32 s37, s33, s34
    s_xor_b32 s51, s32, 3
    s_or_b32 s37, s37, s51
    s_cmp_eq_u32 s37, 0
    s_mov_b32 s51, 0x6401400
    s_cselect_b32 s37, s51, 0x10000000
    v_and_b32 v37, 3, v1
    v_lshlrev_b32 v37, 7, v37
    v_add_u32 v20, s37, v37
    v_cmp_lt_u32 vcc, 3, v1
    v_mov_b32 v4, 0x10000000
    s_nop 0
    v_cndmask_b32 v20, v20, v4, vcc
    v_add_u32 v37, 0x6400000, v37
    s_lshl_b32 s37, s33, 2
    s_add_u32 s37, s37, s32
    s_lshl_b32 s37, s37, 13
    v_and_b32 v4, 1, v3
    v_lshrrev_b32 v5, 1, v3
    v_lshlrev_b32 v23, 9, v4
    v_lshl_add_u32 v23, v5, 10, v23
    v_add_u32 v23, s37, v23
    v_lshl_add_u32 v24, v2, 4, v23
    v_add_u32 v24, 0x2000000, v24
    v_lshrrev_b32 v4, 3, v2
    v_lshl_add_u32 v23, v4, 8, v23
    v_and_b32 v4, 7, v2
    v_lshl_add_u32 v23, v4, 4, v23
    v_add_u32 v23, 0x1000000, v23
    s_lshr_b32 s37, s34, 1
    s_lshl_b32 s37, s37, 2
    s_add_u32 s37, s37, s32
    s_and_b32 s51, s37, 15
    s_lshl_b32 s51, s51, 11
    s_lshr_b32 s37, s37, 4
    s_lshl_b32 s37, s37, 24
    s_add_u32 s37, s37, s51
    s_lshl_b32 s51, s33, 15
    s_add_u32 s37, s37, s51
    s_add_u32 s37, s37, 0x1000000
    v_lshl_add_u32 v31, v1, 5, s37
    v_add_u32 v26, 147456, v6
    v_lshrrev_b32 v4, 3, v2
    v_mul_u32_u24 v4, 896, v4
    s_lshl_b32 s37, s32, 11
    v_add3_u32 v25, s37, v26, v4
    v_bfe_u32 v66, v1, 2, 2
    v_and_b32 v67, 3, v1
    v_lshl_add_u32 v65, v3, 3, v66
    v_lshlrev_b32 v64, 6, v65
    v_lshl_add_u32 v64, v67, 3, v64
    s_lshl_b32 s37, s32, 14
    v_add_u32 v64, s37, v64
    v_add_u32 v5, 65536, v64
    buffer_load_dwordx4 v[72:75], v9, s[76:79], s60 offen
    s_add_u32 s60, s60, s61
    buffer_load_dwordx4 v[76:79], v9, s[76:79], s60 offen
    s_add_u32 s60, s60, s61
    buffer_load_dwordx4 v[80:83], v9, s[76:79], s60 offen
    s_add_u32 s60, s60, s61
    buffer_load_dwordx4 v[84:87], v9, s[76:79], s60 offen
    s_add_u32 s60, s60, s61
    buffer_load_dwordx4 v[88:91], v9, s[76:79], s60 offen
    s_add_u32 s60, s60, s61
    buffer_load_dwordx4 v[92:95], v9, s[76:79], s60 offen
    s_add_u32 s60, s60, s61
    buffer_load_dwordx4 v[96:99], v9, s[76:79], s60 offen
    s_add_u32 s60, s60, s61
    buffer_load_dwordx4 v[100:103], v9, s[76:79], s60 offen
    s_add_u32 s60, s60, s61
    s_waitcnt vmcnt(8)
    s_barrier
    ds_read_b64_tr_b16 a[0:1], v64 offset:0
    ds_read_b64_tr_b16 a[2:3], v64 offset:256
    ds_read_b64_tr_b16 a[4:5], v64 offset:2048
    ds_read_b64_tr_b16 a[6:7], v64 offset:2304
    buffer_load_dwordx4 v[104:107], v9, s[76:79], s60 offen
    s_add_u32 s60, s60, s61
    s_waitcnt lgkmcnt(8)
    ds_read_b64_tr_b16 a[8:9], v64 offset:32
    ds_read_b64_tr_b16 a[10:11], v64 offset:288
    ds_read_b64_tr_b16 a[12:13], v64 offset:2080
    ds_read_b64_tr_b16 a[14:15], v64 offset:2336
    buffer_load_dwordx4 v[108:111], v9, s[76:79], s60 offen
    s_add_u32 s60, s60, s61
    s_waitcnt lgkmcnt(8)
    ds_read_b64_tr_b16 a[16:17], v5 offset:0
    ds_read_b64_tr_b16 a[18:19], v5 offset:256
    ds_read_b64_tr_b16 a[20:21], v5 offset:2048
    ds_read_b64_tr_b16 a[22:23], v5 offset:2304
    buffer_load_dwordx4 v[112:115], v9, s[76:79], s60 offen
    s_add_u32 s60, s60, s61
    s_waitcnt lgkmcnt(8)
    ds_read_b64_tr_b16 a[24:25], v5 offset:32
    ds_read_b64_tr_b16 a[26:27], v5 offset:288
    ds_read_b64_tr_b16 a[28:29], v5 offset:2080
    ds_read_b64_tr_b16 a[30:31], v5 offset:2336
    buffer_load_dwordx4 v[116:119], v9, s[76:79], s60 offen
    s_add_u32 s60, s60, s61
    s_waitcnt lgkmcnt(8)
    ds_read_b64_tr_b16 a[32:33], v64 offset:4096
    ds_read_b64_tr_b16 a[34:35], v64 offset:4352
    ds_read_b64_tr_b16 a[36:37], v64 offset:6144
    ds_read_b64_tr_b16 a[38:39], v64 offset:6400
    buffer_load_dwordx4 v[120:123], v9, s[76:79], s60 offen
    s_add_u32 s60, s60, s61
    s_waitcnt lgkmcnt(8)
    ds_read_b64_tr_b16 a[40:41], v64 offset:4128
    ds_read_b64_tr_b16 a[42:43], v64 offset:4384
    ds_read_b64_tr_b16 a[44:45], v64 offset:6176
    ds_read_b64_tr_b16 a[46:47], v64 offset:6432
    buffer_load_dwordx4 v[124:127], v9, s[76:79], s60 offen
    s_add_u32 s60, s60, s61
    s_waitcnt lgkmcnt(8)
    ds_read_b64_tr_b16 a[48:49], v5 offset:4096
    ds_read_b64_tr_b16 a[50:51], v5 offset:4352
    ds_read_b64_tr_b16 a[52:53], v5 offset:6144
    ds_read_b64_tr_b16 a[54:55], v5 offset:6400
    buffer_load_dwordx4 v[128:131], v9, s[76:79], s60 offen
    s_add_u32 s60, s60, s61
    s_waitcnt lgkmcnt(8)
    ds_read_b64_tr_b16 a[56:57], v5 offset:4128
    ds_read_b64_tr_b16 a[58:59], v5 offset:4384
    ds_read_b64_tr_b16 a[60:61], v5 offset:6176
    ds_read_b64_tr_b16 a[62:63], v5 offset:6432
    buffer_load_dwordx4 v[132:135], v9, s[76:79], s60 offen
    s_add_u32 s60, s60, s61
    s_waitcnt lgkmcnt(8)
    ds_read_b64_tr_b16 a[64:65], v64 offset:8192
    ds_read_b64_tr_b16 a[66:67], v64 offset:8448
    ds_read_b64_tr_b16 a[68:69], v64 offset:10240
    ds_read_b64_tr_b16 a[70:71], v64 offset:10496
    buffer_load_dwordx4 v[136:139], v9, s[76:79], s60 offen
    s_add_u32 s60, s60, s61
    s_waitcnt lgkmcnt(8)
    ds_read_b64_tr_b16 a[72:73], v64 offset:8224
    ds_read_b64_tr_b16 a[74:75], v64 offset:8480
    ds_read_b64_tr_b16 a[76:77], v64 offset:10272
    ds_read_b64_tr_b16 a[78:79], v64 offset:10528
    buffer_load_dwordx4 v[140:143], v9, s[76:79], s60 offen
    s_add_u32 s60, s60, s61
    s_waitcnt lgkmcnt(8)
    ds_read_b64_tr_b16 a[80:81], v5 offset:8192
    ds_read_b64_tr_b16 a[82:83], v5 offset:8448
    ds_read_b64_tr_b16 a[84:85], v5 offset:10240
    ds_read_b64_tr_b16 a[86:87], v5 offset:10496
    buffer_load_dwordx4 v[144:147], v9, s[76:79], s60 offen
    s_add_u32 s60, s60, s61
    s_waitcnt lgkmcnt(8)
    ds_read_b64_tr_b16 a[88:89], v5 offset:8224
    ds_read_b64_tr_b16 a[90:91], v5 offset:8480
    ds_read_b64_tr_b16 a[92:93], v5 offset:10272
    ds_read_b64_tr_b16 a[94:95], v5 offset:10528
    buffer_load_dwordx4 v[148:151], v9, s[76:79], s60 offen
    s_add_u32 s60, s60, s61
    s_waitcnt lgkmcnt(8)
    ds_read_b64_tr_b16 a[96:97], v64 offset:12288
    ds_read_b64_tr_b16 a[98:99], v64 offset:12544
    ds_read_b64_tr_b16 a[100:101], v64 offset:14336
    ds_read_b64_tr_b16 a[102:103], v64 offset:14592
    buffer_load_dwordx4 v[152:155], v9, s[76:79], s60 offen
    s_add_u32 s60, s60, s61
    s_waitcnt lgkmcnt(8)
    ds_read_b64_tr_b16 a[104:105], v64 offset:12320
    ds_read_b64_tr_b16 a[106:107], v64 offset:12576
    ds_read_b64_tr_b16 a[108:109], v64 offset:14368
    ds_read_b64_tr_b16 a[110:111], v64 offset:14624
    buffer_load_dwordx4 v[156:159], v9, s[76:79], s60 offen
    s_add_u32 s60, s60, s61
    s_waitcnt lgkmcnt(8)
    ds_read_b64_tr_b16 a[112:113], v5 offset:12288
    ds_read_b64_tr_b16 a[114:115], v5 offset:12544
    ds_read_b64_tr_b16 a[116:117], v5 offset:14336
    ds_read_b64_tr_b16 a[118:119], v5 offset:14592
    buffer_load_dwordx4 v[160:163], v9, s[76:79], s60 offen
    s_add_u32 s60, s60, s61
    s_waitcnt lgkmcnt(8)
    ds_read_b64_tr_b16 a[120:121], v5 offset:12320
    ds_read_b64_tr_b16 a[122:123], v5 offset:12576
    ds_read_b64_tr_b16 a[124:125], v5 offset:14368
    ds_read_b64_tr_b16 a[126:127], v5 offset:14624
    buffer_load_dwordx4 v[164:167], v9, s[76:79], s60 offen
    s_add_u32 s60, s60, s61
    s_waitcnt lgkmcnt(8)
    s_waitcnt lgkmcnt(0)
    s_barrier
    s_lshl_b32 s37, s32, 10
    v_add_u32 v4, s37, v6
    v_add_u32 v5, 65536, v4
    buffer_load_dwordx4 v[168:171], v9, s[76:79], s60 offen
    s_add_u32 s60, s60, s61
    s_waitcnt vmcnt(24)
    ds_write_b128 v4, v[72:75] offset:0
    s_waitcnt vmcnt(23)
    ds_write_b128 v4, v[76:79] offset:4096
    buffer_load_dwordx4 v[172:175], v9, s[76:79], s60 offen
    s_add_u32 s60, s60, s61
    s_waitcnt vmcnt(23)
    ds_write_b128 v4, v[80:83] offset:8192
    s_waitcnt vmcnt(22)
    ds_write_b128 v4, v[84:87] offset:12288
    s_waitcnt lgkmcnt(8)
    buffer_load_dwordx4 v[176:179], v9, s[76:79], s60 offen
    s_add_u32 s60, s60, s61
    s_waitcnt vmcnt(22)
    ds_write_b128 v4, v[88:91] offset:16384
    s_waitcnt vmcnt(21)
    ds_write_b128 v4, v[92:95] offset:20480
    buffer_load_dwordx4 v[180:183], v9, s[76:79], s60 offen
    s_add_u32 s60, s60, s61
    s_waitcnt vmcnt(21)
    ds_write_b128 v4, v[96:99] offset:24576
    s_waitcnt vmcnt(20)
    ds_write_b128 v4, v[100:103] offset:28672
    s_waitcnt lgkmcnt(8)
    buffer_load_dwordx4 v[184:187], v9, s[76:79], s60 offen
    s_add_u32 s60, s60, s61
    s_waitcnt vmcnt(20)
    ds_write_b128 v4, v[104:107] offset:32768
    s_waitcnt vmcnt(19)
    ds_write_b128 v4, v[108:111] offset:36864
    buffer_load_dwordx4 v[188:191], v9, s[76:79], s60 offen
    s_add_u32 s60, s60, s61
    s_waitcnt vmcnt(19)
    ds_write_b128 v4, v[112:115] offset:40960
    s_waitcnt vmcnt(18)
    ds_write_b128 v4, v[116:119] offset:45056
    s_waitcnt lgkmcnt(8)
    buffer_load_dwordx4 v[192:195], v9, s[76:79], s60 offen
    s_add_u32 s60, s60, s61
    s_waitcnt vmcnt(18)
    ds_write_b128 v4, v[120:123] offset:49152
    s_waitcnt vmcnt(17)
    ds_write_b128 v4, v[124:127] offset:53248
    buffer_load_dwordx4 v[196:199], v9, s[76:79], s60 offen
    s_add_u32 s60, s60, s61
    s_waitcnt vmcnt(17)
    ds_write_b128 v4, v[128:131] offset:57344
    s_waitcnt vmcnt(16)
    ds_write_b128 v4, v[132:135] offset:61440
    s_waitcnt lgkmcnt(8)
    s_waitcnt vmcnt(15)
    ds_write_b128 v5, v[136:139] offset:0
    s_waitcnt vmcnt(14)
    ds_write_b128 v5, v[140:143] offset:4096
    s_waitcnt vmcnt(13)
    ds_write_b128 v5, v[144:147] offset:8192
    s_waitcnt vmcnt(12)
    ds_write_b128 v5, v[148:151] offset:12288
    s_waitcnt lgkmcnt(8)
    s_waitcnt vmcnt(11)
    ds_write_b128 v5, v[152:155] offset:16384
    s_waitcnt vmcnt(10)
    ds_write_b128 v5, v[156:159] offset:20480
    s_waitcnt vmcnt(9)
    ds_write_b128 v5, v[160:163] offset:24576
    s_waitcnt vmcnt(8)
    ds_write_b128 v5, v[164:167] offset:28672
    s_waitcnt lgkmcnt(8)
    s_waitcnt vmcnt(7)
    ds_write_b128 v5, v[168:171] offset:32768
    s_waitcnt vmcnt(6)
    ds_write_b128 v5, v[172:175] offset:36864
    s_waitcnt vmcnt(5)
    ds_write_b128 v5, v[176:179] offset:40960
    s_waitcnt vmcnt(4)
    ds_write_b128 v5, v[180:183] offset:45056
    s_waitcnt lgkmcnt(8)
    s_waitcnt vmcnt(3)
    ds_write_b128 v5, v[184:187] offset:49152
    s_waitcnt vmcnt(2)
    ds_write_b128 v5, v[188:191] offset:53248
    s_waitcnt vmcnt(1)
    ds_write_b128 v5, v[192:195] offset:57344
    s_waitcnt vmcnt(0)
    ds_write_b128 v5, v[196:199] offset:61440
    s_waitcnt lgkmcnt(8)
    s_waitcnt lgkmcnt(0)
    s_barrier
    s_cmp_lg_u32 s32, 1
    s_cbranch_scc1 cpf_13
    global_load_dword v251, v[252:253], off
cpf_13:
    s_cmp_lg_u32 s55, 0
    s_cbranch_scc1 tN_14
    v_lshlrev_b32 v4, 7, v65
    v_lshl_add_u32 v4, v67, 3, v4
    s_lshl_b32 s37, s32, 15
    v_add_u32 v4, s37, v4
    ds_read_b64_tr_b16 a[128:129], v4 offset:0
    ds_read_b64_tr_b16 a[130:131], v4 offset:512
    ds_read_b64_tr_b16 a[132:133], v4 offset:4096
    ds_read_b64_tr_b16 a[134:135], v4 offset:4608
    s_waitcnt lgkmcnt(8)
    ds_read_b64_tr_b16 a[136:137], v4 offset:32
    ds_read_b64_tr_b16 a[138:139], v4 offset:544
    ds_read_b64_tr_b16 a[140:141], v4 offset:4128
    ds_read_b64_tr_b16 a[142:143], v4 offset:4640
    s_waitcnt lgkmcnt(8)
    ds_read_b64_tr_b16 a[144:145], v4 offset:64
    ds_read_b64_tr_b16 a[146:147], v4 offset:576
    ds_read_b64_tr_b16 a[148:149], v4 offset:4160
    ds_read_b64_tr_b16 a[150:151], v4 offset:4672
    s_waitcnt lgkmcnt(8)
    ds_read_b64_tr_b16 a[152:153], v4 offset:96
    ds_read_b64_tr_b16 a[154:155], v4 offset:608
    ds_read_b64_tr_b16 a[156:157], v4 offset:4192
    ds_read_b64_tr_b16 a[158:159], v4 offset:4704
    s_waitcnt lgkmcnt(8)
    ds_read_b64_tr_b16 a[160:161], v4 offset:8192
    ds_read_b64_tr_b16 a[162:163], v4 offset:8704
    ds_read_b64_tr_b16 a[164:165], v4 offset:12288
    ds_read_b64_tr_b16 a[166:167], v4 offset:12800
    s_waitcnt lgkmcnt(8)
    ds_read_b64_tr_b16 a[168:169], v4 offset:8224
    ds_read_b64_tr_b16 a[170:171], v4 offset:8736
    ds_read_b64_tr_b16 a[172:173], v4 offset:12320
    ds_read_b64_tr_b16 a[174:175], v4 offset:12832
    s_waitcnt lgkmcnt(8)
    ds_read_b64_tr_b16 a[176:177], v4 offset:8256
    ds_read_b64_tr_b16 a[178:179], v4 offset:8768
    ds_read_b64_tr_b16 a[180:181], v4 offset:12352
    ds_read_b64_tr_b16 a[182:183], v4 offset:12864
    s_waitcnt lgkmcnt(8)
    ds_read_b64_tr_b16 a[184:185], v4 offset:8288
    ds_read_b64_tr_b16 a[186:187], v4 offset:8800
    ds_read_b64_tr_b16 a[188:189], v4 offset:12384
    ds_read_b64_tr_b16 a[190:191], v4 offset:12896
    s_waitcnt lgkmcnt(8)
    ds_read_b64_tr_b16 a[192:193], v4 offset:16384
    ds_read_b64_tr_b16 a[194:195], v4 offset:16896
    ds_read_b64_tr_b16 a[196:197], v4 offset:20480
    ds_read_b64_tr_b16 a[198:199], v4 offset:20992
    s_waitcnt lgkmcnt(8)
    ds_read_b64_tr_b16 a[200:201], v4 offset:16416
    ds_read_b64_tr_b16 a[202:203], v4 offset:16928
    ds_read_b64_tr_b16 a[204:205], v4 offset:20512
    ds_read_b64_tr_b16 a[206:207], v4 offset:21024
    s_waitcnt lgkmcnt(8)
    ds_read_b64_tr_b16 a[208:209], v4 offset:16448
    ds_read_b64_tr_b16 a[210:211], v4 offset:16960
    ds_read_b64_tr_b16 a[212:213], v4 offset:20544
    ds_read_b64_tr_b16 a[214:215], v4 offset:21056
    s_waitcnt lgkmcnt(8)
    ds_read_b64_tr_b16 a[216:217], v4 offset:16480
    ds_read_b64_tr_b16 a[218:219], v4 offset:16992
    ds_read_b64_tr_b16 a[220:221], v4 offset:20576
    ds_read_b64_tr_b16 a[222:223], v4 offset:21088
    s_waitcnt lgkmcnt(8)
    ds_read_b64_tr_b16 a[224:225], v4 offset:24576
    ds_read_b64_tr_b16 a[226:227], v4 offset:25088
    ds_read_b64_tr_b16 a[228:229], v4 offset:28672
    ds_read_b64_tr_b16 a[230:231], v4 offset:29184
    s_waitcnt lgkmcnt(8)
    ds_read_b64_tr_b16 a[232:233], v4 offset:24608
    ds_read_b64_tr_b16 a[234:235], v4 offset:25120
    ds_read_b64_tr_b16 a[236:237], v4 offset:28704
    ds_read_b64_tr_b16 a[238:239], v4 offset:29216
    s_waitcnt lgkmcnt(8)
    ds_read_b64_tr_b16 a[240:241], v4 offset:24640
    ds_read_b64_tr_b16 a[242:243], v4 offset:25152
    ds_read_b64_tr_b16 a[244:245], v4 offset:28736
    ds_read_b64_tr_b16 a[246:247], v4 offset:29248
    s_waitcnt lgkmcnt(8)
    ds_read_b64_tr_b16 a[248:249], v4 offset:24672
    ds_read_b64_tr_b16 a[250:251], v4 offset:25184
    ds_read_b64_tr_b16 a[252:253], v4 offset:28768
    ds_read_b64_tr_b16 a[254:255], v4 offset:29280
    s_waitcnt lgkmcnt(8)
    s_branch tJ_15
tN_14:
    v_and_b32 v4, 1, v3
    v_lshl_add_u32 v4, v4, 5, v66
    v_lshrrev_b32 v5, 1, v3
    v_lshl_add_u32 v4, v5, 2, v4
    v_lshlrev_b32 v4, 8, v4
    v_lshl_add_u32 v4, v67, 3, v4
    s_lshl_b32 s37, s32, 5
    v_add_u32 v4, s37, v4
    v_add_u32 v5, 65536, v4
    ds_read_b64_tr_b16 a[128:129], v4 offset:0
    ds_read_b64_tr_b16 a[130:131], v4 offset:4096
    ds_read_b64_tr_b16 a[132:133], v4 offset:2048
    ds_read_b64_tr_b16 a[134:135], v4 offset:6144
    s_waitcnt lgkmcnt(8)
    ds_read_b64_tr_b16 a[136:137], v4 offset:128
    ds_read_b64_tr_b16 a[138:139], v4 offset:4224
    ds_read_b64_tr_b16 a[140:141], v4 offset:2176
    ds_read_b64_tr_b16 a[142:143], v4 offset:6272
    s_waitcnt lgkmcnt(8)
    ds_read_b64_tr_b16 a[144:145], v4 offset:16384
    ds_read_b64_tr_b16 a[146:147], v4 offset:20480
    ds_read_b64_tr_b16 a[148:149], v4 offset:18432
    ds_read_b64_tr_b16 a[150:151], v4 offset:22528
    s_waitcnt lgkmcnt(8)
    ds_read_b64_tr_b16 a[152:153], v4 offset:16512
    ds_read_b64_tr_b16 a[154:155], v4 offset:20608
    ds_read_b64_tr_b16 a[156:157], v4 offset:18560
    ds_read_b64_tr_b16 a[158:159], v4 offset:22656
    s_waitcnt lgkmcnt(8)
    ds_read_b64_tr_b16 a[160:161], v4 offset:32768
    ds_read_b64_tr_b16 a[162:163], v4 offset:36864
    ds_read_b64_tr_b16 a[164:165], v4 offset:34816
    ds_read_b64_tr_b16 a[166:167], v4 offset:38912
    s_waitcnt lgkmcnt(8)
    ds_read_b64_tr_b16 a[168:169], v4 offset:32896
    ds_read_b64_tr_b16 a[170:171], v4 offset:36992
    ds_read_b64_tr_b16 a[172:173], v4 offset:34944
    ds_read_b64_tr_b16 a[174:175], v4 offset:39040
    s_waitcnt lgkmcnt(8)
    ds_read_b64_tr_b16 a[176:177], v4 offset:49152
    ds_read_b64_tr_b16 a[178:179], v4 offset:53248
    ds_read_b64_tr_b16 a[180:181], v4 offset:51200
    ds_read_b64_tr_b16 a[182:183], v4 offset:55296
    s_waitcnt lgkmcnt(8)
    ds_read_b64_tr_b16 a[184:185], v4 offset:49280
    ds_read_b64_tr_b16 a[186:187], v4 offset:53376
    ds_read_b64_tr_b16 a[188:189], v4 offset:51328
    ds_read_b64_tr_b16 a[190:191], v4 offset:55424
    s_waitcnt lgkmcnt(8)
    ds_read_b64_tr_b16 a[192:193], v5 offset:0
    ds_read_b64_tr_b16 a[194:195], v5 offset:4096
    ds_read_b64_tr_b16 a[196:197], v5 offset:2048
    ds_read_b64_tr_b16 a[198:199], v5 offset:6144
    s_waitcnt lgkmcnt(8)
    ds_read_b64_tr_b16 a[200:201], v5 offset:128
    ds_read_b64_tr_b16 a[202:203], v5 offset:4224
    ds_read_b64_tr_b16 a[204:205], v5 offset:2176
    ds_read_b64_tr_b16 a[206:207], v5 offset:6272
    s_waitcnt lgkmcnt(8)
    ds_read_b64_tr_b16 a[208:209], v5 offset:16384
    ds_read_b64_tr_b16 a[210:211], v5 offset:20480
    ds_read_b64_tr_b16 a[212:213], v5 offset:18432
    ds_read_b64_tr_b16 a[214:215], v5 offset:22528
    s_waitcnt lgkmcnt(8)
    ds_read_b64_tr_b16 a[216:217], v5 offset:16512
    ds_read_b64_tr_b16 a[218:219], v5 offset:20608
    ds_read_b64_tr_b16 a[220:221], v5 offset:18560
    ds_read_b64_tr_b16 a[222:223], v5 offset:22656
    s_waitcnt lgkmcnt(8)
    ds_read_b64_tr_b16 a[224:225], v5 offset:32768
    ds_read_b64_tr_b16 a[226:227], v5 offset:36864
    ds_read_b64_tr_b16 a[228:229], v5 offset:34816
    ds_read_b64_tr_b16 a[230:231], v5 offset:38912
    s_waitcnt lgkmcnt(8)
    ds_read_b64_tr_b16 a[232:233], v5 offset:32896
    ds_read_b64_tr_b16 a[234:235], v5 offset:36992
    ds_read_b64_tr_b16 a[236:237], v5 offset:34944
    ds_read_b64_tr_b16 a[238:239], v5 offset:39040
    s_waitcnt lgkmcnt(8)
    ds_read_b64_tr_b16 a[240:241], v5 offset:49152
    ds_read_b64_tr_b16 a[242:243], v5 offset:53248
    ds_read_b64_tr_b16 a[244:245], v5 offset:51200
    ds_read_b64_tr_b16 a[246:247], v5 offset:55296
    s_waitcnt lgkmcnt(8)
    ds_read_b64_tr_b16 a[248:249], v5 offset:49280
    ds_read_b64_tr_b16 a[250:251], v5 offset:53376
    ds_read_b64_tr_b16 a[252:253], v5 offset:51328
    ds_read_b64_tr_b16 a[254:255], v5 offset:55424
    s_waitcnt lgkmcnt(8)
tJ_15:
    s_waitcnt lgkmcnt(0)
    s_barrier
    s_mov_b32 s39, 0
    s_mov_b32 s68, 0x40404044
    s_mov_b32 s69, 0x00404040
    s_mov_b32 s40, 0
    s_mov_b32 s41, 0x20000
    s_mov_b32 s42, 0x40000
    s_mov_b32 s43, 0
    s_mov_b32 s44, 0
    s_mov_b32 s45, 4096
    s_mov_b32 s46, 0
    s_mov_b32 s47, 0x10000000
    s_mov_b32 s58, 0
    s_mov_b32 s59, 0x80000
    s_mov_b32 s57, 7168
    s_cmp_lg_u32 s100, 0
    s_cbranch_scc1 pcd_17
    v_and_b32 v4, 7, v1
    v_lshlrev_b32 v4, 2, v4
    s_mov_b32 s51, 0
pcw_16:
    buffer_load_dword v5, v4, s[12:15], 0 offen sc1
    s_add_u32 s51, s51, 1
    s_waitcnt vmcnt(0)
    v_cmp_ne_u32 vcc, 32, v5
    s_nop 0
    s_cbranch_vccz pcd_17
    v_cmp_lt_u32 vcc, 32, v5
    s_nop 0
    s_cbranch_vccnz pcb_18
    s_sleep 8
    s_cmp_lt_u32 s51, 400000
    s_cbranch_scc1 pcw_16
    s_branch pcd_17
pcb_18:
    s_mov_b32 s100, 1
    s_waitcnt vmcnt(0) lgkmcnt(0)
    s_barrier
    s_branch mega_kernel_restart
pcd_17:
    v_mov_b32 v4, 32
    s_mov_b32 s51, 0
    s_branch rdy0_21
rdy_19:
    s_sleep 6
rdy0_21:
    buffer_load_dword v65, v4, s[12:15], 0 offen sc1
    s_add_u32 s51, s51, 1
    s_cmp_gt_u32 s51, s50
    s_cbranch_scc1 rdyd_20
    s_waitcnt vmcnt(0)
    v_and_b32 v64, 0xffff, v65
    v_cmp_gt_u32 vcc, 128, v64
    s_nop 0
    s_cbranch_vccnz rdy_19
rdyd_20:
    s_waitcnt vmcnt(0)
    v_lshrrev_b32 v64, 16, v65
    v_cmp_lt_u32 vcc, 16, v64
    v_mov_b32 v65, 8192
    s_nop 0
    v_cndmask_b32 v64, 0, v65, vcc
    v_add_u32 v28, v28, v64
    v_add_u32 v27, v27, v64
    v_mul_u32_u24 v64, 252, v3
    v_sub_u32 v30, v27, v64
    v_and_b32 v30, 0xffffbfff, v30
    v_lshlrev_b32 v64, 8, v3
    v_sub_u32 v29, v27, v64
    v_and_b32 v64, 1, v3
    v_lshlrev_b32 v64, 14, v64
    v_xor_b32 v29, v29, v64
    v_lshrrev_b32 v64, 1, v3
    v_lshl_add_u32 v29, v64, 28, v29
    v_add_u32 v27, 16384, v30
    v_lshlrev_b32 v64, 2, v3
    v_sub_u32 v39, v30, v64
    v_lshrrev_b32 v64, 1, v3
    v_lshl_add_u32 v39, v64, 14, v39
    v_and_b32 v64, 1, v3
    v_lshl_add_u32 v39, v64, 28, v39
    v_xor_b32 v30, 8192, v39
    s_mov_b32 s51, 0
    s_branch kv00_24
kvw0_22:
    s_sleep 6
kv00_24:
    buffer_load_dword v35, v37, s[8:11], s57 offen sc1
    s_add_u32 s51, s51, 1
    s_cmp_gt_u32 s51, s50
    s_cbranch_scc1 kvd0_23
    s_waitcnt vmcnt(0)
    v_cmp_gt_u32 vcc, 32, v35
    s_nop 0
    s_cbranch_vccnz kvw0_22
kvd0_23:
    s_waitcnt vmcnt(0)
    s_cmp_lg_u32 s100, 0
    s_cbranch_scc1 safe_25
    s_cmp_lg_u32 s55, 0
    s_cbranch_scc1 mega_kernel_firstn
mega_kernel_firstr:
    v_mov_b32 v136, 0
    v_mov_b32 v137, 0
    v_mov_b32 v138, 0
    v_mov_b32 v139, 0
    v_mov_b32 v140, 0
    v_mov_b32 v141, 0
    v_mov_b32 v142, 0
    v_mov_b32 v143, 0
    v_mov_b32 v144, 0
    v_mov_b32 v145, 0
    v_mov_b32 v146, 0
    v_mov_b32 v147, 0
    v_mov_b32 v148, 0
    v_mov_b32 v149, 0
    v_mov_b32 v150, 0
    v_mov_b32 v151, 0
    v_mov_b32 v152, 0
    v_mov_b32 v153, 0
    v_mov_b32 v154, 0
    v_mov_b32 v155, 0
    v_mov_b32 v156, 0
    v_mov_b32 v157, 0
    v_mov_b32 v158, 0
    v_mov_b32 v159, 0
    v_mov_b32 v160, 0
    v_mov_b32 v161, 0
    v_mov_b32 v162, 0
    v_mov_b32 v163, 0
    v_mov_b32 v164, 0
    v_mov_b32 v165, 0
    v_mov_b32 v166, 0
    v_mov_b32 v167, 0
    v_smfmac_f32_16x16x64_bf16 v[136:139], v[224:227], a[0:7], v32
    v_smfmac_f32_16x16x64_bf16 v[140:143], v[224:227], a[8:15], v32
    v_smfmac_f32_16x16x64_bf16 v[144:147], v[224:227], a[16:23], v32
    v_smfmac_f32_16x16x64_bf16 v[148:151], v[224:227], a[24:31], v32
    v_smfmac_f32_16x16x64_bf16 v[136:139], v[228:231], a[32:39], v32
    v_smfmac_f32_16x16x64_bf16 v[140:143], v[228:231], a[40:47], v32
    v_smfmac_f32_16x16x64_bf16 v[144:147], v[228:231], a[48:55], v32
    v_smfmac_f32_16x16x64_bf16 v[148:151], v[228:231], a[56:63], v32
    v_smfmac_f32_16x16x64_bf16 v[136:139], v[232:235], a[64:71], v32
    v_smfmac_f32_16x16x64_bf16 v[140:143], v[232:235], a[72:79], v32
    v_smfmac_f32_16x16x64_bf16 v[144:147], v[232:235], a[80:87], v32
    v_smfmac_f32_16x16x64_bf16 v[148:151], v[232:235], a[88:95], v32
    v_smfmac_f32_16x16x64_bf16 v[136:139], v[236:239], a[96:103], v32
    v_smfmac_f32_16x16x64_bf16 v[140:143], v[236:239], a[104:111], v32
    v_smfmac_f32_16x16x64_bf16 v[144:147], v[236:239], a[112:119], v32
    v_smfmac_f32_16x16x64_bf16 v[148:151], v[236:239], a[120:127], v32
    s_branch mega_kernel_Br
mega_kernel_stepr:
    s_mov_b32 s51, 1
    buffer_load_dwordx4 v[224:227], v12, s[8:11], s40 offen offset:0 sc1
    buffer_load_dwordx4 v[228:231], v12, s[8:11], s40 offen offset:1024 sc1
    buffer_load_dwordx4 v[232:235], v12, s[8:11], s40 offen offset:2048 sc1
    buffer_load_dwordx4 v[236:239], v12, s[8:11], s40 offen offset:3072 sc1
    s_waitcnt vmcnt(3)
    v_max3_u32 v4, v224, v225, v226
    v_max_u32 v4, v4, v227
    v_cmp_eq_u32 vcc, -1, v4
    s_nop 0
    s_cbranch_vccnz rA0_26
oA0_30:
    v_smfmac_f32_16x16x64_bf16 v[136:139], v[224:227], a[0:7], v32
    s_waitcnt vmcnt(2)
    v_max3_u32 v4, v228, v229, v230
    v_smfmac_f32_16x16x64_bf16 v[140:143], v[224:227], a[8:15], v32
    v_max_u32 v4, v4, v231
    v_smfmac_f32_16x16x64_bf16 v[144:147], v[224:227], a[16:23], v32
    v_cmp_eq_u32 vcc, -1, v4
    v_smfmac_f32_16x16x64_bf16 v[148:151], v[224:227], a[24:31], v32
    s_cbranch_vccnz rA1_27
oA1_31:
    v_smfmac_f32_16x16x64_bf16 v[136:139], v[228:231], a[32:39], v32
    s_waitcnt vmcnt(1)
    v_max3_u32 v4, v232, v233, v234
    v_smfmac_f32_16x16x64_bf16 v[140:143], v[228:231], a[40:47], v32
    v_max_u32 v4, v4, v235
    v_smfmac_f32_16x16x64_bf16 v[144:147], v[228:231], a[48:55], v32
    v_cmp_eq_u32 vcc, -1, v4
    v_smfmac_f32_16x16x64_bf16 v[148:151], v[228:231], a[56:63], v32
    s_cbranch_vccnz rA2_28
oA2_32:
    v_smfmac_f32_16x16x64_bf16 v[136:139], v[232:235], a[64:71], v32
    s_waitcnt vmcnt(0)
    v_max3_u32 v4, v236, v237, v238
    v_smfmac_f32_16x16x64_bf16 v[140:143], v[232:235], a[72:79], v32
    v_max_u32 v4, v4, v239
    v_smfmac_f32_16x16x64_bf16 v[144:147], v[232:235], a[80:87], v32
    v_cmp_eq_u32 vcc, -1, v4
    v_smfmac_f32_16x16x64_bf16 v[148:151], v[232:235], a[88:95], v32
    s_cbranch_vccnz rA3_29
oA3_33:
    v_smfmac_f32_16x16x64_bf16 v[136:139], v[236:239], a[96:103], v32
    v_smfmac_f32_16x16x64_bf16 v[140:143], v[236:239], a[104:111], v32
    v_smfmac_f32_16x16x64_bf16 v[144:147], v[236:239], a[112:119], v32
    v_smfmac_f32_16x16x64_bf16 v[148:151], v[236:239], a[120:127], v32
mega_kernel_Br:
    v_smfmac_f32_16x16x64_bf16 v[152:155], v[224:227], a[128:135], v32
    s_nop 3
    v_permlane32_swap_b32 v136, v138
    v_permlane32_swap_b32 v137, v139
    v_smfmac_f32_16x16x64_bf16 v[152:155], v[228:231], a[160:167], v32
    v_pk_add_f32 v[168:169], v[136:137], v[138:139]
    ds_write_b64 v14, v[168:169] offset:0
    v_smfmac_f32_16x16x64_bf16 v[152:155], v[232:235], a[192:199], v32
    v_permlane32_swap_b32 v140, v142
    v_permlane32_swap_b32 v141, v143
    v_smfmac_f32_16x16x64_bf16 v[152:155], v[236:239], a[224:231], v32
    v_pk_add_f32 v[170:171], v[140:141], v[142:143]
    ds_write_b64 v14, v[170:171] offset:512
    v_smfmac_f32_16x16x64_bf16 v[156:159], v[224:227], a[136:143], v32
    v_permlane32_swap_b32 v144, v146
    v_permlane32_swap_b32 v145, v147
    v_smfmac_f32_16x16x64_bf16 v[156:159], v[228:231], a[168:175], v32
    v_pk_add_f32 v[172:173], v[144:145], v[146:147]
    ds_write_b64 v14, v[172:173] offset:1024
    v_smfmac_f32_16x16x64_bf16 v[156:159], v[232:235], a[200:207], v32
    v_permlane32_swap_b32 v148, v150
    v_permlane32_swap_b32 v149, v151
    v_smfmac_f32_16x16x64_bf16 v[156:159], v[236:239], a[232:239], v32
    v_pk_add_f32 v[174:175], v[148:149], v[150:151]
    ds_write_b64 v14, v[174:175] offset:1536
    v_smfmac_f32_16x16x64_bf16 v[160:163], v[224:227], a[144:151], v32
    v_smfmac_f32_16x16x64_bf16 v[160:163], v[228:231], a[176:183], v32
    v_smfmac_f32_16x16x64_bf16 v[160:163], v[232:235], a[208:215], v32
    s_waitcnt lgkmcnt(0)
    s_barrier
    ds_read_b128 v[184:187], v15
    ds_read_b128 v[188:191], v15 offset:4096
    v_smfmac_f32_16x16x64_bf16 v[160:163], v[236:239], a[240:247], v32
    v_smfmac_f32_16x16x64_bf16 v[164:167], v[224:227], a[152:159], v32
    v_smfmac_f32_16x16x64_bf16 v[164:167], v[228:231], a[184:191], v32
    v_smfmac_f32_16x16x64_bf16 v[164:167], v[232:235], a[216:223], v32
    v_smfmac_f32_16x16x64_bf16 v[164:167], v[236:239], a[248:255], v32
    s_waitcnt lgkmcnt(0)
    v_pk_add_f32 v[184:185], v[184:185], v[188:189]
    v_pk_add_f32 v[186:187], v[186:187], v[190:191]
    s_nop 0
    v_permlane32_swap_b32 v184, v185
    v_permlane32_swap_b32 v186, v187
    v_add_f32 v4, v184, v185
    v_add_f32 v5, v186, v187
    v_cvt_pk_bf16_f32 v6, v4, v5
    v_pk_min_u16 v6, v6, s48
    buffer_store_dword v6, v16, s[8:11], s40 offen
    v_permlane32_swap_b32 v152, v154
    v_permlane32_swap_b32 v153, v155
    v_pk_add_f32 v[176:177], v[152:153], v[154:155]
    ds_write_b64 v14, v[176:177] offset:2048
    v_permlane32_swap_b32 v156, v158
    v_permlane32_swap_b32 v157, v159
    v_pk_add_f32 v[178:179], v[156:157], v[158:159]
    ds_write_b64 v14, v[178:179] offset:2560
    v_permlane32_swap_b32 v160, v162
    v_permlane32_swap_b32 v161, v163
    v_pk_add_f32 v[180:181], v[160:161], v[162:163]
    ds_write_b64 v14, v[180:181] offset:3072
    v_permlane32_swap_b32 v164, v166
    v_permlane32_swap_b32 v165, v167
    v_pk_add_f32 v[182:183], v[164:165], v[166:167]
    ds_write_b64 v14, v[182:183] offset:3584
    s_waitcnt lgkmcnt(0)
    s_barrier
    ds_read_b128 v[184:187], v15 offset:2048
    ds_read_b128 v[188:191], v15 offset:6144
    s_waitcnt lgkmcnt(0)
    v_pk_add_f32 v[184:185], v[184:185], v[188:189]
    v_pk_add_f32 v[186:187], v[186:187], v[190:191]
    s_nop 1
    v_permlane32_swap_b32 v184, v186
    v_permlane32_swap_b32 v185, v187
    v_pk_add_f32 v[184:185], v[184:185], v[186:187]
    v_cvt_pk_bf16_f32 v7, v184, v185
    v_pk_min_u16 v7, v7, s48
    buffer_store_dword v7, v18, s[8:11], s40 offen
    buffer_load_dwordx4 v[80:83], v17, s[8:11], s43 offen sc1
    v_mov_b32 v36, s39
    s_waitcnt vmcnt(0)
    s_barrier
    buffer_store_dwordx4 v[80:83], v19, s[8:11], s47 offen sc1
    buffer_store_dword v36, v20, s[8:11], 0 offen sc1
    s_cmp_ge_u32 s39, 63
    s_cbranch_scc1 mega_kernel_lastR
    s_add_u32 s44, s44, 0x40000
    v_cmp_gt_u32 vcc, 32, v35
    s_nop 0
    s_cbranch_vccnz kvslow_35
kvok_34:
    s_bitcmp1_b64 s[68:69], s39
    s_cbranch_scc1 dokv_37
nokv_36:
    buffer_load_dword v34, v31, s[8:11], s44 offen sc1
    buffer_store_dwordx4 v[44:47], v29, s[8:11], s59 offen sc1
    buffer_store_dwordx4 v[44:47], v17, s[8:11], s42 offen
    buffer_store_dword v44, v13, s[8:11], s42 offen
    s_cmp_lg_u32 s39, 59
    s_cbranch_scc1 cpf_38
    s_cmp_lg_u32 s32, 1
    s_cbranch_scc1 cpf_38
    global_load_dword v251, v[252:253], off
cpf_38:
    v_mov_b32 v136, 0
    v_mov_b32 v137, 0
    v_mov_b32 v138, 0
    v_mov_b32 v139, 0
    v_mov_b32 v140, 0
    v_mov_b32 v141, 0
    v_mov_b32 v142, 0
    v_mov_b32 v143, 0
    v_mov_b32 v144, 0
    v_mov_b32 v145, 0
    v_mov_b32 v146, 0
    v_mov_b32 v147, 0
    v_mov_b32 v148, 0
    v_mov_b32 v149, 0
    v_mov_b32 v150, 0
    v_mov_b32 v151, 0
    v_mov_b32 v152, 0
    v_mov_b32 v153, 0
    v_mov_b32 v154, 0
    v_mov_b32 v155, 0
    v_mov_b32 v156, 0
    v_mov_b32 v157, 0
    v_mov_b32 v158, 0
    v_mov_b32 v159, 0
    v_mov_b32 v160, 0
    v_mov_b32 v161, 0
    v_mov_b32 v162, 0
    v_mov_b32 v163, 0
    v_mov_b32 v164, 0
    v_mov_b32 v165, 0
    v_mov_b32 v166, 0
    v_mov_b32 v167, 0
    s_sleep 12
    s_cmp_lg_u32 s32, 0
    s_cbranch_scc1 hd_40
    s_mov_b32 s51, 0
h_39:
    buffer_load_dword v4, v38, s[8:11], 0 offen sc1
    s_add_u32 s51, s51, 1
    s_cmp_gt_u32 s51, s50
    s_cbranch_scc1 hd_40
    s_waitcnt vmcnt(0)
    v_cmp_ne_u32 vcc, s39, v4
    s_nop 0
    s_cbranch_vccnz h_39
hd_40:
    s_barrier
    s_sleep 5
    s_mov_b32 s51, 0
pollE0_41:
    buffer_load_dwordx4 v[72:75], v28, s[8:11], s58 offen offset:0 sc1
    buffer_load_dwordx4 v[76:79], v28, s[8:11], s58 offen offset:1024 sc1
    s_add_u32 s51, s51, 1
    s_cmp_gt_u32 s51, s50
    s_cbranch_scc1 pollfE0_47
chkE0_43:
    s_waitcnt vmcnt(1)
    v_max3_u32 v4, v72, v73, v74
    v_max_u32 v4, v4, v75
    v_cmp_eq_u32 vcc, -1, v4
    s_nop 0
    s_cbranch_vccnz pollE0_41
okE0_45:
    v_mfma_f32_16x16x32_bf16 v[180:183], v[72:75], v[52:55], 0
chkE1_44:
    s_waitcnt vmcnt(0)
    v_max3_u32 v4, v76, v77, v78
    v_max_u32 v4, v4, v79
    v_cmp_eq_u32 vcc, -1, v4
    s_nop 0
    s_cbranch_vccnz pollE1_42
okE1_46:
    v_mfma_f32_16x16x32_bf16 v[180:183], v[76:79], v[52:55], v[180:183]
    s_add_u32 s39, s39, 1
    s_mov_b32 s43, s40
    s_mov_b32 s47, s46
    s_mov_b32 s40, s41
    s_mov_b32 s41, s42
    s_add_u32 s42, s42, 0x20000
    s_and_b32 s42, s42, 0x7ffff
    s_add_u32 s46, s46, 0x20000
    s_lshl_b32 s58, s40, 1
    s_lshl_b32 s59, s42, 1
    v_cvt_pk_bf16_f32 v6, v180, v181
    v_cvt_pk_bf16_f32 v7, v182, v183
    v_cndmask_b32 v6, v6, v7, s[62:63]
    v_pk_min_u16 v6, v6, s48
    buffer_store_dword v6, v13, s[8:11], s40 offen
    s_sleep 4
    s_branch mega_kernel_stepr
mega_kernel_firstn:
    buffer_load_dwordx4 v[72:75], v23, s[8:11], s44 offen offset:0 sc1
    buffer_load_dwordx4 v[88:91], v23, s[8:11], s44 offen offset:128 sc1
    buffer_load_dwordx4 v[76:79], v23, s[8:11], s44 offen offset:2048 sc1
    buffer_load_dwordx4 v[92:95], v23, s[8:11], s44 offen offset:2176 sc1
    buffer_load_dwordx4 v[80:83], v23, s[8:11], s45 offen offset:0 sc1
    buffer_load_dwordx4 v[96:99], v23, s[8:11], s45 offen offset:128 sc1
    buffer_load_dwordx4 v[84:87], v23, s[8:11], s45 offen offset:2048 sc1
    buffer_load_dwordx4 v[100:103], v23, s[8:11], s45 offen offset:2176 sc1
    buffer_load_dwordx4 v[104:107], v24, s[8:11], s44 offen offset:0 sc1
    buffer_load_dwordx4 v[108:111], v24, s[8:11], s44 offen offset:256 sc1
    buffer_load_dwordx4 v[112:115], v24, s[8:11], s44 offen offset:2048 sc1
    buffer_load_dwordx4 v[116:119], v24, s[8:11], s44 offen offset:2304 sc1
    buffer_load_dwordx4 v[120:123], v24, s[8:11], s45 offen offset:0 sc1
    buffer_load_dwordx4 v[124:127], v24, s[8:11], s45 offen offset:256 sc1
    buffer_load_dwordx4 v[128:131], v24, s[8:11], s45 offen offset:2048 sc1
    buffer_load_dwordx4 v[132:135], v24, s[8:11], s45 offen offset:2304 sc1
    v_mov_b32 v136, 0
    v_mov_b32 v137, 0
    v_mov_b32 v138, 0
    v_mov_b32 v139, 0
    v_mov_b32 v140, 0
    v_mov_b32 v141, 0
    v_mov_b32 v142, 0
    v_mov_b32 v143, 0
    v_mov_b32 v144, 0
    v_mov_b32 v145, 0
    v_mov_b32 v146, 0
    v_mov_b32 v147, 0
    v_mov_b32 v148, 0
    v_mov_b32 v149, 0
    v_mov_b32 v150, 0
    v_mov_b32 v151, 0
    v_smfmac_f32_16x16x64_bf16 v[136:139], v[224:227], a[0:7], v32
    v_smfmac_f32_16x16x64_bf16 v[140:143], v[224:227], a[8:15], v32
    v_smfmac_f32_16x16x64_bf16 v[144:147], v[224:227], a[16:23], v32
    v_smfmac_f32_16x16x64_bf16 v[148:151], v[224:227], a[24:31], v32
    v_smfmac_f32_16x16x64_bf16 v[136:139], v[228:231], a[32:39], v32
    v_smfmac_f32_16x16x64_bf16 v[140:143], v[228:231], a[40:47], v32
    v_smfmac_f32_16x16x64_bf16 v[144:147], v[228:231], a[48:55], v32
    v_smfmac_f32_16x16x64_bf16 v[148:151], v[228:231], a[56:63], v32
    v_smfmac_f32_16x16x64_bf16 v[136:139], v[232:235], a[64:71], v32
    v_smfmac_f32_16x16x64_bf16 v[140:143], v[232:235], a[72:79], v32
    v_smfmac_f32_16x16x64_bf16 v[144:147], v[232:235], a[80:87], v32
    v_smfmac_f32_16x16x64_bf16 v[148:151], v[232:235], a[88:95], v32
    v_smfmac_f32_16x16x64_bf16 v[136:139], v[236:239], a[96:103], v32
    v_smfmac_f32_16x16x64_bf16 v[140:143], v[236:239], a[104:111], v32
    v_smfmac_f32_16x16x64_bf16 v[144:147], v[236:239], a[112:119], v32
    v_smfmac_f32_16x16x64_bf16 v[148:151], v[236:239], a[120:127], v32
    s_branch mega_kernel_Bn
mega_kernel_stepn:
    v_mov_b32 v136, 0
    v_mov_b32 v137, 0
    v_mov_b32 v138, 0
    v_mov_b32 v139, 0
    v_mov_b32 v140, 0
    v_mov_b32 v141, 0
    v_mov_b32 v142, 0
    v_mov_b32 v143, 0
    v_mov_b32 v144, 0
    v_mov_b32 v145, 0
    v_mov_b32 v146, 0
    v_mov_b32 v147, 0
    v_mov_b32 v148, 0
    v_mov_b32 v149, 0
    v_mov_b32 v150, 0
    v_mov_b32 v151, 0
    s_mov_b32 s51, 1
    buffer_load_dwordx4 v[224:227], v12, s[8:11], s40 offen offset:0 sc1
    buffer_load_dwordx4 v[228:231], v12, s[8:11], s40 offen offset:1024 sc1
    buffer_load_dwordx4 v[232:235], v12, s[8:11], s40 offen offset:2048 sc1
    buffer_load_dwordx4 v[236:239], v12, s[8:11], s40 offen offset:3072 sc1
    s_waitcnt vmcnt(3)
    v_max3_u32 v4, v224, v225, v226
    v_max_u32 v4, v4, v227
    v_cmp_eq_u32 vcc, -1, v4
    s_nop 0
    s_cbranch_vccnz rA0_49
oA0_53:
    v_smfmac_f32_16x16x64_bf16 v[136:139], v[224:227], a[0:7], v32
    s_waitcnt vmcnt(2)
    v_max3_u32 v4, v228, v229, v230
    v_smfmac_f32_16x16x64_bf16 v[140:143], v[224:227], a[8:15], v32
    v_max_u32 v4, v4, v231
    v_smfmac_f32_16x16x64_bf16 v[144:147], v[224:227], a[16:23], v32
    v_cmp_eq_u32 vcc, -1, v4
    v_smfmac_f32_16x16x64_bf16 v[148:151], v[224:227], a[24:31], v32
    s_cbranch_vccnz rA1_50
oA1_54:
    v_smfmac_f32_16x16x64_bf16 v[136:139], v[228:231], a[32:39], v32
    s_waitcnt vmcnt(1)
    v_max3_u32 v4, v232, v233, v234
    v_smfmac_f32_16x16x64_bf16 v[140:143], v[228:231], a[40:47], v32
    v_max_u32 v4, v4, v235
    v_smfmac_f32_16x16x64_bf16 v[144:147], v[228:231], a[48:55], v32
    v_cmp_eq_u32 vcc, -1, v4
    v_smfmac_f32_16x16x64_bf16 v[148:151], v[228:231], a[56:63], v32
    s_cbranch_vccnz rA2_51
oA2_55:
    v_smfmac_f32_16x16x64_bf16 v[136:139], v[232:235], a[64:71], v32
    s_waitcnt vmcnt(0)
    v_max3_u32 v4, v236, v237, v238
    v_smfmac_f32_16x16x64_bf16 v[140:143], v[232:235], a[72:79], v32
    v_max_u32 v4, v4, v239
    v_smfmac_f32_16x16x64_bf16 v[144:147], v[232:235], a[80:87], v32
    v_cmp_eq_u32 vcc, -1, v4
    v_smfmac_f32_16x16x64_bf16 v[148:151], v[232:235], a[88:95], v32
    s_cbranch_vccnz rA3_52
oA3_56:
    v_smfmac_f32_16x16x64_bf16 v[136:139], v[236:239], a[96:103], v32
    v_smfmac_f32_16x16x64_bf16 v[140:143], v[236:239], a[104:111], v32
    v_smfmac_f32_16x16x64_bf16 v[144:147], v[236:239], a[112:119], v32
    v_smfmac_f32_16x16x64_bf16 v[148:151], v[236:239], a[120:127], v32
mega_kernel_Bn:
    s_nop 4
    v_permlane32_swap_b32 v136, v138
    v_permlane32_swap_b32 v137, v139
    v_pk_add_f32 v[168:169], v[136:137], v[138:139]
    ds_write_b64 v14, v[168:169] offset:0
    v_permlane32_swap_b32 v140, v142
    v_permlane32_swap_b32 v141, v143
    v_pk_add_f32 v[170:171], v[140:141], v[142:143]
    ds_write_b64 v14, v[170:171] offset:512
    v_permlane32_swap_b32 v144, v146
    v_permlane32_swap_b32 v145, v147
    v_pk_add_f32 v[172:173], v[144:145], v[146:147]
    ds_write_b64 v14, v[172:173] offset:1024
    v_permlane32_swap_b32 v148, v150
    v_permlane32_swap_b32 v149, v151
    v_pk_add_f32 v[174:175], v[148:149], v[150:151]
    ds_write_b64 v14, v[174:175] offset:1536
    s_waitcnt lgkmcnt(0)
    s_barrier
    ds_read_b128 v[184:187], v15
    ds_read_b128 v[188:191], v15 offset:4096
    s_waitcnt lgkmcnt(0)
    v_pk_add_f32 v[184:185], v[184:185], v[188:189]
    v_pk_add_f32 v[186:187], v[186:187], v[190:191]
    s_nop 0
    v_permlane32_swap_b32 v184, v185
    v_permlane32_swap_b32 v186, v187
    v_add_f32 v4, v184, v185
    v_add_f32 v5, v186, v187
    v_cvt_pk_bf16_f32 v6, v4, v5
    v_pk_min_u16 v6, v6, s48
    buffer_store_dword v6, v16, s[8:11], s40 offen
    s_cmp_ge_u32 s39, 63
    s_cbranch_scc1 mega_kernel_lastN
    s_add_u32 s44, s44, 0x40000
    s_add_u32 s45, s45, 0x40000
    v_mov_b32 v64, 0
    v_mov_b32 v68, 0
    v_mov_b32 v65, 0
    v_mov_b32 v69, 0
    v_mov_b32 v66, 0
    v_mov_b32 v70, 0
    v_mov_b32 v67, 0
    v_mov_b32 v71, 0
    v_mov_b32 v36, s39
    s_sleep 4
    s_mov_b32 s51, 1
pC_57:
    buffer_load_dwordx4 v[208:211], v21, s[8:11], s40 offen offset:0 sc1
    buffer_load_dwordx4 v[212:215], v21, s[8:11], s40 offen offset:1024 sc1
    buffer_load_dwordx4 v[216:219], v21, s[8:11], s40 offen offset:2048 sc1
    buffer_load_dwordx4 v[220:223], v21, s[8:11], s40 offen offset:3072 sc1
    s_waitcnt vmcnt(3)
    v_mfma_f32_16x16x32_bf16 v[136:139], v[72:75], v[208:211], v[56:59]
    v_max3_u32 v4, v208, v209, v210
    v_mfma_f32_16x16x32_bf16 v[140:143], v[88:91], v[208:211], v[56:59]
    v_max_u32 v4, v4, v211
    v_mfma_f32_16x16x32_bf16 v[144:147], v[208:211], v[208:211], v[48:51]
    s_waitcnt vmcnt(2)
    v_mfma_f32_16x16x32_bf16 v[136:139], v[76:79], v[212:215], v[136:139]
    v_max3_u32 v4, v4, v212, v213
    v_mfma_f32_16x16x32_bf16 v[140:143], v[92:95], v[212:215], v[140:143]
    v_max3_u32 v4, v4, v214, v215
    v_mfma_f32_16x16x32_bf16 v[144:147], v[212:215], v[212:215], v[144:147]
    s_waitcnt vmcnt(1)
    v_mfma_f32_16x16x32_bf16 v[136:139], v[80:83], v[216:219], v[136:139]
    v_max3_u32 v4, v4, v216, v217
    v_mfma_f32_16x16x32_bf16 v[140:143], v[96:99], v[216:219], v[140:143]
    v_max3_u32 v4, v4, v218, v219
    v_mfma_f32_16x16x32_bf16 v[144:147], v[216:219], v[216:219], v[144:147]
    s_waitcnt vmcnt(0)
    v_mfma_f32_16x16x32_bf16 v[136:139], v[84:87], v[220:223], v[136:139]
    v_max3_u32 v4, v4, v220, v221
    v_mfma_f32_16x16x32_bf16 v[140:143], v[100:103], v[220:223], v[140:143]
    v_max3_u32 v4, v4, v222, v223
    v_cmp_eq_u32 vcc, -1, v4
    v_mfma_f32_16x16x32_bf16 v[144:147], v[220:223], v[220:223], v[144:147]
    s_cbranch_vccnz pCf_58
pCd_59:
    s_nop 1
    v_max3_f32 v184, v136, v137, v138
    s_nop 0
    v_max3_f32 v185, v139, v140, v33
    v_max3_f32 v184, v184, v141, v142
    s_nop 0
    v_max3_f32 v185, v185, v143, v144
    v_max3_f32 v184, v184, v145, v146
    v_max3_f32 v184, v184, v185, v147
    v_mov_b32 v185, v184
    buffer_load_dwordx4 v[200:203], v22, s[8:11], s40 offen offset:0 sc1
    buffer_load_dwordx4 v[204:207], v22, s[8:11], s40 offen offset:1024 sc1
    v_permlane32_swap_b32 v184, v185
    v_max_f32 v184, v184, v185
    v_mov_b32 v185, v184
    s_nop 1
    v_permlane16_swap_b32 v184, v185
    v_max_f32 v184, v184, v185
    v_mul_f32 v184, s49, v184
    v_pk_fma_f32 v[136:137], v[136:137], v[40:41], v[184:185] op_sel_hi:[1,0,0] neg_lo:[0,0,1] neg_hi:[0,0,1]
    v_pk_fma_f32 v[138:139], v[138:139], v[40:41], v[184:185] op_sel_hi:[1,0,0] neg_lo:[0,0,1] neg_hi:[0,0,1]
    v_pk_fma_f32 v[140:141], v[140:141], v[40:41], v[184:185] op_sel_hi:[1,0,0] neg_lo:[0,0,1] neg_hi:[0,0,1]
    v_pk_fma_f32 v[142:143], v[142:143], v[40:41], v[184:185] op_sel_hi:[1,0,0] neg_lo:[0,0,1] neg_hi:[0,0,1]
    v_exp_f32 v136, v136
    v_exp_f32 v137, v137
    v_exp_f32 v138, v138
    v_cvt_pk_bf16_f32 v148, v136, v137
    v_exp_f32 v139, v139
    v_exp_f32 v140, v140
    v_cvt_pk_bf16_f32 v149, v138, v139
    v_exp_f32 v141, v141
    v_exp_f32 v142, v142
    v_cvt_pk_bf16_f32 v150, v140, v141
    v_exp_f32 v143, v143
    v_fma_f32 v144, v144, s49, -v184
    v_cvt_pk_bf16_f32 v151, v142, v143
    v_fma_f32 v145, v145, s49, -v184
    s_nop 0
    v_mfma_f32_16x16x32_bf16 v[180:183], v[60:63], v[148:151], 0
    v_fma_f32 v146, v146, s49, -v184
    v_fma_f32 v147, v147, s49, -v184
    v_mov_b32_dpp v152, v148 row_shr:8 row_mask:0xf bank_mask:0xf bound_ctrl:0
    v_mfma_f32_16x16x32_bf16 v[164:167], v[104:107], v[148:151], 0
    v_mov_b32_dpp v153, v149 row_shr:8 row_mask:0xf bank_mask:0xf bound_ctrl:0
    v_mov_b32_dpp v154, v150 row_shr:8 row_mask:0xf bank_mask:0xf bound_ctrl:0
    v_mov_b32_dpp v155, v151 row_shr:8 row_mask:0xf bank_mask:0xf bound_ctrl:0
    v_mfma_f32_16x16x32_bf16 v[168:171], v[108:111], v[148:151], 0
    v_exp_f32 v144, v144
    v_exp_f32 v145, v145
    v_mfma_f32_16x16x32_bf16 v[172:175], v[112:115], v[148:151], 0
    v_exp_f32 v146, v146
    v_exp_f32 v147, v147
    v_mfma_f32_16x16x32_bf16 v[176:179], v[116:119], v[148:151], 0
    v_cvt_pk_bf16_f32 v156, v144, v145
    v_cvt_pk_bf16_f32 v157, v146, v147
    v_mfma_f32_16x16x32_bf16 v[164:167], v[120:123], v[152:155], v[164:167]
    v_mov_b32_dpp v158, v156 row_shr:8 row_mask:0xf bank_mask:0xf bound_ctrl:0
    v_mov_b32_dpp v159, v157 row_shr:8 row_mask:0xf bank_mask:0xf bound_ctrl:0
    v_mfma_f32_16x16x16_bf16 v[180:183], v[60:61], v[156:157], v[180:183]
    v_mfma_f32_16x16x32_bf16 v[168:171], v[124:127], v[152:155], v[168:171]
    s_waitcnt vmcnt(0)
    v_max3_u32 v4, v200, v201, v202
    v_max3_u32 v5, v203, v204, v205
    v_permlane32_swap_b32 v158, v156
    v_mfma_f32_16x16x32_bf16 v[172:175], v[128:131], v[152:155], v[172:175]
    v_permlane32_swap_b32 v159, v157
    v_max3_u32 v4, v4, v206, v207
    v_max_u32 v4, v4, v5
    v_mfma_f32_16x16x32_bf16 v[176:179], v[132:135], v[152:155], v[176:179]
    v_cmp_eq_u32 vcc, -1, v4
    v_rcp_f32 v186, v180
    s_cbranch_vccnz vslow_61
vok_60:
    v_mfma_f32_16x16x16_bf16 v[164:167], v[200:201], v[156:157], v[164:167]
    v_mfma_f32_16x16x16_bf16 v[168:171], v[202:203], v[156:157], v[168:171]
    v_mov_b32_dpp v186, v186 row_shr:8 row_mask:0xf bank_mask:0xc
    v_mfma_f32_16x16x16_bf16 v[172:175], v[204:205], v[156:157], v[172:175]
    v_mfma_f32_16x16x16_bf16 v[176:179], v[206:207], v[156:157], v[176:179]
    s_nop 3
    v_pk_mul_f32 v[164:165], v[164:165], v[186:187] op_sel_hi:[1,0]
    v_pk_mul_f32 v[166:167], v[166:167], v[186:187] op_sel_hi:[1,0]
    v_cvt_pk_bf16_f32 v208, v164, v165
    v_cvt_pk_bf16_f32 v212, v166, v167
    v_pk_mul_f32 v[168:169], v[168:169], v[186:187] op_sel_hi:[1,0]
    v_pk_mul_f32 v[170:171], v[170:171], v[186:187] op_sel_hi:[1,0]
    v_cvt_pk_bf16_f32 v209, v168, v169
    v_cvt_pk_bf16_f32 v213, v170, v171
    v_pk_mul_f32 v[172:173], v[172:173], v[186:187] op_sel_hi:[1,0]
    v_pk_mul_f32 v[174:175], v[174:175], v[186:187] op_sel_hi:[1,0]
    v_cvt_pk_bf16_f32 v210, v172, v173
    v_cvt_pk_bf16_f32 v214, v174, v175
    v_pk_mul_f32 v[176:177], v[176:177], v[186:187] op_sel_hi:[1,0]
    v_pk_mul_f32 v[178:179], v[178:179], v[186:187] op_sel_hi:[1,0]
    v_cvt_pk_bf16_f32 v211, v176, v177
    v_cvt_pk_bf16_f32 v215, v178, v179
    ds_write_b128 v25, v[208:211]
    ds_write_b128 v25, v[212:215] offset:128
    s_waitcnt lgkmcnt(0)
    s_barrier
    buffer_store_dword v36, v38, s[8:11], 0 offen
    ds_read_b128 v[136:139], v26 offset:0
    ds_read_b128 v[140:143], v26 offset:1024
    ds_read_b128 v[144:147], v26 offset:2048
    ds_read_b128 v[148:151], v26 offset:3072
    ds_read_b128 v[152:155], v26 offset:4096
    ds_read_b128 v[156:159], v26 offset:5120
    ds_read_b128 v[160:163], v26 offset:6144
    ds_read_b128 v[164:167], v26 offset:7168
    s_waitcnt lgkmcnt(7)
    v_smfmac_f32_16x16x64_bf16 v[64:67], v[136:139], a[128:135], v32
    v_smfmac_f32_16x16x64_bf16 v[68:71], v[136:139], a[136:143], v32
    s_waitcnt lgkmcnt(6)
    v_smfmac_f32_16x16x64_bf16 v[64:67], v[140:143], a[144:151], v32
    v_smfmac_f32_16x16x64_bf16 v[68:71], v[140:143], a[152:159], v32
    s_waitcnt lgkmcnt(5)
    v_smfmac_f32_16x16x64_bf16 v[64:67], v[144:147], a[160:167], v32
    s_waitcnt lgkmcnt(4)
    v_smfmac_f32_16x16x64_bf16 v[64:67], v[148:151], a[176:183], v32
    s_waitcnt lgkmcnt(3)
    v_smfmac_f32_16x16x64_bf16 v[64:67], v[152:155], a[192:199], v32
    s_waitcnt lgkmcnt(2)
    v_smfmac_f32_16x16x64_bf16 v[64:67], v[156:159], a[208:215], v32
    s_waitcnt lgkmcnt(1)
    v_smfmac_f32_16x16x64_bf16 v[64:67], v[160:163], a[224:231], v32
    s_waitcnt lgkmcnt(0)
    v_smfmac_f32_16x16x64_bf16 v[64:67], v[164:167], a[240:247], v32
    v_smfmac_f32_16x16x64_bf16 v[68:71], v[144:147], a[168:175], v32
    v_smfmac_f32_16x16x64_bf16 v[68:71], v[148:151], a[184:191], v32
    v_smfmac_f32_16x16x64_bf16 v[68:71], v[152:155], a[200:207], v32
    s_nop 4
    v_permlane32_swap_b32 v64, v66
    v_permlane32_swap_b32 v65, v67
    v_smfmac_f32_16x16x64_bf16 v[68:71], v[156:159], a[216:223], v32
    v_pk_add_f32 v[64:65], v[64:65], v[66:67]
    v_cvt_pk_bf16_f32 v200, v64, v65
    v_smfmac_f32_16x16x64_bf16 v[68:71], v[160:163], a[232:239], v32
    v_pk_min_u16 v200, v200, s48
    v_smfmac_f32_16x16x64_bf16 v[68:71], v[164:167], a[248:255], v32
    s_nop 7
    v_permlane32_swap_b32 v68, v70
    v_permlane32_swap_b32 v69, v71
    v_pk_add_f32 v[68:69], v[68:69], v[70:71]
    v_cvt_pk_bf16_f32 v202, v68, v69
    v_pk_min_u16 v202, v202, s48
    s_nop 1
    v_permlane32_swap_b32 v200, v202
    s_nop 1
    v_permlane16_swap_b32 v200, v201
    v_permlane16_swap_b32 v202, v203
    buffer_store_dwordx4 v[200:203], v39, s[8:11], s58 offen sc1
    v_cmp_gt_u32 vcc, 32, v35
    s_nop 0
    s_cbranch_vccnz kvslow_63
kvok_62:
    s_bitcmp1_b64 s[68:69], s39
    s_cbranch_scc1 dokv_65
nokv_64:
    s_cmp_lg_u32 s39, 59
    s_cbranch_scc1 cpf_66
    s_cmp_lg_u32 s32, 1
    s_cbranch_scc1 cpf_66
    global_load_dword v251, v[252:253], off
cpf_66:
    buffer_load_dwordx4 v[72:75], v23, s[8:11], s44 offen offset:0 sc1
    buffer_load_dwordx4 v[88:91], v23, s[8:11], s44 offen offset:128 sc1
    buffer_load_dwordx4 v[76:79], v23, s[8:11], s44 offen offset:2048 sc1
    buffer_load_dwordx4 v[92:95], v23, s[8:11], s44 offen offset:2176 sc1
    buffer_load_dwordx4 v[80:83], v23, s[8:11], s45 offen offset:0 sc1
    buffer_load_dwordx4 v[96:99], v23, s[8:11], s45 offen offset:128 sc1
    buffer_load_dwordx4 v[84:87], v23, s[8:11], s45 offen offset:2048 sc1
    buffer_load_dwordx4 v[100:103], v23, s[8:11], s45 offen offset:2176 sc1
    buffer_load_dwordx4 v[104:107], v24, s[8:11], s44 offen offset:0 sc1
    buffer_load_dwordx4 v[108:111], v24, s[8:11], s44 offen offset:256 sc1
    buffer_load_dwordx4 v[112:115], v24, s[8:11], s44 offen offset:2048 sc1
    buffer_load_dwordx4 v[116:119], v24, s[8:11], s44 offen offset:2304 sc1
    buffer_load_dwordx4 v[120:123], v24, s[8:11], s45 offen offset:0 sc1
    buffer_load_dwordx4 v[124:127], v24, s[8:11], s45 offen offset:256 sc1
    buffer_load_dwordx4 v[128:131], v24, s[8:11], s45 offen offset:2048 sc1
    buffer_load_dwordx4 v[132:135], v24, s[8:11], s45 offen offset:2304 sc1
    s_add_u32 s39, s39, 1
    s_mov_b32 s43, s40
    s_mov_b32 s47, s46
    s_mov_b32 s40, s41
    s_mov_b32 s41, s42
    s_add_u32 s42, s42, 0x20000
    s_and_b32 s42, s42, 0x7ffff
    s_add_u32 s46, s46, 0x20000
    s_lshl_b32 s58, s40, 1
    s_lshl_b32 s59, s42, 1
    s_sleep 10
    s_branch mega_kernel_stepn
rA0_26:
    buffer_load_dwordx4 v[224:227], v12, s[8:11], s40 offen offset:0 sc1
    buffer_load_dwordx4 v[228:231], v12, s[8:11], s40 offen offset:1024 sc1
    buffer_load_dwordx4 v[232:235], v12, s[8:11], s40 offen offset:2048 sc1
    buffer_load_dwordx4 v[236:239], v12, s[8:11], s40 offen offset:3072 sc1
    s_add_u32 s51, s51, 1
    s_waitcnt vmcnt(3)
    v_max3_u32 v4, v224, v225, v226
    v_max_u32 v4, v4, v227
    v_cmp_eq_u32 vcc, -1, v4
    s_nop 0
    s_cbranch_vccz oA0_30
    s_cmp_le_u32 s51, s50
    s_cbranch_scc1 rA0_26
    s_mov_b32 s50, 0
    s_branch oA0_30
rA1_27:
    buffer_load_dwordx4 v[228:231], v12, s[8:11], s40 offen offset:1024 sc1
    buffer_load_dwordx4 v[232:235], v12, s[8:11], s40 offen offset:2048 sc1
    buffer_load_dwordx4 v[236:239], v12, s[8:11], s40 offen offset:3072 sc1
    s_add_u32 s51, s51, 1
    s_waitcnt vmcnt(2)
    v_max3_u32 v4, v228, v229, v230
    v_max_u32 v4, v4, v231
    v_cmp_eq_u32 vcc, -1, v4
    s_nop 0
    s_cbranch_vccz oA1_31
    s_cmp_le_u32 s51, s50
    s_cbranch_scc1 rA1_27
    s_mov_b32 s50, 0
    s_branch oA1_31
rA2_28:
    buffer_load_dwordx4 v[232:235], v12, s[8:11], s40 offen offset:2048 sc1
    buffer_load_dwordx4 v[236:239], v12, s[8:11], s40 offen offset:3072 sc1
    s_add_u32 s51, s51, 1
    s_waitcnt vmcnt(1)
    v_max3_u32 v4, v232, v233, v234
    v_max_u32 v4, v4, v235
    v_cmp_eq_u32 vcc, -1, v4
    s_nop 0
    s_cbranch_vccz oA2_32
    s_cmp_le_u32 s51, s50
    s_cbranch_scc1 rA2_28
    s_mov_b32 s50, 0
    s_branch oA2_32
rA3_29:
    buffer_load_dwordx4 v[236:239], v12, s[8:11], s40 offen offset:3072 sc1
    s_add_u32 s51, s51, 1
    s_waitcnt vmcnt(0)
    v_max3_u32 v4, v236, v237, v238
    v_max_u32 v4, v4, v239
    v_cmp_eq_u32 vcc, -1, v4
    s_nop 0
    s_cbranch_vccz oA3_33
    s_cmp_le_u32 s51, s50
    s_cbranch_scc1 rA3_29
    s_mov_b32 s50, 0
    s_branch oA3_33
kvslow_35:
    s_mov_b32 s51, 0
    s_branch kv0s_69
kvws_67:
    s_sleep 6
kv0s_69:
    buffer_load_dword v35, v37, s[8:11], s57 offen sc1
    s_add_u32 s51, s51, 1
    s_cmp_gt_u32 s51, s50
    s_cbranch_scc1 kvds_68
    s_waitcnt vmcnt(0)
    v_cmp_gt_u32 vcc, 32, v35
    s_nop 0
    s_cbranch_vccnz kvws_67
kvds_68:
    s_waitcnt vmcnt(0)
    s_branch kvok_34
dokv_37:
    s_add_u32 s57, s39, 2
    s_lshr_b32 s57, s57, 3
    s_lshl_b32 s57, s57, 9
    s_add_u32 s57, s57, 10240
    buffer_load_dword v35, v37, s[8:11], s57 offen sc1
    s_branch nokv_36
pollE1_42:
    buffer_load_dwordx4 v[76:79], v28, s[8:11], s58 offen offset:1024 sc1
    s_add_u32 s51, s51, 1
    s_cmp_gt_u32 s51, s50
    s_cbranch_scc1 pollfE1_48
    s_branch chkE1_44
pollfE0_47:
    s_mov_b32 s50, 0
    s_waitcnt vmcnt(0)
    s_branch okE0_45
pollfE1_48:
    s_mov_b32 s50, 0
    s_waitcnt vmcnt(0)
    s_branch okE1_46
rA0_49:
    buffer_load_dwordx4 v[224:227], v12, s[8:11], s40 offen offset:0 sc1
    buffer_load_dwordx4 v[228:231], v12, s[8:11], s40 offen offset:1024 sc1
    buffer_load_dwordx4 v[232:235], v12, s[8:11], s40 offen offset:2048 sc1
    buffer_load_dwordx4 v[236:239], v12, s[8:11], s40 offen offset:3072 sc1
    s_add_u32 s51, s51, 1
    s_waitcnt vmcnt(3)
    v_max3_u32 v4, v224, v225, v226
    v_max_u32 v4, v4, v227
    v_cmp_eq_u32 vcc, -1, v4
    s_nop 0
    s_cbranch_vccz oA0_53
    s_cmp_le_u32 s51, s50
    s_cbranch_scc1 rA0_49
    s_mov_b32 s50, 0
    s_branch oA0_53
rA1_50:
    buffer_load_dwordx4 v[228:231], v12, s[8:11], s40 offen offset:1024 sc1
    buffer_load_dwordx4 v[232:235], v12, s[8:11], s40 offen offset:2048 sc1
    buffer_load_dwordx4 v[236:239], v12, s[8:11], s40 offen offset:3072 sc1
    s_add_u32 s51, s51, 1
    s_waitcnt vmcnt(2)
    v_max3_u32 v4, v228, v229, v230
    v_max_u32 v4, v4, v231
    v_cmp_eq_u32 vcc, -1, v4
    s_nop 0
    s_cbranch_vccz oA1_54
    s_cmp_le_u32 s51, s50
    s_cbranch_scc1 rA1_50
    s_mov_b32 s50, 0
    s_branch oA1_54
rA2_51:
    buffer_load_dwordx4 v[232:235], v12, s[8:11], s40 offen offset:2048 sc1
    buffer_load_dwordx4 v[236:239], v12, s[8:11], s40 offen offset:3072 sc1
    s_add_u32 s51, s51, 1
    s_waitcnt vmcnt(1)
    v_max3_u32 v4, v232, v233, v234
    v_max_u32 v4, v4, v235
    v_cmp_eq_u32 vcc, -1, v4
    s_nop 0
    s_cbranch_vccz oA2_55
    s_cmp_le_u32 s51, s50
    s_cbranch_scc1 rA2_51
    s_mov_b32 s50, 0
    s_branch oA2_55
rA3_52:
    buffer_load_dwordx4 v[236:239], v12, s[8:11], s40 offen offset:3072 sc1
    s_add_u32 s51, s51, 1
    s_waitcnt vmcnt(0)
    v_max3_u32 v4, v236, v237, v238
    v_max_u32 v4, v4, v239
    v_cmp_eq_u32 vcc, -1, v4
    s_nop 0
    s_cbranch_vccz oA3_56
    s_cmp_le_u32 s51, s50
    s_cbranch_scc1 rA3_52
    s_mov_b32 s50, 0
    s_branch oA3_56
pCf_58:
    s_add_u32 s51, s51, 1
    s_cmp_le_u32 s51, s50
    s_cbranch_scc1 pC_57
    s_mov_b32 s50, 0
    s_branch pCd_59
vslow_61:
    s_mov_b32 s51, 0
pollV0_70:
    buffer_load_dwordx4 v[200:203], v22, s[8:11], s40 offen offset:0 sc1
    buffer_load_dwordx4 v[204:207], v22, s[8:11], s40 offen offset:1024 sc1
    s_add_u32 s51, s51, 1
    s_cmp_gt_u32 s51, s50
    s_cbranch_scc1 pollfV0_76
chkV0_72:
    s_waitcnt vmcnt(1)
    v_max3_u32 v4, v200, v201, v202
    v_max_u32 v4, v4, v203
    v_cmp_eq_u32 vcc, -1, v4
    s_nop 0
    s_cbranch_vccnz pollV0_70
okV0_74:
chkV1_73:
    s_waitcnt vmcnt(0)
    v_max3_u32 v4, v204, v205, v206
    v_max_u32 v4, v4, v207
    v_cmp_eq_u32 vcc, -1, v4
    s_nop 0
    s_cbranch_vccnz pollV1_71
okV1_75:
    s_branch vok_60
kvslow_63:
    s_mov_b32 s51, 0
    s_branch kv0s_80
kvws_78:
    s_sleep 6
kv0s_80:
    buffer_load_dword v35, v37, s[8:11], s57 offen sc1
    s_add_u32 s51, s51, 1
    s_cmp_gt_u32 s51, s50
    s_cbranch_scc1 kvds_79
    s_waitcnt vmcnt(0)
    v_cmp_gt_u32 vcc, 32, v35
    s_nop 0
    s_cbranch_vccnz kvws_78
kvds_79:
    s_waitcnt vmcnt(0)
    s_branch kvok_62
dokv_65:
    s_add_u32 s57, s39, 2
    s_lshr_b32 s57, s57, 3
    s_lshl_b32 s57, s57, 9
    s_add_u32 s57, s57, 10240
    buffer_load_dword v35, v37, s[8:11], s57 offen sc1
    s_branch nokv_64
pollV1_71:
    buffer_load_dwordx4 v[204:207], v22, s[8:11], s40 offen offset:1024 sc1
    s_add_u32 s51, s51, 1
    s_cmp_gt_u32 s51, s50
    s_cbranch_scc1 pollfV1_77
    s_branch chkV1_73
pollfV0_76:
    s_mov_b32 s50, 0
    s_waitcnt vmcnt(0)
    s_branch okV0_74
pollfV1_77:
    s_mov_b32 s50, 0
    s_waitcnt vmcnt(0)
    s_branch okV1_75
safe_25:
    s_cmp_lg_u32 s55, 0
    s_cbranch_scc1 mega_kernel_firstnf
mega_kernel_firstrf:
    v_mov_b32 v136, 0
    v_mov_b32 v137, 0
    v_mov_b32 v138, 0
    v_mov_b32 v139, 0
    v_mov_b32 v140, 0
    v_mov_b32 v141, 0
    v_mov_b32 v142, 0
    v_mov_b32 v143, 0
    v_mov_b32 v144, 0
    v_mov_b32 v145, 0
    v_mov_b32 v146, 0
    v_mov_b32 v147, 0
    v_mov_b32 v148, 0
    v_mov_b32 v149, 0
    v_mov_b32 v150, 0
    v_mov_b32 v151, 0
    v_mov_b32 v152, 0
    v_mov_b32 v153, 0
    v_mov_b32 v154, 0
    v_mov_b32 v155, 0
    v_mov_b32 v156, 0
    v_mov_b32 v157, 0
    v_mov_b32 v158, 0
    v_mov_b32 v159, 0
    v_mov_b32 v160, 0
    v_mov_b32 v161, 0
    v_mov_b32 v162, 0
    v_mov_b32 v163, 0
    v_mov_b32 v164, 0
    v_mov_b32 v165, 0
    v_mov_b32 v166, 0
    v_mov_b32 v167, 0
    v_smfmac_f32_16x16x64_bf16 v[136:139], v[224:227], a[0:7], v32
    v_smfmac_f32_16x16x64_bf16 v[140:143], v[224:227], a[8:15], v32
    v_smfmac_f32_16x16x64_bf16 v[144:147], v[224:227], a[16:23], v32
    v_smfmac_f32_16x16x64_bf16 v[148:151], v[224:227], a[24:31], v32
    v_smfmac_f32_16x16x64_bf16 v[136:139], v[228:231], a[32:39], v32
    v_smfmac_f32_16x16x64_bf16 v[140:143], v[228:231], a[40:47], v32
    v_smfmac_f32_16x16x64_bf16 v[144:147], v[228:231], a[48:55], v32
    v_smfmac_f32_16x16x64_bf16 v[148:151], v[228:231], a[56:63], v32
    v_smfmac_f32_16x16x64_bf16 v[136:139], v[232:235], a[64:71], v32
    v_smfmac_f32_16x16x64_bf16 v[140:143], v[232:235], a[72:79], v32
    v_smfmac_f32_16x16x64_bf16 v[144:147], v[232:235], a[80:87], v32
    v_smfmac_f32_16x16x64_bf16 v[148:151], v[232:235], a[88:95], v32
    v_smfmac_f32_16x16x64_bf16 v[136:139], v[236:239], a[96:103], v32
    v_smfmac_f32_16x16x64_bf16 v[140:143], v[236:239], a[104:111], v32
    v_smfmac_f32_16x16x64_bf16 v[144:147], v[236:239], a[112:119], v32
    v_smfmac_f32_16x16x64_bf16 v[148:151], v[236:239], a[120:127], v32
    s_branch mega_kernel_Brf
mega_kernel_steprf:
    s_mov_b32 s51, 1
    buffer_load_dwordx4 v[224:227], v12, s[8:11], s40 offen offset:0 sc1
    buffer_load_dwordx4 v[228:231], v12, s[8:11], s40 offen offset:1024 sc1
    buffer_load_dwordx4 v[232:235], v12, s[8:11], s40 offen offset:2048 sc1
    buffer_load_dwordx4 v[236:239], v12, s[8:11], s40 offen offset:3072 sc1
    s_waitcnt vmcnt(3)
    v_max3_u32 v4, v224, v225, v226
    v_max_u32 v4, v4, v227
    v_cmp_eq_u32 vcc, -1, v4
    s_nop 0
    s_cbranch_vccnz rA0_81
oA0_85:
    v_smfmac_f32_16x16x64_bf16 v[136:139], v[224:227], a[0:7], v32
    s_waitcnt vmcnt(2)
    v_max3_u32 v4, v228, v229, v230
    v_smfmac_f32_16x16x64_bf16 v[140:143], v[224:227], a[8:15], v32
    v_max_u32 v4, v4, v231
    v_smfmac_f32_16x16x64_bf16 v[144:147], v[224:227], a[16:23], v32
    v_cmp_eq_u32 vcc, -1, v4
    v_smfmac_f32_16x16x64_bf16 v[148:151], v[224:227], a[24:31], v32
    s_cbranch_vccnz rA1_82
oA1_86:
    v_smfmac_f32_16x16x64_bf16 v[136:139], v[228:231], a[32:39], v32
    s_waitcnt vmcnt(1)
    v_max3_u32 v4, v232, v233, v234
    v_smfmac_f32_16x16x64_bf16 v[140:143], v[228:231], a[40:47], v32
    v_max_u32 v4, v4, v235
    v_smfmac_f32_16x16x64_bf16 v[144:147], v[228:231], a[48:55], v32
    v_cmp_eq_u32 vcc, -1, v4
    v_smfmac_f32_16x16x64_bf16 v[148:151], v[228:231], a[56:63], v32
    s_cbranch_vccnz rA2_83
oA2_87:
    v_smfmac_f32_16x16x64_bf16 v[136:139], v[232:235], a[64:71], v32
    s_waitcnt vmcnt(0)
    v_max3_u32 v4, v236, v237, v238
    v_smfmac_f32_16x16x64_bf16 v[140:143], v[232:235], a[72:79], v32
    v_max_u32 v4, v4, v239
    v_smfmac_f32_16x16x64_bf16 v[144:147], v[232:235], a[80:87], v32
    v_cmp_eq_u32 vcc, -1, v4
    v_smfmac_f32_16x16x64_bf16 v[148:151], v[232:235], a[88:95], v32
    s_cbranch_vccnz rA3_84
oA3_88:
    v_smfmac_f32_16x16x64_bf16 v[136:139], v[236:239], a[96:103], v32
    v_smfmac_f32_16x16x64_bf16 v[140:143], v[236:239], a[104:111], v32
    v_smfmac_f32_16x16x64_bf16 v[144:147], v[236:239], a[112:119], v32
    v_smfmac_f32_16x16x64_bf16 v[148:151], v[236:239], a[120:127], v32
mega_kernel_Brf:
    v_smfmac_f32_16x16x64_bf16 v[152:155], v[224:227], a[128:135], v32
    s_nop 3
    v_permlane32_swap_b32 v136, v138
    v_permlane32_swap_b32 v137, v139
    v_smfmac_f32_16x16x64_bf16 v[152:155], v[228:231], a[160:167], v32
    v_pk_add_f32 v[168:169], v[136:137], v[138:139]
    ds_write_b64 v14, v[168:169] offset:0
    v_smfmac_f32_16x16x64_bf16 v[152:155], v[232:235], a[192:199], v32
    v_permlane32_swap_b32 v140, v142
    v_permlane32_swap_b32 v141, v143
    v_smfmac_f32_16x16x64_bf16 v[152:155], v[236:239], a[224:231], v32
    v_pk_add_f32 v[170:171], v[140:141], v[142:143]
    ds_write_b64 v14, v[170:171] offset:512
    v_smfmac_f32_16x16x64_bf16 v[156:159], v[224:227], a[136:143], v32
    v_permlane32_swap_b32 v144, v146
    v_permlane32_swap_b32 v145, v147
    v_smfmac_f32_16x16x64_bf16 v[156:159], v[228:231], a[168:175], v32
    v_pk_add_f32 v[172:173], v[144:145], v[146:147]
    ds_write_b64 v14, v[172:173] offset:1024
    v_smfmac_f32_16x16x64_bf16 v[156:159], v[232:235], a[200:207], v32
    v_permlane32_swap_b32 v148, v150
    v_permlane32_swap_b32 v149, v151
    v_smfmac_f32_16x16x64_bf16 v[156:159], v[236:239], a[232:239], v32
    v_pk_add_f32 v[174:175], v[148:149], v[150:151]
    ds_write_b64 v14, v[174:175] offset:1536
    v_smfmac_f32_16x16x64_bf16 v[160:163], v[224:227], a[144:151], v32
    v_smfmac_f32_16x16x64_bf16 v[160:163], v[228:231], a[176:183], v32
    v_smfmac_f32_16x16x64_bf16 v[160:163], v[232:235], a[208:215], v32
    s_waitcnt lgkmcnt(0)
    s_barrier
    ds_read_b128 v[184:187], v15
    ds_read_b128 v[188:191], v15 offset:4096
    v_smfmac_f32_16x16x64_bf16 v[160:163], v[236:239], a[240:247], v32
    v_smfmac_f32_16x16x64_bf16 v[164:167], v[224:227], a[152:159], v32
    v_smfmac_f32_16x16x64_bf16 v[164:167], v[228:231], a[184:191], v32
    v_smfmac_f32_16x16x64_bf16 v[164:167], v[232:235], a[216:223], v32
    v_smfmac_f32_16x16x64_bf16 v[164:167], v[236:239], a[248:255], v32
    s_waitcnt lgkmcnt(0)
    v_pk_add_f32 v[184:185], v[184:185], v[188:189]
    v_pk_add_f32 v[186:187], v[186:187], v[190:191]
    s_nop 0
    v_permlane32_swap_b32 v184, v185
    v_permlane32_swap_b32 v186, v187
    v_add_f32 v4, v184, v185
    v_add_f32 v5, v186, v187
    v_cvt_pk_bf16_f32 v6, v4, v5
    v_pk_min_u16 v6, v6, s48
    buffer_store_dword v6, v16, s[8:11], s40 offen sc1
    v_permlane32_swap_b32 v152, v154
    v_permlane32_swap_b32 v153, v155
    v_pk_add_f32 v[176:177], v[152:153], v[154:155]
    ds_write_b64 v14, v[176:177] offset:2048
    v_permlane32_swap_b32 v156, v158
    v_permlane32_swap_b32 v157, v159
    v_pk_add_f32 v[178:179], v[156:157], v[158:159]
    ds_write_b64 v14, v[178:179] offset:2560
    v_permlane32_swap_b32 v160, v162
    v_permlane32_swap_b32 v161, v163
    v_pk_add_f32 v[180:181], v[160:161], v[162:163]
    ds_write_b64 v14, v[180:181] offset:3072
    v_permlane32_swap_b32 v164, v166
    v_permlane32_swap_b32 v165, v167
    v_pk_add_f32 v[182:183], v[164:165], v[166:167]
    ds_write_b64 v14, v[182:183] offset:3584
    s_waitcnt lgkmcnt(0)
    s_barrier
    ds_read_b128 v[184:187], v15 offset:2048
    ds_read_b128 v[188:191], v15 offset:6144
    s_waitcnt lgkmcnt(0)
    v_pk_add_f32 v[184:185], v[184:185], v[188:189]
    v_pk_add_f32 v[186:187], v[186:187], v[190:191]
    s_nop 1
    v_permlane32_swap_b32 v184, v186
    v_permlane32_swap_b32 v185, v187
    v_pk_add_f32 v[184:185], v[184:185], v[186:187]
    v_cvt_pk_bf16_f32 v7, v184, v185
    v_pk_min_u16 v7, v7, s48
    buffer_store_dword v7, v18, s[8:11], s40 offen sc1
    buffer_load_dwordx4 v[80:83], v17, s[8:11], s43 offen sc1
    v_mov_b32 v36, s39
    s_waitcnt vmcnt(0)
    s_barrier
    buffer_store_dwordx4 v[80:83], v19, s[8:11], s47 offen sc1
    buffer_store_dword v36, v20, s[8:11], 0 offen sc1
    s_cmp_ge_u32 s39, 63
    s_cbranch_scc1 mega_kernel_lastR
    s_add_u32 s44, s44, 0x40000
    v_cmp_gt_u32 vcc, 32, v35
    s_nop 0
    s_cbranch_vccnz kvslow_90
kvok_89:
    s_bitcmp1_b64 s[68:69], s39
    s_cbranch_scc1 dokv_92
nokv_91:
    buffer_load_dword v34, v31, s[8:11], s44 offen sc1
    buffer_store_dwordx4 v[44:47], v29, s[8:11], s59 offen sc1
    buffer_store_dwordx4 v[44:47], v17, s[8:11], s42 offen sc1
    buffer_store_dword v44, v13, s[8:11], s42 offen sc1
    s_cmp_lg_u32 s39, 59
    s_cbranch_scc1 cpf_93
    s_cmp_lg_u32 s32, 1
    s_cbranch_scc1 cpf_93
    global_load_dword v251, v[252:253], off
cpf_93:
    v_mov_b32 v136, 0
    v_mov_b32 v137, 0
    v_mov_b32 v138, 0
    v_mov_b32 v139, 0
    v_mov_b32 v140, 0
    v_mov_b32 v141, 0
    v_mov_b32 v142, 0
    v_mov_b32 v143, 0
    v_mov_b32 v144, 0
    v_mov_b32 v145, 0
    v_mov_b32 v146, 0
    v_mov_b32 v147, 0
    v_mov_b32 v148, 0
    v_mov_b32 v149, 0
    v_mov_b32 v150, 0
    v_mov_b32 v151, 0
    v_mov_b32 v152, 0
    v_mov_b32 v153, 0
    v_mov_b32 v154, 0
    v_mov_b32 v155, 0
    v_mov_b32 v156, 0
    v_mov_b32 v157, 0
    v_mov_b32 v158, 0
    v_mov_b32 v159, 0
    v_mov_b32 v160, 0
    v_mov_b32 v161, 0
    v_mov_b32 v162, 0
    v_mov_b32 v163, 0
    v_mov_b32 v164, 0
    v_mov_b32 v165, 0
    v_mov_b32 v166, 0
    v_mov_b32 v167, 0
    s_sleep 12
    s_cmp_lg_u32 s32, 0
    s_cbranch_scc1 hd_95
    s_mov_b32 s51, 0
h_94:
    buffer_load_dword v4, v38, s[8:11], 0 offen sc1
    s_add_u32 s51, s51, 1
    s_cmp_gt_u32 s51, s50
    s_cbranch_scc1 hd_95
    s_waitcnt vmcnt(0)
    v_cmp_ne_u32 vcc, s39, v4
    s_nop 0
    s_cbranch_vccnz h_94
hd_95:
    s_barrier
    s_sleep 5
    s_mov_b32 s51, 0
pollE0_96:
    buffer_load_dwordx4 v[72:75], v28, s[8:11], s58 offen offset:0 sc1
    buffer_load_dwordx4 v[76:79], v28, s[8:11], s58 offen offset:1024 sc1
    s_add_u32 s51, s51, 1
    s_cmp_gt_u32 s51, s50
    s_cbranch_scc1 pollfE0_102
chkE0_98:
    s_waitcnt vmcnt(1)
    v_max3_u32 v4, v72, v73, v74
    v_max_u32 v4, v4, v75
    v_cmp_eq_u32 vcc, -1, v4
    s_nop 0
    s_cbranch_vccnz pollE0_96
okE0_100:
    v_mfma_f32_16x16x32_bf16 v[180:183], v[72:75], v[52:55], 0
chkE1_99:
    s_waitcnt vmcnt(0)
    v_max3_u32 v4, v76, v77, v78
    v_max_u32 v4, v4, v79
    v_cmp_eq_u32 vcc, -1, v4
    s_nop 0
    s_cbranch_vccnz pollE1_97
okE1_101:
    v_mfma_f32_16x16x32_bf16 v[180:183], v[76:79], v[52:55], v[180:183]
    s_add_u32 s39, s39, 1
    s_mov_b32 s43, s40
    s_mov_b32 s47, s46
    s_mov_b32 s40, s41
    s_mov_b32 s41, s42
    s_add_u32 s42, s42, 0x20000
    s_and_b32 s42, s42, 0x7ffff
    s_add_u32 s46, s46, 0x20000
    s_lshl_b32 s58, s40, 1
    s_lshl_b32 s59, s42, 1
    v_cvt_pk_bf16_f32 v6, v180, v181
    v_cvt_pk_bf16_f32 v7, v182, v183
    v_cndmask_b32 v6, v6, v7, s[62:63]
    v_pk_min_u16 v6, v6, s48
    buffer_store_dword v6, v13, s[8:11], s40 offen sc1
    s_sleep 4
    s_branch mega_kernel_steprf
mega_kernel_firstnf:
    buffer_load_dwordx4 v[72:75], v23, s[8:11], s44 offen offset:0 sc1
    buffer_load_dwordx4 v[88:91], v23, s[8:11], s44 offen offset:128 sc1
    buffer_load_dwordx4 v[76:79], v23, s[8:11], s44 offen offset:2048 sc1
    buffer_load_dwordx4 v[92:95], v23, s[8:11], s44 offen offset:2176 sc1
    buffer_load_dwordx4 v[80:83], v23, s[8:11], s45 offen offset:0 sc1
    buffer_load_dwordx4 v[96:99], v23, s[8:11], s45 offen offset:128 sc1
    buffer_load_dwordx4 v[84:87], v23, s[8:11], s45 offen offset:2048 sc1
    buffer_load_dwordx4 v[100:103], v23, s[8:11], s45 offen offset:2176 sc1
    buffer_load_dwordx4 v[104:107], v24, s[8:11], s44 offen offset:0 sc1
    buffer_load_dwordx4 v[108:111], v24, s[8:11], s44 offen offset:256 sc1
    buffer_load_dwordx4 v[112:115], v24, s[8:11], s44 offen offset:2048 sc1
    buffer_load_dwordx4 v[116:119], v24, s[8:11], s44 offen offset:2304 sc1
    buffer_load_dwordx4 v[120:123], v24, s[8:11], s45 offen offset:0 sc1
    buffer_load_dwordx4 v[124:127], v24, s[8:11], s45 offen offset:256 sc1
    buffer_load_dwordx4 v[128:131], v24, s[8:11], s45 offen offset:2048 sc1
    buffer_load_dwordx4 v[132:135], v24, s[8:11], s45 offen offset:2304 sc1
    v_mov_b32 v136, 0
    v_mov_b32 v137, 0
    v_mov_b32 v138, 0
    v_mov_b32 v139, 0
    v_mov_b32 v140, 0
    v_mov_b32 v141, 0
    v_mov_b32 v142, 0
    v_mov_b32 v143, 0
    v_mov_b32 v144, 0
    v_mov_b32 v145, 0
    v_mov_b32 v146, 0
    v_mov_b32 v147, 0
    v_mov_b32 v148, 0
    v_mov_b32 v149, 0
    v_mov_b32 v150, 0
    v_mov_b32 v151, 0
    v_smfmac_f32_16x16x64_bf16 v[136:139], v[224:227], a[0:7], v32
    v_smfmac_f32_16x16x64_bf16 v[140:143], v[224:227], a[8:15], v32
    v_smfmac_f32_16x16x64_bf16 v[144:147], v[224:227], a[16:23], v32
    v_smfmac_f32_16x16x64_bf16 v[148:151], v[224:227], a[24:31], v32
    v_smfmac_f32_16x16x64_bf16 v[136:139], v[228:231], a[32:39], v32
    v_smfmac_f32_16x16x64_bf16 v[140:143], v[228:231], a[40:47], v32
    v_smfmac_f32_16x16x64_bf16 v[144:147], v[228:231], a[48:55], v32
    v_smfmac_f32_16x16x64_bf16 v[148:151], v[228:231], a[56:63], v32
    v_smfmac_f32_16x16x64_bf16 v[136:139], v[232:235], a[64:71], v32
    v_smfmac_f32_16x16x64_bf16 v[140:143], v[232:235], a[72:79], v32
    v_smfmac_f32_16x16x64_bf16 v[144:147], v[232:235], a[80:87], v32
    v_smfmac_f32_16x16x64_bf16 v[148:151], v[232:235], a[88:95], v32
    v_smfmac_f32_16x16x64_bf16 v[136:139], v[236:239], a[96:103], v32
    v_smfmac_f32_16x16x64_bf16 v[140:143], v[236:239], a[104:111], v32
    v_smfmac_f32_16x16x64_bf16 v[144:147], v[236:239], a[112:119], v32
    v_smfmac_f32_16x16x64_bf16 v[148:151], v[236:239], a[120:127], v32
    s_branch mega_kernel_Bnf
mega_kernel_stepnf:
    v_mov_b32 v136, 0
    v_mov_b32 v137, 0
    v_mov_b32 v138, 0
    v_mov_b32 v139, 0
    v_mov_b32 v140, 0
    v_mov_b32 v141, 0
    v_mov_b32 v142, 0
    v_mov_b32 v143, 0
    v_mov_b32 v144, 0
    v_mov_b32 v145, 0
    v_mov_b32 v146, 0
    v_mov_b32 v147, 0
    v_mov_b32 v148, 0
    v_mov_b32 v149, 0
    v_mov_b32 v150, 0
    v_mov_b32 v151, 0
    s_mov_b32 s51, 1
    buffer_load_dwordx4 v[224:227], v12, s[8:11], s40 offen offset:0 sc1
    buffer_load_dwordx4 v[228:231], v12, s[8:11], s40 offen offset:1024 sc1
    buffer_load_dwordx4 v[232:235], v12, s[8:11], s40 offen offset:2048 sc1
    buffer_load_dwordx4 v[236:239], v12, s[8:11], s40 offen offset:3072 sc1
    s_waitcnt vmcnt(3)
    v_max3_u32 v4, v224, v225, v226
    v_max_u32 v4, v4, v227
    v_cmp_eq_u32 vcc, -1, v4
    s_nop 0
    s_cbranch_vccnz rA0_104
oA0_108:
    v_smfmac_f32_16x16x64_bf16 v[136:139], v[224:227], a[0:7], v32
    s_waitcnt vmcnt(2)
    v_max3_u32 v4, v228, v229, v230
    v_smfmac_f32_16x16x64_bf16 v[140:143], v[224:227], a[8:15], v32
    v_max_u32 v4, v4, v231
    v_smfmac_f32_16x16x64_bf16 v[144:147], v[224:227], a[16:23], v32
    v_cmp_eq_u32 vcc, -1, v4
    v_smfmac_f32_16x16x64_bf16 v[148:151], v[224:227], a[24:31], v32
    s_cbranch_vccnz rA1_105
oA1_109:
    v_smfmac_f32_16x16x64_bf16 v[136:139], v[228:231], a[32:39], v32
    s_waitcnt vmcnt(1)
    v_max3_u32 v4, v232, v233, v234
    v_smfmac_f32_16x16x64_bf16 v[140:143], v[228:231], a[40:47], v32
    v_max_u32 v4, v4, v235
    v_smfmac_f32_16x16x64_bf16 v[144:147], v[228:231], a[48:55], v32
    v_cmp_eq_u32 vcc, -1, v4
    v_smfmac_f32_16x16x64_bf16 v[148:151], v[228:231], a[56:63], v32
    s_cbranch_vccnz rA2_106
oA2_110:
    v_smfmac_f32_16x16x64_bf16 v[136:139], v[232:235], a[64:71], v32
    s_waitcnt vmcnt(0)
    v_max3_u32 v4, v236, v237, v238
    v_smfmac_f32_16x16x64_bf16 v[140:143], v[232:235], a[72:79], v32
    v_max_u32 v4, v4, v239
    v_smfmac_f32_16x16x64_bf16 v[144:147], v[232:235], a[80:87], v32
    v_cmp_eq_u32 vcc, -1, v4
    v_smfmac_f32_16x16x64_bf16 v[148:151], v[232:235], a[88:95], v32
    s_cbranch_vccnz rA3_107
oA3_111:
    v_smfmac_f32_16x16x64_bf16 v[136:139], v[236:239], a[96:103], v32
    v_smfmac_f32_16x16x64_bf16 v[140:143], v[236:239], a[104:111], v32
    v_smfmac_f32_16x16x64_bf16 v[144:147], v[236:239], a[112:119], v32
    v_smfmac_f32_16x16x64_bf16 v[148:151], v[236:239], a[120:127], v32
mega_kernel_Bnf:
    s_nop 4
    v_permlane32_swap_b32 v136, v138
    v_permlane32_swap_b32 v137, v139
    v_pk_add_f32 v[168:169], v[136:137], v[138:139]
    ds_write_b64 v14, v[168:169] offset:0
    v_permlane32_swap_b32 v140, v142
    v_permlane32_swap_b32 v141, v143
    v_pk_add_f32 v[170:171], v[140:141], v[142:143]
    ds_write_b64 v14, v[170:171] offset:512
    v_permlane32_swap_b32 v144, v146
    v_permlane32_swap_b32 v145, v147
    v_pk_add_f32 v[172:173], v[144:145], v[146:147]
    ds_write_b64 v14, v[172:173] offset:1024
    v_permlane32_swap_b32 v148, v150
    v_permlane32_swap_b32 v149, v151
    v_pk_add_f32 v[174:175], v[148:149], v[150:151]
    ds_write_b64 v14, v[174:175] offset:1536
    s_waitcnt lgkmcnt(0)
    s_barrier
    ds_read_b128 v[184:187], v15
    ds_read_b128 v[188:191], v15 offset:4096
    s_waitcnt lgkmcnt(0)
    v_pk_add_f32 v[184:185], v[184:185], v[188:189]
    v_pk_add_f32 v[186:187], v[186:187], v[190:191]
    s_nop 0
    v_permlane32_swap_b32 v184, v185
    v_permlane32_swap_b32 v186, v187
    v_add_f32 v4, v184, v185
    v_add_f32 v5, v186, v187
    v_cvt_pk_bf16_f32 v6, v4, v5
    v_pk_min_u16 v6, v6, s48
    buffer_store_dword v6, v16, s[8:11], s40 offen sc1
    s_cmp_ge_u32 s39, 63
    s_cbranch_scc1 mega_kernel_lastN
    s_add_u32 s44, s44, 0x40000
    s_add_u32 s45, s45, 0x40000
    v_mov_b32 v64, 0
    v_mov_b32 v68, 0
    v_mov_b32 v65, 0
    v_mov_b32 v69, 0
    v_mov_b32 v66, 0
    v_mov_b32 v70, 0
    v_mov_b32 v67, 0
    v_mov_b32 v71, 0
    v_mov_b32 v36, s39
    s_sleep 4
    s_mov_b32 s51, 1
pC_112:
    buffer_load_dwordx4 v[208:211], v21, s[8:11], s40 offen offset:0 sc1
    buffer_load_dwordx4 v[212:215], v21, s[8:11], s40 offen offset:1024 sc1
    buffer_load_dwordx4 v[216:219], v21, s[8:11], s40 offen offset:2048 sc1
    buffer_load_dwordx4 v[220:223], v21, s[8:11], s40 offen offset:3072 sc1
    s_waitcnt vmcnt(3)
    v_mfma_f32_16x16x32_bf16 v[136:139], v[72:75], v[208:211], v[56:59]
    v_max3_u32 v4, v208, v209, v210
    v_mfma_f32_16x16x32_bf16 v[140:143], v[88:91], v[208:211], v[56:59]
    v_max_u32 v4, v4, v211
    v_mfma_f32_16x16x32_bf16 v[144:147], v[208:211], v[208:211], v[48:51]
    s_waitcnt vmcnt(2)
    v_mfma_f32_16x16x32_bf16 v[136:139], v[76:79], v[212:215], v[136:139]
    v_max3_u32 v4, v4, v212, v213
    v_mfma_f32_16x16x32_bf16 v[140:143], v[92:95], v[212:215], v[140:143]
    v_max3_u32 v4, v4, v214, v215
    v_mfma_f32_16x16x32_bf16 v[144:147], v[212:215], v[212:215], v[144:147]
    s_waitcnt vmcnt(1)
    v_mfma_f32_16x16x32_bf16 v[136:139], v[80:83], v[216:219], v[136:139]
    v_max3_u32 v4, v4, v216, v217
    v_mfma_f32_16x16x32_bf16 v[140:143], v[96:99], v[216:219], v[140:143]
    v_max3_u32 v4, v4, v218, v219
    v_mfma_f32_16x16x32_bf16 v[144:147], v[216:219], v[216:219], v[144:147]
    s_waitcnt vmcnt(0)
    v_mfma_f32_16x16x32_bf16 v[136:139], v[84:87], v[220:223], v[136:139]
    v_max3_u32 v4, v4, v220, v221
    v_mfma_f32_16x16x32_bf16 v[140:143], v[100:103], v[220:223], v[140:143]
    v_max3_u32 v4, v4, v222, v223
    v_cmp_eq_u32 vcc, -1, v4
    v_mfma_f32_16x16x32_bf16 v[144:147], v[220:223], v[220:223], v[144:147]
    s_cbranch_vccnz pCf_113
pCd_114:
    s_nop 1
    v_max3_f32 v184, v136, v137, v138
    s_nop 0
    v_max3_f32 v185, v139, v140, v33
    v_max3_f32 v184, v184, v141, v142
    s_nop 0
    v_max3_f32 v185, v185, v143, v144
    v_max3_f32 v184, v184, v145, v146
    v_max3_f32 v184, v184, v185, v147
    v_mov_b32 v185, v184
    buffer_load_dwordx4 v[200:203], v22, s[8:11], s40 offen offset:0 sc1
    buffer_load_dwordx4 v[204:207], v22, s[8:11], s40 offen offset:1024 sc1
    v_permlane32_swap_b32 v184, v185
    v_max_f32 v184, v184, v185
    v_mov_b32 v185, v184
    s_nop 1
    v_permlane16_swap_b32 v184, v185
    v_max_f32 v184, v184, v185
    v_mul_f32 v184, s49, v184
    v_pk_fma_f32 v[136:137], v[136:137], v[40:41], v[184:185] op_sel_hi:[1,0,0] neg_lo:[0,0,1] neg_hi:[0,0,1]
    v_pk_fma_f32 v[138:139], v[138:139], v[40:41], v[184:185] op_sel_hi:[1,0,0] neg_lo:[0,0,1] neg_hi:[0,0,1]
    v_pk_fma_f32 v[140:141], v[140:141], v[40:41], v[184:185] op_sel_hi:[1,0,0] neg_lo:[0,0,1] neg_hi:[0,0,1]
    v_pk_fma_f32 v[142:143], v[142:143], v[40:41], v[184:185] op_sel_hi:[1,0,0] neg_lo:[0,0,1] neg_hi:[0,0,1]
    v_exp_f32 v136, v136
    v_exp_f32 v137, v137
    v_exp_f32 v138, v138
    v_cvt_pk_bf16_f32 v148, v136, v137
    v_exp_f32 v139, v139
    v_exp_f32 v140, v140
    v_cvt_pk_bf16_f32 v149, v138, v139
    v_exp_f32 v141, v141
    v_exp_f32 v142, v142
    v_cvt_pk_bf16_f32 v150, v140, v141
    v_exp_f32 v143, v143
    v_fma_f32 v144, v144, s49, -v184
    v_cvt_pk_bf16_f32 v151, v142, v143
    v_fma_f32 v145, v145, s49, -v184
    s_nop 0
    v_mfma_f32_16x16x32_bf16 v[180:183], v[60:63], v[148:151], 0
    v_fma_f32 v146, v146, s49, -v184
    v_fma_f32 v147, v147, s49, -v184
    v_mov_b32_dpp v152, v148 row_shr:8 row_mask:0xf bank_mask:0xf bound_ctrl:0
    v_mfma_f32_16x16x32_bf16 v[164:167], v[104:107], v[148:151], 0
    v_mov_b32_dpp v153, v149 row_shr:8 row_mask:0xf bank_mask:0xf bound_ctrl:0
    v_mov_b32_dpp v154, v150 row_shr:8 row_mask:0xf bank_mask:0xf bound_ctrl:0
    v_mov_b32_dpp v155, v151 row_shr:8 row_mask:0xf bank_mask:0xf bound_ctrl:0
    v_mfma_f32_16x16x32_bf16 v[168:171], v[108:111], v[148:151], 0
    v_exp_f32 v144, v144
    v_exp_f32 v145, v145
    v_mfma_f32_16x16x32_bf16 v[172:175], v[112:115], v[148:151], 0
    v_exp_f32 v146, v146
    v_exp_f32 v147, v147
    v_mfma_f32_16x16x32_bf16 v[176:179], v[116:119], v[148:151], 0
    v_cvt_pk_bf16_f32 v156, v144, v145
    v_cvt_pk_bf16_f32 v157, v146, v147
    v_mfma_f32_16x16x32_bf16 v[164:167], v[120:123], v[152:155], v[164:167]
    v_mov_b32_dpp v158, v156 row_shr:8 row_mask:0xf bank_mask:0xf bound_ctrl:0
    v_mov_b32_dpp v159, v157 row_shr:8 row_mask:0xf bank_mask:0xf bound_ctrl:0
    v_mfma_f32_16x16x16_bf16 v[180:183], v[60:61], v[156:157], v[180:183]
    v_mfma_f32_16x16x32_bf16 v[168:171], v[124:127], v[152:155], v[168:171]
    s_waitcnt vmcnt(0)
    v_max3_u32 v4, v200, v201, v202
    v_max3_u32 v5, v203, v204, v205
    v_permlane32_swap_b32 v158, v156
    v_mfma_f32_16x16x32_bf16 v[172:175], v[128:131], v[152:155], v[172:175]
    v_permlane32_swap_b32 v159, v157
    v_max3_u32 v4, v4, v206, v207
    v_max_u32 v4, v4, v5
    v_mfma_f32_16x16x32_bf16 v[176:179], v[132:135], v[152:155], v[176:179]
    v_cmp_eq_u32 vcc, -1, v4
    v_rcp_f32 v186, v180
    s_cbranch_vccnz vslow_116
vok_115:
    v_mfma_f32_16x16x16_bf16 v[164:167], v[200:201], v[156:157], v[164:167]
    v_mfma_f32_16x16x16_bf16 v[168:171], v[202:203], v[156:157], v[168:171]
    v_mov_b32_dpp v186, v186 row_shr:8 row_mask:0xf bank_mask:0xc
    v_mfma_f32_16x16x16_bf16 v[172:175], v[204:205], v[156:157], v[172:175]
    v_mfma_f32_16x16x16_bf16 v[176:179], v[206:207], v[156:157], v[176:179]
    s_nop 3
    v_pk_mul_f32 v[164:165], v[164:165], v[186:187] op_sel_hi:[1,0]
    v_pk_mul_f32 v[166:167], v[166:167], v[186:187] op_sel_hi:[1,0]
    v_cvt_pk_bf16_f32 v208, v164, v165
    v_cvt_pk_bf16_f32 v212, v166, v167
    v_pk_mul_f32 v[168:169], v[168:169], v[186:187] op_sel_hi:[1,0]
    v_pk_mul_f32 v[170:171], v[170:171], v[186:187] op_sel_hi:[1,0]
    v_cvt_pk_bf16_f32 v209, v168, v169
    v_cvt_pk_bf16_f32 v213, v170, v171
    v_pk_mul_f32 v[172:173], v[172:173], v[186:187] op_sel_hi:[1,0]
    v_pk_mul_f32 v[174:175], v[174:175], v[186:187] op_sel_hi:[1,0]
    v_cvt_pk_bf16_f32 v210, v172, v173
    v_cvt_pk_bf16_f32 v214, v174, v175
    v_pk_mul_f32 v[176:177], v[176:177], v[186:187] op_sel_hi:[1,0]
    v_pk_mul_f32 v[178:179], v[178:179], v[186:187] op_sel_hi:[1,0]
    v_cvt_pk_bf16_f32 v211, v176, v177
    v_cvt_pk_bf16_f32 v215, v178, v179
    ds_write_b128 v25, v[208:211]
    ds_write_b128 v25, v[212:215] offset:128
    s_waitcnt lgkmcnt(0)
    s_barrier
    buffer_store_dword v36, v38, s[8:11], 0 offen sc1
    ds_read_b128 v[136:139], v26 offset:0
    ds_read_b128 v[140:143], v26 offset:1024
    ds_read_b128 v[144:147], v26 offset:2048
    ds_read_b128 v[148:151], v26 offset:3072
    ds_read_b128 v[152:155], v26 offset:4096
    ds_read_b128 v[156:159], v26 offset:5120
    ds_read_b128 v[160:163], v26 offset:6144
    ds_read_b128 v[164:167], v26 offset:7168
    s_waitcnt lgkmcnt(7)
    v_smfmac_f32_16x16x64_bf16 v[64:67], v[136:139], a[128:135], v32
    v_smfmac_f32_16x16x64_bf16 v[68:71], v[136:139], a[136:143], v32
    s_waitcnt lgkmcnt(6)
    v_smfmac_f32_16x16x64_bf16 v[64:67], v[140:143], a[144:151], v32
    v_smfmac_f32_16x16x64_bf16 v[68:71], v[140:143], a[152:159], v32
    s_waitcnt lgkmcnt(5)
    v_smfmac_f32_16x16x64_bf16 v[64:67], v[144:147], a[160:167], v32
    s_waitcnt lgkmcnt(4)
    v_smfmac_f32_16x16x64_bf16 v[64:67], v[148:151], a[176:183], v32
    s_waitcnt lgkmcnt(3)
    v_smfmac_f32_16x16x64_bf16 v[64:67], v[152:155], a[192:199], v32
    s_waitcnt lgkmcnt(2)
    v_smfmac_f32_16x16x64_bf16 v[64:67], v[156:159], a[208:215], v32
    s_waitcnt lgkmcnt(1)
    v_smfmac_f32_16x16x64_bf16 v[64:67], v[160:163], a[224:231], v32
    s_waitcnt lgkmcnt(0)
    v_smfmac_f32_16x16x64_bf16 v[64:67], v[164:167], a[240:247], v32
    v_smfmac_f32_16x16x64_bf16 v[68:71], v[144:147], a[168:175], v32
    v_smfmac_f32_16x16x64_bf16 v[68:71], v[148:151], a[184:191], v32
    v_smfmac_f32_16x16x64_bf16 v[68:71], v[152:155], a[200:207], v32
    s_nop 4
    v_permlane32_swap_b32 v64, v66
    v_permlane32_swap_b32 v65, v67
    v_smfmac_f32_16x16x64_bf16 v[68:71], v[156:159], a[216:223], v32
    v_pk_add_f32 v[64:65], v[64:65], v[66:67]
    v_cvt_pk_bf16_f32 v200, v64, v65
    v_smfmac_f32_16x16x64_bf16 v[68:71], v[160:163], a[232:239], v32
    v_pk_min_u16 v200, v200, s48
    v_smfmac_f32_16x16x64_bf16 v[68:71], v[164:167], a[248:255], v32
    s_nop 7
    v_permlane32_swap_b32 v68, v70
    v_permlane32_swap_b32 v69, v71
    v_pk_add_f32 v[68:69], v[68:69], v[70:71]
    v_cvt_pk_bf16_f32 v202, v68, v69
    v_pk_min_u16 v202, v202, s48
    s_nop 1
    v_permlane32_swap_b32 v200, v202
    s_nop 1
    v_permlane16_swap_b32 v200, v201
    v_permlane16_swap_b32 v202, v203
    buffer_store_dwordx4 v[200:203], v39, s[8:11], s58 offen sc1
    v_cmp_gt_u32 vcc, 32, v35
    s_nop 0
    s_cbranch_vccnz kvslow_118
kvok_117:
    s_bitcmp1_b64 s[68:69], s39
    s_cbranch_scc1 dokv_120
nokv_119:
    s_cmp_lg_u32 s39, 59
    s_cbranch_scc1 cpf_121
    s_cmp_lg_u32 s32, 1
    s_cbranch_scc1 cpf_121
    global_load_dword v251, v[252:253], off
cpf_121:
    buffer_load_dwordx4 v[72:75], v23, s[8:11], s44 offen offset:0 sc1
    buffer_load_dwordx4 v[88:91], v23, s[8:11], s44 offen offset:128 sc1
    buffer_load_dwordx4 v[76:79], v23, s[8:11], s44 offen offset:2048 sc1
    buffer_load_dwordx4 v[92:95], v23, s[8:11], s44 offen offset:2176 sc1
    buffer_load_dwordx4 v[80:83], v23, s[8:11], s45 offen offset:0 sc1
    buffer_load_dwordx4 v[96:99], v23, s[8:11], s45 offen offset:128 sc1
    buffer_load_dwordx4 v[84:87], v23, s[8:11], s45 offen offset:2048 sc1
    buffer_load_dwordx4 v[100:103], v23, s[8:11], s45 offen offset:2176 sc1
    buffer_load_dwordx4 v[104:107], v24, s[8:11], s44 offen offset:0 sc1
    buffer_load_dwordx4 v[108:111], v24, s[8:11], s44 offen offset:256 sc1
    buffer_load_dwordx4 v[112:115], v24, s[8:11], s44 offen offset:2048 sc1
    buffer_load_dwordx4 v[116:119], v24, s[8:11], s44 offen offset:2304 sc1
    buffer_load_dwordx4 v[120:123], v24, s[8:11], s45 offen offset:0 sc1
    buffer_load_dwordx4 v[124:127], v24, s[8:11], s45 offen offset:256 sc1
    buffer_load_dwordx4 v[128:131], v24, s[8:11], s45 offen offset:2048 sc1
    buffer_load_dwordx4 v[132:135], v24, s[8:11], s45 offen offset:2304 sc1
    s_add_u32 s39, s39, 1
    s_mov_b32 s43, s40
    s_mov_b32 s47, s46
    s_mov_b32 s40, s41
    s_mov_b32 s41, s42
    s_add_u32 s42, s42, 0x20000
    s_and_b32 s42, s42, 0x7ffff
    s_add_u32 s46, s46, 0x20000
    s_lshl_b32 s58, s40, 1
    s_lshl_b32 s59, s42, 1
    s_sleep 10
    s_branch mega_kernel_stepnf
rA0_81:
    buffer_load_dwordx4 v[224:227], v12, s[8:11], s40 offen offset:0 sc1
    buffer_load_dwordx4 v[228:231], v12, s[8:11], s40 offen offset:1024 sc1
    buffer_load_dwordx4 v[232:235], v12, s[8:11], s40 offen offset:2048 sc1
    buffer_load_dwordx4 v[236:239], v12, s[8:11], s40 offen offset:3072 sc1
    s_add_u32 s51, s51, 1
    s_waitcnt vmcnt(3)
    v_max3_u32 v4, v224, v225, v226
    v_max_u32 v4, v4, v227
    v_cmp_eq_u32 vcc, -1, v4
    s_nop 0
    s_cbranch_vccz oA0_85
    s_cmp_le_u32 s51, s50
    s_cbranch_scc1 rA0_81
    s_mov_b32 s50, 0
    s_branch oA0_85
rA1_82:
    buffer_load_dwordx4 v[228:231], v12, s[8:11], s40 offen offset:1024 sc1
    buffer_load_dwordx4 v[232:235], v12, s[8:11], s40 offen offset:2048 sc1
    buffer_load_dwordx4 v[236:239], v12, s[8:11], s40 offen offset:3072 sc1
    s_add_u32 s51, s51, 1
    s_waitcnt vmcnt(2)
    v_max3_u32 v4, v228, v229, v230
    v_max_u32 v4, v4, v231
    v_cmp_eq_u32 vcc, -1, v4
    s_nop 0
    s_cbranch_vccz oA1_86
    s_cmp_le_u32 s51, s50
    s_cbranch_scc1 rA1_82
    s_mov_b32 s50, 0
    s_branch oA1_86
rA2_83:
    buffer_load_dwordx4 v[232:235], v12, s[8:11], s40 offen offset:2048 sc1
    buffer_load_dwordx4 v[236:239], v12, s[8:11], s40 offen offset:3072 sc1
    s_add_u32 s51, s51, 1
    s_waitcnt vmcnt(1)
    v_max3_u32 v4, v232, v233, v234
    v_max_u32 v4, v4, v235
    v_cmp_eq_u32 vcc, -1, v4
    s_nop 0
    s_cbranch_vccz oA2_87
    s_cmp_le_u32 s51, s50
    s_cbranch_scc1 rA2_83
    s_mov_b32 s50, 0
    s_branch oA2_87
rA3_84:
    buffer_load_dwordx4 v[236:239], v12, s[8:11], s40 offen offset:3072 sc1
    s_add_u32 s51, s51, 1
    s_waitcnt vmcnt(0)
    v_max3_u32 v4, v236, v237, v238
    v_max_u32 v4, v4, v239
    v_cmp_eq_u32 vcc, -1, v4
    s_nop 0
    s_cbranch_vccz oA3_88
    s_cmp_le_u32 s51, s50
    s_cbranch_scc1 rA3_84
    s_mov_b32 s50, 0
    s_branch oA3_88
kvslow_90:
    s_mov_b32 s51, 0
    s_branch kv0s_124
kvws_122:
    s_sleep 6
kv0s_124:
    buffer_load_dword v35, v37, s[8:11], s57 offen sc1
    s_add_u32 s51, s51, 1
    s_cmp_gt_u32 s51, s50
    s_cbranch_scc1 kvds_123
    s_waitcnt vmcnt(0)
    v_cmp_gt_u32 vcc, 32, v35
    s_nop 0
    s_cbranch_vccnz kvws_122
kvds_123:
    s_waitcnt vmcnt(0)
    s_branch kvok_89
dokv_92:
    s_add_u32 s57, s39, 2
    s_lshr_b32 s57, s57, 3
    s_lshl_b32 s57, s57, 9
    s_add_u32 s57, s57, 10240
    buffer_load_dword v35, v37, s[8:11], s57 offen sc1
    s_branch nokv_91
pollE1_97:
    buffer_load_dwordx4 v[76:79], v28, s[8:11], s58 offen offset:1024 sc1
    s_add_u32 s51, s51, 1
    s_cmp_gt_u32 s51, s50
    s_cbranch_scc1 pollfE1_103
    s_branch chkE1_99
pollfE0_102:
    s_mov_b32 s50, 0
    s_waitcnt vmcnt(0)
    s_branch okE0_100
pollfE1_103:
    s_mov_b32 s50, 0
    s_waitcnt vmcnt(0)
    s_branch okE1_101
rA0_104:
    buffer_load_dwordx4 v[224:227], v12, s[8:11], s40 offen offset:0 sc1
    buffer_load_dwordx4 v[228:231], v12, s[8:11], s40 offen offset:1024 sc1
    buffer_load_dwordx4 v[232:235], v12, s[8:11], s40 offen offset:2048 sc1
    buffer_load_dwordx4 v[236:239], v12, s[8:11], s40 offen offset:3072 sc1
    s_add_u32 s51, s51, 1
    s_waitcnt vmcnt(3)
    v_max3_u32 v4, v224, v225, v226
    v_max_u32 v4, v4, v227
    v_cmp_eq_u32 vcc, -1, v4
    s_nop 0
    s_cbranch_vccz oA0_108
    s_cmp_le_u32 s51, s50
    s_cbranch_scc1 rA0_104
    s_mov_b32 s50, 0
    s_branch oA0_108
rA1_105:
    buffer_load_dwordx4 v[228:231], v12, s[8:11], s40 offen offset:1024 sc1
    buffer_load_dwordx4 v[232:235], v12, s[8:11], s40 offen offset:2048 sc1
    buffer_load_dwordx4 v[236:239], v12, s[8:11], s40 offen offset:3072 sc1
    s_add_u32 s51, s51, 1
    s_waitcnt vmcnt(2)
    v_max3_u32 v4, v228, v229, v230
    v_max_u32 v4, v4, v231
    v_cmp_eq_u32 vcc, -1, v4
    s_nop 0
    s_cbranch_vccz oA1_109
    s_cmp_le_u32 s51, s50
    s_cbranch_scc1 rA1_105
    s_mov_b32 s50, 0
    s_branch oA1_109
rA2_106:
    buffer_load_dwordx4 v[232:235], v12, s[8:11], s40 offen offset:2048 sc1
    buffer_load_dwordx4 v[236:239], v12, s[8:11], s40 offen offset:3072 sc1
    s_add_u32 s51, s51, 1
    s_waitcnt vmcnt(1)
    v_max3_u32 v4, v232, v233, v234
    v_max_u32 v4, v4, v235
    v_cmp_eq_u32 vcc, -1, v4
    s_nop 0
    s_cbranch_vccz oA2_110
    s_cmp_le_u32 s51, s50
    s_cbranch_scc1 rA2_106
    s_mov_b32 s50, 0
    s_branch oA2_110
rA3_107:
    buffer_load_dwordx4 v[236:239], v12, s[8:11], s40 offen offset:3072 sc1
    s_add_u32 s51, s51, 1
    s_waitcnt vmcnt(0)
    v_max3_u32 v4, v236, v237, v238
    v_max_u32 v4, v4, v239
    v_cmp_eq_u32 vcc, -1, v4
    s_nop 0
    s_cbranch_vccz oA3_111
    s_cmp_le_u32 s51, s50
    s_cbranch_scc1 rA3_107
    s_mov_b32 s50, 0
    s_branch oA3_111
pCf_113:
    s_add_u32 s51, s51, 1
    s_cmp_le_u32 s51, s50
    s_cbranch_scc1 pC_112
    s_mov_b32 s50, 0
    s_branch pCd_114
vslow_116:
    s_mov_b32 s51, 0
pollV0_125:
    buffer_load_dwordx4 v[200:203], v22, s[8:11], s40 offen offset:0 sc1
    buffer_load_dwordx4 v[204:207], v22, s[8:11], s40 offen offset:1024 sc1
    s_add_u32 s51, s51, 1
    s_cmp_gt_u32 s51, s50
    s_cbranch_scc1 pollfV0_131
chkV0_127:
    s_waitcnt vmcnt(1)
    v_max3_u32 v4, v200, v201, v202
    v_max_u32 v4, v4, v203
    v_cmp_eq_u32 vcc, -1, v4
    s_nop 0
    s_cbranch_vccnz pollV0_125
okV0_129:
chkV1_128:
    s_waitcnt vmcnt(0)
    v_max3_u32 v4, v204, v205, v206
    v_max_u32 v4, v4, v207
    v_cmp_eq_u32 vcc, -1, v4
    s_nop 0
    s_cbranch_vccnz pollV1_126
okV1_130:
    s_branch vok_115
kvslow_118:
    s_mov_b32 s51, 0
    s_branch kv0s_135
kvws_133:
    s_sleep 6
kv0s_135:
    buffer_load_dword v35, v37, s[8:11], s57 offen sc1
    s_add_u32 s51, s51, 1
    s_cmp_gt_u32 s51, s50
    s_cbranch_scc1 kvds_134
    s_waitcnt vmcnt(0)
    v_cmp_gt_u32 vcc, 32, v35
    s_nop 0
    s_cbranch_vccnz kvws_133
kvds_134:
    s_waitcnt vmcnt(0)
    s_branch kvok_117
dokv_120:
    s_add_u32 s57, s39, 2
    s_lshr_b32 s57, s57, 3
    s_lshl_b32 s57, s57, 9
    s_add_u32 s57, s57, 10240
    buffer_load_dword v35, v37, s[8:11], s57 offen sc1
    s_branch nokv_119
pollV1_126:
    buffer_load_dwordx4 v[204:207], v22, s[8:11], s40 offen offset:1024 sc1
    s_add_u32 s51, s51, 1
    s_cmp_gt_u32 s51, s50
    s_cbranch_scc1 pollfV1_132
    s_branch chkV1_128
pollfV0_131:
    s_mov_b32 s50, 0
    s_waitcnt vmcnt(0)
    s_branch okV0_129
pollfV1_132:
    s_mov_b32 s50, 0
    s_waitcnt vmcnt(0)
    s_branch okV1_130
mega_kernel_lastN:
    s_waitcnt vmcnt(0)
    s_barrier
    s_cmp_lg_u32 s32, 0
    s_cbranch_scc1 mega_kernel_fin
mega_kernel_lastR:
    s_cmp_eq_u32 s32, 2
    s_cbranch_scc1 mega_kernel_fin
    buffer_load_dwordx4 v[224:227], v17, s[8:11], s40 offen sc1
    s_waitcnt vmcnt(0)
    buffer_store_dwordx4 v[224:227], v19, s[8:11], s46 offen sc1
mega_kernel_fin:
    s_waitcnt vmcnt(0) lgkmcnt(0)
    s_barrier
    s_cmp_lg_u32 s32, 0
    s_cbranch_scc1 mega_kernel_worker
    s_lshr_b32 s35, s33, 1
    s_lshl_b32 s35, s35, 7
    s_add_u32 s35, s35, 0x6401600
    v_mov_b32 v4, s35
    v_mov_b32 v5, 1
    s_mov_b64 exec, 1
    buffer_atomic_add v5, v4, s[8:11], 0 offen sc1
    s_mov_b64 exec, -1
    s_branch mega_kernel_worker
mega_kernel_exit:
    s_endpgm
mega_kernel_worker:
    s_load_dwordx16 s[4:19], s[0:1], 0
    s_load_dwordx8 s[20:27], s[0:1], 64
    s_load_dwordx2 s[28:29], s[0:1], 96
    v_and_b32 v1, 63, v0
    v_lshrrev_b32 v2, 6, v0
    s_nop 0
    v_readfirstlane_b32 s44, v2
    v_lshlrev_b32 v2, 4, v1
    v_and_b32 v3, 31, v1
    v_lshlrev_b32 v3, 12, v3
    v_lshrrev_b32 v4, 5, v1
    v_lshl_add_u32 v3, v4, 4, v3
    s_and_b32 s45, s101, 3
    s_cmp_eq_u32 s3, -1
    s_cselect_b32 s46, s45, s45
    s_mov_b32 s48, 0
    s_mov_b32 s56, 48
    s_waitcnt lgkmcnt(0)
    s_lshl_b32 s49, s100, 27
    s_add_u32 s28, s28, s49
    s_addc_u32 s29, s29, 0
    s_lshl_b32 s49, s100, 7
    s_add_u32 s26, s26, s49
    s_addc_u32 s27, s27, 0
    s_mov_b32 s32, s28
    s_and_b32 s33, s29, 0xffff
    s_mov_b32 s34, 0x8000000
    s_mov_b32 s35, 0x00020000
    s_mov_b32 s36, s26
    s_and_b32 s37, s27, 0xffff
    s_mov_b32 s38, 0x80
    s_mov_b32 s39, 0x00020000
    s_mov_b32 s40, s24
    s_and_b32 s41, s25, 0xffff
    s_mov_b32 s42, 0x800000
    s_mov_b32 s43, 0x00020000
    v_and_b32 v6, 3, v1
    v_lshlrev_b32 v6, 7, v6
    v_add_u32 v6, 0x6400000, v6
    v_mov_b32 v7, 0
    s_mov_b32 s69, 0
    s_mov_b32 s75, 0
    s_mov_b32 s70, 0
    s_mov_b32 s73, 48
    s_mov_b32 s74, 0
    s_mov_b32 s47, s3
    s_cmp_lt_u32 s3, 32
    s_cbranch_scc1 static_138
    s_cmp_lg_u32 s100, 0
    s_cbranch_scc1 pcd_140
    v_and_b32 v4, 7, v1
    v_lshlrev_b32 v4, 2, v4
    s_mov_b32 s52, 0
pcw_139:
    buffer_load_dword v5, v4, s[36:39], 0 offen sc1
    s_add_u32 s52, s52, 1
    s_waitcnt vmcnt(0)
    v_cmp_ne_u32 vcc, 32, v5
    s_nop 0
    s_cbranch_vccz pcd_140
    v_cmp_lt_u32 vcc, 32, v5
    s_nop 0
    s_cbranch_vccnz pcb_141
    s_sleep 8
    s_cmp_lt_u32 s52, 200000
    s_cbranch_scc1 pcw_139
    s_branch pcd_140
pcb_141:
    s_mov_b32 s100, 1
    s_waitcnt vmcnt(0) lgkmcnt(0)
    s_barrier
    s_branch mega_kernel_restart
pcd_140:
    s_branch mega_kernel_wnext
static_138:
    s_branch havejob_136
mega_kernel_wnext:
    s_cmp_lg_u32 s44, 0
    s_cbranch_scc1 nofetch_142
    s_cmp_lg_u32 s69, 0
    s_cbranch_scc1 id_144
    s_mov_b32 s69, 1
    v_mov_b32 v4, 52
    s_mov_b32 s52, 0
iw_143:
    buffer_load_dword v5, v4, s[36:39], 0 offen sc1
    s_add_u32 s52, s52, 1
    s_waitcnt vmcnt(0)
    v_cmp_ne_u32 vcc, 0, v5
    s_nop 0
    s_cbranch_vccnz id_144
    s_sleep 4
    s_cmp_lt_u32 s52, 200000
    s_cbranch_scc1 iw_143
id_144:
    s_lshl_b32 s49, s46, 7
    s_add_u32 s49, s49, 0x6402000
    v_mov_b32 v4, s49
    v_mov_b32 v5, 1
    s_mov_b64 exec, 1
    buffer_atomic_add v5, v4, s[32:35], 0 offen sc0 sc1
    s_waitcnt vmcnt(0)
    v_mov_b32 v4, 131136
    ds_write_b32 v4, v5
    s_waitcnt lgkmcnt(0)
    s_mov_b64 exec, -1
nofetch_142:
    s_barrier
    v_mov_b32 v4, 131136
    ds_read_b32 v5, v4
    s_waitcnt lgkmcnt(0)
    v_readfirstlane_b32 s47, v5
    s_barrier
gotjob_137:
    s_mov_b32 s69, 1
    s_add_u32 s47, s47, 32
havejob_136:
    s_mov_b32 s62, 0
    s_cmp_lt_u32 s47, 16
    s_cbranch_scc1 jobskv_147
    s_sub_u32 s47, s47, 16
    s_mov_b32 s62, 1
    s_cmp_lt_u32 s47, 16
    s_cbranch_scc1 jobbkv_148
    s_sub_u32 s47, s47, 16
    s_mov_b32 s62, 1
    s_cmp_lt_u32 s47, 16
    s_cbranch_scc1 jobskv_147
    s_sub_u32 s47, s47, 16
    s_mov_b32 s62, 3
    s_cmp_lt_u32 s47, 32
    s_cbranch_scc1 jobbkv_148
    s_sub_u32 s47, s47, 32
    s_mov_b32 s62, 7
    s_cmp_lt_u32 s47, 8
    s_cbranch_scc1 jobbkv_148
    s_sub_u32 s47, s47, 8
    s_mov_b32 s62, 0
    s_cmp_lt_u32 s47, 16
    s_cbranch_scc1 jobq_150
    s_sub_u32 s47, s47, 16
    s_mov_b32 s62, 0
    s_cmp_lt_u32 s47, 24
    s_cbranch_scc1 jobbq_149
    s_sub_u32 s47, s47, 24
    s_mov_b32 s62, 0
    s_cmp_lt_u32 s47, 8
    s_cbranch_scc1 jobaattn_154
    s_sub_u32 s47, s47, 8
    s_mov_b32 s62, 4
    s_cmp_lt_u32 s47, 8
    s_cbranch_scc1 jobq_150
    s_sub_u32 s47, s47, 8
    s_mov_b32 s62, 0
    s_cmp_lt_u32 s47, 8
    s_cbranch_scc1 jobaout_155
    s_sub_u32 s47, s47, 8
    s_mov_b32 s62, 6
    s_cmp_lt_u32 s47, 8
    s_cbranch_scc1 jobq_150
    s_sub_u32 s47, s47, 8
    s_mov_b32 s62, 2
    s_cmp_lt_u32 s47, 8
    s_cbranch_scc1 jobaattn_154
    s_sub_u32 s47, s47, 8
    s_mov_b32 s62, 0
    s_cmp_lt_u32 s47, 8
    s_cbranch_scc1 jobbattn_151
    s_sub_u32 s47, s47, 8
    s_mov_b32 s62, 2
    s_cmp_lt_u32 s47, 8
    s_cbranch_scc1 jobaout_155
    s_sub_u32 s47, s47, 8
    s_mov_b32 s62, 8
    s_cmp_lt_u32 s47, 8
    s_cbranch_scc1 jobbattn_151
    s_sub_u32 s47, s47, 8
    s_mov_b32 s62, 4
    s_cmp_lt_u32 s47, 4
    s_cbranch_scc1 jobaattn_154
    s_sub_u32 s47, s47, 4
    s_mov_b32 s62, 16
    s_cmp_lt_u32 s47, 16
    s_cbranch_scc1 jobbattn_151
    s_sub_u32 s47, s47, 16
    s_mov_b32 s62, 4
    s_cmp_lt_u32 s47, 4
    s_cbranch_scc1 jobaout_155
    s_sub_u32 s47, s47, 4
    s_mov_b32 s62, 20
    s_cmp_lt_u32 s47, 4
    s_cbranch_scc1 jobaattn1_156
    s_sub_u32 s47, s47, 4
    s_mov_b32 s62, 21
    s_cmp_lt_u32 s47, 4
    s_cbranch_scc1 jobaattn1_156
    s_sub_u32 s47, s47, 4
    s_mov_b32 s62, 0
    s_cmp_lt_u32 s47, 16
    s_cbranch_scc1 jobwot_153
    s_sub_u32 s47, s47, 16
    s_mov_b32 s62, 10
    s_cmp_lt_u32 s47, 2
    s_cbranch_scc1 jobaoutr_145
    s_sub_u32 s47, s47, 2
    s_mov_b32 s62, 22
    s_cmp_lt_u32 s47, 4
    s_cbranch_scc1 jobaattn1_156
    s_sub_u32 s47, s47, 4
    s_mov_b32 s62, 16
    s_cmp_lt_u32 s47, 16
    s_cbranch_scc1 jobwot_153
    s_sub_u32 s47, s47, 16
    s_mov_b32 s62, 23
    s_cmp_lt_u32 s47, 4
    s_cbranch_scc1 jobaattn1_156
    s_sub_u32 s47, s47, 4
    s_mov_b32 s62, 0
    s_cmp_lt_u32 s47, 8
    s_cbranch_scc1 jobbout_152
    s_sub_u32 s47, s47, 8
    s_mov_b32 s62, 11
    s_cmp_lt_u32 s47, 2
    s_cbranch_scc1 jobaoutr_145
    s_sub_u32 s47, s47, 2
    s_mov_b32 s62, 24
    s_cmp_lt_u32 s47, 4
    s_cbranch_scc1 jobaattn1_156
    s_sub_u32 s47, s47, 4
    s_mov_b32 s62, 25
    s_cmp_lt_u32 s47, 4
    s_cbranch_scc1 jobaattn1_156
    s_sub_u32 s47, s47, 4
    s_mov_b32 s62, 8
    s_cmp_lt_u32 s47, 12
    s_cbranch_scc1 jobbout_152
    s_sub_u32 s47, s47, 12
    s_mov_b32 s62, 12
    s_cmp_lt_u32 s47, 2
    s_cbranch_scc1 jobaoutr_145
    s_sub_u32 s47, s47, 2
    s_mov_b32 s62, 20
    s_cmp_lt_u32 s47, 12
    s_cbranch_scc1 jobbout_152
    s_sub_u32 s47, s47, 12
    s_mov_b32 s62, 26
    s_cmp_lt_u32 s47, 4
    s_cbranch_scc1 jobaattn1_156
    s_sub_u32 s47, s47, 4
    s_mov_b32 s62, 27
    s_cmp_lt_u32 s47, 4
    s_cbranch_scc1 jobaattn1_156
    s_sub_u32 s47, s47, 4
    s_mov_b32 s62, 26
    s_cmp_lt_u32 s47, 8
    s_cbranch_scc1 jobaoutd_157
    s_sub_u32 s47, s47, 8
    s_mov_b32 s62, 28
    s_cmp_lt_u32 s47, 4
    s_cbranch_scc1 jobaattn1_156
    s_sub_u32 s47, s47, 4
    s_mov_b32 s62, 27
    s_cmp_lt_u32 s47, 8
    s_cbranch_scc1 jobaoutd_157
    s_sub_u32 s47, s47, 8
    s_mov_b32 s62, 29
    s_cmp_lt_u32 s47, 4
    s_cbranch_scc1 jobaattn1_156
    s_sub_u32 s47, s47, 4
    s_mov_b32 s62, 28
    s_cmp_lt_u32 s47, 8
    s_cbranch_scc1 jobaoutd_157
    s_sub_u32 s47, s47, 8
    s_mov_b32 s62, 30
    s_cmp_lt_u32 s47, 4
    s_cbranch_scc1 jobaattn1_156
    s_sub_u32 s47, s47, 4
    s_mov_b32 s62, 31
    s_cmp_lt_u32 s47, 4
    s_cbranch_scc1 jobaattn1_156
    s_sub_u32 s47, s47, 4
    s_mov_b32 s62, 29
    s_cmp_lt_u32 s47, 8
    s_cbranch_scc1 jobaoutd_157
    s_sub_u32 s47, s47, 8
    s_mov_b32 s62, 60
    s_cmp_lt_u32 s47, 16
    s_cbranch_scc1 jobaoute_158
    s_sub_u32 s47, s47, 16
    s_mov_b32 s62, 62
    s_cmp_lt_u32 s47, 16
    s_cbranch_scc1 jobaoute_158
    s_sub_u32 s47, s47, 16
mega_kernel_wpeek:
    s_endpgm
jobskv_147:
    s_lshr_b32 s49, s62, 1
    s_lshl_b32 s56, s49, 2
    s_add_u32 s56, s56, 80
    s_mov_b32 s57, 1
    s_mov_b32 s58, s62
    s_lshr_b32 s59, s47, 0
    s_and_b32 s59, s59, 15
    s_lshl_b32 s59, s59, 2
    s_add_u32 s59, s59, s45
    s_cmp_ge_u32 s59, 32
    s_cselect_b32 s55, 1, 0
    s_cselect_b64 s[64:65], s[12:13], s[10:11]
    s_mov_b32 s53, 0x1000000
    s_cselect_b32 s53, 0x2000000, s53
    s_and_b32 s59, s59, 31
    s_mov_b32 s84, s64
    s_and_b32 s85, s65, 0xffff
    s_mov_b32 s86, 0x800000
    s_mov_b32 s87, 0x00020000
    s_mov_b32 s80, s4
    s_and_b32 s81, s5, 0xffff
    s_mov_b32 s82, 0x400000
    s_mov_b32 s83, 0x00020000
    s_lshl_b32 s88, s58, 18
    s_mov_b32 s90, 128
    s_lshl_b32 s89, s59, 8
    s_mov_b32 s91, 524288
    s_mov_b32 s54, 262144
    s_mov_b32 s92, 3
    s_lshr_b32 s49, s44, 1
    s_lshl_b32 s50, s58, 1
    s_add_u32 s49, s49, s50
    s_mul_i32 s49, s49, 2
    s_mul_i32 s49, s49, s54
    s_add_u32 s53, s53, s49
    s_and_b32 s49, s44, 1
    s_lshl_b32 s50, s59, 1
    s_add_u32 s49, s49, s50
    s_mul_i32 s49, s49, 4096
    s_add_u32 s53, s53, s49
    s_cmp_eq_u32 s48, 3
    s_cbranch_scc1 cfg_163
    s_mul_i32 s93, s44, 4096
    s_mul_i32 s94, s44, 4096
    s_add_u32 s94, s94, 16384
    v_lshrrev_b32 v80, 3, v1
    s_mul_i32 s49, s44, 32
    v_add_u32 v80, s49, v80
    v_and_b32 v81, 7, v1
    s_mov_b32 s50, 2048
    v_add_u32 v82, 0, v80
    v_bfe_u32 v83, v82, 1, 3
    v_xor_b32 v83, v83, v81
    v_mul_lo_u32 v82, v82, s50
    v_lshl_add_u32 v8, v83, 4, v82
    v_add_u32 v82, 8, v80
    v_bfe_u32 v83, v82, 1, 3
    v_xor_b32 v83, v83, v81
    v_mul_lo_u32 v82, v82, s50
    v_lshl_add_u32 v9, v83, 4, v82
    v_add_u32 v82, 16, v80
    v_bfe_u32 v83, v82, 1, 3
    v_xor_b32 v83, v83, v81
    v_mul_lo_u32 v82, v82, s50
    v_lshl_add_u32 v10, v83, 4, v82
    v_add_u32 v82, 24, v80
    v_bfe_u32 v83, v82, 1, 3
    v_xor_b32 v83, v83, v81
    v_mul_lo_u32 v82, v82, s50
    v_lshl_add_u32 v11, v83, 4, v82
    v_lshrrev_b32 v80, 4, v1
    s_mul_i32 s49, s44, 16
    v_add_u32 v80, s49, v80
    v_and_b32 v81, 15, v1
    s_mov_b32 s50, 8192
    v_add_u32 v82, 0, v80
    v_and_b32 v83, 3, v82
    v_lshlrev_b32 v83, 2, v83
    v_xor_b32 v83, v83, v81
    v_mul_lo_u32 v82, v82, s50
    v_lshl_add_u32 v12, v83, 4, v82
    v_add_u32 v82, 4, v80
    v_and_b32 v83, 3, v82
    v_lshlrev_b32 v83, 2, v83
    v_xor_b32 v83, v83, v81
    v_mul_lo_u32 v82, v82, s50
    v_lshl_add_u32 v13, v83, 4, v82
    v_add_u32 v82, 8, v80
    v_and_b32 v83, 3, v82
    v_lshlrev_b32 v83, 2, v83
    v_xor_b32 v83, v83, v81
    v_mul_lo_u32 v82, v82, s50
    v_lshl_add_u32 v14, v83, 4, v82
    v_add_u32 v82, 12, v80
    v_and_b32 v83, 3, v82
    v_lshlrev_b32 v83, 2, v83
    v_xor_b32 v83, v83, v81
    v_mul_lo_u32 v82, v82, s50
    v_lshl_add_u32 v15, v83, 4, v82
    s_lshr_b32 s49, s44, 1
    s_mul_i32 s49, s49, 8192
    v_and_b32 v80, 31, v1
    v_lshrrev_b32 v81, 5, v1
    v_bfe_u32 v82, v80, 1, 3
    v_lshlrev_b32 v80, 7, v80
    v_add_u32 v80, s49, v80
    v_add_u32 v83, 0, v81
    v_xor_b32 v83, v83, v82
    v_lshl_add_u32 v16, v83, 4, v80
    v_add_u32 v20, 32768, v16
    v_add_u32 v24, 65536, v16
    v_add_u32 v28, 98304, v16
    v_add_u32 v83, 2, v81
    v_xor_b32 v83, v83, v82
    v_lshl_add_u32 v17, v83, 4, v80
    v_add_u32 v21, 32768, v17
    v_add_u32 v25, 65536, v17
    v_add_u32 v29, 98304, v17
    v_add_u32 v83, 4, v81
    v_xor_b32 v83, v83, v82
    v_lshl_add_u32 v18, v83, 4, v80
    v_add_u32 v22, 32768, v18
    v_add_u32 v26, 65536, v18
    v_add_u32 v30, 98304, v18
    v_add_u32 v83, 6, v81
    v_xor_b32 v83, v83, v82
    v_lshl_add_u32 v19, v83, 4, v80
    v_add_u32 v23, 32768, v19
    v_add_u32 v27, 65536, v19
    v_add_u32 v31, 98304, v19
    v_bfe_u32 v80, v1, 2, 2
    v_lshrrev_b32 v81, 5, v1
    v_mul_u32_u24 v81, 8, v81
    v_add_u32 v81, v81, v80
    v_mul_u32_u24 v81, 256, v81
    v_bfe_u32 v82, v1, 4, 1
    v_lshl_add_u32 v81, v82, 5, v81
    v_and_b32 v82, 3, v1
    v_lshl_add_u32 v81, v82, 3, v81
    s_and_b32 s49, s44, 1
    s_mul_i32 s49, s49, 2
    s_add_u32 s50, s49, 0
    v_xor_b32 v82, s50, v80
    v_lshl_add_u32 v82, v82, 6, v81
    v_add_u32 v32, 16384, v82
    v_add_u32 v36, 49152, v82
    v_add_u32 v40, 81920, v82
    v_add_u32 v44, 114688, v82
    v_add_u32 v33, 17408, v82
    v_add_u32 v37, 50176, v82
    v_add_u32 v41, 82944, v82
    v_add_u32 v45, 115712, v82
    s_add_u32 s50, s49, 1
    v_xor_b32 v82, s50, v80
    v_lshl_add_u32 v82, v82, 6, v81
    v_add_u32 v34, 16384, v82
    v_add_u32 v38, 49152, v82
    v_add_u32 v42, 81920, v82
    v_add_u32 v46, 114688, v82
    v_add_u32 v35, 17408, v82
    v_add_u32 v39, 50176, v82
    v_add_u32 v43, 82944, v82
    v_add_u32 v47, 115712, v82
    s_mov_b32 s48, 3
cfg_163:
    s_mov_b32 s61, 0
    s_branch jobsmall_161
jobaout_155:
    s_lshr_b32 s58, s47, 2
    s_add_u32 s58, s58, s62
    s_lshl_b32 s58, s58, 1
    s_lshr_b32 s49, s45, 1
    s_add_u32 s58, s58, s49
    s_and_b32 s59, s45, 1
    s_lshl_b32 s59, s59, 2
    s_and_b32 s49, s47, 3
    s_add_u32 s59, s59, s49
    s_mov_b32 s54, 4
    s_mov_b32 s60, 0
    s_branch jobaoutj_146
jobaoutr_145:
    s_mov_b32 s58, s62
    s_lshl_b32 s59, s45, 1
    s_add_u32 s59, s59, s47
    s_mov_b32 s54, 0x2222
    s_and_b32 s60, s62, 1
    s_lshl_b32 s60, s60, 4
jobaoutj_146:
    s_mov_b32 s84, s14
    s_and_b32 s85, s15, 0xffff
    s_mov_b32 s86, 0x800000
    s_mov_b32 s87, 0x00020000
    s_mul_i32 s88, s58, 1048576
    s_add_u32 s88, s88, 0x3000000
    s_mov_b32 s92, 15
    s_mov_b32 s53, 0
    s_mov_b32 s51, 208
    s_cmp_eq_u32 s48, 5
    s_cbranch_scc1 cfg_164
    s_mul_i32 s93, s44, 4096
    s_mul_i32 s94, s44, 4096
    s_add_u32 s94, s94, 16384
    v_lshlrev_b32 v80, 4, v1
    s_mul_i32 s49, s44, 4
    s_add_u32 s49, s49, 0
    s_lshr_b32 s50, s49, 2
    s_mul_i32 s50, s50, 262144
    s_and_b32 s49, s49, 3
    s_lshl_b32 s49, s49, 10
    s_add_u32 s49, s49, s50
    v_add_u32 v8, s49, v80
    s_mul_i32 s49, s44, 4
    s_add_u32 s49, s49, 1
    s_lshr_b32 s50, s49, 2
    s_mul_i32 s50, s50, 262144
    s_and_b32 s49, s49, 3
    s_lshl_b32 s49, s49, 10
    s_add_u32 s49, s49, s50
    v_add_u32 v9, s49, v80
    s_mul_i32 s49, s44, 4
    s_add_u32 s49, s49, 2
    s_lshr_b32 s50, s49, 2
    s_mul_i32 s50, s50, 262144
    s_and_b32 s49, s49, 3
    s_lshl_b32 s49, s49, 10
    s_add_u32 s49, s49, s50
    v_add_u32 v10, s49, v80
    s_mul_i32 s49, s44, 4
    s_add_u32 s49, s49, 3
    s_lshr_b32 s50, s49, 2
    s_mul_i32 s50, s50, 262144
    s_and_b32 s49, s49, 3
    s_lshl_b32 s49, s49, 10
    s_add_u32 s49, s49, s50
    v_add_u32 v11, s49, v80
    v_lshrrev_b32 v80, 4, v1
    s_mul_i32 s49, s44, 16
    v_add_u32 v80, s49, v80
    v_and_b32 v81, 15, v1
    s_mov_b32 s50, 2048
    v_add_u32 v82, 0, v80
    v_and_b32 v83, 3, v82
    v_lshlrev_b32 v83, 2, v83
    v_xor_b32 v83, v83, v81
    v_mul_lo_u32 v82, v82, s50
    v_lshl_add_u32 v12, v83, 4, v82
    v_add_u32 v82, 4, v80
    v_and_b32 v83, 3, v82
    v_lshlrev_b32 v83, 2, v83
    v_xor_b32 v83, v83, v81
    v_mul_lo_u32 v82, v82, s50
    v_lshl_add_u32 v13, v83, 4, v82
    v_add_u32 v82, 8, v80
    v_and_b32 v83, 3, v82
    v_lshlrev_b32 v83, 2, v83
    v_xor_b32 v83, v83, v81
    v_mul_lo_u32 v82, v82, s50
    v_lshl_add_u32 v14, v83, 4, v82
    v_add_u32 v82, 12, v80
    v_and_b32 v83, 3, v82
    v_lshlrev_b32 v83, 2, v83
    v_xor_b32 v83, v83, v81
    v_mul_lo_u32 v82, v82, s50
    v_lshl_add_u32 v15, v83, 4, v82
    s_lshr_b32 s49, s44, 1
    s_mul_i32 s49, s49, 8192
    v_lshlrev_b32 v80, 4, v1
    v_add_u32 v80, s49, v80
    v_add_u32 v16, 0, v80
    v_add_u32 v20, 32768, v80
    v_add_u32 v24, 65536, v80
    v_add_u32 v28, 98304, v80
    v_add_u32 v17, 1024, v80
    v_add_u32 v21, 33792, v80
    v_add_u32 v25, 66560, v80
    v_add_u32 v29, 99328, v80
    v_add_u32 v18, 2048, v80
    v_add_u32 v22, 34816, v80
    v_add_u32 v26, 67584, v80
    v_add_u32 v30, 100352, v80
    v_add_u32 v19, 3072, v80
    v_add_u32 v23, 35840, v80
    v_add_u32 v27, 68608, v80
    v_add_u32 v31, 101376, v80
    v_bfe_u32 v80, v1, 2, 2
    v_lshrrev_b32 v81, 5, v1
    v_mul_u32_u24 v81, 4, v81
    v_add_u32 v81, v81, v80
    v_mul_u32_u24 v81, 256, v81
    v_bfe_u32 v82, v1, 4, 1
    v_lshl_add_u32 v81, v82, 5, v81
    v_and_b32 v82, 3, v1
    v_lshl_add_u32 v81, v82, 3, v81
    s_and_b32 s49, s44, 1
    s_mul_i32 s49, s49, 2
    s_add_u32 s50, s49, 0
    v_xor_b32 v82, s50, v80
    v_lshl_add_u32 v82, v82, 6, v81
    v_add_u32 v32, 16384, v82
    v_add_u32 v36, 49152, v82
    v_add_u32 v40, 81920, v82
    v_add_u32 v44, 114688, v82
    v_add_u32 v33, 18432, v82
    v_add_u32 v37, 51200, v82
    v_add_u32 v41, 83968, v82
    v_add_u32 v45, 116736, v82
    s_add_u32 s50, s49, 1
    v_xor_b32 v82, s50, v80
    v_lshl_add_u32 v82, v82, 6, v81
    v_add_u32 v34, 16384, v82
    v_add_u32 v38, 49152, v82
    v_add_u32 v42, 81920, v82
    v_add_u32 v46, 114688, v82
    v_add_u32 v35, 18432, v82
    v_add_u32 v39, 51200, v82
    v_add_u32 v43, 83968, v82
    v_add_u32 v47, 116736, v82
    s_mov_b32 s48, 5
cfg_164:
    s_branch joboutc_162
jobbout_152:
    s_add_u32 s47, s47, s62
    s_lshr_b32 s58, s47, 1
    s_lshr_b32 s59, s47, 0
    s_and_b32 s59, s59, 1
    s_lshl_b32 s59, s59, 2
    s_add_u32 s59, s59, s45
    s_mov_b32 s84, s22
    s_and_b32 s85, s23, 0xffff
    s_mov_b32 s86, 0x200000
    s_mov_b32 s87, 0x00020000
    s_mul_i32 s88, s58, 262144
    s_add_u32 s88, s88, 0x4c00000
    s_mov_b32 s92, 3
    s_mov_b32 s53, 2048
    s_mov_b32 s51, 144
    s_mov_b32 s54, 4
    s_mov_b32 s60, 0
    s_cmp_eq_u32 s48, 4
    s_cbranch_scc1 cfg_165
    s_mul_i32 s93, s44, 4096
    s_mul_i32 s94, s44, 4096
    s_add_u32 s94, s94, 16384
    v_lshlrev_b32 v80, 4, v1
    s_mul_i32 s49, s44, 4
    s_add_u32 s49, s49, 0
    s_lshr_b32 s50, s49, 2
    s_mul_i32 s50, s50, 65536
    s_and_b32 s49, s49, 3
    s_lshl_b32 s49, s49, 10
    s_add_u32 s49, s49, s50
    v_add_u32 v8, s49, v80
    s_mul_i32 s49, s44, 4
    s_add_u32 s49, s49, 1
    s_lshr_b32 s50, s49, 2
    s_mul_i32 s50, s50, 65536
    s_and_b32 s49, s49, 3
    s_lshl_b32 s49, s49, 10
    s_add_u32 s49, s49, s50
    v_add_u32 v9, s49, v80
    s_mul_i32 s49, s44, 4
    s_add_u32 s49, s49, 2
    s_lshr_b32 s50, s49, 2
    s_mul_i32 s50, s50, 65536
    s_and_b32 s49, s49, 3
    s_lshl_b32 s49, s49, 10
    s_add_u32 s49, s49, s50
    v_add_u32 v10, s49, v80
    s_mul_i32 s49, s44, 4
    s_add_u32 s49, s49, 3
    s_lshr_b32 s50, s49, 2
    s_mul_i32 s50, s50, 65536
    s_and_b32 s49, s49, 3
    s_lshl_b32 s49, s49, 10
    s_add_u32 s49, s49, s50
    v_add_u32 v11, s49, v80
    v_lshrrev_b32 v80, 4, v1
    s_mul_i32 s49, s44, 16
    v_add_u32 v80, s49, v80
    v_and_b32 v81, 15, v1
    s_mov_b32 s50, 2048
    v_add_u32 v82, 0, v80
    v_and_b32 v83, 3, v82
    v_lshlrev_b32 v83, 2, v83
    v_xor_b32 v83, v83, v81
    v_mul_lo_u32 v82, v82, s50
    v_lshl_add_u32 v12, v83, 4, v82
    v_add_u32 v82, 4, v80
    v_and_b32 v83, 3, v82
    v_lshlrev_b32 v83, 2, v83
    v_xor_b32 v83, v83, v81
    v_mul_lo_u32 v82, v82, s50
    v_lshl_add_u32 v13, v83, 4, v82
    v_add_u32 v82, 8, v80
    v_and_b32 v83, 3, v82
    v_lshlrev_b32 v83, 2, v83
    v_xor_b32 v83, v83, v81
    v_mul_lo_u32 v82, v82, s50
    v_lshl_add_u32 v14, v83, 4, v82
    v_add_u32 v82, 12, v80
    v_and_b32 v83, 3, v82
    v_lshlrev_b32 v83, 2, v83
    v_xor_b32 v83, v83, v81
    v_mul_lo_u32 v82, v82, s50
    v_lshl_add_u32 v15, v83, 4, v82
    s_lshr_b32 s49, s44, 1
    s_mul_i32 s49, s49, 8192
    v_lshlrev_b32 v80, 4, v1
    v_add_u32 v80, s49, v80
    v_add_u32 v16, 0, v80
    v_add_u32 v20, 32768, v80
    v_add_u32 v24, 65536, v80
    v_add_u32 v28, 98304, v80
    v_add_u32 v17, 1024, v80
    v_add_u32 v21, 33792, v80
    v_add_u32 v25, 66560, v80
    v_add_u32 v29, 99328, v80
    v_add_u32 v18, 2048, v80
    v_add_u32 v22, 34816, v80
    v_add_u32 v26, 67584, v80
    v_add_u32 v30, 100352, v80
    v_add_u32 v19, 3072, v80
    v_add_u32 v23, 35840, v80
    v_add_u32 v27, 68608, v80
    v_add_u32 v31, 101376, v80
    v_bfe_u32 v80, v1, 2, 2
    v_lshrrev_b32 v81, 5, v1
    v_mul_u32_u24 v81, 4, v81
    v_add_u32 v81, v81, v80
    v_mul_u32_u24 v81, 256, v81
    v_bfe_u32 v82, v1, 4, 1
    v_lshl_add_u32 v81, v82, 5, v81
    v_and_b32 v82, 3, v1
    v_lshl_add_u32 v81, v82, 3, v81
    s_and_b32 s49, s44, 1
    s_mul_i32 s49, s49, 2
    s_add_u32 s50, s49, 0
    v_xor_b32 v82, s50, v80
    v_lshl_add_u32 v82, v82, 6, v81
    v_add_u32 v32, 16384, v82
    v_add_u32 v36, 49152, v82
    v_add_u32 v40, 81920, v82
    v_add_u32 v44, 114688, v82
    v_add_u32 v33, 18432, v82
    v_add_u32 v37, 51200, v82
    v_add_u32 v41, 83968, v82
    v_add_u32 v45, 116736, v82
    s_add_u32 s50, s49, 1
    v_xor_b32 v82, s50, v80
    v_lshl_add_u32 v82, v82, 6, v81
    v_add_u32 v34, 16384, v82
    v_add_u32 v38, 49152, v82
    v_add_u32 v42, 81920, v82
    v_add_u32 v46, 114688, v82
    v_add_u32 v35, 18432, v82
    v_add_u32 v39, 51200, v82
    v_add_u32 v43, 83968, v82
    v_add_u32 v47, 116736, v82
    s_mov_b32 s48, 4
cfg_165:
joboutc_162:
    s_mov_b32 s80, s28
    s_and_b32 s81, s29, 0xffff
    s_mov_b32 s82, 0x8000000
    s_mov_b32 s83, 0x00020000
    s_mov_b32 s90, 4096
    s_lshl_b32 s89, s59, 8
    s_mov_b32 s91, 131072
    s_mov_b32 s55, 0
    s_mov_b32 s57, 0
    s_lshr_b32 s49, s44, 1
    s_lshl_b32 s49, s49, 18
    s_add_u32 s53, s53, s49
    s_lshl_b32 s49, s58, 19
    s_add_u32 s53, s53, s49
    s_and_b32 s49, s44, 1
    s_lshl_b32 s49, s49, 7
    s_add_u32 s53, s53, s49
    s_add_u32 s53, s53, s89
    s_lshr_b32 s49, s58, 1
    s_lshl_b32 s49, s49, 2
    s_add_u32 s49, s49, s51
    s_cmp_lg_u32 s44, 0
    s_cbranch_scc1 dd_167
    s_lshl_b32 s76, s49, 7
    s_mov_b32 s52, 0
dw_166:
    buffer_load_dword v5, v6, s[32:35], s76 offen sc1
    s_add_u32 s52, s52, 1
    s_waitcnt vmcnt(0)
    v_bfe_u32 v5, v5, s60, 16
    v_cmp_gt_u32 vcc, s54, v5
    s_nop 0
    s_cbranch_vccz dd_167
    s_sleep 12
    s_cmp_lt_u32 s52, 200000
    s_cbranch_scc1 dw_166
dd_167:
    s_barrier
    s_mov_b32 s61, 1
jobsmall_161:
    s_add_u32 m0, s93, 0
    s_nop 0
    buffer_load_dwordx4 v8, s[80:83], s88 offen sc1 lds
    s_add_u32 m0, s93, 1024
    s_nop 0
    buffer_load_dwordx4 v9, s[80:83], s88 offen sc1 lds
    s_add_u32 m0, s93, 2048
    s_nop 0
    buffer_load_dwordx4 v10, s[80:83], s88 offen sc1 lds
    s_add_u32 m0, s93, 3072
    s_nop 0
    buffer_load_dwordx4 v11, s[80:83], s88 offen sc1 lds
    s_add_u32 m0, s94, 0
    s_nop 0
    buffer_load_dwordx4 v12, s[84:87], s89 offen lds
    s_add_u32 m0, s94, 1024
    s_nop 0
    buffer_load_dwordx4 v13, s[84:87], s89 offen lds
    s_add_u32 m0, s94, 2048
    s_nop 0
    buffer_load_dwordx4 v14, s[84:87], s89 offen lds
    s_add_u32 m0, s94, 3072
    s_nop 0
    buffer_load_dwordx4 v15, s[84:87], s89 offen lds
    s_add_u32 s88, s88, s90
    s_add_u32 s89, s89, s91
    s_add_u32 m0, s93, 32768
    s_nop 0
    buffer_load_dwordx4 v8, s[80:83], s88 offen sc1 lds
    s_add_u32 m0, s93, 33792
    s_nop 0
    buffer_load_dwordx4 v9, s[80:83], s88 offen sc1 lds
    s_add_u32 m0, s93, 34816
    s_nop 0
    buffer_load_dwordx4 v10, s[80:83], s88 offen sc1 lds
    s_add_u32 m0, s93, 35840
    s_nop 0
    buffer_load_dwordx4 v11, s[80:83], s88 offen sc1 lds
    s_add_u32 m0, s94, 32768
    s_nop 0
    buffer_load_dwordx4 v12, s[84:87], s89 offen lds
    s_add_u32 m0, s94, 33792
    s_nop 0
    buffer_load_dwordx4 v13, s[84:87], s89 offen lds
    s_add_u32 m0, s94, 34816
    s_nop 0
    buffer_load_dwordx4 v14, s[84:87], s89 offen lds
    s_add_u32 m0, s94, 35840
    s_nop 0
    buffer_load_dwordx4 v15, s[84:87], s89 offen lds
    s_add_u32 s88, s88, s90
    s_add_u32 s89, s89, s91
    s_add_u32 m0, s93, 65536
    s_nop 0
    buffer_load_dwordx4 v8, s[80:83], s88 offen sc1 lds
    s_add_u32 m0, s93, 66560
    s_nop 0
    buffer_load_dwordx4 v9, s[80:83], s88 offen sc1 lds
    s_add_u32 m0, s93, 67584
    s_nop 0
    buffer_load_dwordx4 v10, s[80:83], s88 offen sc1 lds
    s_add_u32 m0, s93, 68608
    s_nop 0
    buffer_load_dwordx4 v11, s[80:83], s88 offen sc1 lds
    s_add_u32 m0, s94, 65536
    s_nop 0
    buffer_load_dwordx4 v12, s[84:87], s89 offen lds
    s_add_u32 m0, s94, 66560
    s_nop 0
    buffer_load_dwordx4 v13, s[84:87], s89 offen lds
    s_add_u32 m0, s94, 67584
    s_nop 0
    buffer_load_dwordx4 v14, s[84:87], s89 offen lds
    s_add_u32 m0, s94, 68608
    s_nop 0
    buffer_load_dwordx4 v15, s[84:87], s89 offen lds
    s_add_u32 s88, s88, s90
    s_add_u32 s89, s89, s91
    s_add_u32 m0, s93, 98304
    s_nop 0
    buffer_load_dwordx4 v8, s[80:83], s88 offen sc1 lds
    s_add_u32 m0, s93, 99328
    s_nop 0
    buffer_load_dwordx4 v9, s[80:83], s88 offen sc1 lds
    s_add_u32 m0, s93, 100352
    s_nop 0
    buffer_load_dwordx4 v10, s[80:83], s88 offen sc1 lds
    s_add_u32 m0, s93, 101376
    s_nop 0
    buffer_load_dwordx4 v11, s[80:83], s88 offen sc1 lds
    s_add_u32 m0, s94, 98304
    s_nop 0
    buffer_load_dwordx4 v12, s[84:87], s89 offen lds
    s_add_u32 m0, s94, 99328
    s_nop 0
    buffer_load_dwordx4 v13, s[84:87], s89 offen lds
    s_add_u32 m0, s94, 100352
    s_nop 0
    buffer_load_dwordx4 v14, s[84:87], s89 offen lds
    s_add_u32 m0, s94, 101376
    s_nop 0
    buffer_load_dwordx4 v15, s[84:87], s89 offen lds
    s_add_u32 s88, s88, s90
    s_add_u32 s89, s89, s91
    s_waitcnt vmcnt(24)
    s_barrier
    ds_read_b128 v[48:51], v16 offset:0
    ds_read_b64_tr_b16 v[64:65], v32 offset:0
    ds_read_b64_tr_b16 v[66:67], v33 offset:0
    ds_read_b128 v[52:55], v16 offset:4096
    ds_read_b64_tr_b16 v[68:69], v34 offset:0
    ds_read_b64_tr_b16 v[70:71], v35 offset:0
    s_cmp_eq_u32 s55, 1
    s_cbranch_scc1 sN_168
    s_waitcnt lgkmcnt(0)
    v_mfma_f32_32x32x16_bf16 a[0:15], v[64:67], v[48:51], 0
    ds_read_b128 v[56:59], v17 offset:0
    ds_read_b64_tr_b16 v[72:73], v32 offset:4096
    ds_read_b64_tr_b16 v[74:75], v33 offset:4096
    v_mfma_f32_32x32x16_bf16 a[16:31], v[68:71], v[48:51], 0
    ds_read_b128 v[60:63], v17 offset:4096
    ds_read_b64_tr_b16 v[76:77], v34 offset:4096
    ds_read_b64_tr_b16 v[78:79], v35 offset:4096
    v_mfma_f32_32x32x16_bf16 a[32:47], v[64:67], v[52:55], 0
    v_mfma_f32_32x32x16_bf16 a[48:63], v[68:71], v[52:55], 0
    s_waitcnt lgkmcnt(0)
    v_mfma_f32_32x32x16_bf16 a[0:15], v[72:75], v[56:59], a[0:15]
    ds_read_b128 v[48:51], v18 offset:0
    ds_read_b64_tr_b16 v[64:65], v32 offset:8192
    ds_read_b64_tr_b16 v[66:67], v33 offset:8192
    v_mfma_f32_32x32x16_bf16 a[16:31], v[76:79], v[56:59], a[16:31]
    ds_read_b128 v[52:55], v18 offset:4096
    ds_read_b64_tr_b16 v[68:69], v34 offset:8192
    ds_read_b64_tr_b16 v[70:71], v35 offset:8192
    v_mfma_f32_32x32x16_bf16 a[32:47], v[72:75], v[60:63], a[32:47]
    v_mfma_f32_32x32x16_bf16 a[48:63], v[76:79], v[60:63], a[48:63]
    s_waitcnt lgkmcnt(0)
    v_mfma_f32_32x32x16_bf16 a[0:15], v[64:67], v[48:51], a[0:15]
    ds_read_b128 v[56:59], v19 offset:0
    ds_read_b64_tr_b16 v[72:73], v32 offset:12288
    ds_read_b64_tr_b16 v[74:75], v33 offset:12288
    v_mfma_f32_32x32x16_bf16 a[16:31], v[68:71], v[48:51], a[16:31]
    ds_read_b128 v[60:63], v19 offset:4096
    ds_read_b64_tr_b16 v[76:77], v34 offset:12288
    ds_read_b64_tr_b16 v[78:79], v35 offset:12288
    v_mfma_f32_32x32x16_bf16 a[32:47], v[64:67], v[52:55], a[32:47]
    v_mfma_f32_32x32x16_bf16 a[48:63], v[68:71], v[52:55], a[48:63]
    s_waitcnt lgkmcnt(0)
    s_waitcnt vmcnt(16)
    s_barrier
    v_mfma_f32_32x32x16_bf16 a[0:15], v[72:75], v[56:59], a[0:15]
    ds_read_b128 v[48:51], v20 offset:0
    ds_read_b64_tr_b16 v[64:65], v36 offset:0
    s_add_u32 m0, s93, 0
    s_nop 0
    buffer_load_dwordx4 v8, s[80:83], s88 offen sc1 lds
    ds_read_b64_tr_b16 v[66:67], v37 offset:0
    v_mfma_f32_32x32x16_bf16 a[16:31], v[76:79], v[56:59], a[16:31]
    ds_read_b128 v[52:55], v20 offset:4096
    s_add_u32 m0, s93, 1024
    s_nop 0
    buffer_load_dwordx4 v9, s[80:83], s88 offen sc1 lds
    ds_read_b64_tr_b16 v[68:69], v38 offset:0
    ds_read_b64_tr_b16 v[70:71], v39 offset:0
    v_mfma_f32_32x32x16_bf16 a[32:47], v[72:75], v[60:63], a[32:47]
    v_mfma_f32_32x32x16_bf16 a[48:63], v[76:79], v[60:63], a[48:63]
    s_waitcnt lgkmcnt(0)
    v_mfma_f32_32x32x16_bf16 a[0:15], v[64:67], v[48:51], a[0:15]
    ds_read_b128 v[56:59], v21 offset:0
    ds_read_b64_tr_b16 v[72:73], v36 offset:4096
    s_add_u32 m0, s93, 2048
    s_nop 0
    buffer_load_dwordx4 v10, s[80:83], s88 offen sc1 lds
    ds_read_b64_tr_b16 v[74:75], v37 offset:4096
    v_mfma_f32_32x32x16_bf16 a[16:31], v[68:71], v[48:51], a[16:31]
    ds_read_b128 v[60:63], v21 offset:4096
    s_add_u32 m0, s93, 3072
    s_nop 0
    buffer_load_dwordx4 v11, s[80:83], s88 offen sc1 lds
    ds_read_b64_tr_b16 v[76:77], v38 offset:4096
    ds_read_b64_tr_b16 v[78:79], v39 offset:4096
    v_mfma_f32_32x32x16_bf16 a[32:47], v[64:67], v[52:55], a[32:47]
    v_mfma_f32_32x32x16_bf16 a[48:63], v[68:71], v[52:55], a[48:63]
    s_waitcnt lgkmcnt(0)
    v_mfma_f32_32x32x16_bf16 a[0:15], v[72:75], v[56:59], a[0:15]
    ds_read_b128 v[48:51], v22 offset:0
    ds_read_b64_tr_b16 v[64:65], v36 offset:8192
    s_add_u32 m0, s94, 0
    s_nop 0
    buffer_load_dwordx4 v12, s[84:87], s89 offen lds
    ds_read_b64_tr_b16 v[66:67], v37 offset:8192
    v_mfma_f32_32x32x16_bf16 a[16:31], v[76:79], v[56:59], a[16:31]
    ds_read_b128 v[52:55], v22 offset:4096
    s_add_u32 m0, s94, 1024
    s_nop 0
    buffer_load_dwordx4 v13, s[84:87], s89 offen lds
    ds_read_b64_tr_b16 v[68:69], v38 offset:8192
    ds_read_b64_tr_b16 v[70:71], v39 offset:8192
    v_mfma_f32_32x32x16_bf16 a[32:47], v[72:75], v[60:63], a[32:47]
    v_mfma_f32_32x32x16_bf16 a[48:63], v[76:79], v[60:63], a[48:63]
    s_waitcnt lgkmcnt(0)
    v_mfma_f32_32x32x16_bf16 a[0:15], v[64:67], v[48:51], a[0:15]
    ds_read_b128 v[56:59], v23 offset:0
    ds_read_b64_tr_b16 v[72:73], v36 offset:12288
    s_add_u32 m0, s94, 2048
    s_nop 0
    buffer_load_dwordx4 v14, s[84:87], s89 offen lds
    ds_read_b64_tr_b16 v[74:75], v37 offset:12288
    ds_read_b128 v[60:63], v23 offset:4096
    v_mfma_f32_32x32x16_bf16 a[16:31], v[68:71], v[48:51], a[16:31]
    s_add_u32 m0, s94, 3072
    s_nop 0
    buffer_load_dwordx4 v15, s[84:87], s89 offen lds
    ds_read_b64_tr_b16 v[76:77], v38 offset:12288
    ds_read_b64_tr_b16 v[78:79], v39 offset:12288
    s_add_u32 s88, s88, s90
    s_add_u32 s89, s89, s91
    v_mfma_f32_32x32x16_bf16 a[32:47], v[64:67], v[52:55], a[32:47]
    v_mfma_f32_32x32x16_bf16 a[48:63], v[68:71], v[52:55], a[48:63]
    s_waitcnt lgkmcnt(0)
    s_waitcnt vmcnt(16)
    s_barrier
    v_mfma_f32_32x32x16_bf16 a[0:15], v[72:75], v[56:59], a[0:15]
    ds_read_b128 v[48:51], v24 offset:0
    ds_read_b64_tr_b16 v[64:65], v40 offset:0
    s_add_u32 m0, s93, 32768
    s_nop 0
    buffer_load_dwordx4 v8, s[80:83], s88 offen sc1 lds
    ds_read_b64_tr_b16 v[66:67], v41 offset:0
    v_mfma_f32_32x32x16_bf16 a[16:31], v[76:79], v[56:59], a[16:31]
    ds_read_b128 v[52:55], v24 offset:4096
    s_add_u32 m0, s93, 33792
    s_nop 0
    buffer_load_dwordx4 v9, s[80:83], s88 offen sc1 lds
    ds_read_b64_tr_b16 v[68:69], v42 offset:0
    ds_read_b64_tr_b16 v[70:71], v43 offset:0
    v_mfma_f32_32x32x16_bf16 a[32:47], v[72:75], v[60:63], a[32:47]
    v_mfma_f32_32x32x16_bf16 a[48:63], v[76:79], v[60:63], a[48:63]
    s_waitcnt lgkmcnt(0)
    v_mfma_f32_32x32x16_bf16 a[0:15], v[64:67], v[48:51], a[0:15]
    ds_read_b128 v[56:59], v25 offset:0
    ds_read_b64_tr_b16 v[72:73], v40 offset:4096
    s_add_u32 m0, s93, 34816
    s_nop 0
    buffer_load_dwordx4 v10, s[80:83], s88 offen sc1 lds
    ds_read_b64_tr_b16 v[74:75], v41 offset:4096
    v_mfma_f32_32x32x16_bf16 a[16:31], v[68:71], v[48:51], a[16:31]
    ds_read_b128 v[60:63], v25 offset:4096
    s_add_u32 m0, s93, 35840
    s_nop 0
    buffer_load_dwordx4 v11, s[80:83], s88 offen sc1 lds
    ds_read_b64_tr_b16 v[76:77], v42 offset:4096
    ds_read_b64_tr_b16 v[78:79], v43 offset:4096
    v_mfma_f32_32x32x16_bf16 a[32:47], v[64:67], v[52:55], a[32:47]
    v_mfma_f32_32x32x16_bf16 a[48:63], v[68:71], v[52:55], a[48:63]
    s_waitcnt lgkmcnt(0)
    v_mfma_f32_32x32x16_bf16 a[0:15], v[72:75], v[56:59], a[0:15]
    ds_read_b128 v[48:51], v26 offset:0
    ds_read_b64_tr_b16 v[64:65], v40 offset:8192
    s_add_u32 m0, s94, 32768
    s_nop 0
    buffer_load_dwordx4 v12, s[84:87], s89 offen lds
    ds_read_b64_tr_b16 v[66:67], v41 offset:8192
    v_mfma_f32_32x32x16_bf16 a[16:31], v[76:79], v[56:59], a[16:31]
    ds_read_b128 v[52:55], v26 offset:4096
    s_add_u32 m0, s94, 33792
    s_nop 0
    buffer_load_dwordx4 v13, s[84:87], s89 offen lds
    ds_read_b64_tr_b16 v[68:69], v42 offset:8192
    ds_read_b64_tr_b16 v[70:71], v43 offset:8192
    v_mfma_f32_32x32x16_bf16 a[32:47], v[72:75], v[60:63], a[32:47]
    v_mfma_f32_32x32x16_bf16 a[48:63], v[76:79], v[60:63], a[48:63]
    s_waitcnt lgkmcnt(0)
    v_mfma_f32_32x32x16_bf16 a[0:15], v[64:67], v[48:51], a[0:15]
    ds_read_b128 v[56:59], v27 offset:0
    ds_read_b64_tr_b16 v[72:73], v40 offset:12288
    s_add_u32 m0, s94, 34816
    s_nop 0
    buffer_load_dwordx4 v14, s[84:87], s89 offen lds
    ds_read_b64_tr_b16 v[74:75], v41 offset:12288
    ds_read_b128 v[60:63], v27 offset:4096
    v_mfma_f32_32x32x16_bf16 a[16:31], v[68:71], v[48:51], a[16:31]
    s_add_u32 m0, s94, 35840
    s_nop 0
    buffer_load_dwordx4 v15, s[84:87], s89 offen lds
    ds_read_b64_tr_b16 v[76:77], v42 offset:12288
    ds_read_b64_tr_b16 v[78:79], v43 offset:12288
    s_add_u32 s88, s88, s90
    s_add_u32 s89, s89, s91
    v_mfma_f32_32x32x16_bf16 a[32:47], v[64:67], v[52:55], a[32:47]
    v_mfma_f32_32x32x16_bf16 a[48:63], v[68:71], v[52:55], a[48:63]
    s_waitcnt lgkmcnt(0)
    s_waitcnt vmcnt(16)
    s_barrier
    v_mfma_f32_32x32x16_bf16 a[0:15], v[72:75], v[56:59], a[0:15]
    ds_read_b128 v[48:51], v28 offset:0
    ds_read_b64_tr_b16 v[64:65], v44 offset:0
    s_add_u32 m0, s93, 65536
    s_nop 0
    buffer_load_dwordx4 v8, s[80:83], s88 offen sc1 lds
    ds_read_b64_tr_b16 v[66:67], v45 offset:0
    v_mfma_f32_32x32x16_bf16 a[16:31], v[76:79], v[56:59], a[16:31]
    ds_read_b128 v[52:55], v28 offset:4096
    s_add_u32 m0, s93, 66560
    s_nop 0
    buffer_load_dwordx4 v9, s[80:83], s88 offen sc1 lds
    ds_read_b64_tr_b16 v[68:69], v46 offset:0
    ds_read_b64_tr_b16 v[70:71], v47 offset:0
    v_mfma_f32_32x32x16_bf16 a[32:47], v[72:75], v[60:63], a[32:47]
    v_mfma_f32_32x32x16_bf16 a[48:63], v[76:79], v[60:63], a[48:63]
    s_waitcnt lgkmcnt(0)
    v_mfma_f32_32x32x16_bf16 a[0:15], v[64:67], v[48:51], a[0:15]
    ds_read_b128 v[56:59], v29 offset:0
    ds_read_b64_tr_b16 v[72:73], v44 offset:4096
    s_add_u32 m0, s93, 67584
    s_nop 0
    buffer_load_dwordx4 v10, s[80:83], s88 offen sc1 lds
    ds_read_b64_tr_b16 v[74:75], v45 offset:4096
    v_mfma_f32_32x32x16_bf16 a[16:31], v[68:71], v[48:51], a[16:31]
    ds_read_b128 v[60:63], v29 offset:4096
    s_add_u32 m0, s93, 68608
    s_nop 0
    buffer_load_dwordx4 v11, s[80:83], s88 offen sc1 lds
    ds_read_b64_tr_b16 v[76:77], v46 offset:4096
    ds_read_b64_tr_b16 v[78:79], v47 offset:4096
    v_mfma_f32_32x32x16_bf16 a[32:47], v[64:67], v[52:55], a[32:47]
    v_mfma_f32_32x32x16_bf16 a[48:63], v[68:71], v[52:55], a[48:63]
    s_waitcnt lgkmcnt(0)
    v_mfma_f32_32x32x16_bf16 a[0:15], v[72:75], v[56:59], a[0:15]
    ds_read_b128 v[48:51], v30 offset:0
    ds_read_b64_tr_b16 v[64:65], v44 offset:8192
    s_add_u32 m0, s94, 65536
    s_nop 0
    buffer_load_dwordx4 v12, s[84:87], s89 offen lds
    ds_read_b64_tr_b16 v[66:67], v45 offset:8192
    v_mfma_f32_32x32x16_bf16 a[16:31], v[76:79], v[56:59], a[16:31]
    ds_read_b128 v[52:55], v30 offset:4096
    s_add_u32 m0, s94, 66560
    s_nop 0
    buffer_load_dwordx4 v13, s[84:87], s89 offen lds
    ds_read_b64_tr_b16 v[68:69], v46 offset:8192
    ds_read_b64_tr_b16 v[70:71], v47 offset:8192
    v_mfma_f32_32x32x16_bf16 a[32:47], v[72:75], v[60:63], a[32:47]
    v_mfma_f32_32x32x16_bf16 a[48:63], v[76:79], v[60:63], a[48:63]
    s_waitcnt lgkmcnt(0)
    v_mfma_f32_32x32x16_bf16 a[0:15], v[64:67], v[48:51], a[0:15]
    ds_read_b128 v[56:59], v31 offset:0
    ds_read_b64_tr_b16 v[72:73], v44 offset:12288
    s_add_u32 m0, s94, 67584
    s_nop 0
    buffer_load_dwordx4 v14, s[84:87], s89 offen lds
    ds_read_b64_tr_b16 v[74:75], v45 offset:12288
    ds_read_b128 v[60:63], v31 offset:4096
    v_mfma_f32_32x32x16_bf16 a[16:31], v[68:71], v[48:51], a[16:31]
    s_add_u32 m0, s94, 68608
    s_nop 0
    buffer_load_dwordx4 v15, s[84:87], s89 offen lds
    ds_read_b64_tr_b16 v[76:77], v46 offset:12288
    ds_read_b64_tr_b16 v[78:79], v47 offset:12288
    s_add_u32 s88, s88, s90
    s_add_u32 s89, s89, s91
    v_mfma_f32_32x32x16_bf16 a[32:47], v[64:67], v[52:55], a[32:47]
    v_mfma_f32_32x32x16_bf16 a[48:63], v[68:71], v[52:55], a[48:63]
    s_waitcnt lgkmcnt(0)
    s_waitcnt vmcnt(16)
    s_barrier
    v_mfma_f32_32x32x16_bf16 a[0:15], v[72:75], v[56:59], a[0:15]
    ds_read_b128 v[48:51], v16 offset:0
    ds_read_b64_tr_b16 v[64:65], v32 offset:0
    s_add_u32 m0, s93, 98304
    s_nop 0
    buffer_load_dwordx4 v8, s[80:83], s88 offen sc1 lds
    ds_read_b64_tr_b16 v[66:67], v33 offset:0
    v_mfma_f32_32x32x16_bf16 a[16:31], v[76:79], v[56:59], a[16:31]
    ds_read_b128 v[52:55], v16 offset:4096
    s_add_u32 m0, s93, 99328
    s_nop 0
    buffer_load_dwordx4 v9, s[80:83], s88 offen sc1 lds
    ds_read_b64_tr_b16 v[68:69], v34 offset:0
    ds_read_b64_tr_b16 v[70:71], v35 offset:0
    v_mfma_f32_32x32x16_bf16 a[32:47], v[72:75], v[60:63], a[32:47]
    v_mfma_f32_32x32x16_bf16 a[48:63], v[76:79], v[60:63], a[48:63]
    s_sub_u32 s92, s92, 1
    s_cmp_eq_u32 s92, 0
    s_cbranch_scc1 gxst_172
glst_171:
    s_waitcnt lgkmcnt(0)
    v_mfma_f32_32x32x16_bf16 a[0:15], v[64:67], v[48:51], a[0:15]
    ds_read_b128 v[56:59], v17 offset:0
    ds_read_b64_tr_b16 v[72:73], v32 offset:4096
    s_add_u32 m0, s93, 100352
    s_nop 0
    buffer_load_dwordx4 v10, s[80:83], s88 offen sc1 lds
    ds_read_b64_tr_b16 v[74:75], v33 offset:4096
    v_mfma_f32_32x32x16_bf16 a[16:31], v[68:71], v[48:51], a[16:31]
    ds_read_b128 v[60:63], v17 offset:4096
    s_add_u32 m0, s93, 101376
    s_nop 0
    buffer_load_dwordx4 v11, s[80:83], s88 offen sc1 lds
    ds_read_b64_tr_b16 v[76:77], v34 offset:4096
    ds_read_b64_tr_b16 v[78:79], v35 offset:4096
    v_mfma_f32_32x32x16_bf16 a[32:47], v[64:67], v[52:55], a[32:47]
    v_mfma_f32_32x32x16_bf16 a[48:63], v[68:71], v[52:55], a[48:63]
    s_waitcnt lgkmcnt(0)
    v_mfma_f32_32x32x16_bf16 a[0:15], v[72:75], v[56:59], a[0:15]
    ds_read_b128 v[48:51], v18 offset:0
    ds_read_b64_tr_b16 v[64:65], v32 offset:8192
    s_add_u32 m0, s94, 98304
    s_nop 0
    buffer_load_dwordx4 v12, s[84:87], s89 offen lds
    ds_read_b64_tr_b16 v[66:67], v33 offset:8192
    v_mfma_f32_32x32x16_bf16 a[16:31], v[76:79], v[56:59], a[16:31]
    ds_read_b128 v[52:55], v18 offset:4096
    s_add_u32 m0, s94, 99328
    s_nop 0
    buffer_load_dwordx4 v13, s[84:87], s89 offen lds
    ds_read_b64_tr_b16 v[68:69], v34 offset:8192
    ds_read_b64_tr_b16 v[70:71], v35 offset:8192
    v_mfma_f32_32x32x16_bf16 a[32:47], v[72:75], v[60:63], a[32:47]
    v_mfma_f32_32x32x16_bf16 a[48:63], v[76:79], v[60:63], a[48:63]
    s_waitcnt lgkmcnt(0)
    v_mfma_f32_32x32x16_bf16 a[0:15], v[64:67], v[48:51], a[0:15]
    ds_read_b128 v[56:59], v19 offset:0
    ds_read_b64_tr_b16 v[72:73], v32 offset:12288
    s_add_u32 m0, s94, 100352
    s_nop 0
    buffer_load_dwordx4 v14, s[84:87], s89 offen lds
    ds_read_b64_tr_b16 v[74:75], v33 offset:12288
    ds_read_b128 v[60:63], v19 offset:4096
    v_mfma_f32_32x32x16_bf16 a[16:31], v[68:71], v[48:51], a[16:31]
    s_add_u32 m0, s94, 101376
    s_nop 0
    buffer_load_dwordx4 v15, s[84:87], s89 offen lds
    ds_read_b64_tr_b16 v[76:77], v34 offset:12288
    ds_read_b64_tr_b16 v[78:79], v35 offset:12288
    s_add_u32 s88, s88, s90
    s_add_u32 s89, s89, s91
    v_mfma_f32_32x32x16_bf16 a[32:47], v[64:67], v[52:55], a[32:47]
    v_mfma_f32_32x32x16_bf16 a[48:63], v[68:71], v[52:55], a[48:63]
    s_waitcnt lgkmcnt(0)
    s_waitcnt vmcnt(16)
    s_barrier
    v_mfma_f32_32x32x16_bf16 a[0:15], v[72:75], v[56:59], a[0:15]
    ds_read_b128 v[48:51], v20 offset:0
    ds_read_b64_tr_b16 v[64:65], v36 offset:0
    s_add_u32 m0, s93, 0
    s_nop 0
    buffer_load_dwordx4 v8, s[80:83], s88 offen sc1 lds
    ds_read_b64_tr_b16 v[66:67], v37 offset:0
    v_mfma_f32_32x32x16_bf16 a[16:31], v[76:79], v[56:59], a[16:31]
    ds_read_b128 v[52:55], v20 offset:4096
    s_add_u32 m0, s93, 1024
    s_nop 0
    buffer_load_dwordx4 v9, s[80:83], s88 offen sc1 lds
    ds_read_b64_tr_b16 v[68:69], v38 offset:0
    ds_read_b64_tr_b16 v[70:71], v39 offset:0
    v_mfma_f32_32x32x16_bf16 a[32:47], v[72:75], v[60:63], a[32:47]
    v_mfma_f32_32x32x16_bf16 a[48:63], v[76:79], v[60:63], a[48:63]
    s_waitcnt lgkmcnt(0)
    v_mfma_f32_32x32x16_bf16 a[0:15], v[64:67], v[48:51], a[0:15]
    ds_read_b128 v[56:59], v21 offset:0
    ds_read_b64_tr_b16 v[72:73], v36 offset:4096
    s_add_u32 m0, s93, 2048
    s_nop 0
    buffer_load_dwordx4 v10, s[80:83], s88 offen sc1 lds
    ds_read_b64_tr_b16 v[74:75], v37 offset:4096
    v_mfma_f32_32x32x16_bf16 a[16:31], v[68:71], v[48:51], a[16:31]
    ds_read_b128 v[60:63], v21 offset:4096
    s_add_u32 m0, s93, 3072
    s_nop 0
    buffer_load_dwordx4 v11, s[80:83], s88 offen sc1 lds
    ds_read_b64_tr_b16 v[76:77], v38 offset:4096
    ds_read_b64_tr_b16 v[78:79], v39 offset:4096
    v_mfma_f32_32x32x16_bf16 a[32:47], v[64:67], v[52:55], a[32:47]
    v_mfma_f32_32x32x16_bf16 a[48:63], v[68:71], v[52:55], a[48:63]
    s_waitcnt lgkmcnt(0)
    v_mfma_f32_32x32x16_bf16 a[0:15], v[72:75], v[56:59], a[0:15]
    ds_read_b128 v[48:51], v22 offset:0
    ds_read_b64_tr_b16 v[64:65], v36 offset:8192
    s_add_u32 m0, s94, 0
    s_nop 0
    buffer_load_dwordx4 v12, s[84:87], s89 offen lds
    ds_read_b64_tr_b16 v[66:67], v37 offset:8192
    v_mfma_f32_32x32x16_bf16 a[16:31], v[76:79], v[56:59], a[16:31]
    ds_read_b128 v[52:55], v22 offset:4096
    s_add_u32 m0, s94, 1024
    s_nop 0
    buffer_load_dwordx4 v13, s[84:87], s89 offen lds
    ds_read_b64_tr_b16 v[68:69], v38 offset:8192
    ds_read_b64_tr_b16 v[70:71], v39 offset:8192
    v_mfma_f32_32x32x16_bf16 a[32:47], v[72:75], v[60:63], a[32:47]
    v_mfma_f32_32x32x16_bf16 a[48:63], v[76:79], v[60:63], a[48:63]
    s_waitcnt lgkmcnt(0)
    v_mfma_f32_32x32x16_bf16 a[0:15], v[64:67], v[48:51], a[0:15]
    ds_read_b128 v[56:59], v23 offset:0
    ds_read_b64_tr_b16 v[72:73], v36 offset:12288
    s_add_u32 m0, s94, 2048
    s_nop 0
    buffer_load_dwordx4 v14, s[84:87], s89 offen lds
    ds_read_b64_tr_b16 v[74:75], v37 offset:12288
    ds_read_b128 v[60:63], v23 offset:4096
    v_mfma_f32_32x32x16_bf16 a[16:31], v[68:71], v[48:51], a[16:31]
    s_add_u32 m0, s94, 3072
    s_nop 0
    buffer_load_dwordx4 v15, s[84:87], s89 offen lds
    ds_read_b64_tr_b16 v[76:77], v38 offset:12288
    ds_read_b64_tr_b16 v[78:79], v39 offset:12288
    s_add_u32 s88, s88, s90
    s_add_u32 s89, s89, s91
    v_mfma_f32_32x32x16_bf16 a[32:47], v[64:67], v[52:55], a[32:47]
    v_mfma_f32_32x32x16_bf16 a[48:63], v[68:71], v[52:55], a[48:63]
    s_waitcnt lgkmcnt(0)
    s_waitcnt vmcnt(16)
    s_barrier
    v_mfma_f32_32x32x16_bf16 a[0:15], v[72:75], v[56:59], a[0:15]
    ds_read_b128 v[48:51], v24 offset:0
    ds_read_b64_tr_b16 v[64:65], v40 offset:0
    s_add_u32 m0, s93, 32768
    s_nop 0
    buffer_load_dwordx4 v8, s[80:83], s88 offen sc1 lds
    ds_read_b64_tr_b16 v[66:67], v41 offset:0
    v_mfma_f32_32x32x16_bf16 a[16:31], v[76:79], v[56:59], a[16:31]
    ds_read_b128 v[52:55], v24 offset:4096
    s_add_u32 m0, s93, 33792
    s_nop 0
    buffer_load_dwordx4 v9, s[80:83], s88 offen sc1 lds
    ds_read_b64_tr_b16 v[68:69], v42 offset:0
    ds_read_b64_tr_b16 v[70:71], v43 offset:0
    v_mfma_f32_32x32x16_bf16 a[32:47], v[72:75], v[60:63], a[32:47]
    v_mfma_f32_32x32x16_bf16 a[48:63], v[76:79], v[60:63], a[48:63]
    s_waitcnt lgkmcnt(0)
    v_mfma_f32_32x32x16_bf16 a[0:15], v[64:67], v[48:51], a[0:15]
    ds_read_b128 v[56:59], v25 offset:0
    ds_read_b64_tr_b16 v[72:73], v40 offset:4096
    s_add_u32 m0, s93, 34816
    s_nop 0
    buffer_load_dwordx4 v10, s[80:83], s88 offen sc1 lds
    ds_read_b64_tr_b16 v[74:75], v41 offset:4096
    v_mfma_f32_32x32x16_bf16 a[16:31], v[68:71], v[48:51], a[16:31]
    ds_read_b128 v[60:63], v25 offset:4096
    s_add_u32 m0, s93, 35840
    s_nop 0
    buffer_load_dwordx4 v11, s[80:83], s88 offen sc1 lds
    ds_read_b64_tr_b16 v[76:77], v42 offset:4096
    ds_read_b64_tr_b16 v[78:79], v43 offset:4096
    v_mfma_f32_32x32x16_bf16 a[32:47], v[64:67], v[52:55], a[32:47]
    v_mfma_f32_32x32x16_bf16 a[48:63], v[68:71], v[52:55], a[48:63]
    s_waitcnt lgkmcnt(0)
    v_mfma_f32_32x32x16_bf16 a[0:15], v[72:75], v[56:59], a[0:15]
    ds_read_b128 v[48:51], v26 offset:0
    ds_read_b64_tr_b16 v[64:65], v40 offset:8192
    s_add_u32 m0, s94, 32768
    s_nop 0
    buffer_load_dwordx4 v12, s[84:87], s89 offen lds
    ds_read_b64_tr_b16 v[66:67], v41 offset:8192
    v_mfma_f32_32x32x16_bf16 a[16:31], v[76:79], v[56:59], a[16:31]
    ds_read_b128 v[52:55], v26 offset:4096
    s_add_u32 m0, s94, 33792
    s_nop 0
    buffer_load_dwordx4 v13, s[84:87], s89 offen lds
    ds_read_b64_tr_b16 v[68:69], v42 offset:8192
    ds_read_b64_tr_b16 v[70:71], v43 offset:8192
    v_mfma_f32_32x32x16_bf16 a[32:47], v[72:75], v[60:63], a[32:47]
    v_mfma_f32_32x32x16_bf16 a[48:63], v[76:79], v[60:63], a[48:63]
    s_waitcnt lgkmcnt(0)
    v_mfma_f32_32x32x16_bf16 a[0:15], v[64:67], v[48:51], a[0:15]
    ds_read_b128 v[56:59], v27 offset:0
    ds_read_b64_tr_b16 v[72:73], v40 offset:12288
    s_add_u32 m0, s94, 34816
    s_nop 0
    buffer_load_dwordx4 v14, s[84:87], s89 offen lds
    ds_read_b64_tr_b16 v[74:75], v41 offset:12288
    ds_read_b128 v[60:63], v27 offset:4096
    v_mfma_f32_32x32x16_bf16 a[16:31], v[68:71], v[48:51], a[16:31]
    s_add_u32 m0, s94, 35840
    s_nop 0
    buffer_load_dwordx4 v15, s[84:87], s89 offen lds
    ds_read_b64_tr_b16 v[76:77], v42 offset:12288
    ds_read_b64_tr_b16 v[78:79], v43 offset:12288
    s_add_u32 s88, s88, s90
    s_add_u32 s89, s89, s91
    v_mfma_f32_32x32x16_bf16 a[32:47], v[64:67], v[52:55], a[32:47]
    v_mfma_f32_32x32x16_bf16 a[48:63], v[68:71], v[52:55], a[48:63]
    s_waitcnt lgkmcnt(0)
    s_waitcnt vmcnt(16)
    s_barrier
    v_mfma_f32_32x32x16_bf16 a[0:15], v[72:75], v[56:59], a[0:15]
    ds_read_b128 v[48:51], v28 offset:0
    ds_read_b64_tr_b16 v[64:65], v44 offset:0
    s_add_u32 m0, s93, 65536
    s_nop 0
    buffer_load_dwordx4 v8, s[80:83], s88 offen sc1 lds
    ds_read_b64_tr_b16 v[66:67], v45 offset:0
    v_mfma_f32_32x32x16_bf16 a[16:31], v[76:79], v[56:59], a[16:31]
    ds_read_b128 v[52:55], v28 offset:4096
    s_add_u32 m0, s93, 66560
    s_nop 0
    buffer_load_dwordx4 v9, s[80:83], s88 offen sc1 lds
    ds_read_b64_tr_b16 v[68:69], v46 offset:0
    ds_read_b64_tr_b16 v[70:71], v47 offset:0
    v_mfma_f32_32x32x16_bf16 a[32:47], v[72:75], v[60:63], a[32:47]
    v_mfma_f32_32x32x16_bf16 a[48:63], v[76:79], v[60:63], a[48:63]
    s_waitcnt lgkmcnt(0)
    v_mfma_f32_32x32x16_bf16 a[0:15], v[64:67], v[48:51], a[0:15]
    ds_read_b128 v[56:59], v29 offset:0
    ds_read_b64_tr_b16 v[72:73], v44 offset:4096
    s_add_u32 m0, s93, 67584
    s_nop 0
    buffer_load_dwordx4 v10, s[80:83], s88 offen sc1 lds
    ds_read_b64_tr_b16 v[74:75], v45 offset:4096
    v_mfma_f32_32x32x16_bf16 a[16:31], v[68:71], v[48:51], a[16:31]
    ds_read_b128 v[60:63], v29 offset:4096
    s_add_u32 m0, s93, 68608
    s_nop 0
    buffer_load_dwordx4 v11, s[80:83], s88 offen sc1 lds
    ds_read_b64_tr_b16 v[76:77], v46 offset:4096
    ds_read_b64_tr_b16 v[78:79], v47 offset:4096
    v_mfma_f32_32x32x16_bf16 a[32:47], v[64:67], v[52:55], a[32:47]
    v_mfma_f32_32x32x16_bf16 a[48:63], v[68:71], v[52:55], a[48:63]
    s_waitcnt lgkmcnt(0)
    v_mfma_f32_32x32x16_bf16 a[0:15], v[72:75], v[56:59], a[0:15]
    ds_read_b128 v[48:51], v30 offset:0
    ds_read_b64_tr_b16 v[64:65], v44 offset:8192
    s_add_u32 m0, s94, 65536
    s_nop 0
    buffer_load_dwordx4 v12, s[84:87], s89 offen lds
    ds_read_b64_tr_b16 v[66:67], v45 offset:8192
    v_mfma_f32_32x32x16_bf16 a[16:31], v[76:79], v[56:59], a[16:31]
    ds_read_b128 v[52:55], v30 offset:4096
    s_add_u32 m0, s94, 66560
    s_nop 0
    buffer_load_dwordx4 v13, s[84:87], s89 offen lds
    ds_read_b64_tr_b16 v[68:69], v46 offset:8192
    ds_read_b64_tr_b16 v[70:71], v47 offset:8192
    v_mfma_f32_32x32x16_bf16 a[32:47], v[72:75], v[60:63], a[32:47]
    v_mfma_f32_32x32x16_bf16 a[48:63], v[76:79], v[60:63], a[48:63]
    s_waitcnt lgkmcnt(0)
    v_mfma_f32_32x32x16_bf16 a[0:15], v[64:67], v[48:51], a[0:15]
    ds_read_b128 v[56:59], v31 offset:0
    ds_read_b64_tr_b16 v[72:73], v44 offset:12288
    s_add_u32 m0, s94, 67584
    s_nop 0
    buffer_load_dwordx4 v14, s[84:87], s89 offen lds
    ds_read_b64_tr_b16 v[74:75], v45 offset:12288
    ds_read_b128 v[60:63], v31 offset:4096
    v_mfma_f32_32x32x16_bf16 a[16:31], v[68:71], v[48:51], a[16:31]
    s_add_u32 m0, s94, 68608
    s_nop 0
    buffer_load_dwordx4 v15, s[84:87], s89 offen lds
    ds_read_b64_tr_b16 v[76:77], v46 offset:12288
    ds_read_b64_tr_b16 v[78:79], v47 offset:12288
    s_add_u32 s88, s88, s90
    s_add_u32 s89, s89, s91
    v_mfma_f32_32x32x16_bf16 a[32:47], v[64:67], v[52:55], a[32:47]
    v_mfma_f32_32x32x16_bf16 a[48:63], v[68:71], v[52:55], a[48:63]
    s_waitcnt lgkmcnt(0)
    s_waitcnt vmcnt(16)
    s_barrier
    v_mfma_f32_32x32x16_bf16 a[0:15], v[72:75], v[56:59], a[0:15]
    ds_read_b128 v[48:51], v16 offset:0
    ds_read_b64_tr_b16 v[64:65], v32 offset:0
    s_add_u32 m0, s93, 98304
    s_nop 0
    buffer_load_dwordx4 v8, s[80:83], s88 offen sc1 lds
    ds_read_b64_tr_b16 v[66:67], v33 offset:0
    v_mfma_f32_32x32x16_bf16 a[16:31], v[76:79], v[56:59], a[16:31]
    ds_read_b128 v[52:55], v16 offset:4096
    s_add_u32 m0, s93, 99328
    s_nop 0
    buffer_load_dwordx4 v9, s[80:83], s88 offen sc1 lds
    ds_read_b64_tr_b16 v[68:69], v34 offset:0
    ds_read_b64_tr_b16 v[70:71], v35 offset:0
    v_mfma_f32_32x32x16_bf16 a[32:47], v[72:75], v[60:63], a[32:47]
    v_mfma_f32_32x32x16_bf16 a[48:63], v[76:79], v[60:63], a[48:63]
    s_sub_u32 s92, s92, 1
    s_cmp_lg_u32 s92, 0
    s_cbranch_scc1 glst_171
gxst_172:
    s_waitcnt lgkmcnt(0)
    v_mfma_f32_32x32x16_bf16 a[0:15], v[64:67], v[48:51], a[0:15]
    ds_read_b128 v[56:59], v17 offset:0
    ds_read_b64_tr_b16 v[72:73], v32 offset:4096
    s_add_u32 m0, s93, 100352
    s_nop 0
    buffer_load_dwordx4 v10, s[80:83], s88 offen sc1 lds
    ds_read_b64_tr_b16 v[74:75], v33 offset:4096
    v_mfma_f32_32x32x16_bf16 a[16:31], v[68:71], v[48:51], a[16:31]
    ds_read_b128 v[60:63], v17 offset:4096
    s_add_u32 m0, s93, 101376
    s_nop 0
    buffer_load_dwordx4 v11, s[80:83], s88 offen sc1 lds
    ds_read_b64_tr_b16 v[76:77], v34 offset:4096
    ds_read_b64_tr_b16 v[78:79], v35 offset:4096
    v_mfma_f32_32x32x16_bf16 a[32:47], v[64:67], v[52:55], a[32:47]
    v_mfma_f32_32x32x16_bf16 a[48:63], v[68:71], v[52:55], a[48:63]
    s_waitcnt lgkmcnt(0)
    v_mfma_f32_32x32x16_bf16 a[0:15], v[72:75], v[56:59], a[0:15]
    ds_read_b128 v[48:51], v18 offset:0
    ds_read_b64_tr_b16 v[64:65], v32 offset:8192
    s_add_u32 m0, s94, 98304
    s_nop 0
    buffer_load_dwordx4 v12, s[84:87], s89 offen lds
    ds_read_b64_tr_b16 v[66:67], v33 offset:8192
    v_mfma_f32_32x32x16_bf16 a[16:31], v[76:79], v[56:59], a[16:31]
    ds_read_b128 v[52:55], v18 offset:4096
    s_add_u32 m0, s94, 99328
    s_nop 0
    buffer_load_dwordx4 v13, s[84:87], s89 offen lds
    ds_read_b64_tr_b16 v[68:69], v34 offset:8192
    ds_read_b64_tr_b16 v[70:71], v35 offset:8192
    v_mfma_f32_32x32x16_bf16 a[32:47], v[72:75], v[60:63], a[32:47]
    v_mfma_f32_32x32x16_bf16 a[48:63], v[76:79], v[60:63], a[48:63]
    s_waitcnt lgkmcnt(0)
    v_mfma_f32_32x32x16_bf16 a[0:15], v[64:67], v[48:51], a[0:15]
    ds_read_b128 v[56:59], v19 offset:0
    ds_read_b64_tr_b16 v[72:73], v32 offset:12288
    s_add_u32 m0, s94, 100352
    s_nop 0
    buffer_load_dwordx4 v14, s[84:87], s89 offen lds
    ds_read_b64_tr_b16 v[74:75], v33 offset:12288
    ds_read_b128 v[60:63], v19 offset:4096
    v_mfma_f32_32x32x16_bf16 a[16:31], v[68:71], v[48:51], a[16:31]
    s_add_u32 m0, s94, 101376
    s_nop 0
    buffer_load_dwordx4 v15, s[84:87], s89 offen lds
    ds_read_b64_tr_b16 v[76:77], v34 offset:12288
    ds_read_b64_tr_b16 v[78:79], v35 offset:12288
    s_add_u32 s88, s88, s90
    s_add_u32 s89, s89, s91
    v_mfma_f32_32x32x16_bf16 a[32:47], v[64:67], v[52:55], a[32:47]
    v_mfma_f32_32x32x16_bf16 a[48:63], v[68:71], v[52:55], a[48:63]
    s_waitcnt lgkmcnt(0)
    s_waitcnt vmcnt(16)
    s_barrier
    v_mfma_f32_32x32x16_bf16 a[0:15], v[72:75], v[56:59], a[0:15]
    ds_read_b128 v[48:51], v20 offset:0
    ds_read_b64_tr_b16 v[64:65], v36 offset:0
    ds_read_b64_tr_b16 v[66:67], v37 offset:0
    v_mfma_f32_32x32x16_bf16 a[16:31], v[76:79], v[56:59], a[16:31]
    ds_read_b128 v[52:55], v20 offset:4096
    ds_read_b64_tr_b16 v[68:69], v38 offset:0
    ds_read_b64_tr_b16 v[70:71], v39 offset:0
    v_mfma_f32_32x32x16_bf16 a[32:47], v[72:75], v[60:63], a[32:47]
    v_mfma_f32_32x32x16_bf16 a[48:63], v[76:79], v[60:63], a[48:63]
    s_waitcnt lgkmcnt(0)
    v_mfma_f32_32x32x16_bf16 a[0:15], v[64:67], v[48:51], a[0:15]
    ds_read_b128 v[56:59], v21 offset:0
    ds_read_b64_tr_b16 v[72:73], v36 offset:4096
    ds_read_b64_tr_b16 v[74:75], v37 offset:4096
    v_mfma_f32_32x32x16_bf16 a[16:31], v[68:71], v[48:51], a[16:31]
    ds_read_b128 v[60:63], v21 offset:4096
    ds_read_b64_tr_b16 v[76:77], v38 offset:4096
    ds_read_b64_tr_b16 v[78:79], v39 offset:4096
    v_mfma_f32_32x32x16_bf16 a[32:47], v[64:67], v[52:55], a[32:47]
    v_mfma_f32_32x32x16_bf16 a[48:63], v[68:71], v[52:55], a[48:63]
    s_waitcnt lgkmcnt(0)
    v_mfma_f32_32x32x16_bf16 a[0:15], v[72:75], v[56:59], a[0:15]
    ds_read_b128 v[48:51], v22 offset:0
    ds_read_b64_tr_b16 v[64:65], v36 offset:8192
    ds_read_b64_tr_b16 v[66:67], v37 offset:8192
    v_mfma_f32_32x32x16_bf16 a[16:31], v[76:79], v[56:59], a[16:31]
    ds_read_b128 v[52:55], v22 offset:4096
    ds_read_b64_tr_b16 v[68:69], v38 offset:8192
    ds_read_b64_tr_b16 v[70:71], v39 offset:8192
    v_mfma_f32_32x32x16_bf16 a[32:47], v[72:75], v[60:63], a[32:47]
    v_mfma_f32_32x32x16_bf16 a[48:63], v[76:79], v[60:63], a[48:63]
    s_waitcnt lgkmcnt(0)
    v_mfma_f32_32x32x16_bf16 a[0:15], v[64:67], v[48:51], a[0:15]
    ds_read_b128 v[56:59], v23 offset:0
    ds_read_b64_tr_b16 v[72:73], v36 offset:12288
    ds_read_b64_tr_b16 v[74:75], v37 offset:12288
    v_mfma_f32_32x32x16_bf16 a[16:31], v[68:71], v[48:51], a[16:31]
    ds_read_b128 v[60:63], v23 offset:4096
    ds_read_b64_tr_b16 v[76:77], v38 offset:12288
    ds_read_b64_tr_b16 v[78:79], v39 offset:12288
    v_mfma_f32_32x32x16_bf16 a[32:47], v[64:67], v[52:55], a[32:47]
    v_mfma_f32_32x32x16_bf16 a[48:63], v[68:71], v[52:55], a[48:63]
    s_waitcnt lgkmcnt(0)
    s_waitcnt vmcnt(8)
    s_barrier
    v_mfma_f32_32x32x16_bf16 a[0:15], v[72:75], v[56:59], a[0:15]
    ds_read_b128 v[48:51], v24 offset:0
    ds_read_b64_tr_b16 v[64:65], v40 offset:0
    ds_read_b64_tr_b16 v[66:67], v41 offset:0
    v_mfma_f32_32x32x16_bf16 a[16:31], v[76:79], v[56:59], a[16:31]
    ds_read_b128 v[52:55], v24 offset:4096
    ds_read_b64_tr_b16 v[68:69], v42 offset:0
    ds_read_b64_tr_b16 v[70:71], v43 offset:0
    v_mfma_f32_32x32x16_bf16 a[32:47], v[72:75], v[60:63], a[32:47]
    v_mfma_f32_32x32x16_bf16 a[48:63], v[76:79], v[60:63], a[48:63]
    s_waitcnt lgkmcnt(0)
    v_mfma_f32_32x32x16_bf16 a[0:15], v[64:67], v[48:51], a[0:15]
    ds_read_b128 v[56:59], v25 offset:0
    ds_read_b64_tr_b16 v[72:73], v40 offset:4096
    ds_read_b64_tr_b16 v[74:75], v41 offset:4096
    v_mfma_f32_32x32x16_bf16 a[16:31], v[68:71], v[48:51], a[16:31]
    ds_read_b128 v[60:63], v25 offset:4096
    ds_read_b64_tr_b16 v[76:77], v42 offset:4096
    ds_read_b64_tr_b16 v[78:79], v43 offset:4096
    v_mfma_f32_32x32x16_bf16 a[32:47], v[64:67], v[52:55], a[32:47]
    v_mfma_f32_32x32x16_bf16 a[48:63], v[68:71], v[52:55], a[48:63]
    s_waitcnt lgkmcnt(0)
    v_mfma_f32_32x32x16_bf16 a[0:15], v[72:75], v[56:59], a[0:15]
    ds_read_b128 v[48:51], v26 offset:0
    ds_read_b64_tr_b16 v[64:65], v40 offset:8192
    ds_read_b64_tr_b16 v[66:67], v41 offset:8192
    v_mfma_f32_32x32x16_bf16 a[16:31], v[76:79], v[56:59], a[16:31]
    ds_read_b128 v[52:55], v26 offset:4096
    ds_read_b64_tr_b16 v[68:69], v42 offset:8192
    ds_read_b64_tr_b16 v[70:71], v43 offset:8192
    v_mfma_f32_32x32x16_bf16 a[32:47], v[72:75], v[60:63], a[32:47]
    v_mfma_f32_32x32x16_bf16 a[48:63], v[76:79], v[60:63], a[48:63]
    s_waitcnt lgkmcnt(0)
    v_mfma_f32_32x32x16_bf16 a[0:15], v[64:67], v[48:51], a[0:15]
    ds_read_b128 v[56:59], v27 offset:0
    ds_read_b64_tr_b16 v[72:73], v40 offset:12288
    ds_read_b64_tr_b16 v[74:75], v41 offset:12288
    v_mfma_f32_32x32x16_bf16 a[16:31], v[68:71], v[48:51], a[16:31]
    ds_read_b128 v[60:63], v27 offset:4096
    ds_read_b64_tr_b16 v[76:77], v42 offset:12288
    ds_read_b64_tr_b16 v[78:79], v43 offset:12288
    v_mfma_f32_32x32x16_bf16 a[32:47], v[64:67], v[52:55], a[32:47]
    v_mfma_f32_32x32x16_bf16 a[48:63], v[68:71], v[52:55], a[48:63]
    s_waitcnt lgkmcnt(0)
    s_waitcnt vmcnt(0)
    s_barrier
    v_mfma_f32_32x32x16_bf16 a[0:15], v[72:75], v[56:59], a[0:15]
    ds_read_b128 v[48:51], v28 offset:0
    ds_read_b64_tr_b16 v[64:65], v44 offset:0
    ds_read_b64_tr_b16 v[66:67], v45 offset:0
    v_mfma_f32_32x32x16_bf16 a[16:31], v[76:79], v[56:59], a[16:31]
    ds_read_b128 v[52:55], v28 offset:4096
    ds_read_b64_tr_b16 v[68:69], v46 offset:0
    ds_read_b64_tr_b16 v[70:71], v47 offset:0
    v_mfma_f32_32x32x16_bf16 a[32:47], v[72:75], v[60:63], a[32:47]
    v_mfma_f32_32x32x16_bf16 a[48:63], v[76:79], v[60:63], a[48:63]
    s_waitcnt lgkmcnt(0)
    v_mfma_f32_32x32x16_bf16 a[0:15], v[64:67], v[48:51], a[0:15]
    ds_read_b128 v[56:59], v29 offset:0
    ds_read_b64_tr_b16 v[72:73], v44 offset:4096
    ds_read_b64_tr_b16 v[74:75], v45 offset:4096
    v_mfma_f32_32x32x16_bf16 a[16:31], v[68:71], v[48:51], a[16:31]
    ds_read_b128 v[60:63], v29 offset:4096
    ds_read_b64_tr_b16 v[76:77], v46 offset:4096
    ds_read_b64_tr_b16 v[78:79], v47 offset:4096
    v_mfma_f32_32x32x16_bf16 a[32:47], v[64:67], v[52:55], a[32:47]
    v_mfma_f32_32x32x16_bf16 a[48:63], v[68:71], v[52:55], a[48:63]
    s_waitcnt lgkmcnt(0)
    v_mfma_f32_32x32x16_bf16 a[0:15], v[72:75], v[56:59], a[0:15]
    ds_read_b128 v[48:51], v30 offset:0
    ds_read_b64_tr_b16 v[64:65], v44 offset:8192
    ds_read_b64_tr_b16 v[66:67], v45 offset:8192
    v_mfma_f32_32x32x16_bf16 a[16:31], v[76:79], v[56:59], a[16:31]
    ds_read_b128 v[52:55], v30 offset:4096
    ds_read_b64_tr_b16 v[68:69], v46 offset:8192
    ds_read_b64_tr_b16 v[70:71], v47 offset:8192
    v_mfma_f32_32x32x16_bf16 a[32:47], v[72:75], v[60:63], a[32:47]
    v_mfma_f32_32x32x16_bf16 a[48:63], v[76:79], v[60:63], a[48:63]
    s_waitcnt lgkmcnt(0)
    v_mfma_f32_32x32x16_bf16 a[0:15], v[64:67], v[48:51], a[0:15]
    ds_read_b128 v[56:59], v31 offset:0
    ds_read_b64_tr_b16 v[72:73], v44 offset:12288
    ds_read_b64_tr_b16 v[74:75], v45 offset:12288
    v_mfma_f32_32x32x16_bf16 a[16:31], v[68:71], v[48:51], a[16:31]
    ds_read_b128 v[60:63], v31 offset:4096
    ds_read_b64_tr_b16 v[76:77], v46 offset:12288
    ds_read_b64_tr_b16 v[78:79], v47 offset:12288
    v_mfma_f32_32x32x16_bf16 a[32:47], v[64:67], v[52:55], a[32:47]
    v_mfma_f32_32x32x16_bf16 a[48:63], v[68:71], v[52:55], a[48:63]
    s_waitcnt lgkmcnt(0)
    v_mfma_f32_32x32x16_bf16 a[0:15], v[72:75], v[56:59], a[0:15]
    v_mfma_f32_32x32x16_bf16 a[16:31], v[76:79], v[56:59], a[16:31]
    v_mfma_f32_32x32x16_bf16 a[32:47], v[72:75], v[60:63], a[32:47]
    v_mfma_f32_32x32x16_bf16 a[48:63], v[76:79], v[60:63], a[48:63]
    s_nop 15
    s_cmp_eq_u32 s61, 1
    s_cbranch_scc1 sO_170
    s_branch sE_169
sN_168:
    s_waitcnt lgkmcnt(0)
    v_mfma_f32_32x32x16_bf16 a[0:15], v[48:51], v[64:67], 0
    ds_read_b128 v[56:59], v17 offset:0
    ds_read_b64_tr_b16 v[72:73], v32 offset:4096
    ds_read_b64_tr_b16 v[74:75], v33 offset:4096
    v_mfma_f32_32x32x16_bf16 a[16:31], v[48:51], v[68:71], 0
    ds_read_b128 v[60:63], v17 offset:4096
    ds_read_b64_tr_b16 v[76:77], v34 offset:4096
    ds_read_b64_tr_b16 v[78:79], v35 offset:4096
    v_mfma_f32_32x32x16_bf16 a[32:47], v[52:55], v[64:67], 0
    v_mfma_f32_32x32x16_bf16 a[48:63], v[52:55], v[68:71], 0
    s_waitcnt lgkmcnt(0)
    v_mfma_f32_32x32x16_bf16 a[0:15], v[56:59], v[72:75], a[0:15]
    ds_read_b128 v[48:51], v18 offset:0
    ds_read_b64_tr_b16 v[64:65], v32 offset:8192
    ds_read_b64_tr_b16 v[66:67], v33 offset:8192
    v_mfma_f32_32x32x16_bf16 a[16:31], v[56:59], v[76:79], a[16:31]
    ds_read_b128 v[52:55], v18 offset:4096
    ds_read_b64_tr_b16 v[68:69], v34 offset:8192
    ds_read_b64_tr_b16 v[70:71], v35 offset:8192
    v_mfma_f32_32x32x16_bf16 a[32:47], v[60:63], v[72:75], a[32:47]
    v_mfma_f32_32x32x16_bf16 a[48:63], v[60:63], v[76:79], a[48:63]
    s_waitcnt lgkmcnt(0)
    v_mfma_f32_32x32x16_bf16 a[0:15], v[48:51], v[64:67], a[0:15]
    ds_read_b128 v[56:59], v19 offset:0
    ds_read_b64_tr_b16 v[72:73], v32 offset:12288
    ds_read_b64_tr_b16 v[74:75], v33 offset:12288
    v_mfma_f32_32x32x16_bf16 a[16:31], v[48:51], v[68:71], a[16:31]
    ds_read_b128 v[60:63], v19 offset:4096
    ds_read_b64_tr_b16 v[76:77], v34 offset:12288
    ds_read_b64_tr_b16 v[78:79], v35 offset:12288
    v_mfma_f32_32x32x16_bf16 a[32:47], v[52:55], v[64:67], a[32:47]
    v_mfma_f32_32x32x16_bf16 a[48:63], v[52:55], v[68:71], a[48:63]
    s_waitcnt lgkmcnt(0)
    s_waitcnt vmcnt(16)
    s_barrier
    v_mfma_f32_32x32x16_bf16 a[0:15], v[56:59], v[72:75], a[0:15]
    ds_read_b128 v[48:51], v20 offset:0
    ds_read_b64_tr_b16 v[64:65], v36 offset:0
    s_add_u32 m0, s93, 0
    s_nop 0
    buffer_load_dwordx4 v8, s[80:83], s88 offen sc1 lds
    ds_read_b64_tr_b16 v[66:67], v37 offset:0
    v_mfma_f32_32x32x16_bf16 a[16:31], v[56:59], v[76:79], a[16:31]
    ds_read_b128 v[52:55], v20 offset:4096
    s_add_u32 m0, s93, 1024
    s_nop 0
    buffer_load_dwordx4 v9, s[80:83], s88 offen sc1 lds
    ds_read_b64_tr_b16 v[68:69], v38 offset:0
    ds_read_b64_tr_b16 v[70:71], v39 offset:0
    v_mfma_f32_32x32x16_bf16 a[32:47], v[60:63], v[72:75], a[32:47]
    v_mfma_f32_32x32x16_bf16 a[48:63], v[60:63], v[76:79], a[48:63]
    s_waitcnt lgkmcnt(0)
    v_mfma_f32_32x32x16_bf16 a[0:15], v[48:51], v[64:67], a[0:15]
    ds_read_b128 v[56:59], v21 offset:0
    ds_read_b64_tr_b16 v[72:73], v36 offset:4096
    s_add_u32 m0, s93, 2048
    s_nop 0
    buffer_load_dwordx4 v10, s[80:83], s88 offen sc1 lds
    ds_read_b64_tr_b16 v[74:75], v37 offset:4096
    v_mfma_f32_32x32x16_bf16 a[16:31], v[48:51], v[68:71], a[16:31]
    ds_read_b128 v[60:63], v21 offset:4096
    s_add_u32 m0, s93, 3072
    s_nop 0
    buffer_load_dwordx4 v11, s[80:83], s88 offen sc1 lds
    ds_read_b64_tr_b16 v[76:77], v38 offset:4096
    ds_read_b64_tr_b16 v[78:79], v39 offset:4096
    v_mfma_f32_32x32x16_bf16 a[32:47], v[52:55], v[64:67], a[32:47]
    v_mfma_f32_32x32x16_bf16 a[48:63], v[52:55], v[68:71], a[48:63]
    s_waitcnt lgkmcnt(0)
    v_mfma_f32_32x32x16_bf16 a[0:15], v[56:59], v[72:75], a[0:15]
    ds_read_b128 v[48:51], v22 offset:0
    ds_read_b64_tr_b16 v[64:65], v36 offset:8192
    s_add_u32 m0, s94, 0
    s_nop 0
    buffer_load_dwordx4 v12, s[84:87], s89 offen lds
    ds_read_b64_tr_b16 v[66:67], v37 offset:8192
    v_mfma_f32_32x32x16_bf16 a[16:31], v[56:59], v[76:79], a[16:31]
    ds_read_b128 v[52:55], v22 offset:4096
    s_add_u32 m0, s94, 1024
    s_nop 0
    buffer_load_dwordx4 v13, s[84:87], s89 offen lds
    ds_read_b64_tr_b16 v[68:69], v38 offset:8192
    ds_read_b64_tr_b16 v[70:71], v39 offset:8192
    v_mfma_f32_32x32x16_bf16 a[32:47], v[60:63], v[72:75], a[32:47]
    v_mfma_f32_32x32x16_bf16 a[48:63], v[60:63], v[76:79], a[48:63]
    s_waitcnt lgkmcnt(0)
    v_mfma_f32_32x32x16_bf16 a[0:15], v[48:51], v[64:67], a[0:15]
    ds_read_b128 v[56:59], v23 offset:0
    ds_read_b64_tr_b16 v[72:73], v36 offset:12288
    s_add_u32 m0, s94, 2048
    s_nop 0
    buffer_load_dwordx4 v14, s[84:87], s89 offen lds
    ds_read_b64_tr_b16 v[74:75], v37 offset:12288
    ds_read_b128 v[60:63], v23 offset:4096
    v_mfma_f32_32x32x16_bf16 a[16:31], v[48:51], v[68:71], a[16:31]
    s_add_u32 m0, s94, 3072
    s_nop 0
    buffer_load_dwordx4 v15, s[84:87], s89 offen lds
    ds_read_b64_tr_b16 v[76:77], v38 offset:12288
    ds_read_b64_tr_b16 v[78:79], v39 offset:12288
    s_add_u32 s88, s88, s90
    s_add_u32 s89, s89, s91
    v_mfma_f32_32x32x16_bf16 a[32:47], v[52:55], v[64:67], a[32:47]
    v_mfma_f32_32x32x16_bf16 a[48:63], v[52:55], v[68:71], a[48:63]
    s_waitcnt lgkmcnt(0)
    s_waitcnt vmcnt(16)
    s_barrier
    v_mfma_f32_32x32x16_bf16 a[0:15], v[56:59], v[72:75], a[0:15]
    ds_read_b128 v[48:51], v24 offset:0
    ds_read_b64_tr_b16 v[64:65], v40 offset:0
    s_add_u32 m0, s93, 32768
    s_nop 0
    buffer_load_dwordx4 v8, s[80:83], s88 offen sc1 lds
    ds_read_b64_tr_b16 v[66:67], v41 offset:0
    v_mfma_f32_32x32x16_bf16 a[16:31], v[56:59], v[76:79], a[16:31]
    ds_read_b128 v[52:55], v24 offset:4096
    s_add_u32 m0, s93, 33792
    s_nop 0
    buffer_load_dwordx4 v9, s[80:83], s88 offen sc1 lds
    ds_read_b64_tr_b16 v[68:69], v42 offset:0
    ds_read_b64_tr_b16 v[70:71], v43 offset:0
    v_mfma_f32_32x32x16_bf16 a[32:47], v[60:63], v[72:75], a[32:47]
    v_mfma_f32_32x32x16_bf16 a[48:63], v[60:63], v[76:79], a[48:63]
    s_waitcnt lgkmcnt(0)
    v_mfma_f32_32x32x16_bf16 a[0:15], v[48:51], v[64:67], a[0:15]
    ds_read_b128 v[56:59], v25 offset:0
    ds_read_b64_tr_b16 v[72:73], v40 offset:4096
    s_add_u32 m0, s93, 34816
    s_nop 0
    buffer_load_dwordx4 v10, s[80:83], s88 offen sc1 lds
    ds_read_b64_tr_b16 v[74:75], v41 offset:4096
    v_mfma_f32_32x32x16_bf16 a[16:31], v[48:51], v[68:71], a[16:31]
    ds_read_b128 v[60:63], v25 offset:4096
    s_add_u32 m0, s93, 35840
    s_nop 0
    buffer_load_dwordx4 v11, s[80:83], s88 offen sc1 lds
    ds_read_b64_tr_b16 v[76:77], v42 offset:4096
    ds_read_b64_tr_b16 v[78:79], v43 offset:4096
    v_mfma_f32_32x32x16_bf16 a[32:47], v[52:55], v[64:67], a[32:47]
    v_mfma_f32_32x32x16_bf16 a[48:63], v[52:55], v[68:71], a[48:63]
    s_waitcnt lgkmcnt(0)
    v_mfma_f32_32x32x16_bf16 a[0:15], v[56:59], v[72:75], a[0:15]
    ds_read_b128 v[48:51], v26 offset:0
    ds_read_b64_tr_b16 v[64:65], v40 offset:8192
    s_add_u32 m0, s94, 32768
    s_nop 0
    buffer_load_dwordx4 v12, s[84:87], s89 offen lds
    ds_read_b64_tr_b16 v[66:67], v41 offset:8192
    v_mfma_f32_32x32x16_bf16 a[16:31], v[56:59], v[76:79], a[16:31]
    ds_read_b128 v[52:55], v26 offset:4096
    s_add_u32 m0, s94, 33792
    s_nop 0
    buffer_load_dwordx4 v13, s[84:87], s89 offen lds
    ds_read_b64_tr_b16 v[68:69], v42 offset:8192
    ds_read_b64_tr_b16 v[70:71], v43 offset:8192
    v_mfma_f32_32x32x16_bf16 a[32:47], v[60:63], v[72:75], a[32:47]
    v_mfma_f32_32x32x16_bf16 a[48:63], v[60:63], v[76:79], a[48:63]
    s_waitcnt lgkmcnt(0)
    v_mfma_f32_32x32x16_bf16 a[0:15], v[48:51], v[64:67], a[0:15]
    ds_read_b128 v[56:59], v27 offset:0
    ds_read_b64_tr_b16 v[72:73], v40 offset:12288
    s_add_u32 m0, s94, 34816
    s_nop 0
    buffer_load_dwordx4 v14, s[84:87], s89 offen lds
    ds_read_b64_tr_b16 v[74:75], v41 offset:12288
    ds_read_b128 v[60:63], v27 offset:4096
    v_mfma_f32_32x32x16_bf16 a[16:31], v[48:51], v[68:71], a[16:31]
    s_add_u32 m0, s94, 35840
    s_nop 0
    buffer_load_dwordx4 v15, s[84:87], s89 offen lds
    ds_read_b64_tr_b16 v[76:77], v42 offset:12288
    ds_read_b64_tr_b16 v[78:79], v43 offset:12288
    s_add_u32 s88, s88, s90
    s_add_u32 s89, s89, s91
    v_mfma_f32_32x32x16_bf16 a[32:47], v[52:55], v[64:67], a[32:47]
    v_mfma_f32_32x32x16_bf16 a[48:63], v[52:55], v[68:71], a[48:63]
    s_waitcnt lgkmcnt(0)
    s_waitcnt vmcnt(16)
    s_barrier
    v_mfma_f32_32x32x16_bf16 a[0:15], v[56:59], v[72:75], a[0:15]
    ds_read_b128 v[48:51], v28 offset:0
    ds_read_b64_tr_b16 v[64:65], v44 offset:0
    s_add_u32 m0, s93, 65536
    s_nop 0
    buffer_load_dwordx4 v8, s[80:83], s88 offen sc1 lds
    ds_read_b64_tr_b16 v[66:67], v45 offset:0
    v_mfma_f32_32x32x16_bf16 a[16:31], v[56:59], v[76:79], a[16:31]
    ds_read_b128 v[52:55], v28 offset:4096
    s_add_u32 m0, s93, 66560
    s_nop 0
    buffer_load_dwordx4 v9, s[80:83], s88 offen sc1 lds
    ds_read_b64_tr_b16 v[68:69], v46 offset:0
    ds_read_b64_tr_b16 v[70:71], v47 offset:0
    v_mfma_f32_32x32x16_bf16 a[32:47], v[60:63], v[72:75], a[32:47]
    v_mfma_f32_32x32x16_bf16 a[48:63], v[60:63], v[76:79], a[48:63]
    s_waitcnt lgkmcnt(0)
    v_mfma_f32_32x32x16_bf16 a[0:15], v[48:51], v[64:67], a[0:15]
    ds_read_b128 v[56:59], v29 offset:0
    ds_read_b64_tr_b16 v[72:73], v44 offset:4096
    s_add_u32 m0, s93, 67584
    s_nop 0
    buffer_load_dwordx4 v10, s[80:83], s88 offen sc1 lds
    ds_read_b64_tr_b16 v[74:75], v45 offset:4096
    v_mfma_f32_32x32x16_bf16 a[16:31], v[48:51], v[68:71], a[16:31]
    ds_read_b128 v[60:63], v29 offset:4096
    s_add_u32 m0, s93, 68608
    s_nop 0
    buffer_load_dwordx4 v11, s[80:83], s88 offen sc1 lds
    ds_read_b64_tr_b16 v[76:77], v46 offset:4096
    ds_read_b64_tr_b16 v[78:79], v47 offset:4096
    v_mfma_f32_32x32x16_bf16 a[32:47], v[52:55], v[64:67], a[32:47]
    v_mfma_f32_32x32x16_bf16 a[48:63], v[52:55], v[68:71], a[48:63]
    s_waitcnt lgkmcnt(0)
    v_mfma_f32_32x32x16_bf16 a[0:15], v[56:59], v[72:75], a[0:15]
    ds_read_b128 v[48:51], v30 offset:0
    ds_read_b64_tr_b16 v[64:65], v44 offset:8192
    s_add_u32 m0, s94, 65536
    s_nop 0
    buffer_load_dwordx4 v12, s[84:87], s89 offen lds
    ds_read_b64_tr_b16 v[66:67], v45 offset:8192
    v_mfma_f32_32x32x16_bf16 a[16:31], v[56:59], v[76:79], a[16:31]
    ds_read_b128 v[52:55], v30 offset:4096
    s_add_u32 m0, s94, 66560
    s_nop 0
    buffer_load_dwordx4 v13, s[84:87], s89 offen lds
    ds_read_b64_tr_b16 v[68:69], v46 offset:8192
    ds_read_b64_tr_b16 v[70:71], v47 offset:8192
    v_mfma_f32_32x32x16_bf16 a[32:47], v[60:63], v[72:75], a[32:47]
    v_mfma_f32_32x32x16_bf16 a[48:63], v[60:63], v[76:79], a[48:63]
    s_waitcnt lgkmcnt(0)
    v_mfma_f32_32x32x16_bf16 a[0:15], v[48:51], v[64:67], a[0:15]
    ds_read_b128 v[56:59], v31 offset:0
    ds_read_b64_tr_b16 v[72:73], v44 offset:12288
    s_add_u32 m0, s94, 67584
    s_nop 0
    buffer_load_dwordx4 v14, s[84:87], s89 offen lds
    ds_read_b64_tr_b16 v[74:75], v45 offset:12288
    ds_read_b128 v[60:63], v31 offset:4096
    v_mfma_f32_32x32x16_bf16 a[16:31], v[48:51], v[68:71], a[16:31]
    s_add_u32 m0, s94, 68608
    s_nop 0
    buffer_load_dwordx4 v15, s[84:87], s89 offen lds
    ds_read_b64_tr_b16 v[76:77], v46 offset:12288
    ds_read_b64_tr_b16 v[78:79], v47 offset:12288
    s_add_u32 s88, s88, s90
    s_add_u32 s89, s89, s91
    v_mfma_f32_32x32x16_bf16 a[32:47], v[52:55], v[64:67], a[32:47]
    v_mfma_f32_32x32x16_bf16 a[48:63], v[52:55], v[68:71], a[48:63]
    s_waitcnt lgkmcnt(0)
    s_waitcnt vmcnt(16)
    s_barrier
    v_mfma_f32_32x32x16_bf16 a[0:15], v[56:59], v[72:75], a[0:15]
    ds_read_b128 v[48:51], v16 offset:0
    ds_read_b64_tr_b16 v[64:65], v32 offset:0
    s_add_u32 m0, s93, 98304
    s_nop 0
    buffer_load_dwordx4 v8, s[80:83], s88 offen sc1 lds
    ds_read_b64_tr_b16 v[66:67], v33 offset:0
    v_mfma_f32_32x32x16_bf16 a[16:31], v[56:59], v[76:79], a[16:31]
    ds_read_b128 v[52:55], v16 offset:4096
    s_add_u32 m0, s93, 99328
    s_nop 0
    buffer_load_dwordx4 v9, s[80:83], s88 offen sc1 lds
    ds_read_b64_tr_b16 v[68:69], v34 offset:0
    ds_read_b64_tr_b16 v[70:71], v35 offset:0
    v_mfma_f32_32x32x16_bf16 a[32:47], v[60:63], v[72:75], a[32:47]
    v_mfma_f32_32x32x16_bf16 a[48:63], v[60:63], v[76:79], a[48:63]
    s_sub_u32 s92, s92, 1
    s_cmp_eq_u32 s92, 0
    s_cbranch_scc1 gxsn_174
glsn_173:
    s_waitcnt lgkmcnt(0)
    v_mfma_f32_32x32x16_bf16 a[0:15], v[48:51], v[64:67], a[0:15]
    ds_read_b128 v[56:59], v17 offset:0
    ds_read_b64_tr_b16 v[72:73], v32 offset:4096
    s_add_u32 m0, s93, 100352
    s_nop 0
    buffer_load_dwordx4 v10, s[80:83], s88 offen sc1 lds
    ds_read_b64_tr_b16 v[74:75], v33 offset:4096
    v_mfma_f32_32x32x16_bf16 a[16:31], v[48:51], v[68:71], a[16:31]
    ds_read_b128 v[60:63], v17 offset:4096
    s_add_u32 m0, s93, 101376
    s_nop 0
    buffer_load_dwordx4 v11, s[80:83], s88 offen sc1 lds
    ds_read_b64_tr_b16 v[76:77], v34 offset:4096
    ds_read_b64_tr_b16 v[78:79], v35 offset:4096
    v_mfma_f32_32x32x16_bf16 a[32:47], v[52:55], v[64:67], a[32:47]
    v_mfma_f32_32x32x16_bf16 a[48:63], v[52:55], v[68:71], a[48:63]
    s_waitcnt lgkmcnt(0)
    v_mfma_f32_32x32x16_bf16 a[0:15], v[56:59], v[72:75], a[0:15]
    ds_read_b128 v[48:51], v18 offset:0
    ds_read_b64_tr_b16 v[64:65], v32 offset:8192
    s_add_u32 m0, s94, 98304
    s_nop 0
    buffer_load_dwordx4 v12, s[84:87], s89 offen lds
    ds_read_b64_tr_b16 v[66:67], v33 offset:8192
    v_mfma_f32_32x32x16_bf16 a[16:31], v[56:59], v[76:79], a[16:31]
    ds_read_b128 v[52:55], v18 offset:4096
    s_add_u32 m0, s94, 99328
    s_nop 0
    buffer_load_dwordx4 v13, s[84:87], s89 offen lds
    ds_read_b64_tr_b16 v[68:69], v34 offset:8192
    ds_read_b64_tr_b16 v[70:71], v35 offset:8192
    v_mfma_f32_32x32x16_bf16 a[32:47], v[60:63], v[72:75], a[32:47]
    v_mfma_f32_32x32x16_bf16 a[48:63], v[60:63], v[76:79], a[48:63]
    s_waitcnt lgkmcnt(0)
    v_mfma_f32_32x32x16_bf16 a[0:15], v[48:51], v[64:67], a[0:15]
    ds_read_b128 v[56:59], v19 offset:0
    ds_read_b64_tr_b16 v[72:73], v32 offset:12288
    s_add_u32 m0, s94, 100352
    s_nop 0
    buffer_load_dwordx4 v14, s[84:87], s89 offen lds
    ds_read_b64_tr_b16 v[74:75], v33 offset:12288
    ds_read_b128 v[60:63], v19 offset:4096
    v_mfma_f32_32x32x16_bf16 a[16:31], v[48:51], v[68:71], a[16:31]
    s_add_u32 m0, s94, 101376
    s_nop 0
    buffer_load_dwordx4 v15, s[84:87], s89 offen lds
    ds_read_b64_tr_b16 v[76:77], v34 offset:12288
    ds_read_b64_tr_b16 v[78:79], v35 offset:12288
    s_add_u32 s88, s88, s90
    s_add_u32 s89, s89, s91
    v_mfma_f32_32x32x16_bf16 a[32:47], v[52:55], v[64:67], a[32:47]
    v_mfma_f32_32x32x16_bf16 a[48:63], v[52:55], v[68:71], a[48:63]
    s_waitcnt lgkmcnt(0)
    s_waitcnt vmcnt(16)
    s_barrier
    v_mfma_f32_32x32x16_bf16 a[0:15], v[56:59], v[72:75], a[0:15]
    ds_read_b128 v[48:51], v20 offset:0
    ds_read_b64_tr_b16 v[64:65], v36 offset:0
    s_add_u32 m0, s93, 0
    s_nop 0
    buffer_load_dwordx4 v8, s[80:83], s88 offen sc1 lds
    ds_read_b64_tr_b16 v[66:67], v37 offset:0
    v_mfma_f32_32x32x16_bf16 a[16:31], v[56:59], v[76:79], a[16:31]
    ds_read_b128 v[52:55], v20 offset:4096
    s_add_u32 m0, s93, 1024
    s_nop 0
    buffer_load_dwordx4 v9, s[80:83], s88 offen sc1 lds
    ds_read_b64_tr_b16 v[68:69], v38 offset:0
    ds_read_b64_tr_b16 v[70:71], v39 offset:0
    v_mfma_f32_32x32x16_bf16 a[32:47], v[60:63], v[72:75], a[32:47]
    v_mfma_f32_32x32x16_bf16 a[48:63], v[60:63], v[76:79], a[48:63]
    s_waitcnt lgkmcnt(0)
    v_mfma_f32_32x32x16_bf16 a[0:15], v[48:51], v[64:67], a[0:15]
    ds_read_b128 v[56:59], v21 offset:0
    ds_read_b64_tr_b16 v[72:73], v36 offset:4096
    s_add_u32 m0, s93, 2048
    s_nop 0
    buffer_load_dwordx4 v10, s[80:83], s88 offen sc1 lds
    ds_read_b64_tr_b16 v[74:75], v37 offset:4096
    v_mfma_f32_32x32x16_bf16 a[16:31], v[48:51], v[68:71], a[16:31]
    ds_read_b128 v[60:63], v21 offset:4096
    s_add_u32 m0, s93, 3072
    s_nop 0
    buffer_load_dwordx4 v11, s[80:83], s88 offen sc1 lds
    ds_read_b64_tr_b16 v[76:77], v38 offset:4096
    ds_read_b64_tr_b16 v[78:79], v39 offset:4096
    v_mfma_f32_32x32x16_bf16 a[32:47], v[52:55], v[64:67], a[32:47]
    v_mfma_f32_32x32x16_bf16 a[48:63], v[52:55], v[68:71], a[48:63]
    s_waitcnt lgkmcnt(0)
    v_mfma_f32_32x32x16_bf16 a[0:15], v[56:59], v[72:75], a[0:15]
    ds_read_b128 v[48:51], v22 offset:0
    ds_read_b64_tr_b16 v[64:65], v36 offset:8192
    s_add_u32 m0, s94, 0
    s_nop 0
    buffer_load_dwordx4 v12, s[84:87], s89 offen lds
    ds_read_b64_tr_b16 v[66:67], v37 offset:8192
    v_mfma_f32_32x32x16_bf16 a[16:31], v[56:59], v[76:79], a[16:31]
    ds_read_b128 v[52:55], v22 offset:4096
    s_add_u32 m0, s94, 1024
    s_nop 0
    buffer_load_dwordx4 v13, s[84:87], s89 offen lds
    ds_read_b64_tr_b16 v[68:69], v38 offset:8192
    ds_read_b64_tr_b16 v[70:71], v39 offset:8192
    v_mfma_f32_32x32x16_bf16 a[32:47], v[60:63], v[72:75], a[32:47]
    v_mfma_f32_32x32x16_bf16 a[48:63], v[60:63], v[76:79], a[48:63]
    s_waitcnt lgkmcnt(0)
    v_mfma_f32_32x32x16_bf16 a[0:15], v[48:51], v[64:67], a[0:15]
    ds_read_b128 v[56:59], v23 offset:0
    ds_read_b64_tr_b16 v[72:73], v36 offset:12288
    s_add_u32 m0, s94, 2048
    s_nop 0
    buffer_load_dwordx4 v14, s[84:87], s89 offen lds
    ds_read_b64_tr_b16 v[74:75], v37 offset:12288
    ds_read_b128 v[60:63], v23 offset:4096
    v_mfma_f32_32x32x16_bf16 a[16:31], v[48:51], v[68:71], a[16:31]
    s_add_u32 m0, s94, 3072
    s_nop 0
    buffer_load_dwordx4 v15, s[84:87], s89 offen lds
    ds_read_b64_tr_b16 v[76:77], v38 offset:12288
    ds_read_b64_tr_b16 v[78:79], v39 offset:12288
    s_add_u32 s88, s88, s90
    s_add_u32 s89, s89, s91
    v_mfma_f32_32x32x16_bf16 a[32:47], v[52:55], v[64:67], a[32:47]
    v_mfma_f32_32x32x16_bf16 a[48:63], v[52:55], v[68:71], a[48:63]
    s_waitcnt lgkmcnt(0)
    s_waitcnt vmcnt(16)
    s_barrier
    v_mfma_f32_32x32x16_bf16 a[0:15], v[56:59], v[72:75], a[0:15]
    ds_read_b128 v[48:51], v24 offset:0
    ds_read_b64_tr_b16 v[64:65], v40 offset:0
    s_add_u32 m0, s93, 32768
    s_nop 0
    buffer_load_dwordx4 v8, s[80:83], s88 offen sc1 lds
    ds_read_b64_tr_b16 v[66:67], v41 offset:0
    v_mfma_f32_32x32x16_bf16 a[16:31], v[56:59], v[76:79], a[16:31]
    ds_read_b128 v[52:55], v24 offset:4096
    s_add_u32 m0, s93, 33792
    s_nop 0
    buffer_load_dwordx4 v9, s[80:83], s88 offen sc1 lds
    ds_read_b64_tr_b16 v[68:69], v42 offset:0
    ds_read_b64_tr_b16 v[70:71], v43 offset:0
    v_mfma_f32_32x32x16_bf16 a[32:47], v[60:63], v[72:75], a[32:47]
    v_mfma_f32_32x32x16_bf16 a[48:63], v[60:63], v[76:79], a[48:63]
    s_waitcnt lgkmcnt(0)
    v_mfma_f32_32x32x16_bf16 a[0:15], v[48:51], v[64:67], a[0:15]
    ds_read_b128 v[56:59], v25 offset:0
    ds_read_b64_tr_b16 v[72:73], v40 offset:4096
    s_add_u32 m0, s93, 34816
    s_nop 0
    buffer_load_dwordx4 v10, s[80:83], s88 offen sc1 lds
    ds_read_b64_tr_b16 v[74:75], v41 offset:4096
    v_mfma_f32_32x32x16_bf16 a[16:31], v[48:51], v[68:71], a[16:31]
    ds_read_b128 v[60:63], v25 offset:4096
    s_add_u32 m0, s93, 35840
    s_nop 0
    buffer_load_dwordx4 v11, s[80:83], s88 offen sc1 lds
    ds_read_b64_tr_b16 v[76:77], v42 offset:4096
    ds_read_b64_tr_b16 v[78:79], v43 offset:4096
    v_mfma_f32_32x32x16_bf16 a[32:47], v[52:55], v[64:67], a[32:47]
    v_mfma_f32_32x32x16_bf16 a[48:63], v[52:55], v[68:71], a[48:63]
    s_waitcnt lgkmcnt(0)
    v_mfma_f32_32x32x16_bf16 a[0:15], v[56:59], v[72:75], a[0:15]
    ds_read_b128 v[48:51], v26 offset:0
    ds_read_b64_tr_b16 v[64:65], v40 offset:8192
    s_add_u32 m0, s94, 32768
    s_nop 0
    buffer_load_dwordx4 v12, s[84:87], s89 offen lds
    ds_read_b64_tr_b16 v[66:67], v41 offset:8192
    v_mfma_f32_32x32x16_bf16 a[16:31], v[56:59], v[76:79], a[16:31]
    ds_read_b128 v[52:55], v26 offset:4096
    s_add_u32 m0, s94, 33792
    s_nop 0
    buffer_load_dwordx4 v13, s[84:87], s89 offen lds
    ds_read_b64_tr_b16 v[68:69], v42 offset:8192
    ds_read_b64_tr_b16 v[70:71], v43 offset:8192
    v_mfma_f32_32x32x16_bf16 a[32:47], v[60:63], v[72:75], a[32:47]
    v_mfma_f32_32x32x16_bf16 a[48:63], v[60:63], v[76:79], a[48:63]
    s_waitcnt lgkmcnt(0)
    v_mfma_f32_32x32x16_bf16 a[0:15], v[48:51], v[64:67], a[0:15]
    ds_read_b128 v[56:59], v27 offset:0
    ds_read_b64_tr_b16 v[72:73], v40 offset:12288
    s_add_u32 m0, s94, 34816
    s_nop 0
    buffer_load_dwordx4 v14, s[84:87], s89 offen lds
    ds_read_b64_tr_b16 v[74:75], v41 offset:12288
    ds_read_b128 v[60:63], v27 offset:4096
    v_mfma_f32_32x32x16_bf16 a[16:31], v[48:51], v[68:71], a[16:31]
    s_add_u32 m0, s94, 35840
    s_nop 0
    buffer_load_dwordx4 v15, s[84:87], s89 offen lds
    ds_read_b64_tr_b16 v[76:77], v42 offset:12288
    ds_read_b64_tr_b16 v[78:79], v43 offset:12288
    s_add_u32 s88, s88, s90
    s_add_u32 s89, s89, s91
    v_mfma_f32_32x32x16_bf16 a[32:47], v[52:55], v[64:67], a[32:47]
    v_mfma_f32_32x32x16_bf16 a[48:63], v[52:55], v[68:71], a[48:63]
    s_waitcnt lgkmcnt(0)
    s_waitcnt vmcnt(16)
    s_barrier
    v_mfma_f32_32x32x16_bf16 a[0:15], v[56:59], v[72:75], a[0:15]
    ds_read_b128 v[48:51], v28 offset:0
    ds_read_b64_tr_b16 v[64:65], v44 offset:0
    s_add_u32 m0, s93, 65536
    s_nop 0
    buffer_load_dwordx4 v8, s[80:83], s88 offen sc1 lds
    ds_read_b64_tr_b16 v[66:67], v45 offset:0
    v_mfma_f32_32x32x16_bf16 a[16:31], v[56:59], v[76:79], a[16:31]
    ds_read_b128 v[52:55], v28 offset:4096
    s_add_u32 m0, s93, 66560
    s_nop 0
    buffer_load_dwordx4 v9, s[80:83], s88 offen sc1 lds
    ds_read_b64_tr_b16 v[68:69], v46 offset:0
    ds_read_b64_tr_b16 v[70:71], v47 offset:0
    v_mfma_f32_32x32x16_bf16 a[32:47], v[60:63], v[72:75], a[32:47]
    v_mfma_f32_32x32x16_bf16 a[48:63], v[60:63], v[76:79], a[48:63]
    s_waitcnt lgkmcnt(0)
    v_mfma_f32_32x32x16_bf16 a[0:15], v[48:51], v[64:67], a[0:15]
    ds_read_b128 v[56:59], v29 offset:0
    ds_read_b64_tr_b16 v[72:73], v44 offset:4096
    s_add_u32 m0, s93, 67584
    s_nop 0
    buffer_load_dwordx4 v10, s[80:83], s88 offen sc1 lds
    ds_read_b64_tr_b16 v[74:75], v45 offset:4096
    v_mfma_f32_32x32x16_bf16 a[16:31], v[48:51], v[68:71], a[16:31]
    ds_read_b128 v[60:63], v29 offset:4096
    s_add_u32 m0, s93, 68608
    s_nop 0
    buffer_load_dwordx4 v11, s[80:83], s88 offen sc1 lds
    ds_read_b64_tr_b16 v[76:77], v46 offset:4096
    ds_read_b64_tr_b16 v[78:79], v47 offset:4096
    v_mfma_f32_32x32x16_bf16 a[32:47], v[52:55], v[64:67], a[32:47]
    v_mfma_f32_32x32x16_bf16 a[48:63], v[52:55], v[68:71], a[48:63]
    s_waitcnt lgkmcnt(0)
    v_mfma_f32_32x32x16_bf16 a[0:15], v[56:59], v[72:75], a[0:15]
    ds_read_b128 v[48:51], v30 offset:0
    ds_read_b64_tr_b16 v[64:65], v44 offset:8192
    s_add_u32 m0, s94, 65536
    s_nop 0
    buffer_load_dwordx4 v12, s[84:87], s89 offen lds
    ds_read_b64_tr_b16 v[66:67], v45 offset:8192
    v_mfma_f32_32x32x16_bf16 a[16:31], v[56:59], v[76:79], a[16:31]
    ds_read_b128 v[52:55], v30 offset:4096
    s_add_u32 m0, s94, 66560
    s_nop 0
    buffer_load_dwordx4 v13, s[84:87], s89 offen lds
    ds_read_b64_tr_b16 v[68:69], v46 offset:8192
    ds_read_b64_tr_b16 v[70:71], v47 offset:8192
    v_mfma_f32_32x32x16_bf16 a[32:47], v[60:63], v[72:75], a[32:47]
    v_mfma_f32_32x32x16_bf16 a[48:63], v[60:63], v[76:79], a[48:63]
    s_waitcnt lgkmcnt(0)
    v_mfma_f32_32x32x16_bf16 a[0:15], v[48:51], v[64:67], a[0:15]
    ds_read_b128 v[56:59], v31 offset:0
    ds_read_b64_tr_b16 v[72:73], v44 offset:12288
    s_add_u32 m0, s94, 67584
    s_nop 0
    buffer_load_dwordx4 v14, s[84:87], s89 offen lds
    ds_read_b64_tr_b16 v[74:75], v45 offset:12288
    ds_read_b128 v[60:63], v31 offset:4096
    v_mfma_f32_32x32x16_bf16 a[16:31], v[48:51], v[68:71], a[16:31]
    s_add_u32 m0, s94, 68608
    s_nop 0
    buffer_load_dwordx4 v15, s[84:87], s89 offen lds
    ds_read_b64_tr_b16 v[76:77], v46 offset:12288
    ds_read_b64_tr_b16 v[78:79], v47 offset:12288
    s_add_u32 s88, s88, s90
    s_add_u32 s89, s89, s91
    v_mfma_f32_32x32x16_bf16 a[32:47], v[52:55], v[64:67], a[32:47]
    v_mfma_f32_32x32x16_bf16 a[48:63], v[52:55], v[68:71], a[48:63]
    s_waitcnt lgkmcnt(0)
    s_waitcnt vmcnt(16)
    s_barrier
    v_mfma_f32_32x32x16_bf16 a[0:15], v[56:59], v[72:75], a[0:15]
    ds_read_b128 v[48:51], v16 offset:0
    ds_read_b64_tr_b16 v[64:65], v32 offset:0
    s_add_u32 m0, s93, 98304
    s_nop 0
    buffer_load_dwordx4 v8, s[80:83], s88 offen sc1 lds
    ds_read_b64_tr_b16 v[66:67], v33 offset:0
    v_mfma_f32_32x32x16_bf16 a[16:31], v[56:59], v[76:79], a[16:31]
    ds_read_b128 v[52:55], v16 offset:4096
    s_add_u32 m0, s93, 99328
    s_nop 0
    buffer_load_dwordx4 v9, s[80:83], s88 offen sc1 lds
    ds_read_b64_tr_b16 v[68:69], v34 offset:0
    ds_read_b64_tr_b16 v[70:71], v35 offset:0
    v_mfma_f32_32x32x16_bf16 a[32:47], v[60:63], v[72:75], a[32:47]
    v_mfma_f32_32x32x16_bf16 a[48:63], v[60:63], v[76:79], a[48:63]
    s_sub_u32 s92, s92, 1
    s_cmp_lg_u32 s92, 0
    s_cbranch_scc1 glsn_173
gxsn_174:
    s_waitcnt lgkmcnt(0)
    v_mfma_f32_32x32x16_bf16 a[0:15], v[48:51], v[64:67], a[0:15]
    ds_read_b128 v[56:59], v17 offset:0
    ds_read_b64_tr_b16 v[72:73], v32 offset:4096
    s_add_u32 m0, s93, 100352
    s_nop 0
    buffer_load_dwordx4 v10, s[80:83], s88 offen sc1 lds
    ds_read_b64_tr_b16 v[74:75], v33 offset:4096
    v_mfma_f32_32x32x16_bf16 a[16:31], v[48:51], v[68:71], a[16:31]
    ds_read_b128 v[60:63], v17 offset:4096
    s_add_u32 m0, s93, 101376
    s_nop 0
    buffer_load_dwordx4 v11, s[80:83], s88 offen sc1 lds
    ds_read_b64_tr_b16 v[76:77], v34 offset:4096
    ds_read_b64_tr_b16 v[78:79], v35 offset:4096
    v_mfma_f32_32x32x16_bf16 a[32:47], v[52:55], v[64:67], a[32:47]
    v_mfma_f32_32x32x16_bf16 a[48:63], v[52:55], v[68:71], a[48:63]
    s_waitcnt lgkmcnt(0)
    v_mfma_f32_32x32x16_bf16 a[0:15], v[56:59], v[72:75], a[0:15]
    ds_read_b128 v[48:51], v18 offset:0
    ds_read_b64_tr_b16 v[64:65], v32 offset:8192
    s_add_u32 m0, s94, 98304
    s_nop 0
    buffer_load_dwordx4 v12, s[84:87], s89 offen lds
    ds_read_b64_tr_b16 v[66:67], v33 offset:8192
    v_mfma_f32_32x32x16_bf16 a[16:31], v[56:59], v[76:79], a[16:31]
    ds_read_b128 v[52:55], v18 offset:4096
    s_add_u32 m0, s94, 99328
    s_nop 0
    buffer_load_dwordx4 v13, s[84:87], s89 offen lds
    ds_read_b64_tr_b16 v[68:69], v34 offset:8192
    ds_read_b64_tr_b16 v[70:71], v35 offset:8192
    v_mfma_f32_32x32x16_bf16 a[32:47], v[60:63], v[72:75], a[32:47]
    v_mfma_f32_32x32x16_bf16 a[48:63], v[60:63], v[76:79], a[48:63]
    s_waitcnt lgkmcnt(0)
    v_mfma_f32_32x32x16_bf16 a[0:15], v[48:51], v[64:67], a[0:15]
    ds_read_b128 v[56:59], v19 offset:0
    ds_read_b64_tr_b16 v[72:73], v32 offset:12288
    s_add_u32 m0, s94, 100352
    s_nop 0
    buffer_load_dwordx4 v14, s[84:87], s89 offen lds
    ds_read_b64_tr_b16 v[74:75], v33 offset:12288
    ds_read_b128 v[60:63], v19 offset:4096
    v_mfma_f32_32x32x16_bf16 a[16:31], v[48:51], v[68:71], a[16:31]
    s_add_u32 m0, s94, 101376
    s_nop 0
    buffer_load_dwordx4 v15, s[84:87], s89 offen lds
    ds_read_b64_tr_b16 v[76:77], v34 offset:12288
    ds_read_b64_tr_b16 v[78:79], v35 offset:12288
    s_add_u32 s88, s88, s90
    s_add_u32 s89, s89, s91
    v_mfma_f32_32x32x16_bf16 a[32:47], v[52:55], v[64:67], a[32:47]
    v_mfma_f32_32x32x16_bf16 a[48:63], v[52:55], v[68:71], a[48:63]
    s_waitcnt lgkmcnt(0)
    s_waitcnt vmcnt(16)
    s_barrier
    v_mfma_f32_32x32x16_bf16 a[0:15], v[56:59], v[72:75], a[0:15]
    ds_read_b128 v[48:51], v20 offset:0
    ds_read_b64_tr_b16 v[64:65], v36 offset:0
    ds_read_b64_tr_b16 v[66:67], v37 offset:0
    v_mfma_f32_32x32x16_bf16 a[16:31], v[56:59], v[76:79], a[16:31]
    ds_read_b128 v[52:55], v20 offset:4096
    ds_read_b64_tr_b16 v[68:69], v38 offset:0
    ds_read_b64_tr_b16 v[70:71], v39 offset:0
    v_mfma_f32_32x32x16_bf16 a[32:47], v[60:63], v[72:75], a[32:47]
    v_mfma_f32_32x32x16_bf16 a[48:63], v[60:63], v[76:79], a[48:63]
    s_waitcnt lgkmcnt(0)
    v_mfma_f32_32x32x16_bf16 a[0:15], v[48:51], v[64:67], a[0:15]
    ds_read_b128 v[56:59], v21 offset:0
    ds_read_b64_tr_b16 v[72:73], v36 offset:4096
    ds_read_b64_tr_b16 v[74:75], v37 offset:4096
    v_mfma_f32_32x32x16_bf16 a[16:31], v[48:51], v[68:71], a[16:31]
    ds_read_b128 v[60:63], v21 offset:4096
    ds_read_b64_tr_b16 v[76:77], v38 offset:4096
    ds_read_b64_tr_b16 v[78:79], v39 offset:4096
    v_mfma_f32_32x32x16_bf16 a[32:47], v[52:55], v[64:67], a[32:47]
    v_mfma_f32_32x32x16_bf16 a[48:63], v[52:55], v[68:71], a[48:63]
    s_waitcnt lgkmcnt(0)
    v_mfma_f32_32x32x16_bf16 a[0:15], v[56:59], v[72:75], a[0:15]
    ds_read_b128 v[48:51], v22 offset:0
    ds_read_b64_tr_b16 v[64:65], v36 offset:8192
    ds_read_b64_tr_b16 v[66:67], v37 offset:8192
    v_mfma_f32_32x32x16_bf16 a[16:31], v[56:59], v[76:79], a[16:31]
    ds_read_b128 v[52:55], v22 offset:4096
    ds_read_b64_tr_b16 v[68:69], v38 offset:8192
    ds_read_b64_tr_b16 v[70:71], v39 offset:8192
    v_mfma_f32_32x32x16_bf16 a[32:47], v[60:63], v[72:75], a[32:47]
    v_mfma_f32_32x32x16_bf16 a[48:63], v[60:63], v[76:79], a[48:63]
    s_waitcnt lgkmcnt(0)
    v_mfma_f32_32x32x16_bf16 a[0:15], v[48:51], v[64:67], a[0:15]
    ds_read_b128 v[56:59], v23 offset:0
    ds_read_b64_tr_b16 v[72:73], v36 offset:12288
    ds_read_b64_tr_b16 v[74:75], v37 offset:12288
    v_mfma_f32_32x32x16_bf16 a[16:31], v[48:51], v[68:71], a[16:31]
    ds_read_b128 v[60:63], v23 offset:4096
    ds_read_b64_tr_b16 v[76:77], v38 offset:12288
    ds_read_b64_tr_b16 v[78:79], v39 offset:12288
    v_mfma_f32_32x32x16_bf16 a[32:47], v[52:55], v[64:67], a[32:47]
    v_mfma_f32_32x32x16_bf16 a[48:63], v[52:55], v[68:71], a[48:63]
    s_waitcnt lgkmcnt(0)
    s_waitcnt vmcnt(8)
    s_barrier
    v_mfma_f32_32x32x16_bf16 a[0:15], v[56:59], v[72:75], a[0:15]
    ds_read_b128 v[48:51], v24 offset:0
    ds_read_b64_tr_b16 v[64:65], v40 offset:0
    ds_read_b64_tr_b16 v[66:67], v41 offset:0
    v_mfma_f32_32x32x16_bf16 a[16:31], v[56:59], v[76:79], a[16:31]
    ds_read_b128 v[52:55], v24 offset:4096
    ds_read_b64_tr_b16 v[68:69], v42 offset:0
    ds_read_b64_tr_b16 v[70:71], v43 offset:0
    v_mfma_f32_32x32x16_bf16 a[32:47], v[60:63], v[72:75], a[32:47]
    v_mfma_f32_32x32x16_bf16 a[48:63], v[60:63], v[76:79], a[48:63]
    s_waitcnt lgkmcnt(0)
    v_mfma_f32_32x32x16_bf16 a[0:15], v[48:51], v[64:67], a[0:15]
    ds_read_b128 v[56:59], v25 offset:0
    ds_read_b64_tr_b16 v[72:73], v40 offset:4096
    ds_read_b64_tr_b16 v[74:75], v41 offset:4096
    v_mfma_f32_32x32x16_bf16 a[16:31], v[48:51], v[68:71], a[16:31]
    ds_read_b128 v[60:63], v25 offset:4096
    ds_read_b64_tr_b16 v[76:77], v42 offset:4096
    ds_read_b64_tr_b16 v[78:79], v43 offset:4096
    v_mfma_f32_32x32x16_bf16 a[32:47], v[52:55], v[64:67], a[32:47]
    v_mfma_f32_32x32x16_bf16 a[48:63], v[52:55], v[68:71], a[48:63]
    s_waitcnt lgkmcnt(0)
    v_mfma_f32_32x32x16_bf16 a[0:15], v[56:59], v[72:75], a[0:15]
    ds_read_b128 v[48:51], v26 offset:0
    ds_read_b64_tr_b16 v[64:65], v40 offset:8192
    ds_read_b64_tr_b16 v[66:67], v41 offset:8192
    v_mfma_f32_32x32x16_bf16 a[16:31], v[56:59], v[76:79], a[16:31]
    ds_read_b128 v[52:55], v26 offset:4096
    ds_read_b64_tr_b16 v[68:69], v42 offset:8192
    ds_read_b64_tr_b16 v[70:71], v43 offset:8192
    v_mfma_f32_32x32x16_bf16 a[32:47], v[60:63], v[72:75], a[32:47]
    v_mfma_f32_32x32x16_bf16 a[48:63], v[60:63], v[76:79], a[48:63]
    s_waitcnt lgkmcnt(0)
    v_mfma_f32_32x32x16_bf16 a[0:15], v[48:51], v[64:67], a[0:15]
    ds_read_b128 v[56:59], v27 offset:0
    ds_read_b64_tr_b16 v[72:73], v40 offset:12288
    ds_read_b64_tr_b16 v[74:75], v41 offset:12288
    v_mfma_f32_32x32x16_bf16 a[16:31], v[48:51], v[68:71], a[16:31]
    ds_read_b128 v[60:63], v27 offset:4096
    ds_read_b64_tr_b16 v[76:77], v42 offset:12288
    ds_read_b64_tr_b16 v[78:79], v43 offset:12288
    v_mfma_f32_32x32x16_bf16 a[32:47], v[52:55], v[64:67], a[32:47]
    v_mfma_f32_32x32x16_bf16 a[48:63], v[52:55], v[68:71], a[48:63]
    s_waitcnt lgkmcnt(0)
    s_waitcnt vmcnt(0)
    s_barrier
    v_mfma_f32_32x32x16_bf16 a[0:15], v[56:59], v[72:75], a[0:15]
    ds_read_b128 v[48:51], v28 offset:0
    ds_read_b64_tr_b16 v[64:65], v44 offset:0
    ds_read_b64_tr_b16 v[66:67], v45 offset:0
    v_mfma_f32_32x32x16_bf16 a[16:31], v[56:59], v[76:79], a[16:31]
    ds_read_b128 v[52:55], v28 offset:4096
    ds_read_b64_tr_b16 v[68:69], v46 offset:0
    ds_read_b64_tr_b16 v[70:71], v47 offset:0
    v_mfma_f32_32x32x16_bf16 a[32:47], v[60:63], v[72:75], a[32:47]
    v_mfma_f32_32x32x16_bf16 a[48:63], v[60:63], v[76:79], a[48:63]
    s_waitcnt lgkmcnt(0)
    v_mfma_f32_32x32x16_bf16 a[0:15], v[48:51], v[64:67], a[0:15]
    ds_read_b128 v[56:59], v29 offset:0
    ds_read_b64_tr_b16 v[72:73], v44 offset:4096
    ds_read_b64_tr_b16 v[74:75], v45 offset:4096
    v_mfma_f32_32x32x16_bf16 a[16:31], v[48:51], v[68:71], a[16:31]
    ds_read_b128 v[60:63], v29 offset:4096
    ds_read_b64_tr_b16 v[76:77], v46 offset:4096
    ds_read_b64_tr_b16 v[78:79], v47 offset:4096
    v_mfma_f32_32x32x16_bf16 a[32:47], v[52:55], v[64:67], a[32:47]
    v_mfma_f32_32x32x16_bf16 a[48:63], v[52:55], v[68:71], a[48:63]
    s_waitcnt lgkmcnt(0)
    v_mfma_f32_32x32x16_bf16 a[0:15], v[56:59], v[72:75], a[0:15]
    ds_read_b128 v[48:51], v30 offset:0
    ds_read_b64_tr_b16 v[64:65], v44 offset:8192
    ds_read_b64_tr_b16 v[66:67], v45 offset:8192
    v_mfma_f32_32x32x16_bf16 a[16:31], v[56:59], v[76:79], a[16:31]
    ds_read_b128 v[52:55], v30 offset:4096
    ds_read_b64_tr_b16 v[68:69], v46 offset:8192
    ds_read_b64_tr_b16 v[70:71], v47 offset:8192
    v_mfma_f32_32x32x16_bf16 a[32:47], v[60:63], v[72:75], a[32:47]
    v_mfma_f32_32x32x16_bf16 a[48:63], v[60:63], v[76:79], a[48:63]
    s_waitcnt lgkmcnt(0)
    v_mfma_f32_32x32x16_bf16 a[0:15], v[48:51], v[64:67], a[0:15]
    ds_read_b128 v[56:59], v31 offset:0
    ds_read_b64_tr_b16 v[72:73], v44 offset:12288
    ds_read_b64_tr_b16 v[74:75], v45 offset:12288
    v_mfma_f32_32x32x16_bf16 a[16:31], v[48:51], v[68:71], a[16:31]
    ds_read_b128 v[60:63], v31 offset:4096
    ds_read_b64_tr_b16 v[76:77], v46 offset:12288
    ds_read_b64_tr_b16 v[78:79], v47 offset:12288
    v_mfma_f32_32x32x16_bf16 a[32:47], v[52:55], v[64:67], a[32:47]
    v_mfma_f32_32x32x16_bf16 a[48:63], v[52:55], v[68:71], a[48:63]
    s_waitcnt lgkmcnt(0)
    v_mfma_f32_32x32x16_bf16 a[0:15], v[56:59], v[72:75], a[0:15]
    v_mfma_f32_32x32x16_bf16 a[16:31], v[56:59], v[76:79], a[16:31]
    v_mfma_f32_32x32x16_bf16 a[32:47], v[60:63], v[72:75], a[32:47]
    v_mfma_f32_32x32x16_bf16 a[48:63], v[60:63], v[76:79], a[48:63]
sE_169:
    s_nop 11
    s_cmp_eq_u32 s69, 0
    s_cbranch_scc1 et_175
    s_mov_b32 s75, 1
    s_cmp_lg_u32 s44, 0
    s_cbranch_scc1 et_175
    s_lshl_b32 s76, s46, 7
    s_add_u32 s76, s76, 0x6402000
    v_mov_b32 v4, s76
    v_mov_b32 v7, 1
    s_mov_b64 exec, 1
    buffer_atomic_add v7, v4, s[32:35], 0 offen sc0 sc1
    s_mov_b64 exec, -1
et_175:
    s_mov_b32 s49, s53
    v_accvgpr_read_b32 v88, a0
    v_accvgpr_read_b32 v89, a1
    v_accvgpr_read_b32 v90, a2
    v_accvgpr_read_b32 v91, a3
    v_accvgpr_read_b32 v92, a4
    v_accvgpr_read_b32 v93, a5
    v_accvgpr_read_b32 v94, a6
    v_accvgpr_read_b32 v95, a7
    v_accvgpr_read_b32 v96, a8
    v_accvgpr_read_b32 v97, a9
    v_accvgpr_read_b32 v98, a10
    v_accvgpr_read_b32 v99, a11
    v_accvgpr_read_b32 v100, a12
    v_accvgpr_read_b32 v101, a13
    v_accvgpr_read_b32 v102, a14
    v_accvgpr_read_b32 v103, a15
    v_cvt_pk_bf16_f32 v48, v88, v89
    v_cvt_pk_bf16_f32 v49, v90, v91
    v_cvt_pk_bf16_f32 v50, v92, v93
    v_cvt_pk_bf16_f32 v51, v94, v95
    v_cvt_pk_bf16_f32 v52, v96, v97
    v_cvt_pk_bf16_f32 v53, v98, v99
    v_cvt_pk_bf16_f32 v54, v100, v101
    v_cvt_pk_bf16_f32 v55, v102, v103
    buffer_store_dwordx4 v[48:51], v2, s[32:35], s49 offen offset:0 sc1
    buffer_store_dwordx4 v[52:55], v2, s[32:35], s49 offen offset:1024 sc1
    v_accvgpr_read_b32 v88, a16
    v_accvgpr_read_b32 v89, a17
    v_accvgpr_read_b32 v90, a18
    v_accvgpr_read_b32 v91, a19
    v_accvgpr_read_b32 v92, a20
    v_accvgpr_read_b32 v93, a21
    v_accvgpr_read_b32 v94, a22
    v_accvgpr_read_b32 v95, a23
    v_accvgpr_read_b32 v96, a24
    v_accvgpr_read_b32 v97, a25
    v_accvgpr_read_b32 v98, a26
    v_accvgpr_read_b32 v99, a27
    v_accvgpr_read_b32 v100, a28
    v_accvgpr_read_b32 v101, a29
    v_accvgpr_read_b32 v102, a30
    v_accvgpr_read_b32 v103, a31
    v_cvt_pk_bf16_f32 v64, v88, v89
    v_cvt_pk_bf16_f32 v65, v90, v91
    v_cvt_pk_bf16_f32 v66, v92, v93
    v_cvt_pk_bf16_f32 v67, v94, v95
    v_cvt_pk_bf16_f32 v68, v96, v97
    v_cvt_pk_bf16_f32 v69, v98, v99
    v_cvt_pk_bf16_f32 v70, v100, v101
    v_cvt_pk_bf16_f32 v71, v102, v103
    buffer_store_dwordx4 v[64:67], v2, s[32:35], s49 offen offset:2048 sc1
    buffer_store_dwordx4 v[68:71], v2, s[32:35], s49 offen offset:3072 sc1
    s_add_u32 s53, s53, s54
    s_mov_b32 s49, s53
    v_accvgpr_read_b32 v88, a32
    v_accvgpr_read_b32 v89, a33
    v_accvgpr_read_b32 v90, a34
    v_accvgpr_read_b32 v91, a35
    v_accvgpr_read_b32 v92, a36
    v_accvgpr_read_b32 v93, a37
    v_accvgpr_read_b32 v94, a38
    v_accvgpr_read_b32 v95, a39
    v_accvgpr_read_b32 v96, a40
    v_accvgpr_read_b32 v97, a41
    v_accvgpr_read_b32 v98, a42
    v_accvgpr_read_b32 v99, a43
    v_accvgpr_read_b32 v100, a44
    v_accvgpr_read_b32 v101, a45
    v_accvgpr_read_b32 v102, a46
    v_accvgpr_read_b32 v103, a47
    v_cvt_pk_bf16_f32 v48, v88, v89
    v_cvt_pk_bf16_f32 v49, v90, v91
    v_cvt_pk_bf16_f32 v50, v92, v93
    v_cvt_pk_bf16_f32 v51, v94, v95
    v_cvt_pk_bf16_f32 v52, v96, v97
    v_cvt_pk_bf16_f32 v53, v98, v99
    v_cvt_pk_bf16_f32 v54, v100, v101
    v_cvt_pk_bf16_f32 v55, v102, v103
    buffer_store_dwordx4 v[48:51], v2, s[32:35], s49 offen offset:0 sc1
    buffer_store_dwordx4 v[52:55], v2, s[32:35], s49 offen offset:1024 sc1
    v_accvgpr_read_b32 v88, a48
    v_accvgpr_read_b32 v89, a49
    v_accvgpr_read_b32 v90, a50
    v_accvgpr_read_b32 v91, a51
    v_accvgpr_read_b32 v92, a52
    v_accvgpr_read_b32 v93, a53
    v_accvgpr_read_b32 v94, a54
    v_accvgpr_read_b32 v95, a55
    v_accvgpr_read_b32 v96, a56
    v_accvgpr_read_b32 v97, a57
    v_accvgpr_read_b32 v98, a58
    v_accvgpr_read_b32 v99, a59
    v_accvgpr_read_b32 v100, a60
    v_accvgpr_read_b32 v101, a61
    v_accvgpr_read_b32 v102, a62
    v_accvgpr_read_b32 v103, a63
    v_cvt_pk_bf16_f32 v64, v88, v89
    v_cvt_pk_bf16_f32 v65, v90, v91
    v_cvt_pk_bf16_f32 v66, v92, v93
    v_cvt_pk_bf16_f32 v67, v94, v95
    v_cvt_pk_bf16_f32 v68, v96, v97
    v_cvt_pk_bf16_f32 v69, v98, v99
    v_cvt_pk_bf16_f32 v70, v100, v101
    v_cvt_pk_bf16_f32 v71, v102, v103
    buffer_store_dwordx4 v[64:67], v2, s[32:35], s49 offen offset:2048 sc1
    buffer_store_dwordx4 v[68:71], v2, s[32:35], s49 offen offset:3072 sc1
    s_branch mega_kernel_wdone
sO_170:
    s_nop 11
    s_cmp_eq_u32 s69, 0
    s_cbranch_scc1 et_176
    s_mov_b32 s75, 1
    s_cmp_lg_u32 s44, 0
    s_cbranch_scc1 et_176
    s_lshl_b32 s76, s46, 7
    s_add_u32 s76, s76, 0x6402000
    v_mov_b32 v4, s76
    v_mov_b32 v7, 1
    s_mov_b64 exec, 1
    buffer_atomic_add v7, v4, s[32:35], 0 offen sc0 sc1
    s_mov_b64 exec, -1
et_176:
    v_accvgpr_read_b32 v88, a0
    v_accvgpr_read_b32 v89, a1
    v_accvgpr_read_b32 v90, a2
    v_accvgpr_read_b32 v91, a3
    v_accvgpr_read_b32 v92, a4
    v_accvgpr_read_b32 v93, a5
    v_accvgpr_read_b32 v94, a6
    v_accvgpr_read_b32 v95, a7
    v_accvgpr_read_b32 v96, a8
    v_accvgpr_read_b32 v97, a9
    v_accvgpr_read_b32 v98, a10
    v_accvgpr_read_b32 v99, a11
    v_accvgpr_read_b32 v100, a12
    v_accvgpr_read_b32 v101, a13
    v_accvgpr_read_b32 v102, a14
    v_accvgpr_read_b32 v103, a15
    v_cvt_pk_bf16_f32 v48, v88, v89
    v_cvt_pk_bf16_f32 v49, v90, v91
    v_cvt_pk_bf16_f32 v50, v92, v93
    v_cvt_pk_bf16_f32 v51, v94, v95
    v_cvt_pk_bf16_f32 v52, v96, v97
    v_cvt_pk_bf16_f32 v53, v98, v99
    v_cvt_pk_bf16_f32 v54, v100, v101
    v_cvt_pk_bf16_f32 v55, v102, v103
    v_permlane32_swap_b32 v48, v50
    v_permlane32_swap_b32 v49, v51
    v_permlane32_swap_b32 v52, v54
    v_permlane32_swap_b32 v53, v55
    buffer_store_dwordx4 v[48:51], v3, s[40:43], s53 offen offset:0
    buffer_store_dwordx4 v[52:55], v3, s[40:43], s53 offen offset:32
    v_accvgpr_read_b32 v88, a16
    v_accvgpr_read_b32 v89, a17
    v_accvgpr_read_b32 v90, a18
    v_accvgpr_read_b32 v91, a19
    v_accvgpr_read_b32 v92, a20
    v_accvgpr_read_b32 v93, a21
    v_accvgpr_read_b32 v94, a22
    v_accvgpr_read_b32 v95, a23
    v_accvgpr_read_b32 v96, a24
    v_accvgpr_read_b32 v97, a25
    v_accvgpr_read_b32 v98, a26
    v_accvgpr_read_b32 v99, a27
    v_accvgpr_read_b32 v100, a28
    v_accvgpr_read_b32 v101, a29
    v_accvgpr_read_b32 v102, a30
    v_accvgpr_read_b32 v103, a31
    v_cvt_pk_bf16_f32 v64, v88, v89
    v_cvt_pk_bf16_f32 v65, v90, v91
    v_cvt_pk_bf16_f32 v66, v92, v93
    v_cvt_pk_bf16_f32 v67, v94, v95
    v_cvt_pk_bf16_f32 v68, v96, v97
    v_cvt_pk_bf16_f32 v69, v98, v99
    v_cvt_pk_bf16_f32 v70, v100, v101
    v_cvt_pk_bf16_f32 v71, v102, v103
    v_permlane32_swap_b32 v64, v66
    v_permlane32_swap_b32 v65, v67
    v_permlane32_swap_b32 v68, v70
    v_permlane32_swap_b32 v69, v71
    buffer_store_dwordx4 v[64:67], v3, s[40:43], s53 offen offset:64
    buffer_store_dwordx4 v[68:71], v3, s[40:43], s53 offen offset:96
    s_add_u32 s53, s53, 131072
    v_accvgpr_read_b32 v88, a32
    v_accvgpr_read_b32 v89, a33
    v_accvgpr_read_b32 v90, a34
    v_accvgpr_read_b32 v91, a35
    v_accvgpr_read_b32 v92, a36
    v_accvgpr_read_b32 v93, a37
    v_accvgpr_read_b32 v94, a38
    v_accvgpr_read_b32 v95, a39
    v_accvgpr_read_b32 v96, a40
    v_accvgpr_read_b32 v97, a41
    v_accvgpr_read_b32 v98, a42
    v_accvgpr_read_b32 v99, a43
    v_accvgpr_read_b32 v100, a44
    v_accvgpr_read_b32 v101, a45
    v_accvgpr_read_b32 v102, a46
    v_accvgpr_read_b32 v103, a47
    v_cvt_pk_bf16_f32 v48, v88, v89
    v_cvt_pk_bf16_f32 v49, v90, v91
    v_cvt_pk_bf16_f32 v50, v92, v93
    v_cvt_pk_bf16_f32 v51, v94, v95
    v_cvt_pk_bf16_f32 v52, v96, v97
    v_cvt_pk_bf16_f32 v53, v98, v99
    v_cvt_pk_bf16_f32 v54, v100, v101
    v_cvt_pk_bf16_f32 v55, v102, v103
    v_permlane32_swap_b32 v48, v50
    v_permlane32_swap_b32 v49, v51
    v_permlane32_swap_b32 v52, v54
    v_permlane32_swap_b32 v53, v55
    buffer_store_dwordx4 v[48:51], v3, s[40:43], s53 offen offset:0
    buffer_store_dwordx4 v[52:55], v3, s[40:43], s53 offen offset:32
    v_accvgpr_read_b32 v88, a48
    v_accvgpr_read_b32 v89, a49
    v_accvgpr_read_b32 v90, a50
    v_accvgpr_read_b32 v91, a51
    v_accvgpr_read_b32 v92, a52
    v_accvgpr_read_b32 v93, a53
    v_accvgpr_read_b32 v94, a54
    v_accvgpr_read_b32 v95, a55
    v_accvgpr_read_b32 v96, a56
    v_accvgpr_read_b32 v97, a57
    v_accvgpr_read_b32 v98, a58
    v_accvgpr_read_b32 v99, a59
    v_accvgpr_read_b32 v100, a60
    v_accvgpr_read_b32 v101, a61
    v_accvgpr_read_b32 v102, a62
    v_accvgpr_read_b32 v103, a63
    v_cvt_pk_bf16_f32 v64, v88, v89
    v_cvt_pk_bf16_f32 v65, v90, v91
    v_cvt_pk_bf16_f32 v66, v92, v93
    v_cvt_pk_bf16_f32 v67, v94, v95
    v_cvt_pk_bf16_f32 v68, v96, v97
    v_cvt_pk_bf16_f32 v69, v98, v99
    v_cvt_pk_bf16_f32 v70, v100, v101
    v_cvt_pk_bf16_f32 v71, v102, v103
    v_permlane32_swap_b32 v64, v66
    v_permlane32_swap_b32 v65, v67
    v_permlane32_swap_b32 v68, v70
    v_permlane32_swap_b32 v69, v71
    buffer_store_dwordx4 v[64:67], v3, s[40:43], s53 offen offset:64
    buffer_store_dwordx4 v[68:71], v3, s[40:43], s53 offen offset:96
    s_branch mega_kernel_wdone
jobwot_153:
    s_add_u32 s47, s47, s62
    s_lshr_b32 s59, s47, 0
    s_and_b32 s59, s59, 1
    s_lshl_b32 s59, s59, 2
    s_add_u32 s59, s59, s45
    s_lshr_b32 s58, s47, 1
    s_mov_b32 s84, s14
    s_and_b32 s85, s15, 0xffff
    s_mov_b32 s86, 0x800000
    s_mov_b32 s87, 0x00020000
    s_cmp_eq_u32 s48, 5
    s_cbranch_scc1 cfg_177
    s_mul_i32 s93, s44, 4096
    s_mul_i32 s94, s44, 4096
    s_add_u32 s94, s94, 16384
    v_lshlrev_b32 v80, 4, v1
    s_mul_i32 s49, s44, 4
    s_add_u32 s49, s49, 0
    s_lshr_b32 s50, s49, 2
    s_mul_i32 s50, s50, 262144
    s_and_b32 s49, s49, 3
    s_lshl_b32 s49, s49, 10
    s_add_u32 s49, s49, s50
    v_add_u32 v8, s49, v80
    s_mul_i32 s49, s44, 4
    s_add_u32 s49, s49, 1
    s_lshr_b32 s50, s49, 2
    s_mul_i32 s50, s50, 262144
    s_and_b32 s49, s49, 3
    s_lshl_b32 s49, s49, 10
    s_add_u32 s49, s49, s50
    v_add_u32 v9, s49, v80
    s_mul_i32 s49, s44, 4
    s_add_u32 s49, s49, 2
    s_lshr_b32 s50, s49, 2
    s_mul_i32 s50, s50, 262144
    s_and_b32 s49, s49, 3
    s_lshl_b32 s49, s49, 10
    s_add_u32 s49, s49, s50
    v_add_u32 v10, s49, v80
    s_mul_i32 s49, s44, 4
    s_add_u32 s49, s49, 3
    s_lshr_b32 s50, s49, 2
    s_mul_i32 s50, s50, 262144
    s_and_b32 s49, s49, 3
    s_lshl_b32 s49, s49, 10
    s_add_u32 s49, s49, s50
    v_add_u32 v11, s49, v80
    v_lshrrev_b32 v80, 4, v1
    s_mul_i32 s49, s44, 16
    v_add_u32 v80, s49, v80
    v_and_b32 v81, 15, v1
    s_mov_b32 s50, 2048
    v_add_u32 v82, 0, v80
    v_and_b32 v83, 3, v82
    v_lshlrev_b32 v83, 2, v83
    v_xor_b32 v83, v83, v81
    v_mul_lo_u32 v82, v82, s50
    v_lshl_add_u32 v12, v83, 4, v82
    v_add_u32 v82, 4, v80
    v_and_b32 v83, 3, v82
    v_lshlrev_b32 v83, 2, v83
    v_xor_b32 v83, v83, v81
    v_mul_lo_u32 v82, v82, s50
    v_lshl_add_u32 v13, v83, 4, v82
    v_add_u32 v82, 8, v80
    v_and_b32 v83, 3, v82
    v_lshlrev_b32 v83, 2, v83
    v_xor_b32 v83, v83, v81
    v_mul_lo_u32 v82, v82, s50
    v_lshl_add_u32 v14, v83, 4, v82
    v_add_u32 v82, 12, v80
    v_and_b32 v83, 3, v82
    v_lshlrev_b32 v83, 2, v83
    v_xor_b32 v83, v83, v81
    v_mul_lo_u32 v82, v82, s50
    v_lshl_add_u32 v15, v83, 4, v82
    s_lshr_b32 s49, s44, 1
    s_mul_i32 s49, s49, 8192
    v_lshlrev_b32 v80, 4, v1
    v_add_u32 v80, s49, v80
    v_add_u32 v16, 0, v80
    v_add_u32 v20, 32768, v80
    v_add_u32 v24, 65536, v80
    v_add_u32 v28, 98304, v80
    v_add_u32 v17, 1024, v80
    v_add_u32 v21, 33792, v80
    v_add_u32 v25, 66560, v80
    v_add_u32 v29, 99328, v80
    v_add_u32 v18, 2048, v80
    v_add_u32 v22, 34816, v80
    v_add_u32 v26, 67584, v80
    v_add_u32 v30, 100352, v80
    v_add_u32 v19, 3072, v80
    v_add_u32 v23, 35840, v80
    v_add_u32 v27, 68608, v80
    v_add_u32 v31, 101376, v80
    v_bfe_u32 v80, v1, 2, 2
    v_lshrrev_b32 v81, 5, v1
    v_mul_u32_u24 v81, 4, v81
    v_add_u32 v81, v81, v80
    v_mul_u32_u24 v81, 256, v81
    v_bfe_u32 v82, v1, 4, 1
    v_lshl_add_u32 v81, v82, 5, v81
    v_and_b32 v82, 3, v1
    v_lshl_add_u32 v81, v82, 3, v81
    s_and_b32 s49, s44, 1
    s_mul_i32 s49, s49, 2
    s_add_u32 s50, s49, 0
    v_xor_b32 v82, s50, v80
    v_lshl_add_u32 v82, v82, 6, v81
    v_add_u32 v32, 16384, v82
    v_add_u32 v36, 49152, v82
    v_add_u32 v40, 81920, v82
    v_add_u32 v44, 114688, v82
    v_add_u32 v33, 18432, v82
    v_add_u32 v37, 51200, v82
    v_add_u32 v41, 83968, v82
    v_add_u32 v45, 116736, v82
    s_add_u32 s50, s49, 1
    v_xor_b32 v82, s50, v80
    v_lshl_add_u32 v82, v82, 6, v81
    v_add_u32 v34, 16384, v82
    v_add_u32 v38, 49152, v82
    v_add_u32 v42, 81920, v82
    v_add_u32 v46, 114688, v82
    v_add_u32 v35, 18432, v82
    v_add_u32 v39, 51200, v82
    v_add_u32 v43, 83968, v82
    v_add_u32 v47, 116736, v82
    s_mov_b32 s48, 5
cfg_177:
    s_lshl_b32 s89, s59, 8
    s_lshl_b32 s49, s58, 19
    s_add_u32 s89, s89, s49
    s_mov_b32 s57, 1
    s_mov_b32 s56, 48
    s_add_u32 m0, s94, 0
    s_nop 0
    buffer_load_dwordx4 v12, s[84:87], s89 offen lds
    s_add_u32 m0, s94, 1024
    s_nop 0
    buffer_load_dwordx4 v13, s[84:87], s89 offen lds
    s_add_u32 m0, s94, 2048
    s_nop 0
    buffer_load_dwordx4 v14, s[84:87], s89 offen lds
    s_add_u32 m0, s94, 3072
    s_nop 0
    buffer_load_dwordx4 v15, s[84:87], s89 offen lds
    s_add_u32 s89, s89, 131072
    s_add_u32 m0, s94, 32768
    s_nop 0
    buffer_load_dwordx4 v12, s[84:87], s89 offen lds
    s_add_u32 m0, s94, 33792
    s_nop 0
    buffer_load_dwordx4 v13, s[84:87], s89 offen lds
    s_add_u32 m0, s94, 34816
    s_nop 0
    buffer_load_dwordx4 v14, s[84:87], s89 offen lds
    s_add_u32 m0, s94, 35840
    s_nop 0
    buffer_load_dwordx4 v15, s[84:87], s89 offen lds
    s_add_u32 s89, s89, 131072
    s_add_u32 m0, s94, 65536
    s_nop 0
    buffer_load_dwordx4 v12, s[84:87], s89 offen lds
    s_add_u32 m0, s94, 66560
    s_nop 0
    buffer_load_dwordx4 v13, s[84:87], s89 offen lds
    s_add_u32 m0, s94, 67584
    s_nop 0
    buffer_load_dwordx4 v14, s[84:87], s89 offen lds
    s_add_u32 m0, s94, 68608
    s_nop 0
    buffer_load_dwordx4 v15, s[84:87], s89 offen lds
    s_add_u32 s89, s89, 131072
    s_add_u32 m0, s94, 98304
    s_nop 0
    buffer_load_dwordx4 v12, s[84:87], s89 offen lds
    s_add_u32 m0, s94, 99328
    s_nop 0
    buffer_load_dwordx4 v13, s[84:87], s89 offen lds
    s_add_u32 m0, s94, 100352
    s_nop 0
    buffer_load_dwordx4 v14, s[84:87], s89 offen lds
    s_add_u32 m0, s94, 101376
    s_nop 0
    buffer_load_dwordx4 v15, s[84:87], s89 offen lds
    s_add_u32 s89, s89, 131072
    s_and_b32 s49, s44, 1
    s_lshl_b32 s49, s49, 1
    s_lshl_b32 s50, s59, 2
    s_add_u32 s49, s49, s50
    s_lshl_b32 s53, s49, 18
    s_lshl_b32 s49, s58, 14
    s_add_u32 s53, s53, s49
    s_lshr_b32 s49, s44, 1
    s_lshl_b32 s50, s49, 13
    s_add_u32 s53, s53, s50
    s_add_u32 s53, s53, 0x6800000
    s_mul_i32 s49, s49, 65536
    v_add_u32 v176, s49, v32
    v_add_u32 v177, s49, v33
    v_add_u32 v178, s49, v34
    v_add_u32 v179, s49, v35
    s_nop 11
    s_cmp_eq_u32 s69, 0
    s_cbranch_scc1 et_178
    s_mov_b32 s75, 1
    s_cmp_lg_u32 s44, 0
    s_cbranch_scc1 et_178
    s_lshl_b32 s76, s46, 7
    s_add_u32 s76, s76, 0x6402000
    v_mov_b32 v4, s76
    v_mov_b32 v7, 1
    s_mov_b64 exec, 1
    buffer_atomic_add v7, v4, s[32:35], 0 offen sc0 sc1
    s_mov_b64 exec, -1
et_178:
    s_waitcnt vmcnt(0)
    s_barrier
    ds_read_b64_tr_b16 v[112:113], v176 offset:0
    ds_read_b64_tr_b16 v[114:115], v177 offset:0
    ds_read_b64_tr_b16 v[116:117], v176 offset:4096
    ds_read_b64_tr_b16 v[118:119], v177 offset:4096
    ds_read_b64_tr_b16 v[120:121], v176 offset:8192
    ds_read_b64_tr_b16 v[122:123], v177 offset:8192
    ds_read_b64_tr_b16 v[124:125], v176 offset:12288
    ds_read_b64_tr_b16 v[126:127], v177 offset:12288
    s_waitcnt lgkmcnt(0)
    ds_read_b64_tr_b16 v[128:129], v176 offset:32768
    ds_read_b64_tr_b16 v[130:131], v177 offset:32768
    ds_read_b64_tr_b16 v[132:133], v176 offset:36864
    ds_read_b64_tr_b16 v[134:135], v177 offset:36864
    ds_read_b64_tr_b16 v[136:137], v176 offset:40960
    ds_read_b64_tr_b16 v[138:139], v177 offset:40960
    ds_read_b64_tr_b16 v[140:141], v176 offset:45056
    ds_read_b64_tr_b16 v[142:143], v177 offset:45056
    s_waitcnt lgkmcnt(0)
    ds_read_b64_tr_b16 v[144:145], v178 offset:0
    ds_read_b64_tr_b16 v[146:147], v179 offset:0
    ds_read_b64_tr_b16 v[148:149], v178 offset:4096
    ds_read_b64_tr_b16 v[150:151], v179 offset:4096
    ds_read_b64_tr_b16 v[152:153], v178 offset:8192
    ds_read_b64_tr_b16 v[154:155], v179 offset:8192
    ds_read_b64_tr_b16 v[156:157], v178 offset:12288
    ds_read_b64_tr_b16 v[158:159], v179 offset:12288
    s_waitcnt lgkmcnt(0)
    ds_read_b64_tr_b16 v[160:161], v178 offset:32768
    ds_read_b64_tr_b16 v[162:163], v179 offset:32768
    ds_read_b64_tr_b16 v[164:165], v178 offset:36864
    ds_read_b64_tr_b16 v[166:167], v179 offset:36864
    ds_read_b64_tr_b16 v[168:169], v178 offset:40960
    ds_read_b64_tr_b16 v[170:171], v179 offset:40960
    ds_read_b64_tr_b16 v[172:173], v178 offset:45056
    ds_read_b64_tr_b16 v[174:175], v179 offset:45056
    s_waitcnt lgkmcnt(0)
    s_add_u32 s49, s53, 0
    buffer_store_dwordx4 v[112:115], v2, s[32:35], s49 offen offset:0 sc1
    buffer_store_dwordx4 v[116:119], v2, s[32:35], s49 offen offset:1024 sc1
    buffer_store_dwordx4 v[120:123], v2, s[32:35], s49 offen offset:2048 sc1
    buffer_store_dwordx4 v[124:127], v2, s[32:35], s49 offen offset:3072 sc1
    s_add_u32 s49, s53, 4096
    buffer_store_dwordx4 v[128:131], v2, s[32:35], s49 offen offset:0 sc1
    buffer_store_dwordx4 v[132:135], v2, s[32:35], s49 offen offset:1024 sc1
    buffer_store_dwordx4 v[136:139], v2, s[32:35], s49 offen offset:2048 sc1
    buffer_store_dwordx4 v[140:143], v2, s[32:35], s49 offen offset:3072 sc1
    s_add_u32 s49, s53, 262144
    buffer_store_dwordx4 v[144:147], v2, s[32:35], s49 offen offset:0 sc1
    buffer_store_dwordx4 v[148:151], v2, s[32:35], s49 offen offset:1024 sc1
    buffer_store_dwordx4 v[152:155], v2, s[32:35], s49 offen offset:2048 sc1
    buffer_store_dwordx4 v[156:159], v2, s[32:35], s49 offen offset:3072 sc1
    s_add_u32 s49, s53, 266240
    buffer_store_dwordx4 v[160:163], v2, s[32:35], s49 offen offset:0 sc1
    buffer_store_dwordx4 v[164:167], v2, s[32:35], s49 offen offset:1024 sc1
    buffer_store_dwordx4 v[168:171], v2, s[32:35], s49 offen offset:2048 sc1
    buffer_store_dwordx4 v[172:175], v2, s[32:35], s49 offen offset:3072 sc1
    s_branch mega_kernel_wdone
jobbkv_148:
    s_cmp_lg_u32 s62, 1
    s_cbranch_scc1 nt2_179
    s_lshl_b32 s49, s45, 4
    s_add_u32 s51, s47, s49
    s_lshl_b32 s51, s51, 2
    s_add_u32 s51, s51, s44
    s_lshl_b32 s49, s51, 14
    v_lshlrev_b32 v4, 7, v1
    s_mov_b32 s96, s4
    s_and_b32 s97, s5, 0xffff
    s_mov_b32 s98, 0x400000
    s_mov_b32 s99, 0x00020000
    s_add_u32 s50, s49, 0
    buffer_load_dword v7, v4, s[96:99], s50 offen
    s_add_u32 s50, s49, 8192
    buffer_load_dword v7, v4, s[96:99], s50 offen
    s_nop 4
nt2_179:
    s_lshl_b32 s50, s62, 3
    s_add_u32 s50, s50, s47
    s_sub_u32 s50, s50, 24
    s_lshl_b32 s49, s45, 5
    s_add_u32 s61, s50, s49
    s_lshl_b32 s61, s61, 2
    s_add_u32 s61, s61, s44
    s_cmp_lt_u32 s50, 32
    s_cselect_b32 s61, s61, -1
    s_lshr_b32 s58, s47, 3
    s_add_u32 s58, s58, s62
    s_lshr_b32 s59, s47, 0
    s_and_b32 s59, s59, 7
    s_lshl_b32 s59, s59, 2
    s_add_u32 s59, s59, s45
    s_cmp_ge_u32 s59, 16
    s_cselect_b32 s55, 1, 0
    s_cselect_b64 s[64:65], s[12:13], s[10:11]
    s_mov_b32 s53, 0x1000000
    s_cselect_b32 s53, 0x2000000, s53
    s_and_b32 s59, s59, 15
    s_lshl_b32 s56, s58, 2
    s_add_u32 s56, s56, 80
    s_mov_b32 s57, 4
    s_branch jobbigA_160
jobq_150:
    s_mov_b32 s61, -1
    s_lshr_b32 s58, s47, 2
    s_add_u32 s58, s58, s62
    s_lshr_b32 s59, s47, 0
    s_and_b32 s59, s59, 3
    s_lshl_b32 s59, s59, 2
    s_add_u32 s59, s59, s45
    s_mov_b64 s[64:65], s[8:9]
    s_mov_b32 s53, 0x0
    s_mov_b32 s55, 0
    s_lshl_b32 s56, s58, 2
    s_add_u32 s56, s56, 176
    s_mov_b32 s57, 1
jobbigA_160:
    s_mov_b32 s84, s64
    s_and_b32 s85, s65, 0xffff
    s_mov_b32 s86, 0x800000
    s_mov_b32 s87, 0x00020000
    s_mov_b32 s80, s4
    s_and_b32 s81, s5, 0xffff
    s_mov_b32 s82, 0x400000
    s_mov_b32 s83, 0x00020000
    s_lshl_b32 s89, s59, 9
    s_mov_b32 s91, 524288
    s_mov_b32 s54, 262144
    s_cmp_eq_u32 s48, 1
    s_cbranch_scc1 cfg_180
    s_lshl_b32 s93, s44, 13
    s_add_u32 s94, s93, 32768
    v_lshrrev_b32 v176, 3, v1
    s_lshl_b32 s49, s44, 6
    v_add_u32 v176, s49, v176
    v_and_b32 v177, 7, v1
    s_mov_b32 s50, 2048
    v_add_u32 v178, 0, v176
    v_bfe_u32 v179, v178, 1, 2
    v_bfe_u32 v180, v178, 4, 1
    v_lshl_or_b32 v179, v180, 2, v179
    v_xor_b32 v179, v179, v177
    v_mul_lo_u32 v178, v178, s50
    v_lshl_add_u32 v8, v179, 4, v178
    v_add_u32 v178, 8, v176
    v_bfe_u32 v179, v178, 1, 2
    v_bfe_u32 v180, v178, 4, 1
    v_lshl_or_b32 v179, v180, 2, v179
    v_xor_b32 v179, v179, v177
    v_mul_lo_u32 v178, v178, s50
    v_lshl_add_u32 v9, v179, 4, v178
    v_add_u32 v178, 16, v176
    v_bfe_u32 v179, v178, 1, 2
    v_bfe_u32 v180, v178, 4, 1
    v_lshl_or_b32 v179, v180, 2, v179
    v_xor_b32 v179, v179, v177
    v_mul_lo_u32 v178, v178, s50
    v_lshl_add_u32 v10, v179, 4, v178
    v_add_u32 v178, 24, v176
    v_bfe_u32 v179, v178, 1, 2
    v_bfe_u32 v180, v178, 4, 1
    v_lshl_or_b32 v179, v180, 2, v179
    v_xor_b32 v179, v179, v177
    v_mul_lo_u32 v178, v178, s50
    v_lshl_add_u32 v11, v179, 4, v178
    v_add_u32 v178, 32, v176
    v_bfe_u32 v179, v178, 1, 2
    v_bfe_u32 v180, v178, 4, 1
    v_lshl_or_b32 v179, v180, 2, v179
    v_xor_b32 v179, v179, v177
    v_mul_lo_u32 v178, v178, s50
    v_lshl_add_u32 v12, v179, 4, v178
    v_add_u32 v178, 40, v176
    v_bfe_u32 v179, v178, 1, 2
    v_bfe_u32 v180, v178, 4, 1
    v_lshl_or_b32 v179, v180, 2, v179
    v_xor_b32 v179, v179, v177
    v_mul_lo_u32 v178, v178, s50
    v_lshl_add_u32 v13, v179, 4, v178
    v_add_u32 v178, 48, v176
    v_bfe_u32 v179, v178, 1, 2
    v_bfe_u32 v180, v178, 4, 1
    v_lshl_or_b32 v179, v180, 2, v179
    v_xor_b32 v179, v179, v177
    v_mul_lo_u32 v178, v178, s50
    v_lshl_add_u32 v14, v179, 4, v178
    v_add_u32 v178, 56, v176
    v_bfe_u32 v179, v178, 1, 2
    v_bfe_u32 v180, v178, 4, 1
    v_lshl_or_b32 v179, v180, 2, v179
    v_xor_b32 v179, v179, v177
    v_mul_lo_u32 v178, v178, s50
    v_lshl_add_u32 v15, v179, 4, v178
    v_lshrrev_b32 v176, 5, v1
    s_lshl_b32 s49, s44, 4
    v_add_u32 v176, s49, v176
    v_and_b32 v177, 31, v1
    s_mov_b32 s50, 8192
    v_add_u32 v178, 0, v176
    v_and_b32 v179, 3, v178
    v_bfe_u32 v180, v178, 3, 1
    v_lshl_or_b32 v179, v179, 2, v180
    v_xor_b32 v179, v179, v177
    v_mul_lo_u32 v178, v178, s50
    v_lshl_add_u32 v16, v179, 4, v178
    v_add_u32 v178, 2, v176
    v_and_b32 v179, 3, v178
    v_bfe_u32 v180, v178, 3, 1
    v_lshl_or_b32 v179, v179, 2, v180
    v_xor_b32 v179, v179, v177
    v_mul_lo_u32 v178, v178, s50
    v_lshl_add_u32 v17, v179, 4, v178
    v_add_u32 v178, 4, v176
    v_and_b32 v179, 3, v178
    v_bfe_u32 v180, v178, 3, 1
    v_lshl_or_b32 v179, v179, 2, v180
    v_xor_b32 v179, v179, v177
    v_mul_lo_u32 v178, v178, s50
    v_lshl_add_u32 v18, v179, 4, v178
    v_add_u32 v178, 6, v176
    v_and_b32 v179, 3, v178
    v_bfe_u32 v180, v178, 3, 1
    v_lshl_or_b32 v179, v179, 2, v180
    v_xor_b32 v179, v179, v177
    v_mul_lo_u32 v178, v178, s50
    v_lshl_add_u32 v19, v179, 4, v178
    v_add_u32 v178, 8, v176
    v_and_b32 v179, 3, v178
    v_bfe_u32 v180, v178, 3, 1
    v_lshl_or_b32 v179, v179, 2, v180
    v_xor_b32 v179, v179, v177
    v_mul_lo_u32 v178, v178, s50
    v_lshl_add_u32 v20, v179, 4, v178
    v_add_u32 v178, 10, v176
    v_and_b32 v179, 3, v178
    v_bfe_u32 v180, v178, 3, 1
    v_lshl_or_b32 v179, v179, 2, v180
    v_xor_b32 v179, v179, v177
    v_mul_lo_u32 v178, v178, s50
    v_lshl_add_u32 v21, v179, 4, v178
    v_add_u32 v178, 12, v176
    v_and_b32 v179, 3, v178
    v_bfe_u32 v180, v178, 3, 1
    v_lshl_or_b32 v179, v179, 2, v180
    v_xor_b32 v179, v179, v177
    v_mul_lo_u32 v178, v178, s50
    v_lshl_add_u32 v22, v179, 4, v178
    v_add_u32 v178, 14, v176
    v_and_b32 v179, 3, v178
    v_bfe_u32 v180, v178, 3, 1
    v_lshl_or_b32 v179, v179, 2, v180
    v_xor_b32 v179, v179, v177
    v_mul_lo_u32 v178, v178, s50
    v_lshl_add_u32 v23, v179, 4, v178
    v_bfe_u32 v176, v1, 3, 1
    v_and_b32 v177, 7, v1
    v_lshl_add_u32 v176, v176, 4, v177
    v_lshrrev_b32 v177, 4, v1
    v_lshlrev_b32 v44, 4, v176
    v_lshl_add_u32 v44, v177, 9, v44
    v_bfe_u32 v178, v176, 1, 2
    v_bfe_u32 v179, v176, 4, 1
    v_lshl_or_b32 v178, v179, 2, v178
    s_lshr_b32 s49, s44, 1
    s_lshl_b32 s49, s49, 14
    v_lshl_add_u32 v176, v176, 7, s49
    v_add_u32 v179, 0, v177
    v_xor_b32 v179, v179, v178
    v_lshl_add_u32 v24, v179, 4, v176
    v_add_u32 v26, 65536, v24
    v_add_u32 v179, 4, v177
    v_xor_b32 v179, v179, v178
    v_lshl_add_u32 v25, v179, 4, v176
    v_add_u32 v27, 65536, v25
    v_bfe_u32 v176, v1, 2, 2
    v_lshl_add_u32 v178, v177, 3, v176
    v_lshlrev_b32 v178, 9, v178
    v_and_b32 v179, 1, v1
    v_lshl_add_u32 v178, v179, 3, v178
    v_bfe_u32 v179, v1, 1, 1
    v_lshl_add_u32 v178, v179, 5, v178
    v_and_b32 v179, 1, v177
    v_lshl_add_u32 v178, v179, 4, v178
    s_and_b32 s49, s44, 1
    s_lshl_b32 s49, s49, 2
    s_add_u32 s50, s49, 0
    v_xor_b32 v179, s50, v176
    v_lshl_add_u32 v179, v179, 6, v178
    v_add_u32 v28, 32768, v179
    v_xor_b32 v29, 16, v28
    v_add_u32 v36, 98304, v179
    v_xor_b32 v37, 16, v36
    s_add_u32 s50, s49, 1
    v_xor_b32 v179, s50, v176
    v_lshl_add_u32 v179, v179, 6, v178
    v_add_u32 v30, 32768, v179
    v_xor_b32 v31, 16, v30
    v_add_u32 v38, 98304, v179
    v_xor_b32 v39, 16, v38
    s_add_u32 s50, s49, 2
    v_xor_b32 v179, s50, v176
    v_lshl_add_u32 v179, v179, 6, v178
    v_add_u32 v32, 32768, v179
    v_xor_b32 v33, 16, v32
    v_add_u32 v40, 98304, v179
    v_xor_b32 v41, 16, v40
    s_add_u32 s50, s49, 3
    v_xor_b32 v179, s50, v176
    v_lshl_add_u32 v179, v179, 6, v178
    v_add_u32 v34, 32768, v179
    v_xor_b32 v35, 16, v34
    v_add_u32 v42, 98304, v179
    v_xor_b32 v43, 16, v42
    s_mov_b32 s48, 1
cfg_180:
    s_branch jobbig_159
jobbq_149:
    s_add_u32 s47, s47, s62
    s_mov_b32 s61, -1
    s_mul_i32 s58, s47, 43
    s_lshr_b32 s58, s58, 7
    s_mul_i32 s49, s58, 3
    s_sub_u32 s49, s47, s49
    s_cmp_eq_u32 s49, 2
    s_cselect_b32 s55, 1, 0
    s_lshl_b32 s53, s49, 22
    s_add_u32 s53, s53, 0x4000000
    s_lshl_b32 s49, s49, 2
    s_add_u32 s49, s49, s45
    s_lshl_b32 s89, s49, 9
    s_mov_b32 s59, s45
    s_mov_b32 s84, s20
    s_and_b32 s85, s21, 0xffff
    s_mov_b32 s86, 0x600000
    s_mov_b32 s87, 0x00020000
    s_mov_b32 s80, s18
    s_and_b32 s81, s19, 0xffff
    s_mov_b32 s82, 0x400000
    s_mov_b32 s83, 0x00020000
    s_mov_b32 s91, 393216
    s_mov_b32 s54, 65536
    s_lshl_b32 s56, s58, 2
    s_add_u32 s56, s56, 112
    s_mov_b32 s57, 1
    s_cmp_eq_u32 s48, 2
    s_cbranch_scc1 cfg_181
    s_lshl_b32 s93, s44, 13
    s_add_u32 s94, s93, 32768
    v_lshrrev_b32 v176, 3, v1
    s_lshl_b32 s49, s44, 6
    v_add_u32 v176, s49, v176
    v_and_b32 v177, 7, v1
    s_mov_b32 s50, 2048
    v_add_u32 v178, 0, v176
    v_bfe_u32 v179, v178, 1, 2
    v_bfe_u32 v180, v178, 4, 1
    v_lshl_or_b32 v179, v180, 2, v179
    v_xor_b32 v179, v179, v177
    v_mul_lo_u32 v178, v178, s50
    v_lshl_add_u32 v8, v179, 4, v178
    v_add_u32 v178, 8, v176
    v_bfe_u32 v179, v178, 1, 2
    v_bfe_u32 v180, v178, 4, 1
    v_lshl_or_b32 v179, v180, 2, v179
    v_xor_b32 v179, v179, v177
    v_mul_lo_u32 v178, v178, s50
    v_lshl_add_u32 v9, v179, 4, v178
    v_add_u32 v178, 16, v176
    v_bfe_u32 v179, v178, 1, 2
    v_bfe_u32 v180, v178, 4, 1
    v_lshl_or_b32 v179, v180, 2, v179
    v_xor_b32 v179, v179, v177
    v_mul_lo_u32 v178, v178, s50
    v_lshl_add_u32 v10, v179, 4, v178
    v_add_u32 v178, 24, v176
    v_bfe_u32 v179, v178, 1, 2
    v_bfe_u32 v180, v178, 4, 1
    v_lshl_or_b32 v179, v180, 2, v179
    v_xor_b32 v179, v179, v177
    v_mul_lo_u32 v178, v178, s50
    v_lshl_add_u32 v11, v179, 4, v178
    v_add_u32 v178, 32, v176
    v_bfe_u32 v179, v178, 1, 2
    v_bfe_u32 v180, v178, 4, 1
    v_lshl_or_b32 v179, v180, 2, v179
    v_xor_b32 v179, v179, v177
    v_mul_lo_u32 v178, v178, s50
    v_lshl_add_u32 v12, v179, 4, v178
    v_add_u32 v178, 40, v176
    v_bfe_u32 v179, v178, 1, 2
    v_bfe_u32 v180, v178, 4, 1
    v_lshl_or_b32 v179, v180, 2, v179
    v_xor_b32 v179, v179, v177
    v_mul_lo_u32 v178, v178, s50
    v_lshl_add_u32 v13, v179, 4, v178
    v_add_u32 v178, 48, v176
    v_bfe_u32 v179, v178, 1, 2
    v_bfe_u32 v180, v178, 4, 1
    v_lshl_or_b32 v179, v180, 2, v179
    v_xor_b32 v179, v179, v177
    v_mul_lo_u32 v178, v178, s50
    v_lshl_add_u32 v14, v179, 4, v178
    v_add_u32 v178, 56, v176
    v_bfe_u32 v179, v178, 1, 2
    v_bfe_u32 v180, v178, 4, 1
    v_lshl_or_b32 v179, v180, 2, v179
    v_xor_b32 v179, v179, v177
    v_mul_lo_u32 v178, v178, s50
    v_lshl_add_u32 v15, v179, 4, v178
    v_lshrrev_b32 v176, 5, v1
    s_lshl_b32 s49, s44, 4
    v_add_u32 v176, s49, v176
    v_and_b32 v177, 31, v1
    s_mov_b32 s50, 6144
    v_add_u32 v178, 0, v176
    v_and_b32 v179, 3, v178
    v_bfe_u32 v180, v178, 3, 1
    v_lshl_or_b32 v179, v179, 2, v180
    v_xor_b32 v179, v179, v177
    v_mul_lo_u32 v178, v178, s50
    v_lshl_add_u32 v16, v179, 4, v178
    v_add_u32 v178, 2, v176
    v_and_b32 v179, 3, v178
    v_bfe_u32 v180, v178, 3, 1
    v_lshl_or_b32 v179, v179, 2, v180
    v_xor_b32 v179, v179, v177
    v_mul_lo_u32 v178, v178, s50
    v_lshl_add_u32 v17, v179, 4, v178
    v_add_u32 v178, 4, v176
    v_and_b32 v179, 3, v178
    v_bfe_u32 v180, v178, 3, 1
    v_lshl_or_b32 v179, v179, 2, v180
    v_xor_b32 v179, v179, v177
    v_mul_lo_u32 v178, v178, s50
    v_lshl_add_u32 v18, v179, 4, v178
    v_add_u32 v178, 6, v176
    v_and_b32 v179, 3, v178
    v_bfe_u32 v180, v178, 3, 1
    v_lshl_or_b32 v179, v179, 2, v180
    v_xor_b32 v179, v179, v177
    v_mul_lo_u32 v178, v178, s50
    v_lshl_add_u32 v19, v179, 4, v178
    v_add_u32 v178, 8, v176
    v_and_b32 v179, 3, v178
    v_bfe_u32 v180, v178, 3, 1
    v_lshl_or_b32 v179, v179, 2, v180
    v_xor_b32 v179, v179, v177
    v_mul_lo_u32 v178, v178, s50
    v_lshl_add_u32 v20, v179, 4, v178
    v_add_u32 v178, 10, v176
    v_and_b32 v179, 3, v178
    v_bfe_u32 v180, v178, 3, 1
    v_lshl_or_b32 v179, v179, 2, v180
    v_xor_b32 v179, v179, v177
    v_mul_lo_u32 v178, v178, s50
    v_lshl_add_u32 v21, v179, 4, v178
    v_add_u32 v178, 12, v176
    v_and_b32 v179, 3, v178
    v_bfe_u32 v180, v178, 3, 1
    v_lshl_or_b32 v179, v179, 2, v180
    v_xor_b32 v179, v179, v177
    v_mul_lo_u32 v178, v178, s50
    v_lshl_add_u32 v22, v179, 4, v178
    v_add_u32 v178, 14, v176
    v_and_b32 v179, 3, v178
    v_bfe_u32 v180, v178, 3, 1
    v_lshl_or_b32 v179, v179, 2, v180
    v_xor_b32 v179, v179, v177
    v_mul_lo_u32 v178, v178, s50
    v_lshl_add_u32 v23, v179, 4, v178
    v_bfe_u32 v176, v1, 3, 1
    v_and_b32 v177, 7, v1
    v_lshl_add_u32 v176, v176, 4, v177
    v_lshrrev_b32 v177, 4, v1
    v_lshlrev_b32 v44, 4, v176
    v_lshl_add_u32 v44, v177, 9, v44
    v_bfe_u32 v178, v176, 1, 2
    v_bfe_u32 v179, v176, 4, 1
    v_lshl_or_b32 v178, v179, 2, v178
    s_lshr_b32 s49, s44, 1
    s_lshl_b32 s49, s49, 14
    v_lshl_add_u32 v176, v176, 7, s49
    v_add_u32 v179, 0, v177
    v_xor_b32 v179, v179, v178
    v_lshl_add_u32 v24, v179, 4, v176
    v_add_u32 v26, 65536, v24
    v_add_u32 v179, 4, v177
    v_xor_b32 v179, v179, v178
    v_lshl_add_u32 v25, v179, 4, v176
    v_add_u32 v27, 65536, v25
    v_bfe_u32 v176, v1, 2, 2
    v_lshl_add_u32 v178, v177, 3, v176
    v_lshlrev_b32 v178, 9, v178
    v_and_b32 v179, 1, v1
    v_lshl_add_u32 v178, v179, 3, v178
    v_bfe_u32 v179, v1, 1, 1
    v_lshl_add_u32 v178, v179, 5, v178
    v_and_b32 v179, 1, v177
    v_lshl_add_u32 v178, v179, 4, v178
    s_and_b32 s49, s44, 1
    s_lshl_b32 s49, s49, 2
    s_add_u32 s50, s49, 0
    v_xor_b32 v179, s50, v176
    v_lshl_add_u32 v179, v179, 6, v178
    v_add_u32 v28, 32768, v179
    v_xor_b32 v29, 16, v28
    v_add_u32 v36, 98304, v179
    v_xor_b32 v37, 16, v36
    s_add_u32 s50, s49, 1
    v_xor_b32 v179, s50, v176
    v_lshl_add_u32 v179, v179, 6, v178
    v_add_u32 v30, 32768, v179
    v_xor_b32 v31, 16, v30
    v_add_u32 v38, 98304, v179
    v_xor_b32 v39, 16, v38
    s_add_u32 s50, s49, 2
    v_xor_b32 v179, s50, v176
    v_lshl_add_u32 v179, v179, 6, v178
    v_add_u32 v32, 32768, v179
    v_xor_b32 v33, 16, v32
    v_add_u32 v40, 98304, v179
    v_xor_b32 v41, 16, v40
    s_add_u32 s50, s49, 3
    v_xor_b32 v179, s50, v176
    v_lshl_add_u32 v179, v179, 6, v178
    v_add_u32 v34, 32768, v179
    v_xor_b32 v35, 16, v34
    v_add_u32 v42, 98304, v179
    v_xor_b32 v43, 16, v42
    s_mov_b32 s48, 2
cfg_181:
jobbig_159:
    s_lshl_b32 s88, s58, 19
    s_mov_b32 s90, 128
    s_mov_b32 s92, 7
    s_lshr_b32 s49, s44, 1
    s_lshl_b32 s50, s58, 1
    s_add_u32 s49, s49, s50
    s_mul_i32 s49, s49, 4
    s_mul_i32 s49, s49, s54
    s_add_u32 s53, s53, s49
    s_and_b32 s49, s44, 1
    s_lshl_b32 s50, s59, 1
    s_add_u32 s49, s49, s50
    s_mul_i32 s49, s49, 8192
    s_add_u32 s53, s53, s49
    s_add_u32 m0, s93, 0
    s_nop 0
    buffer_load_dwordx4 v8, s[80:83], s88 offen lds
    s_add_u32 m0, s93, 1024
    s_nop 0
    buffer_load_dwordx4 v9, s[80:83], s88 offen lds
    s_add_u32 m0, s93, 2048
    s_nop 0
    buffer_load_dwordx4 v10, s[80:83], s88 offen lds
    s_add_u32 m0, s93, 3072
    s_nop 0
    buffer_load_dwordx4 v11, s[80:83], s88 offen lds
    s_add_u32 m0, s93, 4096
    s_nop 0
    buffer_load_dwordx4 v12, s[80:83], s88 offen lds
    s_add_u32 m0, s93, 5120
    s_nop 0
    buffer_load_dwordx4 v13, s[80:83], s88 offen lds
    s_add_u32 m0, s93, 6144
    s_nop 0
    buffer_load_dwordx4 v14, s[80:83], s88 offen lds
    s_add_u32 m0, s93, 7168
    s_nop 0
    buffer_load_dwordx4 v15, s[80:83], s88 offen lds
    s_add_u32 m0, s94, 0
    s_nop 0
    buffer_load_dwordx4 v16, s[84:87], s89 offen lds
    s_add_u32 m0, s94, 1024
    s_nop 0
    buffer_load_dwordx4 v17, s[84:87], s89 offen lds
    s_add_u32 m0, s94, 2048
    s_nop 0
    buffer_load_dwordx4 v18, s[84:87], s89 offen lds
    s_add_u32 m0, s94, 3072
    s_nop 0
    buffer_load_dwordx4 v19, s[84:87], s89 offen lds
    s_add_u32 m0, s94, 4096
    s_nop 0
    buffer_load_dwordx4 v20, s[84:87], s89 offen lds
    s_add_u32 m0, s94, 5120
    s_nop 0
    buffer_load_dwordx4 v21, s[84:87], s89 offen lds
    s_add_u32 m0, s94, 6144
    s_nop 0
    buffer_load_dwordx4 v22, s[84:87], s89 offen lds
    s_add_u32 m0, s94, 7168
    s_nop 0
    buffer_load_dwordx4 v23, s[84:87], s89 offen lds
    s_add_u32 s88, s88, s90
    s_add_u32 s89, s89, s91
    s_add_u32 m0, s93, 65536
    s_nop 0
    buffer_load_dwordx4 v8, s[80:83], s88 offen lds
    s_add_u32 m0, s93, 66560
    s_nop 0
    buffer_load_dwordx4 v9, s[80:83], s88 offen lds
    s_add_u32 m0, s93, 67584
    s_nop 0
    buffer_load_dwordx4 v10, s[80:83], s88 offen lds
    s_add_u32 m0, s93, 68608
    s_nop 0
    buffer_load_dwordx4 v11, s[80:83], s88 offen lds
    s_add_u32 m0, s93, 69632
    s_nop 0
    buffer_load_dwordx4 v12, s[80:83], s88 offen lds
    s_add_u32 m0, s93, 70656
    s_nop 0
    buffer_load_dwordx4 v13, s[80:83], s88 offen lds
    s_add_u32 m0, s93, 71680
    s_nop 0
    buffer_load_dwordx4 v14, s[80:83], s88 offen lds
    s_add_u32 m0, s93, 72704
    s_nop 0
    buffer_load_dwordx4 v15, s[80:83], s88 offen lds
    s_add_u32 m0, s94, 65536
    s_nop 0
    buffer_load_dwordx4 v16, s[84:87], s89 offen lds
    s_add_u32 m0, s94, 66560
    s_nop 0
    buffer_load_dwordx4 v17, s[84:87], s89 offen lds
    s_add_u32 m0, s94, 67584
    s_nop 0
    buffer_load_dwordx4 v18, s[84:87], s89 offen lds
    s_add_u32 m0, s94, 68608
    s_nop 0
    buffer_load_dwordx4 v19, s[84:87], s89 offen lds
    s_add_u32 m0, s94, 69632
    s_nop 0
    buffer_load_dwordx4 v20, s[84:87], s89 offen lds
    s_add_u32 m0, s94, 70656
    s_nop 0
    buffer_load_dwordx4 v21, s[84:87], s89 offen lds
    s_add_u32 m0, s94, 71680
    s_nop 0
    buffer_load_dwordx4 v22, s[84:87], s89 offen lds
    s_add_u32 m0, s94, 72704
    s_nop 0
    buffer_load_dwordx4 v23, s[84:87], s89 offen lds
    s_add_u32 s88, s88, s90
    s_add_u32 s89, s89, s91
    s_waitcnt vmcnt(16)
    s_barrier
    ds_read_b128 v[48:51], v24 offset:0
    ds_read_b64_tr_b16 v[112:113], v28 offset:0
    ds_read_b64_tr_b16 v[114:115], v28 offset:2048
    ds_read_b128 v[52:55], v24 offset:1024
    ds_read_b64_tr_b16 v[116:117], v29 offset:0
    ds_read_b64_tr_b16 v[118:119], v29 offset:2048
    ds_read_b128 v[56:59], v24 offset:4096
    ds_read_b64_tr_b16 v[120:121], v30 offset:0
    ds_read_b64_tr_b16 v[122:123], v30 offset:2048
    ds_read_b128 v[60:63], v24 offset:5120
    ds_read_b64_tr_b16 v[124:125], v31 offset:0
    ds_read_b64_tr_b16 v[126:127], v31 offset:2048
    ds_read_b128 v[64:67], v24 offset:8192
    ds_read_b64_tr_b16 v[128:129], v32 offset:0
    ds_read_b64_tr_b16 v[130:131], v32 offset:2048
    ds_read_b128 v[68:71], v24 offset:9216
    ds_read_b64_tr_b16 v[132:133], v33 offset:0
    ds_read_b64_tr_b16 v[134:135], v33 offset:2048
    ds_read_b128 v[72:75], v24 offset:12288
    ds_read_b64_tr_b16 v[136:137], v34 offset:0
    ds_read_b64_tr_b16 v[138:139], v34 offset:2048
    ds_read_b128 v[76:79], v24 offset:13312
    ds_read_b64_tr_b16 v[140:141], v35 offset:0
    ds_read_b64_tr_b16 v[142:143], v35 offset:2048
    s_cmp_eq_u32 s61, -1
    s_cbranch_scc1 nt3_182
    s_lshl_b32 s49, s61, 13
    v_lshlrev_b32 v4, 7, v1
    s_mov_b32 s96, s18
    s_and_b32 s97, s19, 0xffff
    s_mov_b32 s98, 0x400000
    s_mov_b32 s99, 0x00020000
    s_add_u32 s50, s49, 0
    buffer_load_dword v7, v4, s[96:99], s50 offen
    s_nop 4
    s_mov_b32 s96, s22
    s_and_b32 s97, s23, 0xffff
    s_mov_b32 s98, 0x200000
    s_mov_b32 s99, 0x00020000
    s_add_u32 s50, s49, 0
    buffer_load_dword v7, v4, s[96:99], s50 offen
    s_nop 4
    s_lshl_b32 s49, s61, 14
    v_lshlrev_b32 v4, 7, v1
    s_mov_b32 s96, s20
    s_and_b32 s97, s21, 0xffff
    s_mov_b32 s98, 0x600000
    s_mov_b32 s99, 0x00020000
    s_add_u32 s50, s49, 0
    buffer_load_dword v7, v4, s[96:99], s50 offen
    s_add_u32 s50, s49, 8192
    buffer_load_dword v7, v4, s[96:99], s50 offen
    s_nop 4
nt3_182:
    s_cmp_eq_u32 s55, 1
    s_cbranch_scc1 bN_183
    s_waitcnt lgkmcnt(0)
    v_mfma_f32_16x16x32_bf16 a[0:3], v[112:115], v[48:51], 0
    ds_read_b128 v[80:83], v25 offset:0
    v_mfma_f32_16x16x32_bf16 a[4:7], v[116:119], v[48:51], 0
    v_mfma_f32_16x16x32_bf16 a[16:19], v[120:123], v[48:51], 0
    ds_read_b64_tr_b16 v[144:145], v28 offset:16384
    v_mfma_f32_16x16x32_bf16 a[20:23], v[124:127], v[48:51], 0
    v_mfma_f32_16x16x32_bf16 a[32:35], v[128:131], v[48:51], 0
    ds_read_b64_tr_b16 v[146:147], v28 offset:18432
    v_mfma_f32_16x16x32_bf16 a[36:39], v[132:135], v[48:51], 0
    v_mfma_f32_16x16x32_bf16 a[48:51], v[136:139], v[48:51], 0
    v_mfma_f32_16x16x32_bf16 a[52:55], v[140:143], v[48:51], 0
    ds_read_b128 v[84:87], v25 offset:1024
    v_mfma_f32_16x16x32_bf16 a[8:11], v[112:115], v[52:55], 0
    v_mfma_f32_16x16x32_bf16 a[12:15], v[116:119], v[52:55], 0
    ds_read_b64_tr_b16 v[148:149], v29 offset:16384
    v_mfma_f32_16x16x32_bf16 a[24:27], v[120:123], v[52:55], 0
    v_mfma_f32_16x16x32_bf16 a[28:31], v[124:127], v[52:55], 0
    v_mfma_f32_16x16x32_bf16 a[40:43], v[128:131], v[52:55], 0
    ds_read_b64_tr_b16 v[150:151], v29 offset:18432
    v_mfma_f32_16x16x32_bf16 a[44:47], v[132:135], v[52:55], 0
    v_mfma_f32_16x16x32_bf16 a[56:59], v[136:139], v[52:55], 0
    ds_read_b128 v[88:91], v25 offset:4096
    v_mfma_f32_16x16x32_bf16 a[60:63], v[140:143], v[52:55], 0
    v_mfma_f32_16x16x32_bf16 a[64:67], v[112:115], v[56:59], 0
    ds_read_b64_tr_b16 v[152:153], v30 offset:16384
    v_mfma_f32_16x16x32_bf16 a[68:71], v[116:119], v[56:59], 0
    v_mfma_f32_16x16x32_bf16 a[80:83], v[120:123], v[56:59], 0
    v_mfma_f32_16x16x32_bf16 a[84:87], v[124:127], v[56:59], 0
    ds_read_b64_tr_b16 v[154:155], v30 offset:18432
    v_mfma_f32_16x16x32_bf16 a[96:99], v[128:131], v[56:59], 0
    v_mfma_f32_16x16x32_bf16 a[100:103], v[132:135], v[56:59], 0
    ds_read_b128 v[92:95], v25 offset:5120
    v_mfma_f32_16x16x32_bf16 a[112:115], v[136:139], v[56:59], 0
    v_mfma_f32_16x16x32_bf16 a[116:119], v[140:143], v[56:59], 0
    v_mfma_f32_16x16x32_bf16 a[72:75], v[112:115], v[60:63], 0
    ds_read_b64_tr_b16 v[156:157], v31 offset:16384
    v_mfma_f32_16x16x32_bf16 a[76:79], v[116:119], v[60:63], 0
    v_mfma_f32_16x16x32_bf16 a[88:91], v[120:123], v[60:63], 0
    ds_read_b64_tr_b16 v[158:159], v31 offset:18432
    v_mfma_f32_16x16x32_bf16 a[92:95], v[124:127], v[60:63], 0
    v_mfma_f32_16x16x32_bf16 a[104:107], v[128:131], v[60:63], 0
    v_mfma_f32_16x16x32_bf16 a[108:111], v[132:135], v[60:63], 0
    ds_read_b128 v[96:99], v25 offset:8192
    v_mfma_f32_16x16x32_bf16 a[120:123], v[136:139], v[60:63], 0
    v_mfma_f32_16x16x32_bf16 a[124:127], v[140:143], v[60:63], 0
    ds_read_b64_tr_b16 v[160:161], v32 offset:16384
    v_mfma_f32_16x16x32_bf16 a[128:131], v[112:115], v[64:67], 0
    v_mfma_f32_16x16x32_bf16 a[132:135], v[116:119], v[64:67], 0
    ds_read_b64_tr_b16 v[162:163], v32 offset:18432
    v_mfma_f32_16x16x32_bf16 a[144:147], v[120:123], v[64:67], 0
    v_mfma_f32_16x16x32_bf16 a[148:151], v[124:127], v[64:67], 0
    v_mfma_f32_16x16x32_bf16 a[160:163], v[128:131], v[64:67], 0
    ds_read_b128 v[100:103], v25 offset:9216
    v_mfma_f32_16x16x32_bf16 a[164:167], v[132:135], v[64:67], 0
    v_mfma_f32_16x16x32_bf16 a[176:179], v[136:139], v[64:67], 0
    ds_read_b64_tr_b16 v[164:165], v33 offset:16384
    v_mfma_f32_16x16x32_bf16 a[180:183], v[140:143], v[64:67], 0
    v_mfma_f32_16x16x32_bf16 a[136:139], v[112:115], v[68:71], 0
    v_mfma_f32_16x16x32_bf16 a[140:143], v[116:119], v[68:71], 0
    ds_read_b64_tr_b16 v[166:167], v33 offset:18432
    v_mfma_f32_16x16x32_bf16 a[152:155], v[120:123], v[68:71], 0
    v_mfma_f32_16x16x32_bf16 a[156:159], v[124:127], v[68:71], 0
    ds_read_b128 v[104:107], v25 offset:12288
    v_mfma_f32_16x16x32_bf16 a[168:171], v[128:131], v[68:71], 0
    v_mfma_f32_16x16x32_bf16 a[172:175], v[132:135], v[68:71], 0
    ds_read_b64_tr_b16 v[168:169], v34 offset:16384
    v_mfma_f32_16x16x32_bf16 a[184:187], v[136:139], v[68:71], 0
    v_mfma_f32_16x16x32_bf16 a[188:191], v[140:143], v[68:71], 0
    v_mfma_f32_16x16x32_bf16 a[192:195], v[112:115], v[72:75], 0
    ds_read_b64_tr_b16 v[170:171], v34 offset:18432
    v_mfma_f32_16x16x32_bf16 a[196:199], v[116:119], v[72:75], 0
    v_mfma_f32_16x16x32_bf16 a[208:211], v[120:123], v[72:75], 0
    ds_read_b128 v[108:111], v25 offset:13312
    v_mfma_f32_16x16x32_bf16 a[212:215], v[124:127], v[72:75], 0
    v_mfma_f32_16x16x32_bf16 a[224:227], v[128:131], v[72:75], 0
    v_mfma_f32_16x16x32_bf16 a[228:231], v[132:135], v[72:75], 0
    ds_read_b64_tr_b16 v[172:173], v35 offset:16384
    v_mfma_f32_16x16x32_bf16 a[240:243], v[136:139], v[72:75], 0
    v_mfma_f32_16x16x32_bf16 a[244:247], v[140:143], v[72:75], 0
    ds_read_b64_tr_b16 v[174:175], v35 offset:18432
    v_mfma_f32_16x16x32_bf16 a[200:203], v[112:115], v[76:79], 0
    v_mfma_f32_16x16x32_bf16 a[204:207], v[116:119], v[76:79], 0
    v_mfma_f32_16x16x32_bf16 a[216:219], v[120:123], v[76:79], 0
    v_mfma_f32_16x16x32_bf16 a[220:223], v[124:127], v[76:79], 0
    v_mfma_f32_16x16x32_bf16 a[232:235], v[128:131], v[76:79], 0
    v_mfma_f32_16x16x32_bf16 a[236:239], v[132:135], v[76:79], 0
    v_mfma_f32_16x16x32_bf16 a[248:251], v[136:139], v[76:79], 0
    v_mfma_f32_16x16x32_bf16 a[252:255], v[140:143], v[76:79], 0
    s_waitcnt lgkmcnt(0)
    s_waitcnt vmcnt(0)
    s_barrier
    v_mfma_f32_16x16x32_bf16 a[0:3], v[144:147], v[80:83], a[0:3]
    s_add_u32 m0, s93, 0
    v_mfma_f32_16x16x32_bf16 a[4:7], v[148:151], v[80:83], a[4:7]
    buffer_load_dwordx4 v8, s[80:83], s88 offen lds
    v_mfma_f32_16x16x32_bf16 a[16:19], v[152:155], v[80:83], a[16:19]
    ds_read_b128 v[48:51], v26 offset:0
    v_mfma_f32_16x16x32_bf16 a[20:23], v[156:159], v[80:83], a[20:23]
    s_add_u32 m0, s93, 1024
    v_mfma_f32_16x16x32_bf16 a[32:35], v[160:163], v[80:83], a[32:35]
    buffer_load_dwordx4 v9, s[80:83], s88 offen lds
    v_mfma_f32_16x16x32_bf16 a[36:39], v[164:167], v[80:83], a[36:39]
    ds_read_b64_tr_b16 v[112:113], v36 offset:0
    v_mfma_f32_16x16x32_bf16 a[48:51], v[168:171], v[80:83], a[48:51]
    ds_read_b64_tr_b16 v[114:115], v36 offset:2048
    v_mfma_f32_16x16x32_bf16 a[52:55], v[172:175], v[80:83], a[52:55]
    s_add_u32 m0, s93, 2048
    v_mfma_f32_16x16x32_bf16 a[8:11], v[144:147], v[84:87], a[8:11]
    buffer_load_dwordx4 v10, s[80:83], s88 offen lds
    v_mfma_f32_16x16x32_bf16 a[12:15], v[148:151], v[84:87], a[12:15]
    ds_read_b128 v[52:55], v26 offset:1024
    v_mfma_f32_16x16x32_bf16 a[24:27], v[152:155], v[84:87], a[24:27]
    s_add_u32 m0, s93, 3072
    v_mfma_f32_16x16x32_bf16 a[28:31], v[156:159], v[84:87], a[28:31]
    buffer_load_dwordx4 v11, s[80:83], s88 offen lds
    v_mfma_f32_16x16x32_bf16 a[40:43], v[160:163], v[84:87], a[40:43]
    ds_read_b64_tr_b16 v[116:117], v37 offset:0
    v_mfma_f32_16x16x32_bf16 a[44:47], v[164:167], v[84:87], a[44:47]
    ds_read_b64_tr_b16 v[118:119], v37 offset:2048
    v_mfma_f32_16x16x32_bf16 a[56:59], v[168:171], v[84:87], a[56:59]
    s_add_u32 m0, s93, 4096
    v_mfma_f32_16x16x32_bf16 a[60:63], v[172:175], v[84:87], a[60:63]
    buffer_load_dwordx4 v12, s[80:83], s88 offen lds
    v_mfma_f32_16x16x32_bf16 a[64:67], v[144:147], v[88:91], a[64:67]
    ds_read_b128 v[56:59], v26 offset:4096
    v_mfma_f32_16x16x32_bf16 a[68:71], v[148:151], v[88:91], a[68:71]
    s_add_u32 m0, s93, 5120
    v_mfma_f32_16x16x32_bf16 a[80:83], v[152:155], v[88:91], a[80:83]
    buffer_load_dwordx4 v13, s[80:83], s88 offen lds
    v_mfma_f32_16x16x32_bf16 a[84:87], v[156:159], v[88:91], a[84:87]
    ds_read_b64_tr_b16 v[120:121], v38 offset:0
    v_mfma_f32_16x16x32_bf16 a[96:99], v[160:163], v[88:91], a[96:99]
    ds_read_b64_tr_b16 v[122:123], v38 offset:2048
    v_mfma_f32_16x16x32_bf16 a[100:103], v[164:167], v[88:91], a[100:103]
    s_add_u32 m0, s93, 6144
    v_mfma_f32_16x16x32_bf16 a[112:115], v[168:171], v[88:91], a[112:115]
    buffer_load_dwordx4 v14, s[80:83], s88 offen lds
    v_mfma_f32_16x16x32_bf16 a[116:119], v[172:175], v[88:91], a[116:119]
    ds_read_b128 v[60:63], v26 offset:5120
    v_mfma_f32_16x16x32_bf16 a[72:75], v[144:147], v[92:95], a[72:75]
    s_add_u32 m0, s93, 7168
    v_mfma_f32_16x16x32_bf16 a[76:79], v[148:151], v[92:95], a[76:79]
    buffer_load_dwordx4 v15, s[80:83], s88 offen lds
    v_mfma_f32_16x16x32_bf16 a[88:91], v[152:155], v[92:95], a[88:91]
    ds_read_b64_tr_b16 v[124:125], v39 offset:0
    v_mfma_f32_16x16x32_bf16 a[92:95], v[156:159], v[92:95], a[92:95]
    ds_read_b64_tr_b16 v[126:127], v39 offset:2048
    v_mfma_f32_16x16x32_bf16 a[104:107], v[160:163], v[92:95], a[104:107]
    s_add_u32 m0, s94, 0
    v_mfma_f32_16x16x32_bf16 a[108:111], v[164:167], v[92:95], a[108:111]
    buffer_load_dwordx4 v16, s[84:87], s89 offen lds
    v_mfma_f32_16x16x32_bf16 a[120:123], v[168:171], v[92:95], a[120:123]
    ds_read_b128 v[64:67], v26 offset:8192
    v_mfma_f32_16x16x32_bf16 a[124:127], v[172:175], v[92:95], a[124:127]
    s_add_u32 m0, s94, 1024
    v_mfma_f32_16x16x32_bf16 a[128:131], v[144:147], v[96:99], a[128:131]
    buffer_load_dwordx4 v17, s[84:87], s89 offen lds
    v_mfma_f32_16x16x32_bf16 a[132:135], v[148:151], v[96:99], a[132:135]
    ds_read_b64_tr_b16 v[128:129], v40 offset:0
    v_mfma_f32_16x16x32_bf16 a[144:147], v[152:155], v[96:99], a[144:147]
    ds_read_b64_tr_b16 v[130:131], v40 offset:2048
    v_mfma_f32_16x16x32_bf16 a[148:151], v[156:159], v[96:99], a[148:151]
    s_add_u32 m0, s94, 2048
    v_mfma_f32_16x16x32_bf16 a[160:163], v[160:163], v[96:99], a[160:163]
    buffer_load_dwordx4 v18, s[84:87], s89 offen lds
    v_mfma_f32_16x16x32_bf16 a[164:167], v[164:167], v[96:99], a[164:167]
    ds_read_b128 v[68:71], v26 offset:9216
    v_mfma_f32_16x16x32_bf16 a[176:179], v[168:171], v[96:99], a[176:179]
    s_add_u32 m0, s94, 3072
    v_mfma_f32_16x16x32_bf16 a[180:183], v[172:175], v[96:99], a[180:183]
    buffer_load_dwordx4 v19, s[84:87], s89 offen lds
    v_mfma_f32_16x16x32_bf16 a[136:139], v[144:147], v[100:103], a[136:139]
    ds_read_b64_tr_b16 v[132:133], v41 offset:0
    v_mfma_f32_16x16x32_bf16 a[140:143], v[148:151], v[100:103], a[140:143]
    ds_read_b64_tr_b16 v[134:135], v41 offset:2048
    v_mfma_f32_16x16x32_bf16 a[152:155], v[152:155], v[100:103], a[152:155]
    s_add_u32 m0, s94, 4096
    v_mfma_f32_16x16x32_bf16 a[156:159], v[156:159], v[100:103], a[156:159]
    buffer_load_dwordx4 v20, s[84:87], s89 offen lds
    v_mfma_f32_16x16x32_bf16 a[168:171], v[160:163], v[100:103], a[168:171]
    ds_read_b128 v[72:75], v26 offset:12288
    v_mfma_f32_16x16x32_bf16 a[172:175], v[164:167], v[100:103], a[172:175]
    s_add_u32 m0, s94, 5120
    v_mfma_f32_16x16x32_bf16 a[184:187], v[168:171], v[100:103], a[184:187]
    buffer_load_dwordx4 v21, s[84:87], s89 offen lds
    v_mfma_f32_16x16x32_bf16 a[188:191], v[172:175], v[100:103], a[188:191]
    ds_read_b64_tr_b16 v[136:137], v42 offset:0
    v_mfma_f32_16x16x32_bf16 a[192:195], v[144:147], v[104:107], a[192:195]
    ds_read_b64_tr_b16 v[138:139], v42 offset:2048
    v_mfma_f32_16x16x32_bf16 a[196:199], v[148:151], v[104:107], a[196:199]
    s_add_u32 m0, s94, 6144
    v_mfma_f32_16x16x32_bf16 a[208:211], v[152:155], v[104:107], a[208:211]
    buffer_load_dwordx4 v22, s[84:87], s89 offen lds
    v_mfma_f32_16x16x32_bf16 a[212:215], v[156:159], v[104:107], a[212:215]
    ds_read_b128 v[76:79], v26 offset:13312
    v_mfma_f32_16x16x32_bf16 a[224:227], v[160:163], v[104:107], a[224:227]
    s_add_u32 m0, s94, 7168
    v_mfma_f32_16x16x32_bf16 a[228:231], v[164:167], v[104:107], a[228:231]
    buffer_load_dwordx4 v23, s[84:87], s89 offen lds
    v_mfma_f32_16x16x32_bf16 a[240:243], v[168:171], v[104:107], a[240:243]
    ds_read_b64_tr_b16 v[140:141], v43 offset:0
    v_mfma_f32_16x16x32_bf16 a[244:247], v[172:175], v[104:107], a[244:247]
    ds_read_b64_tr_b16 v[142:143], v43 offset:2048
    v_mfma_f32_16x16x32_bf16 a[200:203], v[144:147], v[108:111], a[200:203]
    s_add_u32 s88, s88, s90
    s_add_u32 s89, s89, s91
    v_mfma_f32_16x16x32_bf16 a[204:207], v[148:151], v[108:111], a[204:207]
    v_mfma_f32_16x16x32_bf16 a[216:219], v[152:155], v[108:111], a[216:219]
    v_mfma_f32_16x16x32_bf16 a[220:223], v[156:159], v[108:111], a[220:223]
    v_mfma_f32_16x16x32_bf16 a[232:235], v[160:163], v[108:111], a[232:235]
    v_mfma_f32_16x16x32_bf16 a[236:239], v[164:167], v[108:111], a[236:239]
    v_mfma_f32_16x16x32_bf16 a[248:251], v[168:171], v[108:111], a[248:251]
    v_mfma_f32_16x16x32_bf16 a[252:255], v[172:175], v[108:111], a[252:255]
    s_waitcnt lgkmcnt(0)
    v_mfma_f32_16x16x32_bf16 a[0:3], v[112:115], v[48:51], a[0:3]
    ds_read_b128 v[80:83], v27 offset:0
    v_mfma_f32_16x16x32_bf16 a[4:7], v[116:119], v[48:51], a[4:7]
    v_mfma_f32_16x16x32_bf16 a[16:19], v[120:123], v[48:51], a[16:19]
    ds_read_b64_tr_b16 v[144:145], v36 offset:16384
    v_mfma_f32_16x16x32_bf16 a[20:23], v[124:127], v[48:51], a[20:23]
    v_mfma_f32_16x16x32_bf16 a[32:35], v[128:131], v[48:51], a[32:35]
    ds_read_b64_tr_b16 v[146:147], v36 offset:18432
    v_mfma_f32_16x16x32_bf16 a[36:39], v[132:135], v[48:51], a[36:39]
    v_mfma_f32_16x16x32_bf16 a[48:51], v[136:139], v[48:51], a[48:51]
    v_mfma_f32_16x16x32_bf16 a[52:55], v[140:143], v[48:51], a[52:55]
    ds_read_b128 v[84:87], v27 offset:1024
    v_mfma_f32_16x16x32_bf16 a[8:11], v[112:115], v[52:55], a[8:11]
    v_mfma_f32_16x16x32_bf16 a[12:15], v[116:119], v[52:55], a[12:15]
    ds_read_b64_tr_b16 v[148:149], v37 offset:16384
    v_mfma_f32_16x16x32_bf16 a[24:27], v[120:123], v[52:55], a[24:27]
    v_mfma_f32_16x16x32_bf16 a[28:31], v[124:127], v[52:55], a[28:31]
    v_mfma_f32_16x16x32_bf16 a[40:43], v[128:131], v[52:55], a[40:43]
    ds_read_b64_tr_b16 v[150:151], v37 offset:18432
    v_mfma_f32_16x16x32_bf16 a[44:47], v[132:135], v[52:55], a[44:47]
    v_mfma_f32_16x16x32_bf16 a[56:59], v[136:139], v[52:55], a[56:59]
    ds_read_b128 v[88:91], v27 offset:4096
    v_mfma_f32_16x16x32_bf16 a[60:63], v[140:143], v[52:55], a[60:63]
    v_mfma_f32_16x16x32_bf16 a[64:67], v[112:115], v[56:59], a[64:67]
    ds_read_b64_tr_b16 v[152:153], v38 offset:16384
    v_mfma_f32_16x16x32_bf16 a[68:71], v[116:119], v[56:59], a[68:71]
    v_mfma_f32_16x16x32_bf16 a[80:83], v[120:123], v[56:59], a[80:83]
    v_mfma_f32_16x16x32_bf16 a[84:87], v[124:127], v[56:59], a[84:87]
    ds_read_b64_tr_b16 v[154:155], v38 offset:18432
    v_mfma_f32_16x16x32_bf16 a[96:99], v[128:131], v[56:59], a[96:99]
    v_mfma_f32_16x16x32_bf16 a[100:103], v[132:135], v[56:59], a[100:103]
    ds_read_b128 v[92:95], v27 offset:5120
    v_mfma_f32_16x16x32_bf16 a[112:115], v[136:139], v[56:59], a[112:115]
    v_mfma_f32_16x16x32_bf16 a[116:119], v[140:143], v[56:59], a[116:119]
    v_mfma_f32_16x16x32_bf16 a[72:75], v[112:115], v[60:63], a[72:75]
    ds_read_b64_tr_b16 v[156:157], v39 offset:16384
    v_mfma_f32_16x16x32_bf16 a[76:79], v[116:119], v[60:63], a[76:79]
    v_mfma_f32_16x16x32_bf16 a[88:91], v[120:123], v[60:63], a[88:91]
    ds_read_b64_tr_b16 v[158:159], v39 offset:18432
    v_mfma_f32_16x16x32_bf16 a[92:95], v[124:127], v[60:63], a[92:95]
    v_mfma_f32_16x16x32_bf16 a[104:107], v[128:131], v[60:63], a[104:107]
    v_mfma_f32_16x16x32_bf16 a[108:111], v[132:135], v[60:63], a[108:111]
    ds_read_b128 v[96:99], v27 offset:8192
    v_mfma_f32_16x16x32_bf16 a[120:123], v[136:139], v[60:63], a[120:123]
    v_mfma_f32_16x16x32_bf16 a[124:127], v[140:143], v[60:63], a[124:127]
    ds_read_b64_tr_b16 v[160:161], v40 offset:16384
    v_mfma_f32_16x16x32_bf16 a[128:131], v[112:115], v[64:67], a[128:131]
    v_mfma_f32_16x16x32_bf16 a[132:135], v[116:119], v[64:67], a[132:135]
    ds_read_b64_tr_b16 v[162:163], v40 offset:18432
    v_mfma_f32_16x16x32_bf16 a[144:147], v[120:123], v[64:67], a[144:147]
    v_mfma_f32_16x16x32_bf16 a[148:151], v[124:127], v[64:67], a[148:151]
    v_mfma_f32_16x16x32_bf16 a[160:163], v[128:131], v[64:67], a[160:163]
    ds_read_b128 v[100:103], v27 offset:9216
    v_mfma_f32_16x16x32_bf16 a[164:167], v[132:135], v[64:67], a[164:167]
    v_mfma_f32_16x16x32_bf16 a[176:179], v[136:139], v[64:67], a[176:179]
    ds_read_b64_tr_b16 v[164:165], v41 offset:16384
    v_mfma_f32_16x16x32_bf16 a[180:183], v[140:143], v[64:67], a[180:183]
    v_mfma_f32_16x16x32_bf16 a[136:139], v[112:115], v[68:71], a[136:139]
    v_mfma_f32_16x16x32_bf16 a[140:143], v[116:119], v[68:71], a[140:143]
    ds_read_b64_tr_b16 v[166:167], v41 offset:18432
    v_mfma_f32_16x16x32_bf16 a[152:155], v[120:123], v[68:71], a[152:155]
    v_mfma_f32_16x16x32_bf16 a[156:159], v[124:127], v[68:71], a[156:159]
    ds_read_b128 v[104:107], v27 offset:12288
    v_mfma_f32_16x16x32_bf16 a[168:171], v[128:131], v[68:71], a[168:171]
    v_mfma_f32_16x16x32_bf16 a[172:175], v[132:135], v[68:71], a[172:175]
    ds_read_b64_tr_b16 v[168:169], v42 offset:16384
    v_mfma_f32_16x16x32_bf16 a[184:187], v[136:139], v[68:71], a[184:187]
    v_mfma_f32_16x16x32_bf16 a[188:191], v[140:143], v[68:71], a[188:191]
    v_mfma_f32_16x16x32_bf16 a[192:195], v[112:115], v[72:75], a[192:195]
    ds_read_b64_tr_b16 v[170:171], v42 offset:18432
    v_mfma_f32_16x16x32_bf16 a[196:199], v[116:119], v[72:75], a[196:199]
    v_mfma_f32_16x16x32_bf16 a[208:211], v[120:123], v[72:75], a[208:211]
    ds_read_b128 v[108:111], v27 offset:13312
    v_mfma_f32_16x16x32_bf16 a[212:215], v[124:127], v[72:75], a[212:215]
    v_mfma_f32_16x16x32_bf16 a[224:227], v[128:131], v[72:75], a[224:227]
    v_mfma_f32_16x16x32_bf16 a[228:231], v[132:135], v[72:75], a[228:231]
    ds_read_b64_tr_b16 v[172:173], v43 offset:16384
    v_mfma_f32_16x16x32_bf16 a[240:243], v[136:139], v[72:75], a[240:243]
    v_mfma_f32_16x16x32_bf16 a[244:247], v[140:143], v[72:75], a[244:247]
    ds_read_b64_tr_b16 v[174:175], v43 offset:18432
    v_mfma_f32_16x16x32_bf16 a[200:203], v[112:115], v[76:79], a[200:203]
    v_mfma_f32_16x16x32_bf16 a[204:207], v[116:119], v[76:79], a[204:207]
    v_mfma_f32_16x16x32_bf16 a[216:219], v[120:123], v[76:79], a[216:219]
    v_mfma_f32_16x16x32_bf16 a[220:223], v[124:127], v[76:79], a[220:223]
    v_mfma_f32_16x16x32_bf16 a[232:235], v[128:131], v[76:79], a[232:235]
    v_mfma_f32_16x16x32_bf16 a[236:239], v[132:135], v[76:79], a[236:239]
    v_mfma_f32_16x16x32_bf16 a[248:251], v[136:139], v[76:79], a[248:251]
    v_mfma_f32_16x16x32_bf16 a[252:255], v[140:143], v[76:79], a[252:255]
    s_waitcnt lgkmcnt(0)
    s_waitcnt vmcnt(0)
    s_barrier
    v_mfma_f32_16x16x32_bf16 a[0:3], v[144:147], v[80:83], a[0:3]
    s_add_u32 m0, s93, 65536
    v_mfma_f32_16x16x32_bf16 a[4:7], v[148:151], v[80:83], a[4:7]
    buffer_load_dwordx4 v8, s[80:83], s88 offen lds
    v_mfma_f32_16x16x32_bf16 a[16:19], v[152:155], v[80:83], a[16:19]
    ds_read_b128 v[48:51], v24 offset:0
    v_mfma_f32_16x16x32_bf16 a[20:23], v[156:159], v[80:83], a[20:23]
    s_add_u32 m0, s93, 66560
    v_mfma_f32_16x16x32_bf16 a[32:35], v[160:163], v[80:83], a[32:35]
    buffer_load_dwordx4 v9, s[80:83], s88 offen lds
    v_mfma_f32_16x16x32_bf16 a[36:39], v[164:167], v[80:83], a[36:39]
    ds_read_b64_tr_b16 v[112:113], v28 offset:0
    v_mfma_f32_16x16x32_bf16 a[48:51], v[168:171], v[80:83], a[48:51]
    ds_read_b64_tr_b16 v[114:115], v28 offset:2048
    v_mfma_f32_16x16x32_bf16 a[52:55], v[172:175], v[80:83], a[52:55]
    s_add_u32 m0, s93, 67584
    v_mfma_f32_16x16x32_bf16 a[8:11], v[144:147], v[84:87], a[8:11]
    buffer_load_dwordx4 v10, s[80:83], s88 offen lds
    v_mfma_f32_16x16x32_bf16 a[12:15], v[148:151], v[84:87], a[12:15]
    ds_read_b128 v[52:55], v24 offset:1024
    v_mfma_f32_16x16x32_bf16 a[24:27], v[152:155], v[84:87], a[24:27]
    s_add_u32 m0, s93, 68608
    v_mfma_f32_16x16x32_bf16 a[28:31], v[156:159], v[84:87], a[28:31]
    buffer_load_dwordx4 v11, s[80:83], s88 offen lds
    v_mfma_f32_16x16x32_bf16 a[40:43], v[160:163], v[84:87], a[40:43]
    ds_read_b64_tr_b16 v[116:117], v29 offset:0
    v_mfma_f32_16x16x32_bf16 a[44:47], v[164:167], v[84:87], a[44:47]
    ds_read_b64_tr_b16 v[118:119], v29 offset:2048
    v_mfma_f32_16x16x32_bf16 a[56:59], v[168:171], v[84:87], a[56:59]
    s_add_u32 m0, s93, 69632
    v_mfma_f32_16x16x32_bf16 a[60:63], v[172:175], v[84:87], a[60:63]
    buffer_load_dwordx4 v12, s[80:83], s88 offen lds
    v_mfma_f32_16x16x32_bf16 a[64:67], v[144:147], v[88:91], a[64:67]
    ds_read_b128 v[56:59], v24 offset:4096
    v_mfma_f32_16x16x32_bf16 a[68:71], v[148:151], v[88:91], a[68:71]
    s_add_u32 m0, s93, 70656
    v_mfma_f32_16x16x32_bf16 a[80:83], v[152:155], v[88:91], a[80:83]
    buffer_load_dwordx4 v13, s[80:83], s88 offen lds
    v_mfma_f32_16x16x32_bf16 a[84:87], v[156:159], v[88:91], a[84:87]
    ds_read_b64_tr_b16 v[120:121], v30 offset:0
    v_mfma_f32_16x16x32_bf16 a[96:99], v[160:163], v[88:91], a[96:99]
    ds_read_b64_tr_b16 v[122:123], v30 offset:2048
    v_mfma_f32_16x16x32_bf16 a[100:103], v[164:167], v[88:91], a[100:103]
    s_add_u32 m0, s93, 71680
    v_mfma_f32_16x16x32_bf16 a[112:115], v[168:171], v[88:91], a[112:115]
    buffer_load_dwordx4 v14, s[80:83], s88 offen lds
    v_mfma_f32_16x16x32_bf16 a[116:119], v[172:175], v[88:91], a[116:119]
    ds_read_b128 v[60:63], v24 offset:5120
    v_mfma_f32_16x16x32_bf16 a[72:75], v[144:147], v[92:95], a[72:75]
    s_add_u32 m0, s93, 72704
    v_mfma_f32_16x16x32_bf16 a[76:79], v[148:151], v[92:95], a[76:79]
    buffer_load_dwordx4 v15, s[80:83], s88 offen lds
    v_mfma_f32_16x16x32_bf16 a[88:91], v[152:155], v[92:95], a[88:91]
    ds_read_b64_tr_b16 v[124:125], v31 offset:0
    v_mfma_f32_16x16x32_bf16 a[92:95], v[156:159], v[92:95], a[92:95]
    ds_read_b64_tr_b16 v[126:127], v31 offset:2048
    v_mfma_f32_16x16x32_bf16 a[104:107], v[160:163], v[92:95], a[104:107]
    s_add_u32 m0, s94, 65536
    v_mfma_f32_16x16x32_bf16 a[108:111], v[164:167], v[92:95], a[108:111]
    buffer_load_dwordx4 v16, s[84:87], s89 offen lds
    v_mfma_f32_16x16x32_bf16 a[120:123], v[168:171], v[92:95], a[120:123]
    ds_read_b128 v[64:67], v24 offset:8192
    v_mfma_f32_16x16x32_bf16 a[124:127], v[172:175], v[92:95], a[124:127]
    s_add_u32 m0, s94, 66560
    v_mfma_f32_16x16x32_bf16 a[128:131], v[144:147], v[96:99], a[128:131]
    buffer_load_dwordx4 v17, s[84:87], s89 offen lds
    v_mfma_f32_16x16x32_bf16 a[132:135], v[148:151], v[96:99], a[132:135]
    ds_read_b64_tr_b16 v[128:129], v32 offset:0
    v_mfma_f32_16x16x32_bf16 a[144:147], v[152:155], v[96:99], a[144:147]
    ds_read_b64_tr_b16 v[130:131], v32 offset:2048
    v_mfma_f32_16x16x32_bf16 a[148:151], v[156:159], v[96:99], a[148:151]
    s_add_u32 m0, s94, 67584
    v_mfma_f32_16x16x32_bf16 a[160:163], v[160:163], v[96:99], a[160:163]
    buffer_load_dwordx4 v18, s[84:87], s89 offen lds
    v_mfma_f32_16x16x32_bf16 a[164:167], v[164:167], v[96:99], a[164:167]
    ds_read_b128 v[68:71], v24 offset:9216
    v_mfma_f32_16x16x32_bf16 a[176:179], v[168:171], v[96:99], a[176:179]
    s_add_u32 m0, s94, 68608
    v_mfma_f32_16x16x32_bf16 a[180:183], v[172:175], v[96:99], a[180:183]
    buffer_load_dwordx4 v19, s[84:87], s89 offen lds
    v_mfma_f32_16x16x32_bf16 a[136:139], v[144:147], v[100:103], a[136:139]
    ds_read_b64_tr_b16 v[132:133], v33 offset:0
    v_mfma_f32_16x16x32_bf16 a[140:143], v[148:151], v[100:103], a[140:143]
    ds_read_b64_tr_b16 v[134:135], v33 offset:2048
    v_mfma_f32_16x16x32_bf16 a[152:155], v[152:155], v[100:103], a[152:155]
    s_add_u32 m0, s94, 69632
    v_mfma_f32_16x16x32_bf16 a[156:159], v[156:159], v[100:103], a[156:159]
    buffer_load_dwordx4 v20, s[84:87], s89 offen lds
    v_mfma_f32_16x16x32_bf16 a[168:171], v[160:163], v[100:103], a[168:171]
    ds_read_b128 v[72:75], v24 offset:12288
    v_mfma_f32_16x16x32_bf16 a[172:175], v[164:167], v[100:103], a[172:175]
    s_add_u32 m0, s94, 70656
    v_mfma_f32_16x16x32_bf16 a[184:187], v[168:171], v[100:103], a[184:187]
    buffer_load_dwordx4 v21, s[84:87], s89 offen lds
    v_mfma_f32_16x16x32_bf16 a[188:191], v[172:175], v[100:103], a[188:191]
    ds_read_b64_tr_b16 v[136:137], v34 offset:0
    v_mfma_f32_16x16x32_bf16 a[192:195], v[144:147], v[104:107], a[192:195]
    ds_read_b64_tr_b16 v[138:139], v34 offset:2048
    v_mfma_f32_16x16x32_bf16 a[196:199], v[148:151], v[104:107], a[196:199]
    s_add_u32 m0, s94, 71680
    v_mfma_f32_16x16x32_bf16 a[208:211], v[152:155], v[104:107], a[208:211]
    buffer_load_dwordx4 v22, s[84:87], s89 offen lds
    v_mfma_f32_16x16x32_bf16 a[212:215], v[156:159], v[104:107], a[212:215]
    ds_read_b128 v[76:79], v24 offset:13312
    v_mfma_f32_16x16x32_bf16 a[224:227], v[160:163], v[104:107], a[224:227]
    s_add_u32 m0, s94, 72704
    v_mfma_f32_16x16x32_bf16 a[228:231], v[164:167], v[104:107], a[228:231]
    buffer_load_dwordx4 v23, s[84:87], s89 offen lds
    v_mfma_f32_16x16x32_bf16 a[240:243], v[168:171], v[104:107], a[240:243]
    ds_read_b64_tr_b16 v[140:141], v35 offset:0
    v_mfma_f32_16x16x32_bf16 a[244:247], v[172:175], v[104:107], a[244:247]
    ds_read_b64_tr_b16 v[142:143], v35 offset:2048
    v_mfma_f32_16x16x32_bf16 a[200:203], v[144:147], v[108:111], a[200:203]
    s_add_u32 s88, s88, s90
    s_add_u32 s89, s89, s91
    v_mfma_f32_16x16x32_bf16 a[204:207], v[148:151], v[108:111], a[204:207]
    v_mfma_f32_16x16x32_bf16 a[216:219], v[152:155], v[108:111], a[216:219]
    v_mfma_f32_16x16x32_bf16 a[220:223], v[156:159], v[108:111], a[220:223]
    v_mfma_f32_16x16x32_bf16 a[232:235], v[160:163], v[108:111], a[232:235]
    v_mfma_f32_16x16x32_bf16 a[236:239], v[164:167], v[108:111], a[236:239]
    v_mfma_f32_16x16x32_bf16 a[248:251], v[168:171], v[108:111], a[248:251]
    v_mfma_f32_16x16x32_bf16 a[252:255], v[172:175], v[108:111], a[252:255]
    s_sub_u32 s92, s92, 1
    s_cmp_eq_u32 s92, 0
    s_cbranch_scc1 gxbt_186
glbt_185:
    s_waitcnt lgkmcnt(0)
    v_mfma_f32_16x16x32_bf16 a[0:3], v[112:115], v[48:51], a[0:3]
    ds_read_b128 v[80:83], v25 offset:0
    v_mfma_f32_16x16x32_bf16 a[4:7], v[116:119], v[48:51], a[4:7]
    v_mfma_f32_16x16x32_bf16 a[16:19], v[120:123], v[48:51], a[16:19]
    ds_read_b64_tr_b16 v[144:145], v28 offset:16384
    v_mfma_f32_16x16x32_bf16 a[20:23], v[124:127], v[48:51], a[20:23]
    v_mfma_f32_16x16x32_bf16 a[32:35], v[128:131], v[48:51], a[32:35]
    ds_read_b64_tr_b16 v[146:147], v28 offset:18432
    v_mfma_f32_16x16x32_bf16 a[36:39], v[132:135], v[48:51], a[36:39]
    v_mfma_f32_16x16x32_bf16 a[48:51], v[136:139], v[48:51], a[48:51]
    v_mfma_f32_16x16x32_bf16 a[52:55], v[140:143], v[48:51], a[52:55]
    ds_read_b128 v[84:87], v25 offset:1024
    v_mfma_f32_16x16x32_bf16 a[8:11], v[112:115], v[52:55], a[8:11]
    v_mfma_f32_16x16x32_bf16 a[12:15], v[116:119], v[52:55], a[12:15]
    ds_read_b64_tr_b16 v[148:149], v29 offset:16384
    v_mfma_f32_16x16x32_bf16 a[24:27], v[120:123], v[52:55], a[24:27]
    v_mfma_f32_16x16x32_bf16 a[28:31], v[124:127], v[52:55], a[28:31]
    v_mfma_f32_16x16x32_bf16 a[40:43], v[128:131], v[52:55], a[40:43]
    ds_read_b64_tr_b16 v[150:151], v29 offset:18432
    v_mfma_f32_16x16x32_bf16 a[44:47], v[132:135], v[52:55], a[44:47]
    v_mfma_f32_16x16x32_bf16 a[56:59], v[136:139], v[52:55], a[56:59]
    ds_read_b128 v[88:91], v25 offset:4096
    v_mfma_f32_16x16x32_bf16 a[60:63], v[140:143], v[52:55], a[60:63]
    v_mfma_f32_16x16x32_bf16 a[64:67], v[112:115], v[56:59], a[64:67]
    ds_read_b64_tr_b16 v[152:153], v30 offset:16384
    v_mfma_f32_16x16x32_bf16 a[68:71], v[116:119], v[56:59], a[68:71]
    v_mfma_f32_16x16x32_bf16 a[80:83], v[120:123], v[56:59], a[80:83]
    v_mfma_f32_16x16x32_bf16 a[84:87], v[124:127], v[56:59], a[84:87]
    ds_read_b64_tr_b16 v[154:155], v30 offset:18432
    v_mfma_f32_16x16x32_bf16 a[96:99], v[128:131], v[56:59], a[96:99]
    v_mfma_f32_16x16x32_bf16 a[100:103], v[132:135], v[56:59], a[100:103]
    ds_read_b128 v[92:95], v25 offset:5120
    v_mfma_f32_16x16x32_bf16 a[112:115], v[136:139], v[56:59], a[112:115]
    v_mfma_f32_16x16x32_bf16 a[116:119], v[140:143], v[56:59], a[116:119]
    v_mfma_f32_16x16x32_bf16 a[72:75], v[112:115], v[60:63], a[72:75]
    ds_read_b64_tr_b16 v[156:157], v31 offset:16384
    v_mfma_f32_16x16x32_bf16 a[76:79], v[116:119], v[60:63], a[76:79]
    v_mfma_f32_16x16x32_bf16 a[88:91], v[120:123], v[60:63], a[88:91]
    ds_read_b64_tr_b16 v[158:159], v31 offset:18432
    v_mfma_f32_16x16x32_bf16 a[92:95], v[124:127], v[60:63], a[92:95]
    v_mfma_f32_16x16x32_bf16 a[104:107], v[128:131], v[60:63], a[104:107]
    v_mfma_f32_16x16x32_bf16 a[108:111], v[132:135], v[60:63], a[108:111]
    ds_read_b128 v[96:99], v25 offset:8192
    v_mfma_f32_16x16x32_bf16 a[120:123], v[136:139], v[60:63], a[120:123]
    v_mfma_f32_16x16x32_bf16 a[124:127], v[140:143], v[60:63], a[124:127]
    ds_read_b64_tr_b16 v[160:161], v32 offset:16384
    v_mfma_f32_16x16x32_bf16 a[128:131], v[112:115], v[64:67], a[128:131]
    v_mfma_f32_16x16x32_bf16 a[132:135], v[116:119], v[64:67], a[132:135]
    ds_read_b64_tr_b16 v[162:163], v32 offset:18432
    v_mfma_f32_16x16x32_bf16 a[144:147], v[120:123], v[64:67], a[144:147]
    v_mfma_f32_16x16x32_bf16 a[148:151], v[124:127], v[64:67], a[148:151]
    v_mfma_f32_16x16x32_bf16 a[160:163], v[128:131], v[64:67], a[160:163]
    ds_read_b128 v[100:103], v25 offset:9216
    v_mfma_f32_16x16x32_bf16 a[164:167], v[132:135], v[64:67], a[164:167]
    v_mfma_f32_16x16x32_bf16 a[176:179], v[136:139], v[64:67], a[176:179]
    ds_read_b64_tr_b16 v[164:165], v33 offset:16384
    v_mfma_f32_16x16x32_bf16 a[180:183], v[140:143], v[64:67], a[180:183]
    v_mfma_f32_16x16x32_bf16 a[136:139], v[112:115], v[68:71], a[136:139]
    v_mfma_f32_16x16x32_bf16 a[140:143], v[116:119], v[68:71], a[140:143]
    ds_read_b64_tr_b16 v[166:167], v33 offset:18432
    v_mfma_f32_16x16x32_bf16 a[152:155], v[120:123], v[68:71], a[152:155]
    v_mfma_f32_16x16x32_bf16 a[156:159], v[124:127], v[68:71], a[156:159]
    ds_read_b128 v[104:107], v25 offset:12288
    v_mfma_f32_16x16x32_bf16 a[168:171], v[128:131], v[68:71], a[168:171]
    v_mfma_f32_16x16x32_bf16 a[172:175], v[132:135], v[68:71], a[172:175]
    ds_read_b64_tr_b16 v[168:169], v34 offset:16384
    v_mfma_f32_16x16x32_bf16 a[184:187], v[136:139], v[68:71], a[184:187]
    v_mfma_f32_16x16x32_bf16 a[188:191], v[140:143], v[68:71], a[188:191]
    v_mfma_f32_16x16x32_bf16 a[192:195], v[112:115], v[72:75], a[192:195]
    ds_read_b64_tr_b16 v[170:171], v34 offset:18432
    v_mfma_f32_16x16x32_bf16 a[196:199], v[116:119], v[72:75], a[196:199]
    v_mfma_f32_16x16x32_bf16 a[208:211], v[120:123], v[72:75], a[208:211]
    ds_read_b128 v[108:111], v25 offset:13312
    v_mfma_f32_16x16x32_bf16 a[212:215], v[124:127], v[72:75], a[212:215]
    v_mfma_f32_16x16x32_bf16 a[224:227], v[128:131], v[72:75], a[224:227]
    v_mfma_f32_16x16x32_bf16 a[228:231], v[132:135], v[72:75], a[228:231]
    ds_read_b64_tr_b16 v[172:173], v35 offset:16384
    v_mfma_f32_16x16x32_bf16 a[240:243], v[136:139], v[72:75], a[240:243]
    v_mfma_f32_16x16x32_bf16 a[244:247], v[140:143], v[72:75], a[244:247]
    ds_read_b64_tr_b16 v[174:175], v35 offset:18432
    v_mfma_f32_16x16x32_bf16 a[200:203], v[112:115], v[76:79], a[200:203]
    v_mfma_f32_16x16x32_bf16 a[204:207], v[116:119], v[76:79], a[204:207]
    v_mfma_f32_16x16x32_bf16 a[216:219], v[120:123], v[76:79], a[216:219]
    v_mfma_f32_16x16x32_bf16 a[220:223], v[124:127], v[76:79], a[220:223]
    v_mfma_f32_16x16x32_bf16 a[232:235], v[128:131], v[76:79], a[232:235]
    v_mfma_f32_16x16x32_bf16 a[236:239], v[132:135], v[76:79], a[236:239]
    v_mfma_f32_16x16x32_bf16 a[248:251], v[136:139], v[76:79], a[248:251]
    v_mfma_f32_16x16x32_bf16 a[252:255], v[140:143], v[76:79], a[252:255]
    s_waitcnt lgkmcnt(0)
    s_waitcnt vmcnt(0)
    s_barrier
    v_mfma_f32_16x16x32_bf16 a[0:3], v[144:147], v[80:83], a[0:3]
    s_add_u32 m0, s93, 0
    v_mfma_f32_16x16x32_bf16 a[4:7], v[148:151], v[80:83], a[4:7]
    buffer_load_dwordx4 v8, s[80:83], s88 offen lds
    v_mfma_f32_16x16x32_bf16 a[16:19], v[152:155], v[80:83], a[16:19]
    ds_read_b128 v[48:51], v26 offset:0
    v_mfma_f32_16x16x32_bf16 a[20:23], v[156:159], v[80:83], a[20:23]
    s_add_u32 m0, s93, 1024
    v_mfma_f32_16x16x32_bf16 a[32:35], v[160:163], v[80:83], a[32:35]
    buffer_load_dwordx4 v9, s[80:83], s88 offen lds
    v_mfma_f32_16x16x32_bf16 a[36:39], v[164:167], v[80:83], a[36:39]
    ds_read_b64_tr_b16 v[112:113], v36 offset:0
    v_mfma_f32_16x16x32_bf16 a[48:51], v[168:171], v[80:83], a[48:51]
    ds_read_b64_tr_b16 v[114:115], v36 offset:2048
    v_mfma_f32_16x16x32_bf16 a[52:55], v[172:175], v[80:83], a[52:55]
    s_add_u32 m0, s93, 2048
    v_mfma_f32_16x16x32_bf16 a[8:11], v[144:147], v[84:87], a[8:11]
    buffer_load_dwordx4 v10, s[80:83], s88 offen lds
    v_mfma_f32_16x16x32_bf16 a[12:15], v[148:151], v[84:87], a[12:15]
    ds_read_b128 v[52:55], v26 offset:1024
    v_mfma_f32_16x16x32_bf16 a[24:27], v[152:155], v[84:87], a[24:27]
    s_add_u32 m0, s93, 3072
    v_mfma_f32_16x16x32_bf16 a[28:31], v[156:159], v[84:87], a[28:31]
    buffer_load_dwordx4 v11, s[80:83], s88 offen lds
    v_mfma_f32_16x16x32_bf16 a[40:43], v[160:163], v[84:87], a[40:43]
    ds_read_b64_tr_b16 v[116:117], v37 offset:0
    v_mfma_f32_16x16x32_bf16 a[44:47], v[164:167], v[84:87], a[44:47]
    ds_read_b64_tr_b16 v[118:119], v37 offset:2048
    v_mfma_f32_16x16x32_bf16 a[56:59], v[168:171], v[84:87], a[56:59]
    s_add_u32 m0, s93, 4096
    v_mfma_f32_16x16x32_bf16 a[60:63], v[172:175], v[84:87], a[60:63]
    buffer_load_dwordx4 v12, s[80:83], s88 offen lds
    v_mfma_f32_16x16x32_bf16 a[64:67], v[144:147], v[88:91], a[64:67]
    ds_read_b128 v[56:59], v26 offset:4096
    v_mfma_f32_16x16x32_bf16 a[68:71], v[148:151], v[88:91], a[68:71]
    s_add_u32 m0, s93, 5120
    v_mfma_f32_16x16x32_bf16 a[80:83], v[152:155], v[88:91], a[80:83]
    buffer_load_dwordx4 v13, s[80:83], s88 offen lds
    v_mfma_f32_16x16x32_bf16 a[84:87], v[156:159], v[88:91], a[84:87]
    ds_read_b64_tr_b16 v[120:121], v38 offset:0
    v_mfma_f32_16x16x32_bf16 a[96:99], v[160:163], v[88:91], a[96:99]
    ds_read_b64_tr_b16 v[122:123], v38 offset:2048
    v_mfma_f32_16x16x32_bf16 a[100:103], v[164:167], v[88:91], a[100:103]
    s_add_u32 m0, s93, 6144
    v_mfma_f32_16x16x32_bf16 a[112:115], v[168:171], v[88:91], a[112:115]
    buffer_load_dwordx4 v14, s[80:83], s88 offen lds
    v_mfma_f32_16x16x32_bf16 a[116:119], v[172:175], v[88:91], a[116:119]
    ds_read_b128 v[60:63], v26 offset:5120
    v_mfma_f32_16x16x32_bf16 a[72:75], v[144:147], v[92:95], a[72:75]
    s_add_u32 m0, s93, 7168
    v_mfma_f32_16x16x32_bf16 a[76:79], v[148:151], v[92:95], a[76:79]
    buffer_load_dwordx4 v15, s[80:83], s88 offen lds
    v_mfma_f32_16x16x32_bf16 a[88:91], v[152:155], v[92:95], a[88:91]
    ds_read_b64_tr_b16 v[124:125], v39 offset:0
    v_mfma_f32_16x16x32_bf16 a[92:95], v[156:159], v[92:95], a[92:95]
    ds_read_b64_tr_b16 v[126:127], v39 offset:2048
    v_mfma_f32_16x16x32_bf16 a[104:107], v[160:163], v[92:95], a[104:107]
    s_add_u32 m0, s94, 0
    v_mfma_f32_16x16x32_bf16 a[108:111], v[164:167], v[92:95], a[108:111]
    buffer_load_dwordx4 v16, s[84:87], s89 offen lds
    v_mfma_f32_16x16x32_bf16 a[120:123], v[168:171], v[92:95], a[120:123]
    ds_read_b128 v[64:67], v26 offset:8192
    v_mfma_f32_16x16x32_bf16 a[124:127], v[172:175], v[92:95], a[124:127]
    s_add_u32 m0, s94, 1024
    v_mfma_f32_16x16x32_bf16 a[128:131], v[144:147], v[96:99], a[128:131]
    buffer_load_dwordx4 v17, s[84:87], s89 offen lds
    v_mfma_f32_16x16x32_bf16 a[132:135], v[148:151], v[96:99], a[132:135]
    ds_read_b64_tr_b16 v[128:129], v40 offset:0
    v_mfma_f32_16x16x32_bf16 a[144:147], v[152:155], v[96:99], a[144:147]
    ds_read_b64_tr_b16 v[130:131], v40 offset:2048
    v_mfma_f32_16x16x32_bf16 a[148:151], v[156:159], v[96:99], a[148:151]
    s_add_u32 m0, s94, 2048
    v_mfma_f32_16x16x32_bf16 a[160:163], v[160:163], v[96:99], a[160:163]
    buffer_load_dwordx4 v18, s[84:87], s89 offen lds
    v_mfma_f32_16x16x32_bf16 a[164:167], v[164:167], v[96:99], a[164:167]
    ds_read_b128 v[68:71], v26 offset:9216
    v_mfma_f32_16x16x32_bf16 a[176:179], v[168:171], v[96:99], a[176:179]
    s_add_u32 m0, s94, 3072
    v_mfma_f32_16x16x32_bf16 a[180:183], v[172:175], v[96:99], a[180:183]
    buffer_load_dwordx4 v19, s[84:87], s89 offen lds
    v_mfma_f32_16x16x32_bf16 a[136:139], v[144:147], v[100:103], a[136:139]
    ds_read_b64_tr_b16 v[132:133], v41 offset:0
    v_mfma_f32_16x16x32_bf16 a[140:143], v[148:151], v[100:103], a[140:143]
    ds_read_b64_tr_b16 v[134:135], v41 offset:2048
    v_mfma_f32_16x16x32_bf16 a[152:155], v[152:155], v[100:103], a[152:155]
    s_add_u32 m0, s94, 4096
    v_mfma_f32_16x16x32_bf16 a[156:159], v[156:159], v[100:103], a[156:159]
    buffer_load_dwordx4 v20, s[84:87], s89 offen lds
    v_mfma_f32_16x16x32_bf16 a[168:171], v[160:163], v[100:103], a[168:171]
    ds_read_b128 v[72:75], v26 offset:12288
    v_mfma_f32_16x16x32_bf16 a[172:175], v[164:167], v[100:103], a[172:175]
    s_add_u32 m0, s94, 5120
    v_mfma_f32_16x16x32_bf16 a[184:187], v[168:171], v[100:103], a[184:187]
    buffer_load_dwordx4 v21, s[84:87], s89 offen lds
    v_mfma_f32_16x16x32_bf16 a[188:191], v[172:175], v[100:103], a[188:191]
    ds_read_b64_tr_b16 v[136:137], v42 offset:0
    v_mfma_f32_16x16x32_bf16 a[192:195], v[144:147], v[104:107], a[192:195]
    ds_read_b64_tr_b16 v[138:139], v42 offset:2048
    v_mfma_f32_16x16x32_bf16 a[196:199], v[148:151], v[104:107], a[196:199]
    s_add_u32 m0, s94, 6144
    v_mfma_f32_16x16x32_bf16 a[208:211], v[152:155], v[104:107], a[208:211]
    buffer_load_dwordx4 v22, s[84:87], s89 offen lds
    v_mfma_f32_16x16x32_bf16 a[212:215], v[156:159], v[104:107], a[212:215]
    ds_read_b128 v[76:79], v26 offset:13312
    v_mfma_f32_16x16x32_bf16 a[224:227], v[160:163], v[104:107], a[224:227]
    s_add_u32 m0, s94, 7168
    v_mfma_f32_16x16x32_bf16 a[228:231], v[164:167], v[104:107], a[228:231]
    buffer_load_dwordx4 v23, s[84:87], s89 offen lds
    v_mfma_f32_16x16x32_bf16 a[240:243], v[168:171], v[104:107], a[240:243]
    ds_read_b64_tr_b16 v[140:141], v43 offset:0
    v_mfma_f32_16x16x32_bf16 a[244:247], v[172:175], v[104:107], a[244:247]
    ds_read_b64_tr_b16 v[142:143], v43 offset:2048
    v_mfma_f32_16x16x32_bf16 a[200:203], v[144:147], v[108:111], a[200:203]
    s_add_u32 s88, s88, s90
    s_add_u32 s89, s89, s91
    v_mfma_f32_16x16x32_bf16 a[204:207], v[148:151], v[108:111], a[204:207]
    v_mfma_f32_16x16x32_bf16 a[216:219], v[152:155], v[108:111], a[216:219]
    v_mfma_f32_16x16x32_bf16 a[220:223], v[156:159], v[108:111], a[220:223]
    v_mfma_f32_16x16x32_bf16 a[232:235], v[160:163], v[108:111], a[232:235]
    v_mfma_f32_16x16x32_bf16 a[236:239], v[164:167], v[108:111], a[236:239]
    v_mfma_f32_16x16x32_bf16 a[248:251], v[168:171], v[108:111], a[248:251]
    v_mfma_f32_16x16x32_bf16 a[252:255], v[172:175], v[108:111], a[252:255]
    s_waitcnt lgkmcnt(0)
    v_mfma_f32_16x16x32_bf16 a[0:3], v[112:115], v[48:51], a[0:3]
    ds_read_b128 v[80:83], v27 offset:0
    v_mfma_f32_16x16x32_bf16 a[4:7], v[116:119], v[48:51], a[4:7]
    v_mfma_f32_16x16x32_bf16 a[16:19], v[120:123], v[48:51], a[16:19]
    ds_read_b64_tr_b16 v[144:145], v36 offset:16384
    v_mfma_f32_16x16x32_bf16 a[20:23], v[124:127], v[48:51], a[20:23]
    v_mfma_f32_16x16x32_bf16 a[32:35], v[128:131], v[48:51], a[32:35]
    ds_read_b64_tr_b16 v[146:147], v36 offset:18432
    v_mfma_f32_16x16x32_bf16 a[36:39], v[132:135], v[48:51], a[36:39]
    v_mfma_f32_16x16x32_bf16 a[48:51], v[136:139], v[48:51], a[48:51]
    v_mfma_f32_16x16x32_bf16 a[52:55], v[140:143], v[48:51], a[52:55]
    ds_read_b128 v[84:87], v27 offset:1024
    v_mfma_f32_16x16x32_bf16 a[8:11], v[112:115], v[52:55], a[8:11]
    v_mfma_f32_16x16x32_bf16 a[12:15], v[116:119], v[52:55], a[12:15]
    ds_read_b64_tr_b16 v[148:149], v37 offset:16384
    v_mfma_f32_16x16x32_bf16 a[24:27], v[120:123], v[52:55], a[24:27]
    v_mfma_f32_16x16x32_bf16 a[28:31], v[124:127], v[52:55], a[28:31]
    v_mfma_f32_16x16x32_bf16 a[40:43], v[128:131], v[52:55], a[40:43]
    ds_read_b64_tr_b16 v[150:151], v37 offset:18432
    v_mfma_f32_16x16x32_bf16 a[44:47], v[132:135], v[52:55], a[44:47]
    v_mfma_f32_16x16x32_bf16 a[56:59], v[136:139], v[52:55], a[56:59]
    ds_read_b128 v[88:91], v27 offset:4096
    v_mfma_f32_16x16x32_bf16 a[60:63], v[140:143], v[52:55], a[60:63]
    v_mfma_f32_16x16x32_bf16 a[64:67], v[112:115], v[56:59], a[64:67]
    ds_read_b64_tr_b16 v[152:153], v38 offset:16384
    v_mfma_f32_16x16x32_bf16 a[68:71], v[116:119], v[56:59], a[68:71]
    v_mfma_f32_16x16x32_bf16 a[80:83], v[120:123], v[56:59], a[80:83]
    v_mfma_f32_16x16x32_bf16 a[84:87], v[124:127], v[56:59], a[84:87]
    ds_read_b64_tr_b16 v[154:155], v38 offset:18432
    v_mfma_f32_16x16x32_bf16 a[96:99], v[128:131], v[56:59], a[96:99]
    v_mfma_f32_16x16x32_bf16 a[100:103], v[132:135], v[56:59], a[100:103]
    ds_read_b128 v[92:95], v27 offset:5120
    v_mfma_f32_16x16x32_bf16 a[112:115], v[136:139], v[56:59], a[112:115]
    v_mfma_f32_16x16x32_bf16 a[116:119], v[140:143], v[56:59], a[116:119]
    v_mfma_f32_16x16x32_bf16 a[72:75], v[112:115], v[60:63], a[72:75]
    ds_read_b64_tr_b16 v[156:157], v39 offset:16384
    v_mfma_f32_16x16x32_bf16 a[76:79], v[116:119], v[60:63], a[76:79]
    v_mfma_f32_16x16x32_bf16 a[88:91], v[120:123], v[60:63], a[88:91]
    ds_read_b64_tr_b16 v[158:159], v39 offset:18432
    v_mfma_f32_16x16x32_bf16 a[92:95], v[124:127], v[60:63], a[92:95]
    v_mfma_f32_16x16x32_bf16 a[104:107], v[128:131], v[60:63], a[104:107]
    v_mfma_f32_16x16x32_bf16 a[108:111], v[132:135], v[60:63], a[108:111]
    ds_read_b128 v[96:99], v27 offset:8192
    v_mfma_f32_16x16x32_bf16 a[120:123], v[136:139], v[60:63], a[120:123]
    v_mfma_f32_16x16x32_bf16 a[124:127], v[140:143], v[60:63], a[124:127]
    ds_read_b64_tr_b16 v[160:161], v40 offset:16384
    v_mfma_f32_16x16x32_bf16 a[128:131], v[112:115], v[64:67], a[128:131]
    v_mfma_f32_16x16x32_bf16 a[132:135], v[116:119], v[64:67], a[132:135]
    ds_read_b64_tr_b16 v[162:163], v40 offset:18432
    v_mfma_f32_16x16x32_bf16 a[144:147], v[120:123], v[64:67], a[144:147]
    v_mfma_f32_16x16x32_bf16 a[148:151], v[124:127], v[64:67], a[148:151]
    v_mfma_f32_16x16x32_bf16 a[160:163], v[128:131], v[64:67], a[160:163]
    ds_read_b128 v[100:103], v27 offset:9216
    v_mfma_f32_16x16x32_bf16 a[164:167], v[132:135], v[64:67], a[164:167]
    v_mfma_f32_16x16x32_bf16 a[176:179], v[136:139], v[64:67], a[176:179]
    ds_read_b64_tr_b16 v[164:165], v41 offset:16384
    v_mfma_f32_16x16x32_bf16 a[180:183], v[140:143], v[64:67], a[180:183]
    v_mfma_f32_16x16x32_bf16 a[136:139], v[112:115], v[68:71], a[136:139]
    v_mfma_f32_16x16x32_bf16 a[140:143], v[116:119], v[68:71], a[140:143]
    ds_read_b64_tr_b16 v[166:167], v41 offset:18432
    v_mfma_f32_16x16x32_bf16 a[152:155], v[120:123], v[68:71], a[152:155]
    v_mfma_f32_16x16x32_bf16 a[156:159], v[124:127], v[68:71], a[156:159]
    ds_read_b128 v[104:107], v27 offset:12288
    v_mfma_f32_16x16x32_bf16 a[168:171], v[128:131], v[68:71], a[168:171]
    v_mfma_f32_16x16x32_bf16 a[172:175], v[132:135], v[68:71], a[172:175]
    ds_read_b64_tr_b16 v[168:169], v42 offset:16384
    v_mfma_f32_16x16x32_bf16 a[184:187], v[136:139], v[68:71], a[184:187]
    v_mfma_f32_16x16x32_bf16 a[188:191], v[140:143], v[68:71], a[188:191]
    v_mfma_f32_16x16x32_bf16 a[192:195], v[112:115], v[72:75], a[192:195]
    ds_read_b64_tr_b16 v[170:171], v42 offset:18432
    v_mfma_f32_16x16x32_bf16 a[196:199], v[116:119], v[72:75], a[196:199]
    v_mfma_f32_16x16x32_bf16 a[208:211], v[120:123], v[72:75], a[208:211]
    ds_read_b128 v[108:111], v27 offset:13312
    v_mfma_f32_16x16x32_bf16 a[212:215], v[124:127], v[72:75], a[212:215]
    v_mfma_f32_16x16x32_bf16 a[224:227], v[128:131], v[72:75], a[224:227]
    v_mfma_f32_16x16x32_bf16 a[228:231], v[132:135], v[72:75], a[228:231]
    ds_read_b64_tr_b16 v[172:173], v43 offset:16384
    v_mfma_f32_16x16x32_bf16 a[240:243], v[136:139], v[72:75], a[240:243]
    v_mfma_f32_16x16x32_bf16 a[244:247], v[140:143], v[72:75], a[244:247]
    ds_read_b64_tr_b16 v[174:175], v43 offset:18432
    v_mfma_f32_16x16x32_bf16 a[200:203], v[112:115], v[76:79], a[200:203]
    v_mfma_f32_16x16x32_bf16 a[204:207], v[116:119], v[76:79], a[204:207]
    v_mfma_f32_16x16x32_bf16 a[216:219], v[120:123], v[76:79], a[216:219]
    v_mfma_f32_16x16x32_bf16 a[220:223], v[124:127], v[76:79], a[220:223]
    v_mfma_f32_16x16x32_bf16 a[232:235], v[128:131], v[76:79], a[232:235]
    v_mfma_f32_16x16x32_bf16 a[236:239], v[132:135], v[76:79], a[236:239]
    v_mfma_f32_16x16x32_bf16 a[248:251], v[136:139], v[76:79], a[248:251]
    v_mfma_f32_16x16x32_bf16 a[252:255], v[140:143], v[76:79], a[252:255]
    s_waitcnt lgkmcnt(0)
    s_waitcnt vmcnt(0)
    s_barrier
    v_mfma_f32_16x16x32_bf16 a[0:3], v[144:147], v[80:83], a[0:3]
    s_add_u32 m0, s93, 65536
    v_mfma_f32_16x16x32_bf16 a[4:7], v[148:151], v[80:83], a[4:7]
    buffer_load_dwordx4 v8, s[80:83], s88 offen lds
    v_mfma_f32_16x16x32_bf16 a[16:19], v[152:155], v[80:83], a[16:19]
    ds_read_b128 v[48:51], v24 offset:0
    v_mfma_f32_16x16x32_bf16 a[20:23], v[156:159], v[80:83], a[20:23]
    s_add_u32 m0, s93, 66560
    v_mfma_f32_16x16x32_bf16 a[32:35], v[160:163], v[80:83], a[32:35]
    buffer_load_dwordx4 v9, s[80:83], s88 offen lds
    v_mfma_f32_16x16x32_bf16 a[36:39], v[164:167], v[80:83], a[36:39]
    ds_read_b64_tr_b16 v[112:113], v28 offset:0
    v_mfma_f32_16x16x32_bf16 a[48:51], v[168:171], v[80:83], a[48:51]
    ds_read_b64_tr_b16 v[114:115], v28 offset:2048
    v_mfma_f32_16x16x32_bf16 a[52:55], v[172:175], v[80:83], a[52:55]
    s_add_u32 m0, s93, 67584
    v_mfma_f32_16x16x32_bf16 a[8:11], v[144:147], v[84:87], a[8:11]
    buffer_load_dwordx4 v10, s[80:83], s88 offen lds
    v_mfma_f32_16x16x32_bf16 a[12:15], v[148:151], v[84:87], a[12:15]
    ds_read_b128 v[52:55], v24 offset:1024
    v_mfma_f32_16x16x32_bf16 a[24:27], v[152:155], v[84:87], a[24:27]
    s_add_u32 m0, s93, 68608
    v_mfma_f32_16x16x32_bf16 a[28:31], v[156:159], v[84:87], a[28:31]
    buffer_load_dwordx4 v11, s[80:83], s88 offen lds
    v_mfma_f32_16x16x32_bf16 a[40:43], v[160:163], v[84:87], a[40:43]
    ds_read_b64_tr_b16 v[116:117], v29 offset:0
    v_mfma_f32_16x16x32_bf16 a[44:47], v[164:167], v[84:87], a[44:47]
    ds_read_b64_tr_b16 v[118:119], v29 offset:2048
    v_mfma_f32_16x16x32_bf16 a[56:59], v[168:171], v[84:87], a[56:59]
    s_add_u32 m0, s93, 69632
    v_mfma_f32_16x16x32_bf16 a[60:63], v[172:175], v[84:87], a[60:63]
    buffer_load_dwordx4 v12, s[80:83], s88 offen lds
    v_mfma_f32_16x16x32_bf16 a[64:67], v[144:147], v[88:91], a[64:67]
    ds_read_b128 v[56:59], v24 offset:4096
    v_mfma_f32_16x16x32_bf16 a[68:71], v[148:151], v[88:91], a[68:71]
    s_add_u32 m0, s93, 70656
    v_mfma_f32_16x16x32_bf16 a[80:83], v[152:155], v[88:91], a[80:83]
    buffer_load_dwordx4 v13, s[80:83], s88 offen lds
    v_mfma_f32_16x16x32_bf16 a[84:87], v[156:159], v[88:91], a[84:87]
    ds_read_b64_tr_b16 v[120:121], v30 offset:0
    v_mfma_f32_16x16x32_bf16 a[96:99], v[160:163], v[88:91], a[96:99]
    ds_read_b64_tr_b16 v[122:123], v30 offset:2048
    v_mfma_f32_16x16x32_bf16 a[100:103], v[164:167], v[88:91], a[100:103]
    s_add_u32 m0, s93, 71680
    v_mfma_f32_16x16x32_bf16 a[112:115], v[168:171], v[88:91], a[112:115]
    buffer_load_dwordx4 v14, s[80:83], s88 offen lds
    v_mfma_f32_16x16x32_bf16 a[116:119], v[172:175], v[88:91], a[116:119]
    ds_read_b128 v[60:63], v24 offset:5120
    v_mfma_f32_16x16x32_bf16 a[72:75], v[144:147], v[92:95], a[72:75]
    s_add_u32 m0, s93, 72704
    v_mfma_f32_16x16x32_bf16 a[76:79], v[148:151], v[92:95], a[76:79]
    buffer_load_dwordx4 v15, s[80:83], s88 offen lds
    v_mfma_f32_16x16x32_bf16 a[88:91], v[152:155], v[92:95], a[88:91]
    ds_read_b64_tr_b16 v[124:125], v31 offset:0
    v_mfma_f32_16x16x32_bf16 a[92:95], v[156:159], v[92:95], a[92:95]
    ds_read_b64_tr_b16 v[126:127], v31 offset:2048
    v_mfma_f32_16x16x32_bf16 a[104:107], v[160:163], v[92:95], a[104:107]
    s_add_u32 m0, s94, 65536
    v_mfma_f32_16x16x32_bf16 a[108:111], v[164:167], v[92:95], a[108:111]
    buffer_load_dwordx4 v16, s[84:87], s89 offen lds
    v_mfma_f32_16x16x32_bf16 a[120:123], v[168:171], v[92:95], a[120:123]
    ds_read_b128 v[64:67], v24 offset:8192
    v_mfma_f32_16x16x32_bf16 a[124:127], v[172:175], v[92:95], a[124:127]
    s_add_u32 m0, s94, 66560
    v_mfma_f32_16x16x32_bf16 a[128:131], v[144:147], v[96:99], a[128:131]
    buffer_load_dwordx4 v17, s[84:87], s89 offen lds
    v_mfma_f32_16x16x32_bf16 a[132:135], v[148:151], v[96:99], a[132:135]
    ds_read_b64_tr_b16 v[128:129], v32 offset:0
    v_mfma_f32_16x16x32_bf16 a[144:147], v[152:155], v[96:99], a[144:147]
    ds_read_b64_tr_b16 v[130:131], v32 offset:2048
    v_mfma_f32_16x16x32_bf16 a[148:151], v[156:159], v[96:99], a[148:151]
    s_add_u32 m0, s94, 67584
    v_mfma_f32_16x16x32_bf16 a[160:163], v[160:163], v[96:99], a[160:163]
    buffer_load_dwordx4 v18, s[84:87], s89 offen lds
    v_mfma_f32_16x16x32_bf16 a[164:167], v[164:167], v[96:99], a[164:167]
    ds_read_b128 v[68:71], v24 offset:9216
    v_mfma_f32_16x16x32_bf16 a[176:179], v[168:171], v[96:99], a[176:179]
    s_add_u32 m0, s94, 68608
    v_mfma_f32_16x16x32_bf16 a[180:183], v[172:175], v[96:99], a[180:183]
    buffer_load_dwordx4 v19, s[84:87], s89 offen lds
    v_mfma_f32_16x16x32_bf16 a[136:139], v[144:147], v[100:103], a[136:139]
    ds_read_b64_tr_b16 v[132:133], v33 offset:0
    v_mfma_f32_16x16x32_bf16 a[140:143], v[148:151], v[100:103], a[140:143]
    ds_read_b64_tr_b16 v[134:135], v33 offset:2048
    v_mfma_f32_16x16x32_bf16 a[152:155], v[152:155], v[100:103], a[152:155]
    s_add_u32 m0, s94, 69632
    v_mfma_f32_16x16x32_bf16 a[156:159], v[156:159], v[100:103], a[156:159]
    buffer_load_dwordx4 v20, s[84:87], s89 offen lds
    v_mfma_f32_16x16x32_bf16 a[168:171], v[160:163], v[100:103], a[168:171]
    ds_read_b128 v[72:75], v24 offset:12288
    v_mfma_f32_16x16x32_bf16 a[172:175], v[164:167], v[100:103], a[172:175]
    s_add_u32 m0, s94, 70656
    v_mfma_f32_16x16x32_bf16 a[184:187], v[168:171], v[100:103], a[184:187]
    buffer_load_dwordx4 v21, s[84:87], s89 offen lds
    v_mfma_f32_16x16x32_bf16 a[188:191], v[172:175], v[100:103], a[188:191]
    ds_read_b64_tr_b16 v[136:137], v34 offset:0
    v_mfma_f32_16x16x32_bf16 a[192:195], v[144:147], v[104:107], a[192:195]
    ds_read_b64_tr_b16 v[138:139], v34 offset:2048
    v_mfma_f32_16x16x32_bf16 a[196:199], v[148:151], v[104:107], a[196:199]
    s_add_u32 m0, s94, 71680
    v_mfma_f32_16x16x32_bf16 a[208:211], v[152:155], v[104:107], a[208:211]
    buffer_load_dwordx4 v22, s[84:87], s89 offen lds
    v_mfma_f32_16x16x32_bf16 a[212:215], v[156:159], v[104:107], a[212:215]
    ds_read_b128 v[76:79], v24 offset:13312
    v_mfma_f32_16x16x32_bf16 a[224:227], v[160:163], v[104:107], a[224:227]
    s_add_u32 m0, s94, 72704
    v_mfma_f32_16x16x32_bf16 a[228:231], v[164:167], v[104:107], a[228:231]
    buffer_load_dwordx4 v23, s[84:87], s89 offen lds
    v_mfma_f32_16x16x32_bf16 a[240:243], v[168:171], v[104:107], a[240:243]
    ds_read_b64_tr_b16 v[140:141], v35 offset:0
    v_mfma_f32_16x16x32_bf16 a[244:247], v[172:175], v[104:107], a[244:247]
    ds_read_b64_tr_b16 v[142:143], v35 offset:2048
    v_mfma_f32_16x16x32_bf16 a[200:203], v[144:147], v[108:111], a[200:203]
    s_add_u32 s88, s88, s90
    s_add_u32 s89, s89, s91
    v_mfma_f32_16x16x32_bf16 a[204:207], v[148:151], v[108:111], a[204:207]
    v_mfma_f32_16x16x32_bf16 a[216:219], v[152:155], v[108:111], a[216:219]
    v_mfma_f32_16x16x32_bf16 a[220:223], v[156:159], v[108:111], a[220:223]
    v_mfma_f32_16x16x32_bf16 a[232:235], v[160:163], v[108:111], a[232:235]
    v_mfma_f32_16x16x32_bf16 a[236:239], v[164:167], v[108:111], a[236:239]
    v_mfma_f32_16x16x32_bf16 a[248:251], v[168:171], v[108:111], a[248:251]
    v_mfma_f32_16x16x32_bf16 a[252:255], v[172:175], v[108:111], a[252:255]
    s_sub_u32 s92, s92, 1
    s_cmp_lg_u32 s92, 0
    s_cbranch_scc1 glbt_185
gxbt_186:
    s_waitcnt lgkmcnt(0)
    v_mfma_f32_16x16x32_bf16 a[0:3], v[112:115], v[48:51], a[0:3]
    ds_read_b128 v[80:83], v25 offset:0
    v_mfma_f32_16x16x32_bf16 a[4:7], v[116:119], v[48:51], a[4:7]
    v_mfma_f32_16x16x32_bf16 a[16:19], v[120:123], v[48:51], a[16:19]
    ds_read_b64_tr_b16 v[144:145], v28 offset:16384
    v_mfma_f32_16x16x32_bf16 a[20:23], v[124:127], v[48:51], a[20:23]
    v_mfma_f32_16x16x32_bf16 a[32:35], v[128:131], v[48:51], a[32:35]
    ds_read_b64_tr_b16 v[146:147], v28 offset:18432
    v_mfma_f32_16x16x32_bf16 a[36:39], v[132:135], v[48:51], a[36:39]
    v_mfma_f32_16x16x32_bf16 a[48:51], v[136:139], v[48:51], a[48:51]
    v_mfma_f32_16x16x32_bf16 a[52:55], v[140:143], v[48:51], a[52:55]
    ds_read_b128 v[84:87], v25 offset:1024
    v_mfma_f32_16x16x32_bf16 a[8:11], v[112:115], v[52:55], a[8:11]
    v_mfma_f32_16x16x32_bf16 a[12:15], v[116:119], v[52:55], a[12:15]
    ds_read_b64_tr_b16 v[148:149], v29 offset:16384
    v_mfma_f32_16x16x32_bf16 a[24:27], v[120:123], v[52:55], a[24:27]
    v_mfma_f32_16x16x32_bf16 a[28:31], v[124:127], v[52:55], a[28:31]
    v_mfma_f32_16x16x32_bf16 a[40:43], v[128:131], v[52:55], a[40:43]
    ds_read_b64_tr_b16 v[150:151], v29 offset:18432
    v_mfma_f32_16x16x32_bf16 a[44:47], v[132:135], v[52:55], a[44:47]
    v_mfma_f32_16x16x32_bf16 a[56:59], v[136:139], v[52:55], a[56:59]
    ds_read_b128 v[88:91], v25 offset:4096
    v_mfma_f32_16x16x32_bf16 a[60:63], v[140:143], v[52:55], a[60:63]
    v_mfma_f32_16x16x32_bf16 a[64:67], v[112:115], v[56:59], a[64:67]
    ds_read_b64_tr_b16 v[152:153], v30 offset:16384
    v_mfma_f32_16x16x32_bf16 a[68:71], v[116:119], v[56:59], a[68:71]
    v_mfma_f32_16x16x32_bf16 a[80:83], v[120:123], v[56:59], a[80:83]
    v_mfma_f32_16x16x32_bf16 a[84:87], v[124:127], v[56:59], a[84:87]
    ds_read_b64_tr_b16 v[154:155], v30 offset:18432
    v_mfma_f32_16x16x32_bf16 a[96:99], v[128:131], v[56:59], a[96:99]
    v_mfma_f32_16x16x32_bf16 a[100:103], v[132:135], v[56:59], a[100:103]
    ds_read_b128 v[92:95], v25 offset:5120
    v_mfma_f32_16x16x32_bf16 a[112:115], v[136:139], v[56:59], a[112:115]
    v_mfma_f32_16x16x32_bf16 a[116:119], v[140:143], v[56:59], a[116:119]
    v_mfma_f32_16x16x32_bf16 a[72:75], v[112:115], v[60:63], a[72:75]
    ds_read_b64_tr_b16 v[156:157], v31 offset:16384
    v_mfma_f32_16x16x32_bf16 a[76:79], v[116:119], v[60:63], a[76:79]
    v_mfma_f32_16x16x32_bf16 a[88:91], v[120:123], v[60:63], a[88:91]
    ds_read_b64_tr_b16 v[158:159], v31 offset:18432
    v_mfma_f32_16x16x32_bf16 a[92:95], v[124:127], v[60:63], a[92:95]
    v_mfma_f32_16x16x32_bf16 a[104:107], v[128:131], v[60:63], a[104:107]
    v_mfma_f32_16x16x32_bf16 a[108:111], v[132:135], v[60:63], a[108:111]
    ds_read_b128 v[96:99], v25 offset:8192
    v_mfma_f32_16x16x32_bf16 a[120:123], v[136:139], v[60:63], a[120:123]
    v_mfma_f32_16x16x32_bf16 a[124:127], v[140:143], v[60:63], a[124:127]
    ds_read_b64_tr_b16 v[160:161], v32 offset:16384
    v_mfma_f32_16x16x32_bf16 a[128:131], v[112:115], v[64:67], a[128:131]
    v_mfma_f32_16x16x32_bf16 a[132:135], v[116:119], v[64:67], a[132:135]
    ds_read_b64_tr_b16 v[162:163], v32 offset:18432
    v_mfma_f32_16x16x32_bf16 a[144:147], v[120:123], v[64:67], a[144:147]
    v_mfma_f32_16x16x32_bf16 a[148:151], v[124:127], v[64:67], a[148:151]
    v_mfma_f32_16x16x32_bf16 a[160:163], v[128:131], v[64:67], a[160:163]
    ds_read_b128 v[100:103], v25 offset:9216
    v_mfma_f32_16x16x32_bf16 a[164:167], v[132:135], v[64:67], a[164:167]
    v_mfma_f32_16x16x32_bf16 a[176:179], v[136:139], v[64:67], a[176:179]
    ds_read_b64_tr_b16 v[164:165], v33 offset:16384
    v_mfma_f32_16x16x32_bf16 a[180:183], v[140:143], v[64:67], a[180:183]
    v_mfma_f32_16x16x32_bf16 a[136:139], v[112:115], v[68:71], a[136:139]
    v_mfma_f32_16x16x32_bf16 a[140:143], v[116:119], v[68:71], a[140:143]
    ds_read_b64_tr_b16 v[166:167], v33 offset:18432
    v_mfma_f32_16x16x32_bf16 a[152:155], v[120:123], v[68:71], a[152:155]
    v_mfma_f32_16x16x32_bf16 a[156:159], v[124:127], v[68:71], a[156:159]
    ds_read_b128 v[104:107], v25 offset:12288
    v_mfma_f32_16x16x32_bf16 a[168:171], v[128:131], v[68:71], a[168:171]
    v_mfma_f32_16x16x32_bf16 a[172:175], v[132:135], v[68:71], a[172:175]
    ds_read_b64_tr_b16 v[168:169], v34 offset:16384
    v_mfma_f32_16x16x32_bf16 a[184:187], v[136:139], v[68:71], a[184:187]
    v_mfma_f32_16x16x32_bf16 a[188:191], v[140:143], v[68:71], a[188:191]
    v_mfma_f32_16x16x32_bf16 a[192:195], v[112:115], v[72:75], a[192:195]
    ds_read_b64_tr_b16 v[170:171], v34 offset:18432
    v_mfma_f32_16x16x32_bf16 a[196:199], v[116:119], v[72:75], a[196:199]
    v_mfma_f32_16x16x32_bf16 a[208:211], v[120:123], v[72:75], a[208:211]
    ds_read_b128 v[108:111], v25 offset:13312
    v_mfma_f32_16x16x32_bf16 a[212:215], v[124:127], v[72:75], a[212:215]
    v_mfma_f32_16x16x32_bf16 a[224:227], v[128:131], v[72:75], a[224:227]
    v_mfma_f32_16x16x32_bf16 a[228:231], v[132:135], v[72:75], a[228:231]
    ds_read_b64_tr_b16 v[172:173], v35 offset:16384
    v_mfma_f32_16x16x32_bf16 a[240:243], v[136:139], v[72:75], a[240:243]
    v_mfma_f32_16x16x32_bf16 a[244:247], v[140:143], v[72:75], a[244:247]
    ds_read_b64_tr_b16 v[174:175], v35 offset:18432
    v_mfma_f32_16x16x32_bf16 a[200:203], v[112:115], v[76:79], a[200:203]
    v_mfma_f32_16x16x32_bf16 a[204:207], v[116:119], v[76:79], a[204:207]
    v_mfma_f32_16x16x32_bf16 a[216:219], v[120:123], v[76:79], a[216:219]
    v_mfma_f32_16x16x32_bf16 a[220:223], v[124:127], v[76:79], a[220:223]
    v_mfma_f32_16x16x32_bf16 a[232:235], v[128:131], v[76:79], a[232:235]
    v_mfma_f32_16x16x32_bf16 a[236:239], v[132:135], v[76:79], a[236:239]
    v_mfma_f32_16x16x32_bf16 a[248:251], v[136:139], v[76:79], a[248:251]
    v_mfma_f32_16x16x32_bf16 a[252:255], v[140:143], v[76:79], a[252:255]
    s_waitcnt lgkmcnt(0)
    s_waitcnt vmcnt(0)
    s_barrier
    v_mfma_f32_16x16x32_bf16 a[0:3], v[144:147], v[80:83], a[0:3]
    ds_read_b128 v[48:51], v26 offset:0
    v_mfma_f32_16x16x32_bf16 a[4:7], v[148:151], v[80:83], a[4:7]
    v_mfma_f32_16x16x32_bf16 a[16:19], v[152:155], v[80:83], a[16:19]
    ds_read_b64_tr_b16 v[112:113], v36 offset:0
    v_mfma_f32_16x16x32_bf16 a[20:23], v[156:159], v[80:83], a[20:23]
    v_mfma_f32_16x16x32_bf16 a[32:35], v[160:163], v[80:83], a[32:35]
    ds_read_b64_tr_b16 v[114:115], v36 offset:2048
    v_mfma_f32_16x16x32_bf16 a[36:39], v[164:167], v[80:83], a[36:39]
    v_mfma_f32_16x16x32_bf16 a[48:51], v[168:171], v[80:83], a[48:51]
    v_mfma_f32_16x16x32_bf16 a[52:55], v[172:175], v[80:83], a[52:55]
    ds_read_b128 v[52:55], v26 offset:1024
    v_mfma_f32_16x16x32_bf16 a[8:11], v[144:147], v[84:87], a[8:11]
    v_mfma_f32_16x16x32_bf16 a[12:15], v[148:151], v[84:87], a[12:15]
    ds_read_b64_tr_b16 v[116:117], v37 offset:0
    v_mfma_f32_16x16x32_bf16 a[24:27], v[152:155], v[84:87], a[24:27]
    v_mfma_f32_16x16x32_bf16 a[28:31], v[156:159], v[84:87], a[28:31]
    v_mfma_f32_16x16x32_bf16 a[40:43], v[160:163], v[84:87], a[40:43]
    ds_read_b64_tr_b16 v[118:119], v37 offset:2048
    v_mfma_f32_16x16x32_bf16 a[44:47], v[164:167], v[84:87], a[44:47]
    v_mfma_f32_16x16x32_bf16 a[56:59], v[168:171], v[84:87], a[56:59]
    ds_read_b128 v[56:59], v26 offset:4096
    v_mfma_f32_16x16x32_bf16 a[60:63], v[172:175], v[84:87], a[60:63]
    v_mfma_f32_16x16x32_bf16 a[64:67], v[144:147], v[88:91], a[64:67]
    ds_read_b64_tr_b16 v[120:121], v38 offset:0
    v_mfma_f32_16x16x32_bf16 a[68:71], v[148:151], v[88:91], a[68:71]
    v_mfma_f32_16x16x32_bf16 a[80:83], v[152:155], v[88:91], a[80:83]
    v_mfma_f32_16x16x32_bf16 a[84:87], v[156:159], v[88:91], a[84:87]
    ds_read_b64_tr_b16 v[122:123], v38 offset:2048
    v_mfma_f32_16x16x32_bf16 a[96:99], v[160:163], v[88:91], a[96:99]
    v_mfma_f32_16x16x32_bf16 a[100:103], v[164:167], v[88:91], a[100:103]
    ds_read_b128 v[60:63], v26 offset:5120
    v_mfma_f32_16x16x32_bf16 a[112:115], v[168:171], v[88:91], a[112:115]
    v_mfma_f32_16x16x32_bf16 a[116:119], v[172:175], v[88:91], a[116:119]
    v_mfma_f32_16x16x32_bf16 a[72:75], v[144:147], v[92:95], a[72:75]
    ds_read_b64_tr_b16 v[124:125], v39 offset:0
    v_mfma_f32_16x16x32_bf16 a[76:79], v[148:151], v[92:95], a[76:79]
    v_mfma_f32_16x16x32_bf16 a[88:91], v[152:155], v[92:95], a[88:91]
    ds_read_b64_tr_b16 v[126:127], v39 offset:2048
    v_mfma_f32_16x16x32_bf16 a[92:95], v[156:159], v[92:95], a[92:95]
    v_mfma_f32_16x16x32_bf16 a[104:107], v[160:163], v[92:95], a[104:107]
    v_mfma_f32_16x16x32_bf16 a[108:111], v[164:167], v[92:95], a[108:111]
    ds_read_b128 v[64:67], v26 offset:8192
    v_mfma_f32_16x16x32_bf16 a[120:123], v[168:171], v[92:95], a[120:123]
    v_mfma_f32_16x16x32_bf16 a[124:127], v[172:175], v[92:95], a[124:127]
    ds_read_b64_tr_b16 v[128:129], v40 offset:0
    v_mfma_f32_16x16x32_bf16 a[128:131], v[144:147], v[96:99], a[128:131]
    v_mfma_f32_16x16x32_bf16 a[132:135], v[148:151], v[96:99], a[132:135]
    ds_read_b64_tr_b16 v[130:131], v40 offset:2048
    v_mfma_f32_16x16x32_bf16 a[144:147], v[152:155], v[96:99], a[144:147]
    v_mfma_f32_16x16x32_bf16 a[148:151], v[156:159], v[96:99], a[148:151]
    v_mfma_f32_16x16x32_bf16 a[160:163], v[160:163], v[96:99], a[160:163]
    ds_read_b128 v[68:71], v26 offset:9216
    v_mfma_f32_16x16x32_bf16 a[164:167], v[164:167], v[96:99], a[164:167]
    v_mfma_f32_16x16x32_bf16 a[176:179], v[168:171], v[96:99], a[176:179]
    ds_read_b64_tr_b16 v[132:133], v41 offset:0
    v_mfma_f32_16x16x32_bf16 a[180:183], v[172:175], v[96:99], a[180:183]
    v_mfma_f32_16x16x32_bf16 a[136:139], v[144:147], v[100:103], a[136:139]
    v_mfma_f32_16x16x32_bf16 a[140:143], v[148:151], v[100:103], a[140:143]
    ds_read_b64_tr_b16 v[134:135], v41 offset:2048
    v_mfma_f32_16x16x32_bf16 a[152:155], v[152:155], v[100:103], a[152:155]
    v_mfma_f32_16x16x32_bf16 a[156:159], v[156:159], v[100:103], a[156:159]
    ds_read_b128 v[72:75], v26 offset:12288
    v_mfma_f32_16x16x32_bf16 a[168:171], v[160:163], v[100:103], a[168:171]
    v_mfma_f32_16x16x32_bf16 a[172:175], v[164:167], v[100:103], a[172:175]
    ds_read_b64_tr_b16 v[136:137], v42 offset:0
    v_mfma_f32_16x16x32_bf16 a[184:187], v[168:171], v[100:103], a[184:187]
    v_mfma_f32_16x16x32_bf16 a[188:191], v[172:175], v[100:103], a[188:191]
    v_mfma_f32_16x16x32_bf16 a[192:195], v[144:147], v[104:107], a[192:195]
    ds_read_b64_tr_b16 v[138:139], v42 offset:2048
    v_mfma_f32_16x16x32_bf16 a[196:199], v[148:151], v[104:107], a[196:199]
    v_mfma_f32_16x16x32_bf16 a[208:211], v[152:155], v[104:107], a[208:211]
    ds_read_b128 v[76:79], v26 offset:13312
    v_mfma_f32_16x16x32_bf16 a[212:215], v[156:159], v[104:107], a[212:215]
    v_mfma_f32_16x16x32_bf16 a[224:227], v[160:163], v[104:107], a[224:227]
    v_mfma_f32_16x16x32_bf16 a[228:231], v[164:167], v[104:107], a[228:231]
    ds_read_b64_tr_b16 v[140:141], v43 offset:0
    v_mfma_f32_16x16x32_bf16 a[240:243], v[168:171], v[104:107], a[240:243]
    v_mfma_f32_16x16x32_bf16 a[244:247], v[172:175], v[104:107], a[244:247]
    ds_read_b64_tr_b16 v[142:143], v43 offset:2048
    v_mfma_f32_16x16x32_bf16 a[200:203], v[144:147], v[108:111], a[200:203]
    v_mfma_f32_16x16x32_bf16 a[204:207], v[148:151], v[108:111], a[204:207]
    v_mfma_f32_16x16x32_bf16 a[216:219], v[152:155], v[108:111], a[216:219]
    v_mfma_f32_16x16x32_bf16 a[220:223], v[156:159], v[108:111], a[220:223]
    v_mfma_f32_16x16x32_bf16 a[232:235], v[160:163], v[108:111], a[232:235]
    v_mfma_f32_16x16x32_bf16 a[236:239], v[164:167], v[108:111], a[236:239]
    v_mfma_f32_16x16x32_bf16 a[248:251], v[168:171], v[108:111], a[248:251]
    v_mfma_f32_16x16x32_bf16 a[252:255], v[172:175], v[108:111], a[252:255]
    s_waitcnt lgkmcnt(0)
    v_mfma_f32_16x16x32_bf16 a[0:3], v[112:115], v[48:51], a[0:3]
    ds_read_b128 v[80:83], v27 offset:0
    v_mfma_f32_16x16x32_bf16 a[4:7], v[116:119], v[48:51], a[4:7]
    v_mfma_f32_16x16x32_bf16 a[16:19], v[120:123], v[48:51], a[16:19]
    ds_read_b64_tr_b16 v[144:145], v36 offset:16384
    v_mfma_f32_16x16x32_bf16 a[20:23], v[124:127], v[48:51], a[20:23]
    v_mfma_f32_16x16x32_bf16 a[32:35], v[128:131], v[48:51], a[32:35]
    ds_read_b64_tr_b16 v[146:147], v36 offset:18432
    v_mfma_f32_16x16x32_bf16 a[36:39], v[132:135], v[48:51], a[36:39]
    v_mfma_f32_16x16x32_bf16 a[48:51], v[136:139], v[48:51], a[48:51]
    v_mfma_f32_16x16x32_bf16 a[52:55], v[140:143], v[48:51], a[52:55]
    ds_read_b128 v[84:87], v27 offset:1024
    v_mfma_f32_16x16x32_bf16 a[8:11], v[112:115], v[52:55], a[8:11]
    v_mfma_f32_16x16x32_bf16 a[12:15], v[116:119], v[52:55], a[12:15]
    ds_read_b64_tr_b16 v[148:149], v37 offset:16384
    v_mfma_f32_16x16x32_bf16 a[24:27], v[120:123], v[52:55], a[24:27]
    v_mfma_f32_16x16x32_bf16 a[28:31], v[124:127], v[52:55], a[28:31]
    v_mfma_f32_16x16x32_bf16 a[40:43], v[128:131], v[52:55], a[40:43]
    ds_read_b64_tr_b16 v[150:151], v37 offset:18432
    v_mfma_f32_16x16x32_bf16 a[44:47], v[132:135], v[52:55], a[44:47]
    v_mfma_f32_16x16x32_bf16 a[56:59], v[136:139], v[52:55], a[56:59]
    ds_read_b128 v[88:91], v27 offset:4096
    v_mfma_f32_16x16x32_bf16 a[60:63], v[140:143], v[52:55], a[60:63]
    v_mfma_f32_16x16x32_bf16 a[64:67], v[112:115], v[56:59], a[64:67]
    ds_read_b64_tr_b16 v[152:153], v38 offset:16384
    v_mfma_f32_16x16x32_bf16 a[68:71], v[116:119], v[56:59], a[68:71]
    v_mfma_f32_16x16x32_bf16 a[80:83], v[120:123], v[56:59], a[80:83]
    v_mfma_f32_16x16x32_bf16 a[84:87], v[124:127], v[56:59], a[84:87]
    ds_read_b64_tr_b16 v[154:155], v38 offset:18432
    v_mfma_f32_16x16x32_bf16 a[96:99], v[128:131], v[56:59], a[96:99]
    v_mfma_f32_16x16x32_bf16 a[100:103], v[132:135], v[56:59], a[100:103]
    ds_read_b128 v[92:95], v27 offset:5120
    v_mfma_f32_16x16x32_bf16 a[112:115], v[136:139], v[56:59], a[112:115]
    v_mfma_f32_16x16x32_bf16 a[116:119], v[140:143], v[56:59], a[116:119]
    v_mfma_f32_16x16x32_bf16 a[72:75], v[112:115], v[60:63], a[72:75]
    ds_read_b64_tr_b16 v[156:157], v39 offset:16384
    v_mfma_f32_16x16x32_bf16 a[76:79], v[116:119], v[60:63], a[76:79]
    v_mfma_f32_16x16x32_bf16 a[88:91], v[120:123], v[60:63], a[88:91]
    ds_read_b64_tr_b16 v[158:159], v39 offset:18432
    v_mfma_f32_16x16x32_bf16 a[92:95], v[124:127], v[60:63], a[92:95]
    v_mfma_f32_16x16x32_bf16 a[104:107], v[128:131], v[60:63], a[104:107]
    v_mfma_f32_16x16x32_bf16 a[108:111], v[132:135], v[60:63], a[108:111]
    ds_read_b128 v[96:99], v27 offset:8192
    v_mfma_f32_16x16x32_bf16 a[120:123], v[136:139], v[60:63], a[120:123]
    v_mfma_f32_16x16x32_bf16 a[124:127], v[140:143], v[60:63], a[124:127]
    ds_read_b64_tr_b16 v[160:161], v40 offset:16384
    v_mfma_f32_16x16x32_bf16 a[128:131], v[112:115], v[64:67], a[128:131]
    v_mfma_f32_16x16x32_bf16 a[132:135], v[116:119], v[64:67], a[132:135]
    ds_read_b64_tr_b16 v[162:163], v40 offset:18432
    v_mfma_f32_16x16x32_bf16 a[144:147], v[120:123], v[64:67], a[144:147]
    v_mfma_f32_16x16x32_bf16 a[148:151], v[124:127], v[64:67], a[148:151]
    v_mfma_f32_16x16x32_bf16 a[160:163], v[128:131], v[64:67], a[160:163]
    ds_read_b128 v[100:103], v27 offset:9216
    v_mfma_f32_16x16x32_bf16 a[164:167], v[132:135], v[64:67], a[164:167]
    v_mfma_f32_16x16x32_bf16 a[176:179], v[136:139], v[64:67], a[176:179]
    ds_read_b64_tr_b16 v[164:165], v41 offset:16384
    v_mfma_f32_16x16x32_bf16 a[180:183], v[140:143], v[64:67], a[180:183]
    v_mfma_f32_16x16x32_bf16 a[136:139], v[112:115], v[68:71], a[136:139]
    v_mfma_f32_16x16x32_bf16 a[140:143], v[116:119], v[68:71], a[140:143]
    ds_read_b64_tr_b16 v[166:167], v41 offset:18432
    v_mfma_f32_16x16x32_bf16 a[152:155], v[120:123], v[68:71], a[152:155]
    v_mfma_f32_16x16x32_bf16 a[156:159], v[124:127], v[68:71], a[156:159]
    ds_read_b128 v[104:107], v27 offset:12288
    v_mfma_f32_16x16x32_bf16 a[168:171], v[128:131], v[68:71], a[168:171]
    v_mfma_f32_16x16x32_bf16 a[172:175], v[132:135], v[68:71], a[172:175]
    ds_read_b64_tr_b16 v[168:169], v42 offset:16384
    v_mfma_f32_16x16x32_bf16 a[184:187], v[136:139], v[68:71], a[184:187]
    v_mfma_f32_16x16x32_bf16 a[188:191], v[140:143], v[68:71], a[188:191]
    v_mfma_f32_16x16x32_bf16 a[192:195], v[112:115], v[72:75], a[192:195]
    ds_read_b64_tr_b16 v[170:171], v42 offset:18432
    v_mfma_f32_16x16x32_bf16 a[196:199], v[116:119], v[72:75], a[196:199]
    v_mfma_f32_16x16x32_bf16 a[208:211], v[120:123], v[72:75], a[208:211]
    ds_read_b128 v[108:111], v27 offset:13312
    v_mfma_f32_16x16x32_bf16 a[212:215], v[124:127], v[72:75], a[212:215]
    v_mfma_f32_16x16x32_bf16 a[224:227], v[128:131], v[72:75], a[224:227]
    v_mfma_f32_16x16x32_bf16 a[228:231], v[132:135], v[72:75], a[228:231]
    ds_read_b64_tr_b16 v[172:173], v43 offset:16384
    v_mfma_f32_16x16x32_bf16 a[240:243], v[136:139], v[72:75], a[240:243]
    v_mfma_f32_16x16x32_bf16 a[244:247], v[140:143], v[72:75], a[244:247]
    ds_read_b64_tr_b16 v[174:175], v43 offset:18432
    v_mfma_f32_16x16x32_bf16 a[200:203], v[112:115], v[76:79], a[200:203]
    v_mfma_f32_16x16x32_bf16 a[204:207], v[116:119], v[76:79], a[204:207]
    v_mfma_f32_16x16x32_bf16 a[216:219], v[120:123], v[76:79], a[216:219]
    v_mfma_f32_16x16x32_bf16 a[220:223], v[124:127], v[76:79], a[220:223]
    v_mfma_f32_16x16x32_bf16 a[232:235], v[128:131], v[76:79], a[232:235]
    v_mfma_f32_16x16x32_bf16 a[236:239], v[132:135], v[76:79], a[236:239]
    v_mfma_f32_16x16x32_bf16 a[248:251], v[136:139], v[76:79], a[248:251]
    v_mfma_f32_16x16x32_bf16 a[252:255], v[140:143], v[76:79], a[252:255]
    s_waitcnt lgkmcnt(0)
    v_mfma_f32_16x16x32_bf16 a[0:3], v[144:147], v[80:83], a[0:3]
    v_mfma_f32_16x16x32_bf16 a[4:7], v[148:151], v[80:83], a[4:7]
    v_mfma_f32_16x16x32_bf16 a[16:19], v[152:155], v[80:83], a[16:19]
    v_mfma_f32_16x16x32_bf16 a[20:23], v[156:159], v[80:83], a[20:23]
    v_mfma_f32_16x16x32_bf16 a[32:35], v[160:163], v[80:83], a[32:35]
    v_mfma_f32_16x16x32_bf16 a[36:39], v[164:167], v[80:83], a[36:39]
    v_mfma_f32_16x16x32_bf16 a[48:51], v[168:171], v[80:83], a[48:51]
    v_mfma_f32_16x16x32_bf16 a[52:55], v[172:175], v[80:83], a[52:55]
    v_mfma_f32_16x16x32_bf16 a[8:11], v[144:147], v[84:87], a[8:11]
    v_mfma_f32_16x16x32_bf16 a[12:15], v[148:151], v[84:87], a[12:15]
    v_mfma_f32_16x16x32_bf16 a[24:27], v[152:155], v[84:87], a[24:27]
    v_mfma_f32_16x16x32_bf16 a[28:31], v[156:159], v[84:87], a[28:31]
    v_mfma_f32_16x16x32_bf16 a[40:43], v[160:163], v[84:87], a[40:43]
    v_mfma_f32_16x16x32_bf16 a[44:47], v[164:167], v[84:87], a[44:47]
    v_mfma_f32_16x16x32_bf16 a[56:59], v[168:171], v[84:87], a[56:59]
    v_mfma_f32_16x16x32_bf16 a[60:63], v[172:175], v[84:87], a[60:63]
    v_mfma_f32_16x16x32_bf16 a[64:67], v[144:147], v[88:91], a[64:67]
    v_mfma_f32_16x16x32_bf16 a[68:71], v[148:151], v[88:91], a[68:71]
    v_mfma_f32_16x16x32_bf16 a[80:83], v[152:155], v[88:91], a[80:83]
    v_mfma_f32_16x16x32_bf16 a[84:87], v[156:159], v[88:91], a[84:87]
    v_mfma_f32_16x16x32_bf16 a[96:99], v[160:163], v[88:91], a[96:99]
    v_mfma_f32_16x16x32_bf16 a[100:103], v[164:167], v[88:91], a[100:103]
    v_mfma_f32_16x16x32_bf16 a[112:115], v[168:171], v[88:91], a[112:115]
    v_mfma_f32_16x16x32_bf16 a[116:119], v[172:175], v[88:91], a[116:119]
    v_mfma_f32_16x16x32_bf16 a[72:75], v[144:147], v[92:95], a[72:75]
    v_mfma_f32_16x16x32_bf16 a[76:79], v[148:151], v[92:95], a[76:79]
    v_mfma_f32_16x16x32_bf16 a[88:91], v[152:155], v[92:95], a[88:91]
    v_mfma_f32_16x16x32_bf16 a[92:95], v[156:159], v[92:95], a[92:95]
    v_mfma_f32_16x16x32_bf16 a[104:107], v[160:163], v[92:95], a[104:107]
    v_mfma_f32_16x16x32_bf16 a[108:111], v[164:167], v[92:95], a[108:111]
    v_mfma_f32_16x16x32_bf16 a[120:123], v[168:171], v[92:95], a[120:123]
    v_mfma_f32_16x16x32_bf16 a[124:127], v[172:175], v[92:95], a[124:127]
    v_mfma_f32_16x16x32_bf16 a[128:131], v[144:147], v[96:99], a[128:131]
    v_mfma_f32_16x16x32_bf16 a[132:135], v[148:151], v[96:99], a[132:135]
    v_mfma_f32_16x16x32_bf16 a[144:147], v[152:155], v[96:99], a[144:147]
    v_mfma_f32_16x16x32_bf16 a[148:151], v[156:159], v[96:99], a[148:151]
    v_mfma_f32_16x16x32_bf16 a[160:163], v[160:163], v[96:99], a[160:163]
    v_mfma_f32_16x16x32_bf16 a[164:167], v[164:167], v[96:99], a[164:167]
    v_mfma_f32_16x16x32_bf16 a[176:179], v[168:171], v[96:99], a[176:179]
    v_mfma_f32_16x16x32_bf16 a[180:183], v[172:175], v[96:99], a[180:183]
    v_mfma_f32_16x16x32_bf16 a[136:139], v[144:147], v[100:103], a[136:139]
    v_mfma_f32_16x16x32_bf16 a[140:143], v[148:151], v[100:103], a[140:143]
    v_mfma_f32_16x16x32_bf16 a[152:155], v[152:155], v[100:103], a[152:155]
    v_mfma_f32_16x16x32_bf16 a[156:159], v[156:159], v[100:103], a[156:159]
    v_mfma_f32_16x16x32_bf16 a[168:171], v[160:163], v[100:103], a[168:171]
    v_mfma_f32_16x16x32_bf16 a[172:175], v[164:167], v[100:103], a[172:175]
    v_mfma_f32_16x16x32_bf16 a[184:187], v[168:171], v[100:103], a[184:187]
    v_mfma_f32_16x16x32_bf16 a[188:191], v[172:175], v[100:103], a[188:191]
    v_mfma_f32_16x16x32_bf16 a[192:195], v[144:147], v[104:107], a[192:195]
    v_mfma_f32_16x16x32_bf16 a[196:199], v[148:151], v[104:107], a[196:199]
    v_mfma_f32_16x16x32_bf16 a[208:211], v[152:155], v[104:107], a[208:211]
    v_mfma_f32_16x16x32_bf16 a[212:215], v[156:159], v[104:107], a[212:215]
    v_mfma_f32_16x16x32_bf16 a[224:227], v[160:163], v[104:107], a[224:227]
    v_mfma_f32_16x16x32_bf16 a[228:231], v[164:167], v[104:107], a[228:231]
    v_mfma_f32_16x16x32_bf16 a[240:243], v[168:171], v[104:107], a[240:243]
    v_mfma_f32_16x16x32_bf16 a[244:247], v[172:175], v[104:107], a[244:247]
    v_mfma_f32_16x16x32_bf16 a[200:203], v[144:147], v[108:111], a[200:203]
    v_mfma_f32_16x16x32_bf16 a[204:207], v[148:151], v[108:111], a[204:207]
    v_mfma_f32_16x16x32_bf16 a[216:219], v[152:155], v[108:111], a[216:219]
    v_mfma_f32_16x16x32_bf16 a[220:223], v[156:159], v[108:111], a[220:223]
    v_mfma_f32_16x16x32_bf16 a[232:235], v[160:163], v[108:111], a[232:235]
    v_mfma_f32_16x16x32_bf16 a[236:239], v[164:167], v[108:111], a[236:239]
    v_mfma_f32_16x16x32_bf16 a[248:251], v[168:171], v[108:111], a[248:251]
    v_mfma_f32_16x16x32_bf16 a[252:255], v[172:175], v[108:111], a[252:255]
    s_nop 15
    s_branch bE_184
bN_183:
    s_waitcnt lgkmcnt(0)
    v_mfma_f32_16x16x32_bf16 a[0:3], v[48:51], v[112:115], 0
    ds_read_b128 v[80:83], v25 offset:0
    v_mfma_f32_16x16x32_bf16 a[8:11], v[48:51], v[116:119], 0
    v_mfma_f32_16x16x32_bf16 a[16:19], v[48:51], v[120:123], 0
    ds_read_b64_tr_b16 v[144:145], v28 offset:16384
    v_mfma_f32_16x16x32_bf16 a[24:27], v[48:51], v[124:127], 0
    v_mfma_f32_16x16x32_bf16 a[32:35], v[48:51], v[128:131], 0
    ds_read_b64_tr_b16 v[146:147], v28 offset:18432
    v_mfma_f32_16x16x32_bf16 a[40:43], v[48:51], v[132:135], 0
    v_mfma_f32_16x16x32_bf16 a[48:51], v[48:51], v[136:139], 0
    v_mfma_f32_16x16x32_bf16 a[56:59], v[48:51], v[140:143], 0
    ds_read_b128 v[84:87], v25 offset:1024
    v_mfma_f32_16x16x32_bf16 a[4:7], v[52:55], v[112:115], 0
    v_mfma_f32_16x16x32_bf16 a[12:15], v[52:55], v[116:119], 0
    ds_read_b64_tr_b16 v[148:149], v29 offset:16384
    v_mfma_f32_16x16x32_bf16 a[20:23], v[52:55], v[120:123], 0
    v_mfma_f32_16x16x32_bf16 a[28:31], v[52:55], v[124:127], 0
    v_mfma_f32_16x16x32_bf16 a[36:39], v[52:55], v[128:131], 0
    ds_read_b64_tr_b16 v[150:151], v29 offset:18432
    v_mfma_f32_16x16x32_bf16 a[44:47], v[52:55], v[132:135], 0
    v_mfma_f32_16x16x32_bf16 a[52:55], v[52:55], v[136:139], 0
    ds_read_b128 v[88:91], v25 offset:4096
    v_mfma_f32_16x16x32_bf16 a[60:63], v[52:55], v[140:143], 0
    v_mfma_f32_16x16x32_bf16 a[64:67], v[56:59], v[112:115], 0
    ds_read_b64_tr_b16 v[152:153], v30 offset:16384
    v_mfma_f32_16x16x32_bf16 a[72:75], v[56:59], v[116:119], 0
    v_mfma_f32_16x16x32_bf16 a[80:83], v[56:59], v[120:123], 0
    v_mfma_f32_16x16x32_bf16 a[88:91], v[56:59], v[124:127], 0
    ds_read_b64_tr_b16 v[154:155], v30 offset:18432
    v_mfma_f32_16x16x32_bf16 a[96:99], v[56:59], v[128:131], 0
    v_mfma_f32_16x16x32_bf16 a[104:107], v[56:59], v[132:135], 0
    ds_read_b128 v[92:95], v25 offset:5120
    v_mfma_f32_16x16x32_bf16 a[112:115], v[56:59], v[136:139], 0
    v_mfma_f32_16x16x32_bf16 a[120:123], v[56:59], v[140:143], 0
    v_mfma_f32_16x16x32_bf16 a[68:71], v[60:63], v[112:115], 0
    ds_read_b64_tr_b16 v[156:157], v31 offset:16384
    v_mfma_f32_16x16x32_bf16 a[76:79], v[60:63], v[116:119], 0
    v_mfma_f32_16x16x32_bf16 a[84:87], v[60:63], v[120:123], 0
    ds_read_b64_tr_b16 v[158:159], v31 offset:18432
    v_mfma_f32_16x16x32_bf16 a[92:95], v[60:63], v[124:127], 0
    v_mfma_f32_16x16x32_bf16 a[100:103], v[60:63], v[128:131], 0
    v_mfma_f32_16x16x32_bf16 a[108:111], v[60:63], v[132:135], 0
    ds_read_b128 v[96:99], v25 offset:8192
    v_mfma_f32_16x16x32_bf16 a[116:119], v[60:63], v[136:139], 0
    v_mfma_f32_16x16x32_bf16 a[124:127], v[60:63], v[140:143], 0
    ds_read_b64_tr_b16 v[160:161], v32 offset:16384
    v_mfma_f32_16x16x32_bf16 a[128:131], v[64:67], v[112:115], 0
    v_mfma_f32_16x16x32_bf16 a[136:139], v[64:67], v[116:119], 0
    ds_read_b64_tr_b16 v[162:163], v32 offset:18432
    v_mfma_f32_16x16x32_bf16 a[144:147], v[64:67], v[120:123], 0
    v_mfma_f32_16x16x32_bf16 a[152:155], v[64:67], v[124:127], 0
    v_mfma_f32_16x16x32_bf16 a[160:163], v[64:67], v[128:131], 0
    ds_read_b128 v[100:103], v25 offset:9216
    v_mfma_f32_16x16x32_bf16 a[168:171], v[64:67], v[132:135], 0
    v_mfma_f32_16x16x32_bf16 a[176:179], v[64:67], v[136:139], 0
    ds_read_b64_tr_b16 v[164:165], v33 offset:16384
    v_mfma_f32_16x16x32_bf16 a[184:187], v[64:67], v[140:143], 0
    v_mfma_f32_16x16x32_bf16 a[132:135], v[68:71], v[112:115], 0
    v_mfma_f32_16x16x32_bf16 a[140:143], v[68:71], v[116:119], 0
    ds_read_b64_tr_b16 v[166:167], v33 offset:18432
    v_mfma_f32_16x16x32_bf16 a[148:151], v[68:71], v[120:123], 0
    v_mfma_f32_16x16x32_bf16 a[156:159], v[68:71], v[124:127], 0
    ds_read_b128 v[104:107], v25 offset:12288
    v_mfma_f32_16x16x32_bf16 a[164:167], v[68:71], v[128:131], 0
    v_mfma_f32_16x16x32_bf16 a[172:175], v[68:71], v[132:135], 0
    ds_read_b64_tr_b16 v[168:169], v34 offset:16384
    v_mfma_f32_16x16x32_bf16 a[180:183], v[68:71], v[136:139], 0
    v_mfma_f32_16x16x32_bf16 a[188:191], v[68:71], v[140:143], 0
    v_mfma_f32_16x16x32_bf16 a[192:195], v[72:75], v[112:115], 0
    ds_read_b64_tr_b16 v[170:171], v34 offset:18432
    v_mfma_f32_16x16x32_bf16 a[200:203], v[72:75], v[116:119], 0
    v_mfma_f32_16x16x32_bf16 a[208:211], v[72:75], v[120:123], 0
    ds_read_b128 v[108:111], v25 offset:13312
    v_mfma_f32_16x16x32_bf16 a[216:219], v[72:75], v[124:127], 0
    v_mfma_f32_16x16x32_bf16 a[224:227], v[72:75], v[128:131], 0
    v_mfma_f32_16x16x32_bf16 a[232:235], v[72:75], v[132:135], 0
    ds_read_b64_tr_b16 v[172:173], v35 offset:16384
    v_mfma_f32_16x16x32_bf16 a[240:243], v[72:75], v[136:139], 0
    v_mfma_f32_16x16x32_bf16 a[248:251], v[72:75], v[140:143], 0
    ds_read_b64_tr_b16 v[174:175], v35 offset:18432
    v_mfma_f32_16x16x32_bf16 a[196:199], v[76:79], v[112:115], 0
    v_mfma_f32_16x16x32_bf16 a[204:207], v[76:79], v[116:119], 0
    v_mfma_f32_16x16x32_bf16 a[212:215], v[76:79], v[120:123], 0
    v_mfma_f32_16x16x32_bf16 a[220:223], v[76:79], v[124:127], 0
    v_mfma_f32_16x16x32_bf16 a[228:231], v[76:79], v[128:131], 0
    v_mfma_f32_16x16x32_bf16 a[236:239], v[76:79], v[132:135], 0
    v_mfma_f32_16x16x32_bf16 a[244:247], v[76:79], v[136:139], 0
    v_mfma_f32_16x16x32_bf16 a[252:255], v[76:79], v[140:143], 0
    s_waitcnt lgkmcnt(0)
    s_waitcnt vmcnt(0)
    s_barrier
    v_mfma_f32_16x16x32_bf16 a[0:3], v[80:83], v[144:147], a[0:3]
    s_add_u32 m0, s93, 0
    v_mfma_f32_16x16x32_bf16 a[8:11], v[80:83], v[148:151], a[8:11]
    buffer_load_dwordx4 v8, s[80:83], s88 offen lds
    v_mfma_f32_16x16x32_bf16 a[16:19], v[80:83], v[152:155], a[16:19]
    ds_read_b128 v[48:51], v26 offset:0
    v_mfma_f32_16x16x32_bf16 a[24:27], v[80:83], v[156:159], a[24:27]
    s_add_u32 m0, s93, 1024
    v_mfma_f32_16x16x32_bf16 a[32:35], v[80:83], v[160:163], a[32:35]
    buffer_load_dwordx4 v9, s[80:83], s88 offen lds
    v_mfma_f32_16x16x32_bf16 a[40:43], v[80:83], v[164:167], a[40:43]
    ds_read_b64_tr_b16 v[112:113], v36 offset:0
    v_mfma_f32_16x16x32_bf16 a[48:51], v[80:83], v[168:171], a[48:51]
    ds_read_b64_tr_b16 v[114:115], v36 offset:2048
    v_mfma_f32_16x16x32_bf16 a[56:59], v[80:83], v[172:175], a[56:59]
    s_add_u32 m0, s93, 2048
    v_mfma_f32_16x16x32_bf16 a[4:7], v[84:87], v[144:147], a[4:7]
    buffer_load_dwordx4 v10, s[80:83], s88 offen lds
    v_mfma_f32_16x16x32_bf16 a[12:15], v[84:87], v[148:151], a[12:15]
    ds_read_b128 v[52:55], v26 offset:1024
    v_mfma_f32_16x16x32_bf16 a[20:23], v[84:87], v[152:155], a[20:23]
    s_add_u32 m0, s93, 3072
    v_mfma_f32_16x16x32_bf16 a[28:31], v[84:87], v[156:159], a[28:31]
    buffer_load_dwordx4 v11, s[80:83], s88 offen lds
    v_mfma_f32_16x16x32_bf16 a[36:39], v[84:87], v[160:163], a[36:39]
    ds_read_b64_tr_b16 v[116:117], v37 offset:0
    v_mfma_f32_16x16x32_bf16 a[44:47], v[84:87], v[164:167], a[44:47]
    ds_read_b64_tr_b16 v[118:119], v37 offset:2048
    v_mfma_f32_16x16x32_bf16 a[52:55], v[84:87], v[168:171], a[52:55]
    s_add_u32 m0, s93, 4096
    v_mfma_f32_16x16x32_bf16 a[60:63], v[84:87], v[172:175], a[60:63]
    buffer_load_dwordx4 v12, s[80:83], s88 offen lds
    v_mfma_f32_16x16x32_bf16 a[64:67], v[88:91], v[144:147], a[64:67]
    ds_read_b128 v[56:59], v26 offset:4096
    v_mfma_f32_16x16x32_bf16 a[72:75], v[88:91], v[148:151], a[72:75]
    s_add_u32 m0, s93, 5120
    v_mfma_f32_16x16x32_bf16 a[80:83], v[88:91], v[152:155], a[80:83]
    buffer_load_dwordx4 v13, s[80:83], s88 offen lds
    v_mfma_f32_16x16x32_bf16 a[88:91], v[88:91], v[156:159], a[88:91]
    ds_read_b64_tr_b16 v[120:121], v38 offset:0
    v_mfma_f32_16x16x32_bf16 a[96:99], v[88:91], v[160:163], a[96:99]
    ds_read_b64_tr_b16 v[122:123], v38 offset:2048
    v_mfma_f32_16x16x32_bf16 a[104:107], v[88:91], v[164:167], a[104:107]
    s_add_u32 m0, s93, 6144
    v_mfma_f32_16x16x32_bf16 a[112:115], v[88:91], v[168:171], a[112:115]
    buffer_load_dwordx4 v14, s[80:83], s88 offen lds
    v_mfma_f32_16x16x32_bf16 a[120:123], v[88:91], v[172:175], a[120:123]
    ds_read_b128 v[60:63], v26 offset:5120
    v_mfma_f32_16x16x32_bf16 a[68:71], v[92:95], v[144:147], a[68:71]
    s_add_u32 m0, s93, 7168
    v_mfma_f32_16x16x32_bf16 a[76:79], v[92:95], v[148:151], a[76:79]
    buffer_load_dwordx4 v15, s[80:83], s88 offen lds
    v_mfma_f32_16x16x32_bf16 a[84:87], v[92:95], v[152:155], a[84:87]
    ds_read_b64_tr_b16 v[124:125], v39 offset:0
    v_mfma_f32_16x16x32_bf16 a[92:95], v[92:95], v[156:159], a[92:95]
    ds_read_b64_tr_b16 v[126:127], v39 offset:2048
    v_mfma_f32_16x16x32_bf16 a[100:103], v[92:95], v[160:163], a[100:103]
    s_add_u32 m0, s94, 0
    v_mfma_f32_16x16x32_bf16 a[108:111], v[92:95], v[164:167], a[108:111]
    buffer_load_dwordx4 v16, s[84:87], s89 offen lds
    v_mfma_f32_16x16x32_bf16 a[116:119], v[92:95], v[168:171], a[116:119]
    ds_read_b128 v[64:67], v26 offset:8192
    v_mfma_f32_16x16x32_bf16 a[124:127], v[92:95], v[172:175], a[124:127]
    s_add_u32 m0, s94, 1024
    v_mfma_f32_16x16x32_bf16 a[128:131], v[96:99], v[144:147], a[128:131]
    buffer_load_dwordx4 v17, s[84:87], s89 offen lds
    v_mfma_f32_16x16x32_bf16 a[136:139], v[96:99], v[148:151], a[136:139]
    ds_read_b64_tr_b16 v[128:129], v40 offset:0
    v_mfma_f32_16x16x32_bf16 a[144:147], v[96:99], v[152:155], a[144:147]
    ds_read_b64_tr_b16 v[130:131], v40 offset:2048
    v_mfma_f32_16x16x32_bf16 a[152:155], v[96:99], v[156:159], a[152:155]
    s_add_u32 m0, s94, 2048
    v_mfma_f32_16x16x32_bf16 a[160:163], v[96:99], v[160:163], a[160:163]
    buffer_load_dwordx4 v18, s[84:87], s89 offen lds
    v_mfma_f32_16x16x32_bf16 a[168:171], v[96:99], v[164:167], a[168:171]
    ds_read_b128 v[68:71], v26 offset:9216
    v_mfma_f32_16x16x32_bf16 a[176:179], v[96:99], v[168:171], a[176:179]
    s_add_u32 m0, s94, 3072
    v_mfma_f32_16x16x32_bf16 a[184:187], v[96:99], v[172:175], a[184:187]
    buffer_load_dwordx4 v19, s[84:87], s89 offen lds
    v_mfma_f32_16x16x32_bf16 a[132:135], v[100:103], v[144:147], a[132:135]
    ds_read_b64_tr_b16 v[132:133], v41 offset:0
    v_mfma_f32_16x16x32_bf16 a[140:143], v[100:103], v[148:151], a[140:143]
    ds_read_b64_tr_b16 v[134:135], v41 offset:2048
    v_mfma_f32_16x16x32_bf16 a[148:151], v[100:103], v[152:155], a[148:151]
    s_add_u32 m0, s94, 4096
    v_mfma_f32_16x16x32_bf16 a[156:159], v[100:103], v[156:159], a[156:159]
    buffer_load_dwordx4 v20, s[84:87], s89 offen lds
    v_mfma_f32_16x16x32_bf16 a[164:167], v[100:103], v[160:163], a[164:167]
    ds_read_b128 v[72:75], v26 offset:12288
    v_mfma_f32_16x16x32_bf16 a[172:175], v[100:103], v[164:167], a[172:175]
    s_add_u32 m0, s94, 5120
    v_mfma_f32_16x16x32_bf16 a[180:183], v[100:103], v[168:171], a[180:183]
    buffer_load_dwordx4 v21, s[84:87], s89 offen lds
    v_mfma_f32_16x16x32_bf16 a[188:191], v[100:103], v[172:175], a[188:191]
    ds_read_b64_tr_b16 v[136:137], v42 offset:0
    v_mfma_f32_16x16x32_bf16 a[192:195], v[104:107], v[144:147], a[192:195]
    ds_read_b64_tr_b16 v[138:139], v42 offset:2048
    v_mfma_f32_16x16x32_bf16 a[200:203], v[104:107], v[148:151], a[200:203]
    s_add_u32 m0, s94, 6144
    v_mfma_f32_16x16x32_bf16 a[208:211], v[104:107], v[152:155], a[208:211]
    buffer_load_dwordx4 v22, s[84:87], s89 offen lds
    v_mfma_f32_16x16x32_bf16 a[216:219], v[104:107], v[156:159], a[216:219]
    ds_read_b128 v[76:79], v26 offset:13312
    v_mfma_f32_16x16x32_bf16 a[224:227], v[104:107], v[160:163], a[224:227]
    s_add_u32 m0, s94, 7168
    v_mfma_f32_16x16x32_bf16 a[232:235], v[104:107], v[164:167], a[232:235]
    buffer_load_dwordx4 v23, s[84:87], s89 offen lds
    v_mfma_f32_16x16x32_bf16 a[240:243], v[104:107], v[168:171], a[240:243]
    ds_read_b64_tr_b16 v[140:141], v43 offset:0
    v_mfma_f32_16x16x32_bf16 a[248:251], v[104:107], v[172:175], a[248:251]
    ds_read_b64_tr_b16 v[142:143], v43 offset:2048
    v_mfma_f32_16x16x32_bf16 a[196:199], v[108:111], v[144:147], a[196:199]
    s_add_u32 s88, s88, s90
    s_add_u32 s89, s89, s91
    v_mfma_f32_16x16x32_bf16 a[204:207], v[108:111], v[148:151], a[204:207]
    v_mfma_f32_16x16x32_bf16 a[212:215], v[108:111], v[152:155], a[212:215]
    v_mfma_f32_16x16x32_bf16 a[220:223], v[108:111], v[156:159], a[220:223]
    v_mfma_f32_16x16x32_bf16 a[228:231], v[108:111], v[160:163], a[228:231]
    v_mfma_f32_16x16x32_bf16 a[236:239], v[108:111], v[164:167], a[236:239]
    v_mfma_f32_16x16x32_bf16 a[244:247], v[108:111], v[168:171], a[244:247]
    v_mfma_f32_16x16x32_bf16 a[252:255], v[108:111], v[172:175], a[252:255]
    s_waitcnt lgkmcnt(0)
    v_mfma_f32_16x16x32_bf16 a[0:3], v[48:51], v[112:115], a[0:3]
    ds_read_b128 v[80:83], v27 offset:0
    v_mfma_f32_16x16x32_bf16 a[8:11], v[48:51], v[116:119], a[8:11]
    v_mfma_f32_16x16x32_bf16 a[16:19], v[48:51], v[120:123], a[16:19]
    ds_read_b64_tr_b16 v[144:145], v36 offset:16384
    v_mfma_f32_16x16x32_bf16 a[24:27], v[48:51], v[124:127], a[24:27]
    v_mfma_f32_16x16x32_bf16 a[32:35], v[48:51], v[128:131], a[32:35]
    ds_read_b64_tr_b16 v[146:147], v36 offset:18432
    v_mfma_f32_16x16x32_bf16 a[40:43], v[48:51], v[132:135], a[40:43]
    v_mfma_f32_16x16x32_bf16 a[48:51], v[48:51], v[136:139], a[48:51]
    v_mfma_f32_16x16x32_bf16 a[56:59], v[48:51], v[140:143], a[56:59]
    ds_read_b128 v[84:87], v27 offset:1024
    v_mfma_f32_16x16x32_bf16 a[4:7], v[52:55], v[112:115], a[4:7]
    v_mfma_f32_16x16x32_bf16 a[12:15], v[52:55], v[116:119], a[12:15]
    ds_read_b64_tr_b16 v[148:149], v37 offset:16384
    v_mfma_f32_16x16x32_bf16 a[20:23], v[52:55], v[120:123], a[20:23]
    v_mfma_f32_16x16x32_bf16 a[28:31], v[52:55], v[124:127], a[28:31]
    v_mfma_f32_16x16x32_bf16 a[36:39], v[52:55], v[128:131], a[36:39]
    ds_read_b64_tr_b16 v[150:151], v37 offset:18432
    v_mfma_f32_16x16x32_bf16 a[44:47], v[52:55], v[132:135], a[44:47]
    v_mfma_f32_16x16x32_bf16 a[52:55], v[52:55], v[136:139], a[52:55]
    ds_read_b128 v[88:91], v27 offset:4096
    v_mfma_f32_16x16x32_bf16 a[60:63], v[52:55], v[140:143], a[60:63]
    v_mfma_f32_16x16x32_bf16 a[64:67], v[56:59], v[112:115], a[64:67]
    ds_read_b64_tr_b16 v[152:153], v38 offset:16384
    v_mfma_f32_16x16x32_bf16 a[72:75], v[56:59], v[116:119], a[72:75]
    v_mfma_f32_16x16x32_bf16 a[80:83], v[56:59], v[120:123], a[80:83]
    v_mfma_f32_16x16x32_bf16 a[88:91], v[56:59], v[124:127], a[88:91]
    ds_read_b64_tr_b16 v[154:155], v38 offset:18432
    v_mfma_f32_16x16x32_bf16 a[96:99], v[56:59], v[128:131], a[96:99]
    v_mfma_f32_16x16x32_bf16 a[104:107], v[56:59], v[132:135], a[104:107]
    ds_read_b128 v[92:95], v27 offset:5120
    v_mfma_f32_16x16x32_bf16 a[112:115], v[56:59], v[136:139], a[112:115]
    v_mfma_f32_16x16x32_bf16 a[120:123], v[56:59], v[140:143], a[120:123]
    v_mfma_f32_16x16x32_bf16 a[68:71], v[60:63], v[112:115], a[68:71]
    ds_read_b64_tr_b16 v[156:157], v39 offset:16384
    v_mfma_f32_16x16x32_bf16 a[76:79], v[60:63], v[116:119], a[76:79]
    v_mfma_f32_16x16x32_bf16 a[84:87], v[60:63], v[120:123], a[84:87]
    ds_read_b64_tr_b16 v[158:159], v39 offset:18432
    v_mfma_f32_16x16x32_bf16 a[92:95], v[60:63], v[124:127], a[92:95]
    v_mfma_f32_16x16x32_bf16 a[100:103], v[60:63], v[128:131], a[100:103]
    v_mfma_f32_16x16x32_bf16 a[108:111], v[60:63], v[132:135], a[108:111]
    ds_read_b128 v[96:99], v27 offset:8192
    v_mfma_f32_16x16x32_bf16 a[116:119], v[60:63], v[136:139], a[116:119]
    v_mfma_f32_16x16x32_bf16 a[124:127], v[60:63], v[140:143], a[124:127]
    ds_read_b64_tr_b16 v[160:161], v40 offset:16384
    v_mfma_f32_16x16x32_bf16 a[128:131], v[64:67], v[112:115], a[128:131]
    v_mfma_f32_16x16x32_bf16 a[136:139], v[64:67], v[116:119], a[136:139]
    ds_read_b64_tr_b16 v[162:163], v40 offset:18432
    v_mfma_f32_16x16x32_bf16 a[144:147], v[64:67], v[120:123], a[144:147]
    v_mfma_f32_16x16x32_bf16 a[152:155], v[64:67], v[124:127], a[152:155]
    v_mfma_f32_16x16x32_bf16 a[160:163], v[64:67], v[128:131], a[160:163]
    ds_read_b128 v[100:103], v27 offset:9216
    v_mfma_f32_16x16x32_bf16 a[168:171], v[64:67], v[132:135], a[168:171]
    v_mfma_f32_16x16x32_bf16 a[176:179], v[64:67], v[136:139], a[176:179]
    ds_read_b64_tr_b16 v[164:165], v41 offset:16384
    v_mfma_f32_16x16x32_bf16 a[184:187], v[64:67], v[140:143], a[184:187]
    v_mfma_f32_16x16x32_bf16 a[132:135], v[68:71], v[112:115], a[132:135]
    v_mfma_f32_16x16x32_bf16 a[140:143], v[68:71], v[116:119], a[140:143]
    ds_read_b64_tr_b16 v[166:167], v41 offset:18432
    v_mfma_f32_16x16x32_bf16 a[148:151], v[68:71], v[120:123], a[148:151]
    v_mfma_f32_16x16x32_bf16 a[156:159], v[68:71], v[124:127], a[156:159]
    ds_read_b128 v[104:107], v27 offset:12288
    v_mfma_f32_16x16x32_bf16 a[164:167], v[68:71], v[128:131], a[164:167]
    v_mfma_f32_16x16x32_bf16 a[172:175], v[68:71], v[132:135], a[172:175]
    ds_read_b64_tr_b16 v[168:169], v42 offset:16384
    v_mfma_f32_16x16x32_bf16 a[180:183], v[68:71], v[136:139], a[180:183]
    v_mfma_f32_16x16x32_bf16 a[188:191], v[68:71], v[140:143], a[188:191]
    v_mfma_f32_16x16x32_bf16 a[192:195], v[72:75], v[112:115], a[192:195]
    ds_read_b64_tr_b16 v[170:171], v42 offset:18432
    v_mfma_f32_16x16x32_bf16 a[200:203], v[72:75], v[116:119], a[200:203]
    v_mfma_f32_16x16x32_bf16 a[208:211], v[72:75], v[120:123], a[208:211]
    ds_read_b128 v[108:111], v27 offset:13312
    v_mfma_f32_16x16x32_bf16 a[216:219], v[72:75], v[124:127], a[216:219]
    v_mfma_f32_16x16x32_bf16 a[224:227], v[72:75], v[128:131], a[224:227]
    v_mfma_f32_16x16x32_bf16 a[232:235], v[72:75], v[132:135], a[232:235]
    ds_read_b64_tr_b16 v[172:173], v43 offset:16384
    v_mfma_f32_16x16x32_bf16 a[240:243], v[72:75], v[136:139], a[240:243]
    v_mfma_f32_16x16x32_bf16 a[248:251], v[72:75], v[140:143], a[248:251]
    ds_read_b64_tr_b16 v[174:175], v43 offset:18432
    v_mfma_f32_16x16x32_bf16 a[196:199], v[76:79], v[112:115], a[196:199]
    v_mfma_f32_16x16x32_bf16 a[204:207], v[76:79], v[116:119], a[204:207]
    v_mfma_f32_16x16x32_bf16 a[212:215], v[76:79], v[120:123], a[212:215]
    v_mfma_f32_16x16x32_bf16 a[220:223], v[76:79], v[124:127], a[220:223]
    v_mfma_f32_16x16x32_bf16 a[228:231], v[76:79], v[128:131], a[228:231]
    v_mfma_f32_16x16x32_bf16 a[236:239], v[76:79], v[132:135], a[236:239]
    v_mfma_f32_16x16x32_bf16 a[244:247], v[76:79], v[136:139], a[244:247]
    v_mfma_f32_16x16x32_bf16 a[252:255], v[76:79], v[140:143], a[252:255]
    s_waitcnt lgkmcnt(0)
    s_waitcnt vmcnt(0)
    s_barrier
    v_mfma_f32_16x16x32_bf16 a[0:3], v[80:83], v[144:147], a[0:3]
    s_add_u32 m0, s93, 65536
    v_mfma_f32_16x16x32_bf16 a[8:11], v[80:83], v[148:151], a[8:11]
    buffer_load_dwordx4 v8, s[80:83], s88 offen lds
    v_mfma_f32_16x16x32_bf16 a[16:19], v[80:83], v[152:155], a[16:19]
    ds_read_b128 v[48:51], v24 offset:0
    v_mfma_f32_16x16x32_bf16 a[24:27], v[80:83], v[156:159], a[24:27]
    s_add_u32 m0, s93, 66560
    v_mfma_f32_16x16x32_bf16 a[32:35], v[80:83], v[160:163], a[32:35]
    buffer_load_dwordx4 v9, s[80:83], s88 offen lds
    v_mfma_f32_16x16x32_bf16 a[40:43], v[80:83], v[164:167], a[40:43]
    ds_read_b64_tr_b16 v[112:113], v28 offset:0
    v_mfma_f32_16x16x32_bf16 a[48:51], v[80:83], v[168:171], a[48:51]
    ds_read_b64_tr_b16 v[114:115], v28 offset:2048
    v_mfma_f32_16x16x32_bf16 a[56:59], v[80:83], v[172:175], a[56:59]
    s_add_u32 m0, s93, 67584
    v_mfma_f32_16x16x32_bf16 a[4:7], v[84:87], v[144:147], a[4:7]
    buffer_load_dwordx4 v10, s[80:83], s88 offen lds
    v_mfma_f32_16x16x32_bf16 a[12:15], v[84:87], v[148:151], a[12:15]
    ds_read_b128 v[52:55], v24 offset:1024
    v_mfma_f32_16x16x32_bf16 a[20:23], v[84:87], v[152:155], a[20:23]
    s_add_u32 m0, s93, 68608
    v_mfma_f32_16x16x32_bf16 a[28:31], v[84:87], v[156:159], a[28:31]
    buffer_load_dwordx4 v11, s[80:83], s88 offen lds
    v_mfma_f32_16x16x32_bf16 a[36:39], v[84:87], v[160:163], a[36:39]
    ds_read_b64_tr_b16 v[116:117], v29 offset:0
    v_mfma_f32_16x16x32_bf16 a[44:47], v[84:87], v[164:167], a[44:47]
    ds_read_b64_tr_b16 v[118:119], v29 offset:2048
    v_mfma_f32_16x16x32_bf16 a[52:55], v[84:87], v[168:171], a[52:55]
    s_add_u32 m0, s93, 69632
    v_mfma_f32_16x16x32_bf16 a[60:63], v[84:87], v[172:175], a[60:63]
    buffer_load_dwordx4 v12, s[80:83], s88 offen lds
    v_mfma_f32_16x16x32_bf16 a[64:67], v[88:91], v[144:147], a[64:67]
    ds_read_b128 v[56:59], v24 offset:4096
    v_mfma_f32_16x16x32_bf16 a[72:75], v[88:91], v[148:151], a[72:75]
    s_add_u32 m0, s93, 70656
    v_mfma_f32_16x16x32_bf16 a[80:83], v[88:91], v[152:155], a[80:83]
    buffer_load_dwordx4 v13, s[80:83], s88 offen lds
    v_mfma_f32_16x16x32_bf16 a[88:91], v[88:91], v[156:159], a[88:91]
    ds_read_b64_tr_b16 v[120:121], v30 offset:0
    v_mfma_f32_16x16x32_bf16 a[96:99], v[88:91], v[160:163], a[96:99]
    ds_read_b64_tr_b16 v[122:123], v30 offset:2048
    v_mfma_f32_16x16x32_bf16 a[104:107], v[88:91], v[164:167], a[104:107]
    s_add_u32 m0, s93, 71680
    v_mfma_f32_16x16x32_bf16 a[112:115], v[88:91], v[168:171], a[112:115]
    buffer_load_dwordx4 v14, s[80:83], s88 offen lds
    v_mfma_f32_16x16x32_bf16 a[120:123], v[88:91], v[172:175], a[120:123]
    ds_read_b128 v[60:63], v24 offset:5120
    v_mfma_f32_16x16x32_bf16 a[68:71], v[92:95], v[144:147], a[68:71]
    s_add_u32 m0, s93, 72704
    v_mfma_f32_16x16x32_bf16 a[76:79], v[92:95], v[148:151], a[76:79]
    buffer_load_dwordx4 v15, s[80:83], s88 offen lds
    v_mfma_f32_16x16x32_bf16 a[84:87], v[92:95], v[152:155], a[84:87]
    ds_read_b64_tr_b16 v[124:125], v31 offset:0
    v_mfma_f32_16x16x32_bf16 a[92:95], v[92:95], v[156:159], a[92:95]
    ds_read_b64_tr_b16 v[126:127], v31 offset:2048
    v_mfma_f32_16x16x32_bf16 a[100:103], v[92:95], v[160:163], a[100:103]
    s_add_u32 m0, s94, 65536
    v_mfma_f32_16x16x32_bf16 a[108:111], v[92:95], v[164:167], a[108:111]
    buffer_load_dwordx4 v16, s[84:87], s89 offen lds
    v_mfma_f32_16x16x32_bf16 a[116:119], v[92:95], v[168:171], a[116:119]
    ds_read_b128 v[64:67], v24 offset:8192
    v_mfma_f32_16x16x32_bf16 a[124:127], v[92:95], v[172:175], a[124:127]
    s_add_u32 m0, s94, 66560
    v_mfma_f32_16x16x32_bf16 a[128:131], v[96:99], v[144:147], a[128:131]
    buffer_load_dwordx4 v17, s[84:87], s89 offen lds
    v_mfma_f32_16x16x32_bf16 a[136:139], v[96:99], v[148:151], a[136:139]
    ds_read_b64_tr_b16 v[128:129], v32 offset:0
    v_mfma_f32_16x16x32_bf16 a[144:147], v[96:99], v[152:155], a[144:147]
    ds_read_b64_tr_b16 v[130:131], v32 offset:2048
    v_mfma_f32_16x16x32_bf16 a[152:155], v[96:99], v[156:159], a[152:155]
    s_add_u32 m0, s94, 67584
    v_mfma_f32_16x16x32_bf16 a[160:163], v[96:99], v[160:163], a[160:163]
    buffer_load_dwordx4 v18, s[84:87], s89 offen lds
    v_mfma_f32_16x16x32_bf16 a[168:171], v[96:99], v[164:167], a[168:171]
    ds_read_b128 v[68:71], v24 offset:9216
    v_mfma_f32_16x16x32_bf16 a[176:179], v[96:99], v[168:171], a[176:179]
    s_add_u32 m0, s94, 68608
    v_mfma_f32_16x16x32_bf16 a[184:187], v[96:99], v[172:175], a[184:187]
    buffer_load_dwordx4 v19, s[84:87], s89 offen lds
    v_mfma_f32_16x16x32_bf16 a[132:135], v[100:103], v[144:147], a[132:135]
    ds_read_b64_tr_b16 v[132:133], v33 offset:0
    v_mfma_f32_16x16x32_bf16 a[140:143], v[100:103], v[148:151], a[140:143]
    ds_read_b64_tr_b16 v[134:135], v33 offset:2048
    v_mfma_f32_16x16x32_bf16 a[148:151], v[100:103], v[152:155], a[148:151]
    s_add_u32 m0, s94, 69632
    v_mfma_f32_16x16x32_bf16 a[156:159], v[100:103], v[156:159], a[156:159]
    buffer_load_dwordx4 v20, s[84:87], s89 offen lds
    v_mfma_f32_16x16x32_bf16 a[164:167], v[100:103], v[160:163], a[164:167]
    ds_read_b128 v[72:75], v24 offset:12288
    v_mfma_f32_16x16x32_bf16 a[172:175], v[100:103], v[164:167], a[172:175]
    s_add_u32 m0, s94, 70656
    v_mfma_f32_16x16x32_bf16 a[180:183], v[100:103], v[168:171], a[180:183]
    buffer_load_dwordx4 v21, s[84:87], s89 offen lds
    v_mfma_f32_16x16x32_bf16 a[188:191], v[100:103], v[172:175], a[188:191]
    ds_read_b64_tr_b16 v[136:137], v34 offset:0
    v_mfma_f32_16x16x32_bf16 a[192:195], v[104:107], v[144:147], a[192:195]
    ds_read_b64_tr_b16 v[138:139], v34 offset:2048
    v_mfma_f32_16x16x32_bf16 a[200:203], v[104:107], v[148:151], a[200:203]
    s_add_u32 m0, s94, 71680
    v_mfma_f32_16x16x32_bf16 a[208:211], v[104:107], v[152:155], a[208:211]
    buffer_load_dwordx4 v22, s[84:87], s89 offen lds
    v_mfma_f32_16x16x32_bf16 a[216:219], v[104:107], v[156:159], a[216:219]
    ds_read_b128 v[76:79], v24 offset:13312
    v_mfma_f32_16x16x32_bf16 a[224:227], v[104:107], v[160:163], a[224:227]
    s_add_u32 m0, s94, 72704
    v_mfma_f32_16x16x32_bf16 a[232:235], v[104:107], v[164:167], a[232:235]
    buffer_load_dwordx4 v23, s[84:87], s89 offen lds
    v_mfma_f32_16x16x32_bf16 a[240:243], v[104:107], v[168:171], a[240:243]
    ds_read_b64_tr_b16 v[140:141], v35 offset:0
    v_mfma_f32_16x16x32_bf16 a[248:251], v[104:107], v[172:175], a[248:251]
    ds_read_b64_tr_b16 v[142:143], v35 offset:2048
    v_mfma_f32_16x16x32_bf16 a[196:199], v[108:111], v[144:147], a[196:199]
    s_add_u32 s88, s88, s90
    s_add_u32 s89, s89, s91
    v_mfma_f32_16x16x32_bf16 a[204:207], v[108:111], v[148:151], a[204:207]
    v_mfma_f32_16x16x32_bf16 a[212:215], v[108:111], v[152:155], a[212:215]
    v_mfma_f32_16x16x32_bf16 a[220:223], v[108:111], v[156:159], a[220:223]
    v_mfma_f32_16x16x32_bf16 a[228:231], v[108:111], v[160:163], a[228:231]
    v_mfma_f32_16x16x32_bf16 a[236:239], v[108:111], v[164:167], a[236:239]
    v_mfma_f32_16x16x32_bf16 a[244:247], v[108:111], v[168:171], a[244:247]
    v_mfma_f32_16x16x32_bf16 a[252:255], v[108:111], v[172:175], a[252:255]
    s_sub_u32 s92, s92, 1
    s_cmp_eq_u32 s92, 0
    s_cbranch_scc1 gxbn_188
glbn_187:
    s_waitcnt lgkmcnt(0)
    v_mfma_f32_16x16x32_bf16 a[0:3], v[48:51], v[112:115], a[0:3]
    ds_read_b128 v[80:83], v25 offset:0
    v_mfma_f32_16x16x32_bf16 a[8:11], v[48:51], v[116:119], a[8:11]
    v_mfma_f32_16x16x32_bf16 a[16:19], v[48:51], v[120:123], a[16:19]
    ds_read_b64_tr_b16 v[144:145], v28 offset:16384
    v_mfma_f32_16x16x32_bf16 a[24:27], v[48:51], v[124:127], a[24:27]
    v_mfma_f32_16x16x32_bf16 a[32:35], v[48:51], v[128:131], a[32:35]
    ds_read_b64_tr_b16 v[146:147], v28 offset:18432
    v_mfma_f32_16x16x32_bf16 a[40:43], v[48:51], v[132:135], a[40:43]
    v_mfma_f32_16x16x32_bf16 a[48:51], v[48:51], v[136:139], a[48:51]
    v_mfma_f32_16x16x32_bf16 a[56:59], v[48:51], v[140:143], a[56:59]
    ds_read_b128 v[84:87], v25 offset:1024
    v_mfma_f32_16x16x32_bf16 a[4:7], v[52:55], v[112:115], a[4:7]
    v_mfma_f32_16x16x32_bf16 a[12:15], v[52:55], v[116:119], a[12:15]
    ds_read_b64_tr_b16 v[148:149], v29 offset:16384
    v_mfma_f32_16x16x32_bf16 a[20:23], v[52:55], v[120:123], a[20:23]
    v_mfma_f32_16x16x32_bf16 a[28:31], v[52:55], v[124:127], a[28:31]
    v_mfma_f32_16x16x32_bf16 a[36:39], v[52:55], v[128:131], a[36:39]
    ds_read_b64_tr_b16 v[150:151], v29 offset:18432
    v_mfma_f32_16x16x32_bf16 a[44:47], v[52:55], v[132:135], a[44:47]
    v_mfma_f32_16x16x32_bf16 a[52:55], v[52:55], v[136:139], a[52:55]
    ds_read_b128 v[88:91], v25 offset:4096
    v_mfma_f32_16x16x32_bf16 a[60:63], v[52:55], v[140:143], a[60:63]
    v_mfma_f32_16x16x32_bf16 a[64:67], v[56:59], v[112:115], a[64:67]
    ds_read_b64_tr_b16 v[152:153], v30 offset:16384
    v_mfma_f32_16x16x32_bf16 a[72:75], v[56:59], v[116:119], a[72:75]
    v_mfma_f32_16x16x32_bf16 a[80:83], v[56:59], v[120:123], a[80:83]
    v_mfma_f32_16x16x32_bf16 a[88:91], v[56:59], v[124:127], a[88:91]
    ds_read_b64_tr_b16 v[154:155], v30 offset:18432
    v_mfma_f32_16x16x32_bf16 a[96:99], v[56:59], v[128:131], a[96:99]
    v_mfma_f32_16x16x32_bf16 a[104:107], v[56:59], v[132:135], a[104:107]
    ds_read_b128 v[92:95], v25 offset:5120
    v_mfma_f32_16x16x32_bf16 a[112:115], v[56:59], v[136:139], a[112:115]
    v_mfma_f32_16x16x32_bf16 a[120:123], v[56:59], v[140:143], a[120:123]
    v_mfma_f32_16x16x32_bf16 a[68:71], v[60:63], v[112:115], a[68:71]
    ds_read_b64_tr_b16 v[156:157], v31 offset:16384
    v_mfma_f32_16x16x32_bf16 a[76:79], v[60:63], v[116:119], a[76:79]
    v_mfma_f32_16x16x32_bf16 a[84:87], v[60:63], v[120:123], a[84:87]
    ds_read_b64_tr_b16 v[158:159], v31 offset:18432
    v_mfma_f32_16x16x32_bf16 a[92:95], v[60:63], v[124:127], a[92:95]
    v_mfma_f32_16x16x32_bf16 a[100:103], v[60:63], v[128:131], a[100:103]
    v_mfma_f32_16x16x32_bf16 a[108:111], v[60:63], v[132:135], a[108:111]
    ds_read_b128 v[96:99], v25 offset:8192
    v_mfma_f32_16x16x32_bf16 a[116:119], v[60:63], v[136:139], a[116:119]
    v_mfma_f32_16x16x32_bf16 a[124:127], v[60:63], v[140:143], a[124:127]
    ds_read_b64_tr_b16 v[160:161], v32 offset:16384
    v_mfma_f32_16x16x32_bf16 a[128:131], v[64:67], v[112:115], a[128:131]
    v_mfma_f32_16x16x32_bf16 a[136:139], v[64:67], v[116:119], a[136:139]
    ds_read_b64_tr_b16 v[162:163], v32 offset:18432
    v_mfma_f32_16x16x32_bf16 a[144:147], v[64:67], v[120:123], a[144:147]
    v_mfma_f32_16x16x32_bf16 a[152:155], v[64:67], v[124:127], a[152:155]
    v_mfma_f32_16x16x32_bf16 a[160:163], v[64:67], v[128:131], a[160:163]
    ds_read_b128 v[100:103], v25 offset:9216
    v_mfma_f32_16x16x32_bf16 a[168:171], v[64:67], v[132:135], a[168:171]
    v_mfma_f32_16x16x32_bf16 a[176:179], v[64:67], v[136:139], a[176:179]
    ds_read_b64_tr_b16 v[164:165], v33 offset:16384
    v_mfma_f32_16x16x32_bf16 a[184:187], v[64:67], v[140:143], a[184:187]
    v_mfma_f32_16x16x32_bf16 a[132:135], v[68:71], v[112:115], a[132:135]
    v_mfma_f32_16x16x32_bf16 a[140:143], v[68:71], v[116:119], a[140:143]
    ds_read_b64_tr_b16 v[166:167], v33 offset:18432
    v_mfma_f32_16x16x32_bf16 a[148:151], v[68:71], v[120:123], a[148:151]
    v_mfma_f32_16x16x32_bf16 a[156:159], v[68:71], v[124:127], a[156:159]
    ds_read_b128 v[104:107], v25 offset:12288
    v_mfma_f32_16x16x32_bf16 a[164:167], v[68:71], v[128:131], a[164:167]
    v_mfma_f32_16x16x32_bf16 a[172:175], v[68:71], v[132:135], a[172:175]
    ds_read_b64_tr_b16 v[168:169], v34 offset:16384
    v_mfma_f32_16x16x32_bf16 a[180:183], v[68:71], v[136:139], a[180:183]
    v_mfma_f32_16x16x32_bf16 a[188:191], v[68:71], v[140:143], a[188:191]
    v_mfma_f32_16x16x32_bf16 a[192:195], v[72:75], v[112:115], a[192:195]
    ds_read_b64_tr_b16 v[170:171], v34 offset:18432
    v_mfma_f32_16x16x32_bf16 a[200:203], v[72:75], v[116:119], a[200:203]
    v_mfma_f32_16x16x32_bf16 a[208:211], v[72:75], v[120:123], a[208:211]
    ds_read_b128 v[108:111], v25 offset:13312
    v_mfma_f32_16x16x32_bf16 a[216:219], v[72:75], v[124:127], a[216:219]
    v_mfma_f32_16x16x32_bf16 a[224:227], v[72:75], v[128:131], a[224:227]
    v_mfma_f32_16x16x32_bf16 a[232:235], v[72:75], v[132:135], a[232:235]
    ds_read_b64_tr_b16 v[172:173], v35 offset:16384
    v_mfma_f32_16x16x32_bf16 a[240:243], v[72:75], v[136:139], a[240:243]
    v_mfma_f32_16x16x32_bf16 a[248:251], v[72:75], v[140:143], a[248:251]
    ds_read_b64_tr_b16 v[174:175], v35 offset:18432
    v_mfma_f32_16x16x32_bf16 a[196:199], v[76:79], v[112:115], a[196:199]
    v_mfma_f32_16x16x32_bf16 a[204:207], v[76:79], v[116:119], a[204:207]
    v_mfma_f32_16x16x32_bf16 a[212:215], v[76:79], v[120:123], a[212:215]
    v_mfma_f32_16x16x32_bf16 a[220:223], v[76:79], v[124:127], a[220:223]
    v_mfma_f32_16x16x32_bf16 a[228:231], v[76:79], v[128:131], a[228:231]
    v_mfma_f32_16x16x32_bf16 a[236:239], v[76:79], v[132:135], a[236:239]
    v_mfma_f32_16x16x32_bf16 a[244:247], v[76:79], v[136:139], a[244:247]
    v_mfma_f32_16x16x32_bf16 a[252:255], v[76:79], v[140:143], a[252:255]
    s_waitcnt lgkmcnt(0)
    s_waitcnt vmcnt(0)
    s_barrier
    v_mfma_f32_16x16x32_bf16 a[0:3], v[80:83], v[144:147], a[0:3]
    s_add_u32 m0, s93, 0
    v_mfma_f32_16x16x32_bf16 a[8:11], v[80:83], v[148:151], a[8:11]
    buffer_load_dwordx4 v8, s[80:83], s88 offen lds
    v_mfma_f32_16x16x32_bf16 a[16:19], v[80:83], v[152:155], a[16:19]
    ds_read_b128 v[48:51], v26 offset:0
    v_mfma_f32_16x16x32_bf16 a[24:27], v[80:83], v[156:159], a[24:27]
    s_add_u32 m0, s93, 1024
    v_mfma_f32_16x16x32_bf16 a[32:35], v[80:83], v[160:163], a[32:35]
    buffer_load_dwordx4 v9, s[80:83], s88 offen lds
    v_mfma_f32_16x16x32_bf16 a[40:43], v[80:83], v[164:167], a[40:43]
    ds_read_b64_tr_b16 v[112:113], v36 offset:0
    v_mfma_f32_16x16x32_bf16 a[48:51], v[80:83], v[168:171], a[48:51]
    ds_read_b64_tr_b16 v[114:115], v36 offset:2048
    v_mfma_f32_16x16x32_bf16 a[56:59], v[80:83], v[172:175], a[56:59]
    s_add_u32 m0, s93, 2048
    v_mfma_f32_16x16x32_bf16 a[4:7], v[84:87], v[144:147], a[4:7]
    buffer_load_dwordx4 v10, s[80:83], s88 offen lds
    v_mfma_f32_16x16x32_bf16 a[12:15], v[84:87], v[148:151], a[12:15]
    ds_read_b128 v[52:55], v26 offset:1024
    v_mfma_f32_16x16x32_bf16 a[20:23], v[84:87], v[152:155], a[20:23]
    s_add_u32 m0, s93, 3072
    v_mfma_f32_16x16x32_bf16 a[28:31], v[84:87], v[156:159], a[28:31]
    buffer_load_dwordx4 v11, s[80:83], s88 offen lds
    v_mfma_f32_16x16x32_bf16 a[36:39], v[84:87], v[160:163], a[36:39]
    ds_read_b64_tr_b16 v[116:117], v37 offset:0
    v_mfma_f32_16x16x32_bf16 a[44:47], v[84:87], v[164:167], a[44:47]
    ds_read_b64_tr_b16 v[118:119], v37 offset:2048
    v_mfma_f32_16x16x32_bf16 a[52:55], v[84:87], v[168:171], a[52:55]
    s_add_u32 m0, s93, 4096
    v_mfma_f32_16x16x32_bf16 a[60:63], v[84:87], v[172:175], a[60:63]
    buffer_load_dwordx4 v12, s[80:83], s88 offen lds
    v_mfma_f32_16x16x32_bf16 a[64:67], v[88:91], v[144:147], a[64:67]
    ds_read_b128 v[56:59], v26 offset:4096
    v_mfma_f32_16x16x32_bf16 a[72:75], v[88:91], v[148:151], a[72:75]
    s_add_u32 m0, s93, 5120
    v_mfma_f32_16x16x32_bf16 a[80:83], v[88:91], v[152:155], a[80:83]
    buffer_load_dwordx4 v13, s[80:83], s88 offen lds
    v_mfma_f32_16x16x32_bf16 a[88:91], v[88:91], v[156:159], a[88:91]
    ds_read_b64_tr_b16 v[120:121], v38 offset:0
    v_mfma_f32_16x16x32_bf16 a[96:99], v[88:91], v[160:163], a[96:99]
    ds_read_b64_tr_b16 v[122:123], v38 offset:2048
    v_mfma_f32_16x16x32_bf16 a[104:107], v[88:91], v[164:167], a[104:107]
    s_add_u32 m0, s93, 6144
    v_mfma_f32_16x16x32_bf16 a[112:115], v[88:91], v[168:171], a[112:115]
    buffer_load_dwordx4 v14, s[80:83], s88 offen lds
    v_mfma_f32_16x16x32_bf16 a[120:123], v[88:91], v[172:175], a[120:123]
    ds_read_b128 v[60:63], v26 offset:5120
    v_mfma_f32_16x16x32_bf16 a[68:71], v[92:95], v[144:147], a[68:71]
    s_add_u32 m0, s93, 7168
    v_mfma_f32_16x16x32_bf16 a[76:79], v[92:95], v[148:151], a[76:79]
    buffer_load_dwordx4 v15, s[80:83], s88 offen lds
    v_mfma_f32_16x16x32_bf16 a[84:87], v[92:95], v[152:155], a[84:87]
    ds_read_b64_tr_b16 v[124:125], v39 offset:0
    v_mfma_f32_16x16x32_bf16 a[92:95], v[92:95], v[156:159], a[92:95]
    ds_read_b64_tr_b16 v[126:127], v39 offset:2048
    v_mfma_f32_16x16x32_bf16 a[100:103], v[92:95], v[160:163], a[100:103]
    s_add_u32 m0, s94, 0
    v_mfma_f32_16x16x32_bf16 a[108:111], v[92:95], v[164:167], a[108:111]
    buffer_load_dwordx4 v16, s[84:87], s89 offen lds
    v_mfma_f32_16x16x32_bf16 a[116:119], v[92:95], v[168:171], a[116:119]
    ds_read_b128 v[64:67], v26 offset:8192
    v_mfma_f32_16x16x32_bf16 a[124:127], v[92:95], v[172:175], a[124:127]
    s_add_u32 m0, s94, 1024
    v_mfma_f32_16x16x32_bf16 a[128:131], v[96:99], v[144:147], a[128:131]
    buffer_load_dwordx4 v17, s[84:87], s89 offen lds
    v_mfma_f32_16x16x32_bf16 a[136:139], v[96:99], v[148:151], a[136:139]
    ds_read_b64_tr_b16 v[128:129], v40 offset:0
    v_mfma_f32_16x16x32_bf16 a[144:147], v[96:99], v[152:155], a[144:147]
    ds_read_b64_tr_b16 v[130:131], v40 offset:2048
    v_mfma_f32_16x16x32_bf16 a[152:155], v[96:99], v[156:159], a[152:155]
    s_add_u32 m0, s94, 2048
    v_mfma_f32_16x16x32_bf16 a[160:163], v[96:99], v[160:163], a[160:163]
    buffer_load_dwordx4 v18, s[84:87], s89 offen lds
    v_mfma_f32_16x16x32_bf16 a[168:171], v[96:99], v[164:167], a[168:171]
    ds_read_b128 v[68:71], v26 offset:9216
    v_mfma_f32_16x16x32_bf16 a[176:179], v[96:99], v[168:171], a[176:179]
    s_add_u32 m0, s94, 3072
    v_mfma_f32_16x16x32_bf16 a[184:187], v[96:99], v[172:175], a[184:187]
    buffer_load_dwordx4 v19, s[84:87], s89 offen lds
    v_mfma_f32_16x16x32_bf16 a[132:135], v[100:103], v[144:147], a[132:135]
    ds_read_b64_tr_b16 v[132:133], v41 offset:0
    v_mfma_f32_16x16x32_bf16 a[140:143], v[100:103], v[148:151], a[140:143]
    ds_read_b64_tr_b16 v[134:135], v41 offset:2048
    v_mfma_f32_16x16x32_bf16 a[148:151], v[100:103], v[152:155], a[148:151]
    s_add_u32 m0, s94, 4096
    v_mfma_f32_16x16x32_bf16 a[156:159], v[100:103], v[156:159], a[156:159]
    buffer_load_dwordx4 v20, s[84:87], s89 offen lds
    v_mfma_f32_16x16x32_bf16 a[164:167], v[100:103], v[160:163], a[164:167]
    ds_read_b128 v[72:75], v26 offset:12288
    v_mfma_f32_16x16x32_bf16 a[172:175], v[100:103], v[164:167], a[172:175]
    s_add_u32 m0, s94, 5120
    v_mfma_f32_16x16x32_bf16 a[180:183], v[100:103], v[168:171], a[180:183]
    buffer_load_dwordx4 v21, s[84:87], s89 offen lds
    v_mfma_f32_16x16x32_bf16 a[188:191], v[100:103], v[172:175], a[188:191]
    ds_read_b64_tr_b16 v[136:137], v42 offset:0
    v_mfma_f32_16x16x32_bf16 a[192:195], v[104:107], v[144:147], a[192:195]
    ds_read_b64_tr_b16 v[138:139], v42 offset:2048
    v_mfma_f32_16x16x32_bf16 a[200:203], v[104:107], v[148:151], a[200:203]
    s_add_u32 m0, s94, 6144
    v_mfma_f32_16x16x32_bf16 a[208:211], v[104:107], v[152:155], a[208:211]
    buffer_load_dwordx4 v22, s[84:87], s89 offen lds
    v_mfma_f32_16x16x32_bf16 a[216:219], v[104:107], v[156:159], a[216:219]
    ds_read_b128 v[76:79], v26 offset:13312
    v_mfma_f32_16x16x32_bf16 a[224:227], v[104:107], v[160:163], a[224:227]
    s_add_u32 m0, s94, 7168
    v_mfma_f32_16x16x32_bf16 a[232:235], v[104:107], v[164:167], a[232:235]
    buffer_load_dwordx4 v23, s[84:87], s89 offen lds
    v_mfma_f32_16x16x32_bf16 a[240:243], v[104:107], v[168:171], a[240:243]
    ds_read_b64_tr_b16 v[140:141], v43 offset:0
    v_mfma_f32_16x16x32_bf16 a[248:251], v[104:107], v[172:175], a[248:251]
    ds_read_b64_tr_b16 v[142:143], v43 offset:2048
    v_mfma_f32_16x16x32_bf16 a[196:199], v[108:111], v[144:147], a[196:199]
    s_add_u32 s88, s88, s90
    s_add_u32 s89, s89, s91
    v_mfma_f32_16x16x32_bf16 a[204:207], v[108:111], v[148:151], a[204:207]
    v_mfma_f32_16x16x32_bf16 a[212:215], v[108:111], v[152:155], a[212:215]
    v_mfma_f32_16x16x32_bf16 a[220:223], v[108:111], v[156:159], a[220:223]
    v_mfma_f32_16x16x32_bf16 a[228:231], v[108:111], v[160:163], a[228:231]
    v_mfma_f32_16x16x32_bf16 a[236:239], v[108:111], v[164:167], a[236:239]
    v_mfma_f32_16x16x32_bf16 a[244:247], v[108:111], v[168:171], a[244:247]
    v_mfma_f32_16x16x32_bf16 a[252:255], v[108:111], v[172:175], a[252:255]
    s_waitcnt lgkmcnt(0)
    v_mfma_f32_16x16x32_bf16 a[0:3], v[48:51], v[112:115], a[0:3]
    ds_read_b128 v[80:83], v27 offset:0
    v_mfma_f32_16x16x32_bf16 a[8:11], v[48:51], v[116:119], a[8:11]
    v_mfma_f32_16x16x32_bf16 a[16:19], v[48:51], v[120:123], a[16:19]
    ds_read_b64_tr_b16 v[144:145], v36 offset:16384
    v_mfma_f32_16x16x32_bf16 a[24:27], v[48:51], v[124:127], a[24:27]
    v_mfma_f32_16x16x32_bf16 a[32:35], v[48:51], v[128:131], a[32:35]
    ds_read_b64_tr_b16 v[146:147], v36 offset:18432
    v_mfma_f32_16x16x32_bf16 a[40:43], v[48:51], v[132:135], a[40:43]
    v_mfma_f32_16x16x32_bf16 a[48:51], v[48:51], v[136:139], a[48:51]
    v_mfma_f32_16x16x32_bf16 a[56:59], v[48:51], v[140:143], a[56:59]
    ds_read_b128 v[84:87], v27 offset:1024
    v_mfma_f32_16x16x32_bf16 a[4:7], v[52:55], v[112:115], a[4:7]
    v_mfma_f32_16x16x32_bf16 a[12:15], v[52:55], v[116:119], a[12:15]
    ds_read_b64_tr_b16 v[148:149], v37 offset:16384
    v_mfma_f32_16x16x32_bf16 a[20:23], v[52:55], v[120:123], a[20:23]
    v_mfma_f32_16x16x32_bf16 a[28:31], v[52:55], v[124:127], a[28:31]
    v_mfma_f32_16x16x32_bf16 a[36:39], v[52:55], v[128:131], a[36:39]
    ds_read_b64_tr_b16 v[150:151], v37 offset:18432
    v_mfma_f32_16x16x32_bf16 a[44:47], v[52:55], v[132:135], a[44:47]
    v_mfma_f32_16x16x32_bf16 a[52:55], v[52:55], v[136:139], a[52:55]
    ds_read_b128 v[88:91], v27 offset:4096
    v_mfma_f32_16x16x32_bf16 a[60:63], v[52:55], v[140:143], a[60:63]
    v_mfma_f32_16x16x32_bf16 a[64:67], v[56:59], v[112:115], a[64:67]
    ds_read_b64_tr_b16 v[152:153], v38 offset:16384
    v_mfma_f32_16x16x32_bf16 a[72:75], v[56:59], v[116:119], a[72:75]
    v_mfma_f32_16x16x32_bf16 a[80:83], v[56:59], v[120:123], a[80:83]
    v_mfma_f32_16x16x32_bf16 a[88:91], v[56:59], v[124:127], a[88:91]
    ds_read_b64_tr_b16 v[154:155], v38 offset:18432
    v_mfma_f32_16x16x32_bf16 a[96:99], v[56:59], v[128:131], a[96:99]
    v_mfma_f32_16x16x32_bf16 a[104:107], v[56:59], v[132:135], a[104:107]
    ds_read_b128 v[92:95], v27 offset:5120
    v_mfma_f32_16x16x32_bf16 a[112:115], v[56:59], v[136:139], a[112:115]
    v_mfma_f32_16x16x32_bf16 a[120:123], v[56:59], v[140:143], a[120:123]
    v_mfma_f32_16x16x32_bf16 a[68:71], v[60:63], v[112:115], a[68:71]
    ds_read_b64_tr_b16 v[156:157], v39 offset:16384
    v_mfma_f32_16x16x32_bf16 a[76:79], v[60:63], v[116:119], a[76:79]
    v_mfma_f32_16x16x32_bf16 a[84:87], v[60:63], v[120:123], a[84:87]
    ds_read_b64_tr_b16 v[158:159], v39 offset:18432
    v_mfma_f32_16x16x32_bf16 a[92:95], v[60:63], v[124:127], a[92:95]
    v_mfma_f32_16x16x32_bf16 a[100:103], v[60:63], v[128:131], a[100:103]
    v_mfma_f32_16x16x32_bf16 a[108:111], v[60:63], v[132:135], a[108:111]
    ds_read_b128 v[96:99], v27 offset:8192
    v_mfma_f32_16x16x32_bf16 a[116:119], v[60:63], v[136:139], a[116:119]
    v_mfma_f32_16x16x32_bf16 a[124:127], v[60:63], v[140:143], a[124:127]
    ds_read_b64_tr_b16 v[160:161], v40 offset:16384
    v_mfma_f32_16x16x32_bf16 a[128:131], v[64:67], v[112:115], a[128:131]
    v_mfma_f32_16x16x32_bf16 a[136:139], v[64:67], v[116:119], a[136:139]
    ds_read_b64_tr_b16 v[162:163], v40 offset:18432
    v_mfma_f32_16x16x32_bf16 a[144:147], v[64:67], v[120:123], a[144:147]
    v_mfma_f32_16x16x32_bf16 a[152:155], v[64:67], v[124:127], a[152:155]
    v_mfma_f32_16x16x32_bf16 a[160:163], v[64:67], v[128:131], a[160:163]
    ds_read_b128 v[100:103], v27 offset:9216
    v_mfma_f32_16x16x32_bf16 a[168:171], v[64:67], v[132:135], a[168:171]
    v_mfma_f32_16x16x32_bf16 a[176:179], v[64:67], v[136:139], a[176:179]
    ds_read_b64_tr_b16 v[164:165], v41 offset:16384
    v_mfma_f32_16x16x32_bf16 a[184:187], v[64:67], v[140:143], a[184:187]
    v_mfma_f32_16x16x32_bf16 a[132:135], v[68:71], v[112:115], a[132:135]
    v_mfma_f32_16x16x32_bf16 a[140:143], v[68:71], v[116:119], a[140:143]
    ds_read_b64_tr_b16 v[166:167], v41 offset:18432
    v_mfma_f32_16x16x32_bf16 a[148:151], v[68:71], v[120:123], a[148:151]
    v_mfma_f32_16x16x32_bf16 a[156:159], v[68:71], v[124:127], a[156:159]
    ds_read_b128 v[104:107], v27 offset:12288
    v_mfma_f32_16x16x32_bf16 a[164:167], v[68:71], v[128:131], a[164:167]
    v_mfma_f32_16x16x32_bf16 a[172:175], v[68:71], v[132:135], a[172:175]
    ds_read_b64_tr_b16 v[168:169], v42 offset:16384
    v_mfma_f32_16x16x32_bf16 a[180:183], v[68:71], v[136:139], a[180:183]
    v_mfma_f32_16x16x32_bf16 a[188:191], v[68:71], v[140:143], a[188:191]
    v_mfma_f32_16x16x32_bf16 a[192:195], v[72:75], v[112:115], a[192:195]
    ds_read_b64_tr_b16 v[170:171], v42 offset:18432
    v_mfma_f32_16x16x32_bf16 a[200:203], v[72:75], v[116:119], a[200:203]
    v_mfma_f32_16x16x32_bf16 a[208:211], v[72:75], v[120:123], a[208:211]
    ds_read_b128 v[108:111], v27 offset:13312
    v_mfma_f32_16x16x32_bf16 a[216:219], v[72:75], v[124:127], a[216:219]
    v_mfma_f32_16x16x32_bf16 a[224:227], v[72:75], v[128:131], a[224:227]
    v_mfma_f32_16x16x32_bf16 a[232:235], v[72:75], v[132:135], a[232:235]
    ds_read_b64_tr_b16 v[172:173], v43 offset:16384
    v_mfma_f32_16x16x32_bf16 a[240:243], v[72:75], v[136:139], a[240:243]
    v_mfma_f32_16x16x32_bf16 a[248:251], v[72:75], v[140:143], a[248:251]
    ds_read_b64_tr_b16 v[174:175], v43 offset:18432
    v_mfma_f32_16x16x32_bf16 a[196:199], v[76:79], v[112:115], a[196:199]
    v_mfma_f32_16x16x32_bf16 a[204:207], v[76:79], v[116:119], a[204:207]
    v_mfma_f32_16x16x32_bf16 a[212:215], v[76:79], v[120:123], a[212:215]
    v_mfma_f32_16x16x32_bf16 a[220:223], v[76:79], v[124:127], a[220:223]
    v_mfma_f32_16x16x32_bf16 a[228:231], v[76:79], v[128:131], a[228:231]
    v_mfma_f32_16x16x32_bf16 a[236:239], v[76:79], v[132:135], a[236:239]
    v_mfma_f32_16x16x32_bf16 a[244:247], v[76:79], v[136:139], a[244:247]
    v_mfma_f32_16x16x32_bf16 a[252:255], v[76:79], v[140:143], a[252:255]
    s_waitcnt lgkmcnt(0)
    s_waitcnt vmcnt(0)
    s_barrier
    v_mfma_f32_16x16x32_bf16 a[0:3], v[80:83], v[144:147], a[0:3]
    s_add_u32 m0, s93, 65536
    v_mfma_f32_16x16x32_bf16 a[8:11], v[80:83], v[148:151], a[8:11]
    buffer_load_dwordx4 v8, s[80:83], s88 offen lds
    v_mfma_f32_16x16x32_bf16 a[16:19], v[80:83], v[152:155], a[16:19]
    ds_read_b128 v[48:51], v24 offset:0
    v_mfma_f32_16x16x32_bf16 a[24:27], v[80:83], v[156:159], a[24:27]
    s_add_u32 m0, s93, 66560
    v_mfma_f32_16x16x32_bf16 a[32:35], v[80:83], v[160:163], a[32:35]
    buffer_load_dwordx4 v9, s[80:83], s88 offen lds
    v_mfma_f32_16x16x32_bf16 a[40:43], v[80:83], v[164:167], a[40:43]
    ds_read_b64_tr_b16 v[112:113], v28 offset:0
    v_mfma_f32_16x16x32_bf16 a[48:51], v[80:83], v[168:171], a[48:51]
    ds_read_b64_tr_b16 v[114:115], v28 offset:2048
    v_mfma_f32_16x16x32_bf16 a[56:59], v[80:83], v[172:175], a[56:59]
    s_add_u32 m0, s93, 67584
    v_mfma_f32_16x16x32_bf16 a[4:7], v[84:87], v[144:147], a[4:7]
    buffer_load_dwordx4 v10, s[80:83], s88 offen lds
    v_mfma_f32_16x16x32_bf16 a[12:15], v[84:87], v[148:151], a[12:15]
    ds_read_b128 v[52:55], v24 offset:1024
    v_mfma_f32_16x16x32_bf16 a[20:23], v[84:87], v[152:155], a[20:23]
    s_add_u32 m0, s93, 68608
    v_mfma_f32_16x16x32_bf16 a[28:31], v[84:87], v[156:159], a[28:31]
    buffer_load_dwordx4 v11, s[80:83], s88 offen lds
    v_mfma_f32_16x16x32_bf16 a[36:39], v[84:87], v[160:163], a[36:39]
    ds_read_b64_tr_b16 v[116:117], v29 offset:0
    v_mfma_f32_16x16x32_bf16 a[44:47], v[84:87], v[164:167], a[44:47]
    ds_read_b64_tr_b16 v[118:119], v29 offset:2048
    v_mfma_f32_16x16x32_bf16 a[52:55], v[84:87], v[168:171], a[52:55]
    s_add_u32 m0, s93, 69632
    v_mfma_f32_16x16x32_bf16 a[60:63], v[84:87], v[172:175], a[60:63]
    buffer_load_dwordx4 v12, s[80:83], s88 offen lds
    v_mfma_f32_16x16x32_bf16 a[64:67], v[88:91], v[144:147], a[64:67]
    ds_read_b128 v[56:59], v24 offset:4096
    v_mfma_f32_16x16x32_bf16 a[72:75], v[88:91], v[148:151], a[72:75]
    s_add_u32 m0, s93, 70656
    v_mfma_f32_16x16x32_bf16 a[80:83], v[88:91], v[152:155], a[80:83]
    buffer_load_dwordx4 v13, s[80:83], s88 offen lds
    v_mfma_f32_16x16x32_bf16 a[88:91], v[88:91], v[156:159], a[88:91]
    ds_read_b64_tr_b16 v[120:121], v30 offset:0
    v_mfma_f32_16x16x32_bf16 a[96:99], v[88:91], v[160:163], a[96:99]
    ds_read_b64_tr_b16 v[122:123], v30 offset:2048
    v_mfma_f32_16x16x32_bf16 a[104:107], v[88:91], v[164:167], a[104:107]
    s_add_u32 m0, s93, 71680
    v_mfma_f32_16x16x32_bf16 a[112:115], v[88:91], v[168:171], a[112:115]
    buffer_load_dwordx4 v14, s[80:83], s88 offen lds
    v_mfma_f32_16x16x32_bf16 a[120:123], v[88:91], v[172:175], a[120:123]
    ds_read_b128 v[60:63], v24 offset:5120
    v_mfma_f32_16x16x32_bf16 a[68:71], v[92:95], v[144:147], a[68:71]
    s_add_u32 m0, s93, 72704
    v_mfma_f32_16x16x32_bf16 a[76:79], v[92:95], v[148:151], a[76:79]
    buffer_load_dwordx4 v15, s[80:83], s88 offen lds
    v_mfma_f32_16x16x32_bf16 a[84:87], v[92:95], v[152:155], a[84:87]
    ds_read_b64_tr_b16 v[124:125], v31 offset:0
    v_mfma_f32_16x16x32_bf16 a[92:95], v[92:95], v[156:159], a[92:95]
    ds_read_b64_tr_b16 v[126:127], v31 offset:2048
    v_mfma_f32_16x16x32_bf16 a[100:103], v[92:95], v[160:163], a[100:103]
    s_add_u32 m0, s94, 65536
    v_mfma_f32_16x16x32_bf16 a[108:111], v[92:95], v[164:167], a[108:111]
    buffer_load_dwordx4 v16, s[84:87], s89 offen lds
    v_mfma_f32_16x16x32_bf16 a[116:119], v[92:95], v[168:171], a[116:119]
    ds_read_b128 v[64:67], v24 offset:8192
    v_mfma_f32_16x16x32_bf16 a[124:127], v[92:95], v[172:175], a[124:127]
    s_add_u32 m0, s94, 66560
    v_mfma_f32_16x16x32_bf16 a[128:131], v[96:99], v[144:147], a[128:131]
    buffer_load_dwordx4 v17, s[84:87], s89 offen lds
    v_mfma_f32_16x16x32_bf16 a[136:139], v[96:99], v[148:151], a[136:139]
    ds_read_b64_tr_b16 v[128:129], v32 offset:0
    v_mfma_f32_16x16x32_bf16 a[144:147], v[96:99], v[152:155], a[144:147]
    ds_read_b64_tr_b16 v[130:131], v32 offset:2048
    v_mfma_f32_16x16x32_bf16 a[152:155], v[96:99], v[156:159], a[152:155]
    s_add_u32 m0, s94, 67584
    v_mfma_f32_16x16x32_bf16 a[160:163], v[96:99], v[160:163], a[160:163]
    buffer_load_dwordx4 v18, s[84:87], s89 offen lds
    v_mfma_f32_16x16x32_bf16 a[168:171], v[96:99], v[164:167], a[168:171]
    ds_read_b128 v[68:71], v24 offset:9216
    v_mfma_f32_16x16x32_bf16 a[176:179], v[96:99], v[168:171], a[176:179]
    s_add_u32 m0, s94, 68608
    v_mfma_f32_16x16x32_bf16 a[184:187], v[96:99], v[172:175], a[184:187]
    buffer_load_dwordx4 v19, s[84:87], s89 offen lds
    v_mfma_f32_16x16x32_bf16 a[132:135], v[100:103], v[144:147], a[132:135]
    ds_read_b64_tr_b16 v[132:133], v33 offset:0
    v_mfma_f32_16x16x32_bf16 a[140:143], v[100:103], v[148:151], a[140:143]
    ds_read_b64_tr_b16 v[134:135], v33 offset:2048
    v_mfma_f32_16x16x32_bf16 a[148:151], v[100:103], v[152:155], a[148:151]
    s_add_u32 m0, s94, 69632
    v_mfma_f32_16x16x32_bf16 a[156:159], v[100:103], v[156:159], a[156:159]
    buffer_load_dwordx4 v20, s[84:87], s89 offen lds
    v_mfma_f32_16x16x32_bf16 a[164:167], v[100:103], v[160:163], a[164:167]
    ds_read_b128 v[72:75], v24 offset:12288
    v_mfma_f32_16x16x32_bf16 a[172:175], v[100:103], v[164:167], a[172:175]
    s_add_u32 m0, s94, 70656
    v_mfma_f32_16x16x32_bf16 a[180:183], v[100:103], v[168:171], a[180:183]
    buffer_load_dwordx4 v21, s[84:87], s89 offen lds
    v_mfma_f32_16x16x32_bf16 a[188:191], v[100:103], v[172:175], a[188:191]
    ds_read_b64_tr_b16 v[136:137], v34 offset:0
    v_mfma_f32_16x16x32_bf16 a[192:195], v[104:107], v[144:147], a[192:195]
    ds_read_b64_tr_b16 v[138:139], v34 offset:2048
    v_mfma_f32_16x16x32_bf16 a[200:203], v[104:107], v[148:151], a[200:203]
    s_add_u32 m0, s94, 71680
    v_mfma_f32_16x16x32_bf16 a[208:211], v[104:107], v[152:155], a[208:211]
    buffer_load_dwordx4 v22, s[84:87], s89 offen lds
    v_mfma_f32_16x16x32_bf16 a[216:219], v[104:107], v[156:159], a[216:219]
    ds_read_b128 v[76:79], v24 offset:13312
    v_mfma_f32_16x16x32_bf16 a[224:227], v[104:107], v[160:163], a[224:227]
    s_add_u32 m0, s94, 72704
    v_mfma_f32_16x16x32_bf16 a[232:235], v[104:107], v[164:167], a[232:235]
    buffer_load_dwordx4 v23, s[84:87], s89 offen lds
    v_mfma_f32_16x16x32_bf16 a[240:243], v[104:107], v[168:171], a[240:243]
    ds_read_b64_tr_b16 v[140:141], v35 offset:0
    v_mfma_f32_16x16x32_bf16 a[248:251], v[104:107], v[172:175], a[248:251]
    ds_read_b64_tr_b16 v[142:143], v35 offset:2048
    v_mfma_f32_16x16x32_bf16 a[196:199], v[108:111], v[144:147], a[196:199]
    s_add_u32 s88, s88, s90
    s_add_u32 s89, s89, s91
    v_mfma_f32_16x16x32_bf16 a[204:207], v[108:111], v[148:151], a[204:207]
    v_mfma_f32_16x16x32_bf16 a[212:215], v[108:111], v[152:155], a[212:215]
    v_mfma_f32_16x16x32_bf16 a[220:223], v[108:111], v[156:159], a[220:223]
    v_mfma_f32_16x16x32_bf16 a[228:231], v[108:111], v[160:163], a[228:231]
    v_mfma_f32_16x16x32_bf16 a[236:239], v[108:111], v[164:167], a[236:239]
    v_mfma_f32_16x16x32_bf16 a[244:247], v[108:111], v[168:171], a[244:247]
    v_mfma_f32_16x16x32_bf16 a[252:255], v[108:111], v[172:175], a[252:255]
    s_sub_u32 s92, s92, 1
    s_cmp_lg_u32 s92, 0
    s_cbranch_scc1 glbn_187
gxbn_188:
    s_waitcnt lgkmcnt(0)
    v_mfma_f32_16x16x32_bf16 a[0:3], v[48:51], v[112:115], a[0:3]
    ds_read_b128 v[80:83], v25 offset:0
    v_mfma_f32_16x16x32_bf16 a[8:11], v[48:51], v[116:119], a[8:11]
    v_mfma_f32_16x16x32_bf16 a[16:19], v[48:51], v[120:123], a[16:19]
    ds_read_b64_tr_b16 v[144:145], v28 offset:16384
    v_mfma_f32_16x16x32_bf16 a[24:27], v[48:51], v[124:127], a[24:27]
    v_mfma_f32_16x16x32_bf16 a[32:35], v[48:51], v[128:131], a[32:35]
    ds_read_b64_tr_b16 v[146:147], v28 offset:18432
    v_mfma_f32_16x16x32_bf16 a[40:43], v[48:51], v[132:135], a[40:43]
    v_mfma_f32_16x16x32_bf16 a[48:51], v[48:51], v[136:139], a[48:51]
    v_mfma_f32_16x16x32_bf16 a[56:59], v[48:51], v[140:143], a[56:59]
    ds_read_b128 v[84:87], v25 offset:1024
    v_mfma_f32_16x16x32_bf16 a[4:7], v[52:55], v[112:115], a[4:7]
    v_mfma_f32_16x16x32_bf16 a[12:15], v[52:55], v[116:119], a[12:15]
    ds_read_b64_tr_b16 v[148:149], v29 offset:16384
    v_mfma_f32_16x16x32_bf16 a[20:23], v[52:55], v[120:123], a[20:23]
    v_mfma_f32_16x16x32_bf16 a[28:31], v[52:55], v[124:127], a[28:31]
    v_mfma_f32_16x16x32_bf16 a[36:39], v[52:55], v[128:131], a[36:39]
    ds_read_b64_tr_b16 v[150:151], v29 offset:18432
    v_mfma_f32_16x16x32_bf16 a[44:47], v[52:55], v[132:135], a[44:47]
    v_mfma_f32_16x16x32_bf16 a[52:55], v[52:55], v[136:139], a[52:55]
    ds_read_b128 v[88:91], v25 offset:4096
    v_mfma_f32_16x16x32_bf16 a[60:63], v[52:55], v[140:143], a[60:63]
    v_mfma_f32_16x16x32_bf16 a[64:67], v[56:59], v[112:115], a[64:67]
    ds_read_b64_tr_b16 v[152:153], v30 offset:16384
    v_mfma_f32_16x16x32_bf16 a[72:75], v[56:59], v[116:119], a[72:75]
    v_mfma_f32_16x16x32_bf16 a[80:83], v[56:59], v[120:123], a[80:83]
    v_mfma_f32_16x16x32_bf16 a[88:91], v[56:59], v[124:127], a[88:91]
    ds_read_b64_tr_b16 v[154:155], v30 offset:18432
    v_mfma_f32_16x16x32_bf16 a[96:99], v[56:59], v[128:131], a[96:99]
    v_mfma_f32_16x16x32_bf16 a[104:107], v[56:59], v[132:135], a[104:107]
    ds_read_b128 v[92:95], v25 offset:5120
    v_mfma_f32_16x16x32_bf16 a[112:115], v[56:59], v[136:139], a[112:115]
    v_mfma_f32_16x16x32_bf16 a[120:123], v[56:59], v[140:143], a[120:123]
    v_mfma_f32_16x16x32_bf16 a[68:71], v[60:63], v[112:115], a[68:71]
    ds_read_b64_tr_b16 v[156:157], v31 offset:16384
    v_mfma_f32_16x16x32_bf16 a[76:79], v[60:63], v[116:119], a[76:79]
    v_mfma_f32_16x16x32_bf16 a[84:87], v[60:63], v[120:123], a[84:87]
    ds_read_b64_tr_b16 v[158:159], v31 offset:18432
    v_mfma_f32_16x16x32_bf16 a[92:95], v[60:63], v[124:127], a[92:95]
    v_mfma_f32_16x16x32_bf16 a[100:103], v[60:63], v[128:131], a[100:103]
    v_mfma_f32_16x16x32_bf16 a[108:111], v[60:63], v[132:135], a[108:111]
    ds_read_b128 v[96:99], v25 offset:8192
    v_mfma_f32_16x16x32_bf16 a[116:119], v[60:63], v[136:139], a[116:119]
    v_mfma_f32_16x16x32_bf16 a[124:127], v[60:63], v[140:143], a[124:127]
    ds_read_b64_tr_b16 v[160:161], v32 offset:16384
    v_mfma_f32_16x16x32_bf16 a[128:131], v[64:67], v[112:115], a[128:131]
    v_mfma_f32_16x16x32_bf16 a[136:139], v[64:67], v[116:119], a[136:139]
    ds_read_b64_tr_b16 v[162:163], v32 offset:18432
    v_mfma_f32_16x16x32_bf16 a[144:147], v[64:67], v[120:123], a[144:147]
    v_mfma_f32_16x16x32_bf16 a[152:155], v[64:67], v[124:127], a[152:155]
    v_mfma_f32_16x16x32_bf16 a[160:163], v[64:67], v[128:131], a[160:163]
    ds_read_b128 v[100:103], v25 offset:9216
    v_mfma_f32_16x16x32_bf16 a[168:171], v[64:67], v[132:135], a[168:171]
    v_mfma_f32_16x16x32_bf16 a[176:179], v[64:67], v[136:139], a[176:179]
    ds_read_b64_tr_b16 v[164:165], v33 offset:16384
    v_mfma_f32_16x16x32_bf16 a[184:187], v[64:67], v[140:143], a[184:187]
    v_mfma_f32_16x16x32_bf16 a[132:135], v[68:71], v[112:115], a[132:135]
    v_mfma_f32_16x16x32_bf16 a[140:143], v[68:71], v[116:119], a[140:143]
    ds_read_b64_tr_b16 v[166:167], v33 offset:18432
    v_mfma_f32_16x16x32_bf16 a[148:151], v[68:71], v[120:123], a[148:151]
    v_mfma_f32_16x16x32_bf16 a[156:159], v[68:71], v[124:127], a[156:159]
    ds_read_b128 v[104:107], v25 offset:12288
    v_mfma_f32_16x16x32_bf16 a[164:167], v[68:71], v[128:131], a[164:167]
    v_mfma_f32_16x16x32_bf16 a[172:175], v[68:71], v[132:135], a[172:175]
    ds_read_b64_tr_b16 v[168:169], v34 offset:16384
    v_mfma_f32_16x16x32_bf16 a[180:183], v[68:71], v[136:139], a[180:183]
    v_mfma_f32_16x16x32_bf16 a[188:191], v[68:71], v[140:143], a[188:191]
    v_mfma_f32_16x16x32_bf16 a[192:195], v[72:75], v[112:115], a[192:195]
    ds_read_b64_tr_b16 v[170:171], v34 offset:18432
    v_mfma_f32_16x16x32_bf16 a[200:203], v[72:75], v[116:119], a[200:203]
    v_mfma_f32_16x16x32_bf16 a[208:211], v[72:75], v[120:123], a[208:211]
    ds_read_b128 v[108:111], v25 offset:13312
    v_mfma_f32_16x16x32_bf16 a[216:219], v[72:75], v[124:127], a[216:219]
    v_mfma_f32_16x16x32_bf16 a[224:227], v[72:75], v[128:131], a[224:227]
    v_mfma_f32_16x16x32_bf16 a[232:235], v[72:75], v[132:135], a[232:235]
    ds_read_b64_tr_b16 v[172:173], v35 offset:16384
    v_mfma_f32_16x16x32_bf16 a[240:243], v[72:75], v[136:139], a[240:243]
    v_mfma_f32_16x16x32_bf16 a[248:251], v[72:75], v[140:143], a[248:251]
    ds_read_b64_tr_b16 v[174:175], v35 offset:18432
    v_mfma_f32_16x16x32_bf16 a[196:199], v[76:79], v[112:115], a[196:199]
    v_mfma_f32_16x16x32_bf16 a[204:207], v[76:79], v[116:119], a[204:207]
    v_mfma_f32_16x16x32_bf16 a[212:215], v[76:79], v[120:123], a[212:215]
    v_mfma_f32_16x16x32_bf16 a[220:223], v[76:79], v[124:127], a[220:223]
    v_mfma_f32_16x16x32_bf16 a[228:231], v[76:79], v[128:131], a[228:231]
    v_mfma_f32_16x16x32_bf16 a[236:239], v[76:79], v[132:135], a[236:239]
    v_mfma_f32_16x16x32_bf16 a[244:247], v[76:79], v[136:139], a[244:247]
    v_mfma_f32_16x16x32_bf16 a[252:255], v[76:79], v[140:143], a[252:255]
    s_waitcnt lgkmcnt(0)
    s_waitcnt vmcnt(0)
    s_barrier
    v_mfma_f32_16x16x32_bf16 a[0:3], v[80:83], v[144:147], a[0:3]
    ds_read_b128 v[48:51], v26 offset:0
    v_mfma_f32_16x16x32_bf16 a[8:11], v[80:83], v[148:151], a[8:11]
    v_mfma_f32_16x16x32_bf16 a[16:19], v[80:83], v[152:155], a[16:19]
    ds_read_b64_tr_b16 v[112:113], v36 offset:0
    v_mfma_f32_16x16x32_bf16 a[24:27], v[80:83], v[156:159], a[24:27]
    v_mfma_f32_16x16x32_bf16 a[32:35], v[80:83], v[160:163], a[32:35]
    ds_read_b64_tr_b16 v[114:115], v36 offset:2048
    v_mfma_f32_16x16x32_bf16 a[40:43], v[80:83], v[164:167], a[40:43]
    v_mfma_f32_16x16x32_bf16 a[48:51], v[80:83], v[168:171], a[48:51]
    v_mfma_f32_16x16x32_bf16 a[56:59], v[80:83], v[172:175], a[56:59]
    ds_read_b128 v[52:55], v26 offset:1024
    v_mfma_f32_16x16x32_bf16 a[4:7], v[84:87], v[144:147], a[4:7]
    v_mfma_f32_16x16x32_bf16 a[12:15], v[84:87], v[148:151], a[12:15]
    ds_read_b64_tr_b16 v[116:117], v37 offset:0
    v_mfma_f32_16x16x32_bf16 a[20:23], v[84:87], v[152:155], a[20:23]
    v_mfma_f32_16x16x32_bf16 a[28:31], v[84:87], v[156:159], a[28:31]
    v_mfma_f32_16x16x32_bf16 a[36:39], v[84:87], v[160:163], a[36:39]
    ds_read_b64_tr_b16 v[118:119], v37 offset:2048
    v_mfma_f32_16x16x32_bf16 a[44:47], v[84:87], v[164:167], a[44:47]
    v_mfma_f32_16x16x32_bf16 a[52:55], v[84:87], v[168:171], a[52:55]
    ds_read_b128 v[56:59], v26 offset:4096
    v_mfma_f32_16x16x32_bf16 a[60:63], v[84:87], v[172:175], a[60:63]
    v_mfma_f32_16x16x32_bf16 a[64:67], v[88:91], v[144:147], a[64:67]
    ds_read_b64_tr_b16 v[120:121], v38 offset:0
    v_mfma_f32_16x16x32_bf16 a[72:75], v[88:91], v[148:151], a[72:75]
    v_mfma_f32_16x16x32_bf16 a[80:83], v[88:91], v[152:155], a[80:83]
    v_mfma_f32_16x16x32_bf16 a[88:91], v[88:91], v[156:159], a[88:91]
    ds_read_b64_tr_b16 v[122:123], v38 offset:2048
    v_mfma_f32_16x16x32_bf16 a[96:99], v[88:91], v[160:163], a[96:99]
    v_mfma_f32_16x16x32_bf16 a[104:107], v[88:91], v[164:167], a[104:107]
    ds_read_b128 v[60:63], v26 offset:5120
    v_mfma_f32_16x16x32_bf16 a[112:115], v[88:91], v[168:171], a[112:115]
    v_mfma_f32_16x16x32_bf16 a[120:123], v[88:91], v[172:175], a[120:123]
    v_mfma_f32_16x16x32_bf16 a[68:71], v[92:95], v[144:147], a[68:71]
    ds_read_b64_tr_b16 v[124:125], v39 offset:0
    v_mfma_f32_16x16x32_bf16 a[76:79], v[92:95], v[148:151], a[76:79]
    v_mfma_f32_16x16x32_bf16 a[84:87], v[92:95], v[152:155], a[84:87]
    ds_read_b64_tr_b16 v[126:127], v39 offset:2048
    v_mfma_f32_16x16x32_bf16 a[92:95], v[92:95], v[156:159], a[92:95]
    v_mfma_f32_16x16x32_bf16 a[100:103], v[92:95], v[160:163], a[100:103]
    v_mfma_f32_16x16x32_bf16 a[108:111], v[92:95], v[164:167], a[108:111]
    ds_read_b128 v[64:67], v26 offset:8192
    v_mfma_f32_16x16x32_bf16 a[116:119], v[92:95], v[168:171], a[116:119]
    v_mfma_f32_16x16x32_bf16 a[124:127], v[92:95], v[172:175], a[124:127]
    ds_read_b64_tr_b16 v[128:129], v40 offset:0
    v_mfma_f32_16x16x32_bf16 a[128:131], v[96:99], v[144:147], a[128:131]
    v_mfma_f32_16x16x32_bf16 a[136:139], v[96:99], v[148:151], a[136:139]
    ds_read_b64_tr_b16 v[130:131], v40 offset:2048
    v_mfma_f32_16x16x32_bf16 a[144:147], v[96:99], v[152:155], a[144:147]
    v_mfma_f32_16x16x32_bf16 a[152:155], v[96:99], v[156:159], a[152:155]
    v_mfma_f32_16x16x32_bf16 a[160:163], v[96:99], v[160:163], a[160:163]
    ds_read_b128 v[68:71], v26 offset:9216
    v_mfma_f32_16x16x32_bf16 a[168:171], v[96:99], v[164:167], a[168:171]
    v_mfma_f32_16x16x32_bf16 a[176:179], v[96:99], v[168:171], a[176:179]
    ds_read_b64_tr_b16 v[132:133], v41 offset:0
    v_mfma_f32_16x16x32_bf16 a[184:187], v[96:99], v[172:175], a[184:187]
    v_mfma_f32_16x16x32_bf16 a[132:135], v[100:103], v[144:147], a[132:135]
    v_mfma_f32_16x16x32_bf16 a[140:143], v[100:103], v[148:151], a[140:143]
    ds_read_b64_tr_b16 v[134:135], v41 offset:2048
    v_mfma_f32_16x16x32_bf16 a[148:151], v[100:103], v[152:155], a[148:151]
    v_mfma_f32_16x16x32_bf16 a[156:159], v[100:103], v[156:159], a[156:159]
    ds_read_b128 v[72:75], v26 offset:12288
    v_mfma_f32_16x16x32_bf16 a[164:167], v[100:103], v[160:163], a[164:167]
    v_mfma_f32_16x16x32_bf16 a[172:175], v[100:103], v[164:167], a[172:175]
    ds_read_b64_tr_b16 v[136:137], v42 offset:0
    v_mfma_f32_16x16x32_bf16 a[180:183], v[100:103], v[168:171], a[180:183]
    v_mfma_f32_16x16x32_bf16 a[188:191], v[100:103], v[172:175], a[188:191]
    v_mfma_f32_16x16x32_bf16 a[192:195], v[104:107], v[144:147], a[192:195]
    ds_read_b64_tr_b16 v[138:139], v42 offset:2048
    v_mfma_f32_16x16x32_bf16 a[200:203], v[104:107], v[148:151], a[200:203]
    v_mfma_f32_16x16x32_bf16 a[208:211], v[104:107], v[152:155], a[208:211]
    ds_read_b128 v[76:79], v26 offset:13312
    v_mfma_f32_16x16x32_bf16 a[216:219], v[104:107], v[156:159], a[216:219]
    v_mfma_f32_16x16x32_bf16 a[224:227], v[104:107], v[160:163], a[224:227]
    v_mfma_f32_16x16x32_bf16 a[232:235], v[104:107], v[164:167], a[232:235]
    ds_read_b64_tr_b16 v[140:141], v43 offset:0
    v_mfma_f32_16x16x32_bf16 a[240:243], v[104:107], v[168:171], a[240:243]
    v_mfma_f32_16x16x32_bf16 a[248:251], v[104:107], v[172:175], a[248:251]
    ds_read_b64_tr_b16 v[142:143], v43 offset:2048
    v_mfma_f32_16x16x32_bf16 a[196:199], v[108:111], v[144:147], a[196:199]
    v_mfma_f32_16x16x32_bf16 a[204:207], v[108:111], v[148:151], a[204:207]
    v_mfma_f32_16x16x32_bf16 a[212:215], v[108:111], v[152:155], a[212:215]
    v_mfma_f32_16x16x32_bf16 a[220:223], v[108:111], v[156:159], a[220:223]
    v_mfma_f32_16x16x32_bf16 a[228:231], v[108:111], v[160:163], a[228:231]
    v_mfma_f32_16x16x32_bf16 a[236:239], v[108:111], v[164:167], a[236:239]
    v_mfma_f32_16x16x32_bf16 a[244:247], v[108:111], v[168:171], a[244:247]
    v_mfma_f32_16x16x32_bf16 a[252:255], v[108:111], v[172:175], a[252:255]
    s_waitcnt lgkmcnt(0)
    v_mfma_f32_16x16x32_bf16 a[0:3], v[48:51], v[112:115], a[0:3]
    ds_read_b128 v[80:83], v27 offset:0
    v_mfma_f32_16x16x32_bf16 a[8:11], v[48:51], v[116:119], a[8:11]
    v_mfma_f32_16x16x32_bf16 a[16:19], v[48:51], v[120:123], a[16:19]
    ds_read_b64_tr_b16 v[144:145], v36 offset:16384
    v_mfma_f32_16x16x32_bf16 a[24:27], v[48:51], v[124:127], a[24:27]
    v_mfma_f32_16x16x32_bf16 a[32:35], v[48:51], v[128:131], a[32:35]
    ds_read_b64_tr_b16 v[146:147], v36 offset:18432
    v_mfma_f32_16x16x32_bf16 a[40:43], v[48:51], v[132:135], a[40:43]
    v_mfma_f32_16x16x32_bf16 a[48:51], v[48:51], v[136:139], a[48:51]
    v_mfma_f32_16x16x32_bf16 a[56:59], v[48:51], v[140:143], a[56:59]
    ds_read_b128 v[84:87], v27 offset:1024
    v_mfma_f32_16x16x32_bf16 a[4:7], v[52:55], v[112:115], a[4:7]
    v_mfma_f32_16x16x32_bf16 a[12:15], v[52:55], v[116:119], a[12:15]
    ds_read_b64_tr_b16 v[148:149], v37 offset:16384
    v_mfma_f32_16x16x32_bf16 a[20:23], v[52:55], v[120:123], a[20:23]
    v_mfma_f32_16x16x32_bf16 a[28:31], v[52:55], v[124:127], a[28:31]
    v_mfma_f32_16x16x32_bf16 a[36:39], v[52:55], v[128:131], a[36:39]
    ds_read_b64_tr_b16 v[150:151], v37 offset:18432
    v_mfma_f32_16x16x32_bf16 a[44:47], v[52:55], v[132:135], a[44:47]
    v_mfma_f32_16x16x32_bf16 a[52:55], v[52:55], v[136:139], a[52:55]
    ds_read_b128 v[88:91], v27 offset:4096
    v_mfma_f32_16x16x32_bf16 a[60:63], v[52:55], v[140:143], a[60:63]
    v_mfma_f32_16x16x32_bf16 a[64:67], v[56:59], v[112:115], a[64:67]
    ds_read_b64_tr_b16 v[152:153], v38 offset:16384
    v_mfma_f32_16x16x32_bf16 a[72:75], v[56:59], v[116:119], a[72:75]
    v_mfma_f32_16x16x32_bf16 a[80:83], v[56:59], v[120:123], a[80:83]
    v_mfma_f32_16x16x32_bf16 a[88:91], v[56:59], v[124:127], a[88:91]
    ds_read_b64_tr_b16 v[154:155], v38 offset:18432
    v_mfma_f32_16x16x32_bf16 a[96:99], v[56:59], v[128:131], a[96:99]
    v_mfma_f32_16x16x32_bf16 a[104:107], v[56:59], v[132:135], a[104:107]
    ds_read_b128 v[92:95], v27 offset:5120
    v_mfma_f32_16x16x32_bf16 a[112:115], v[56:59], v[136:139], a[112:115]
    v_mfma_f32_16x16x32_bf16 a[120:123], v[56:59], v[140:143], a[120:123]
    v_mfma_f32_16x16x32_bf16 a[68:71], v[60:63], v[112:115], a[68:71]
    ds_read_b64_tr_b16 v[156:157], v39 offset:16384
    v_mfma_f32_16x16x32_bf16 a[76:79], v[60:63], v[116:119], a[76:79]
    v_mfma_f32_16x16x32_bf16 a[84:87], v[60:63], v[120:123], a[84:87]
    ds_read_b64_tr_b16 v[158:159], v39 offset:18432
    v_mfma_f32_16x16x32_bf16 a[92:95], v[60:63], v[124:127], a[92:95]
    v_mfma_f32_16x16x32_bf16 a[100:103], v[60:63], v[128:131], a[100:103]
    v_mfma_f32_16x16x32_bf16 a[108:111], v[60:63], v[132:135], a[108:111]
    ds_read_b128 v[96:99], v27 offset:8192
    v_mfma_f32_16x16x32_bf16 a[116:119], v[60:63], v[136:139], a[116:119]
    v_mfma_f32_16x16x32_bf16 a[124:127], v[60:63], v[140:143], a[124:127]
    ds_read_b64_tr_b16 v[160:161], v40 offset:16384
    v_mfma_f32_16x16x32_bf16 a[128:131], v[64:67], v[112:115], a[128:131]
    v_mfma_f32_16x16x32_bf16 a[136:139], v[64:67], v[116:119], a[136:139]
    ds_read_b64_tr_b16 v[162:163], v40 offset:18432
    v_mfma_f32_16x16x32_bf16 a[144:147], v[64:67], v[120:123], a[144:147]
    v_mfma_f32_16x16x32_bf16 a[152:155], v[64:67], v[124:127], a[152:155]
    v_mfma_f32_16x16x32_bf16 a[160:163], v[64:67], v[128:131], a[160:163]
    ds_read_b128 v[100:103], v27 offset:9216
    v_mfma_f32_16x16x32_bf16 a[168:171], v[64:67], v[132:135], a[168:171]
    v_mfma_f32_16x16x32_bf16 a[176:179], v[64:67], v[136:139], a[176:179]
    ds_read_b64_tr_b16 v[164:165], v41 offset:16384
    v_mfma_f32_16x16x32_bf16 a[184:187], v[64:67], v[140:143], a[184:187]
    v_mfma_f32_16x16x32_bf16 a[132:135], v[68:71], v[112:115], a[132:135]
    v_mfma_f32_16x16x32_bf16 a[140:143], v[68:71], v[116:119], a[140:143]
    ds_read_b64_tr_b16 v[166:167], v41 offset:18432
    v_mfma_f32_16x16x32_bf16 a[148:151], v[68:71], v[120:123], a[148:151]
    v_mfma_f32_16x16x32_bf16 a[156:159], v[68:71], v[124:127], a[156:159]
    ds_read_b128 v[104:107], v27 offset:12288
    v_mfma_f32_16x16x32_bf16 a[164:167], v[68:71], v[128:131], a[164:167]
    v_mfma_f32_16x16x32_bf16 a[172:175], v[68:71], v[132:135], a[172:175]
    ds_read_b64_tr_b16 v[168:169], v42 offset:16384
    v_mfma_f32_16x16x32_bf16 a[180:183], v[68:71], v[136:139], a[180:183]
    v_mfma_f32_16x16x32_bf16 a[188:191], v[68:71], v[140:143], a[188:191]
    v_mfma_f32_16x16x32_bf16 a[192:195], v[72:75], v[112:115], a[192:195]
    ds_read_b64_tr_b16 v[170:171], v42 offset:18432
    v_mfma_f32_16x16x32_bf16 a[200:203], v[72:75], v[116:119], a[200:203]
    v_mfma_f32_16x16x32_bf16 a[208:211], v[72:75], v[120:123], a[208:211]
    ds_read_b128 v[108:111], v27 offset:13312
    v_mfma_f32_16x16x32_bf16 a[216:219], v[72:75], v[124:127], a[216:219]
    v_mfma_f32_16x16x32_bf16 a[224:227], v[72:75], v[128:131], a[224:227]
    v_mfma_f32_16x16x32_bf16 a[232:235], v[72:75], v[132:135], a[232:235]
    ds_read_b64_tr_b16 v[172:173], v43 offset:16384
    v_mfma_f32_16x16x32_bf16 a[240:243], v[72:75], v[136:139], a[240:243]
    v_mfma_f32_16x16x32_bf16 a[248:251], v[72:75], v[140:143], a[248:251]
    ds_read_b64_tr_b16 v[174:175], v43 offset:18432
    v_mfma_f32_16x16x32_bf16 a[196:199], v[76:79], v[112:115], a[196:199]
    v_mfma_f32_16x16x32_bf16 a[204:207], v[76:79], v[116:119], a[204:207]
    v_mfma_f32_16x16x32_bf16 a[212:215], v[76:79], v[120:123], a[212:215]
    v_mfma_f32_16x16x32_bf16 a[220:223], v[76:79], v[124:127], a[220:223]
    v_mfma_f32_16x16x32_bf16 a[228:231], v[76:79], v[128:131], a[228:231]
    v_mfma_f32_16x16x32_bf16 a[236:239], v[76:79], v[132:135], a[236:239]
    v_mfma_f32_16x16x32_bf16 a[244:247], v[76:79], v[136:139], a[244:247]
    v_mfma_f32_16x16x32_bf16 a[252:255], v[76:79], v[140:143], a[252:255]
    s_waitcnt lgkmcnt(0)
    v_mfma_f32_16x16x32_bf16 a[0:3], v[80:83], v[144:147], a[0:3]
    v_mfma_f32_16x16x32_bf16 a[8:11], v[80:83], v[148:151], a[8:11]
    v_mfma_f32_16x16x32_bf16 a[16:19], v[80:83], v[152:155], a[16:19]
    v_mfma_f32_16x16x32_bf16 a[24:27], v[80:83], v[156:159], a[24:27]
    v_mfma_f32_16x16x32_bf16 a[32:35], v[80:83], v[160:163], a[32:35]
    v_mfma_f32_16x16x32_bf16 a[40:43], v[80:83], v[164:167], a[40:43]
    v_mfma_f32_16x16x32_bf16 a[48:51], v[80:83], v[168:171], a[48:51]
    v_mfma_f32_16x16x32_bf16 a[56:59], v[80:83], v[172:175], a[56:59]
    v_mfma_f32_16x16x32_bf16 a[4:7], v[84:87], v[144:147], a[4:7]
    v_mfma_f32_16x16x32_bf16 a[12:15], v[84:87], v[148:151], a[12:15]
    v_mfma_f32_16x16x32_bf16 a[20:23], v[84:87], v[152:155], a[20:23]
    v_mfma_f32_16x16x32_bf16 a[28:31], v[84:87], v[156:159], a[28:31]
    v_mfma_f32_16x16x32_bf16 a[36:39], v[84:87], v[160:163], a[36:39]
    v_mfma_f32_16x16x32_bf16 a[44:47], v[84:87], v[164:167], a[44:47]
    v_mfma_f32_16x16x32_bf16 a[52:55], v[84:87], v[168:171], a[52:55]
    v_mfma_f32_16x16x32_bf16 a[60:63], v[84:87], v[172:175], a[60:63]
    v_mfma_f32_16x16x32_bf16 a[64:67], v[88:91], v[144:147], a[64:67]
    v_mfma_f32_16x16x32_bf16 a[72:75], v[88:91], v[148:151], a[72:75]
    v_mfma_f32_16x16x32_bf16 a[80:83], v[88:91], v[152:155], a[80:83]
    v_mfma_f32_16x16x32_bf16 a[88:91], v[88:91], v[156:159], a[88:91]
    v_mfma_f32_16x16x32_bf16 a[96:99], v[88:91], v[160:163], a[96:99]
    v_mfma_f32_16x16x32_bf16 a[104:107], v[88:91], v[164:167], a[104:107]
    v_mfma_f32_16x16x32_bf16 a[112:115], v[88:91], v[168:171], a[112:115]
    v_mfma_f32_16x16x32_bf16 a[120:123], v[88:91], v[172:175], a[120:123]
    v_mfma_f32_16x16x32_bf16 a[68:71], v[92:95], v[144:147], a[68:71]
    v_mfma_f32_16x16x32_bf16 a[76:79], v[92:95], v[148:151], a[76:79]
    v_mfma_f32_16x16x32_bf16 a[84:87], v[92:95], v[152:155], a[84:87]
    v_mfma_f32_16x16x32_bf16 a[92:95], v[92:95], v[156:159], a[92:95]
    v_mfma_f32_16x16x32_bf16 a[100:103], v[92:95], v[160:163], a[100:103]
    v_mfma_f32_16x16x32_bf16 a[108:111], v[92:95], v[164:167], a[108:111]
    v_mfma_f32_16x16x32_bf16 a[116:119], v[92:95], v[168:171], a[116:119]
    v_mfma_f32_16x16x32_bf16 a[124:127], v[92:95], v[172:175], a[124:127]
    v_mfma_f32_16x16x32_bf16 a[128:131], v[96:99], v[144:147], a[128:131]
    v_mfma_f32_16x16x32_bf16 a[136:139], v[96:99], v[148:151], a[136:139]
    v_mfma_f32_16x16x32_bf16 a[144:147], v[96:99], v[152:155], a[144:147]
    v_mfma_f32_16x16x32_bf16 a[152:155], v[96:99], v[156:159], a[152:155]
    v_mfma_f32_16x16x32_bf16 a[160:163], v[96:99], v[160:163], a[160:163]
    v_mfma_f32_16x16x32_bf16 a[168:171], v[96:99], v[164:167], a[168:171]
    v_mfma_f32_16x16x32_bf16 a[176:179], v[96:99], v[168:171], a[176:179]
    v_mfma_f32_16x16x32_bf16 a[184:187], v[96:99], v[172:175], a[184:187]
    v_mfma_f32_16x16x32_bf16 a[132:135], v[100:103], v[144:147], a[132:135]
    v_mfma_f32_16x16x32_bf16 a[140:143], v[100:103], v[148:151], a[140:143]
    v_mfma_f32_16x16x32_bf16 a[148:151], v[100:103], v[152:155], a[148:151]
    v_mfma_f32_16x16x32_bf16 a[156:159], v[100:103], v[156:159], a[156:159]
    v_mfma_f32_16x16x32_bf16 a[164:167], v[100:103], v[160:163], a[164:167]
    v_mfma_f32_16x16x32_bf16 a[172:175], v[100:103], v[164:167], a[172:175]
    v_mfma_f32_16x16x32_bf16 a[180:183], v[100:103], v[168:171], a[180:183]
    v_mfma_f32_16x16x32_bf16 a[188:191], v[100:103], v[172:175], a[188:191]
    v_mfma_f32_16x16x32_bf16 a[192:195], v[104:107], v[144:147], a[192:195]
    v_mfma_f32_16x16x32_bf16 a[200:203], v[104:107], v[148:151], a[200:203]
    v_mfma_f32_16x16x32_bf16 a[208:211], v[104:107], v[152:155], a[208:211]
    v_mfma_f32_16x16x32_bf16 a[216:219], v[104:107], v[156:159], a[216:219]
    v_mfma_f32_16x16x32_bf16 a[224:227], v[104:107], v[160:163], a[224:227]
    v_mfma_f32_16x16x32_bf16 a[232:235], v[104:107], v[164:167], a[232:235]
    v_mfma_f32_16x16x32_bf16 a[240:243], v[104:107], v[168:171], a[240:243]
    v_mfma_f32_16x16x32_bf16 a[248:251], v[104:107], v[172:175], a[248:251]
    v_mfma_f32_16x16x32_bf16 a[196:199], v[108:111], v[144:147], a[196:199]
    v_mfma_f32_16x16x32_bf16 a[204:207], v[108:111], v[148:151], a[204:207]
    v_mfma_f32_16x16x32_bf16 a[212:215], v[108:111], v[152:155], a[212:215]
    v_mfma_f32_16x16x32_bf16 a[220:223], v[108:111], v[156:159], a[220:223]
    v_mfma_f32_16x16x32_bf16 a[228:231], v[108:111], v[160:163], a[228:231]
    v_mfma_f32_16x16x32_bf16 a[236:239], v[108:111], v[164:167], a[236:239]
    v_mfma_f32_16x16x32_bf16 a[244:247], v[108:111], v[168:171], a[244:247]
    v_mfma_f32_16x16x32_bf16 a[252:255], v[108:111], v[172:175], a[252:255]
bE_184:
    s_nop 11
    s_cmp_eq_u32 s69, 0
    s_cbranch_scc1 et_189
    s_mov_b32 s75, 1
    s_cmp_lg_u32 s44, 0
    s_cbranch_scc1 et_189
    s_lshl_b32 s76, s46, 7
    s_add_u32 s76, s76, 0x6402000
    v_mov_b32 v4, s76
    v_mov_b32 v7, 1
    s_mov_b64 exec, 1
    buffer_atomic_add v7, v4, s[32:35], 0 offen sc0 sc1
    s_mov_b64 exec, -1
et_189:
    s_mov_b32 s49, s53
    v_accvgpr_read_b32 v184, a0
    v_accvgpr_read_b32 v185, a1
    v_accvgpr_read_b32 v186, a2
    v_accvgpr_read_b32 v187, a3
    v_accvgpr_read_b32 v188, a4
    v_accvgpr_read_b32 v189, a5
    v_accvgpr_read_b32 v190, a6
    v_accvgpr_read_b32 v191, a7
    v_accvgpr_read_b32 v192, a8
    v_accvgpr_read_b32 v193, a9
    v_accvgpr_read_b32 v194, a10
    v_accvgpr_read_b32 v195, a11
    v_accvgpr_read_b32 v196, a12
    v_accvgpr_read_b32 v197, a13
    v_accvgpr_read_b32 v198, a14
    v_accvgpr_read_b32 v199, a15
    v_cvt_pk_bf16_f32 v48, v184, v185
    v_cvt_pk_bf16_f32 v49, v186, v187
    v_cvt_pk_bf16_f32 v50, v188, v189
    v_cvt_pk_bf16_f32 v51, v190, v191
    v_cvt_pk_bf16_f32 v52, v192, v193
    v_cvt_pk_bf16_f32 v53, v194, v195
    v_cvt_pk_bf16_f32 v54, v196, v197
    v_cvt_pk_bf16_f32 v55, v198, v199
    buffer_store_dwordx4 v[48:51], v44, s[32:35], s49 offen offset:0 sc1
    buffer_store_dwordx4 v[52:55], v44, s[32:35], s49 offen offset:128 sc1
    v_accvgpr_read_b32 v184, a16
    v_accvgpr_read_b32 v185, a17
    v_accvgpr_read_b32 v186, a18
    v_accvgpr_read_b32 v187, a19
    v_accvgpr_read_b32 v188, a20
    v_accvgpr_read_b32 v189, a21
    v_accvgpr_read_b32 v190, a22
    v_accvgpr_read_b32 v191, a23
    v_accvgpr_read_b32 v192, a24
    v_accvgpr_read_b32 v193, a25
    v_accvgpr_read_b32 v194, a26
    v_accvgpr_read_b32 v195, a27
    v_accvgpr_read_b32 v196, a28
    v_accvgpr_read_b32 v197, a29
    v_accvgpr_read_b32 v198, a30
    v_accvgpr_read_b32 v199, a31
    v_cvt_pk_bf16_f32 v56, v184, v185
    v_cvt_pk_bf16_f32 v57, v186, v187
    v_cvt_pk_bf16_f32 v58, v188, v189
    v_cvt_pk_bf16_f32 v59, v190, v191
    v_cvt_pk_bf16_f32 v60, v192, v193
    v_cvt_pk_bf16_f32 v61, v194, v195
    v_cvt_pk_bf16_f32 v62, v196, v197
    v_cvt_pk_bf16_f32 v63, v198, v199
    buffer_store_dwordx4 v[56:59], v44, s[32:35], s49 offen offset:2048 sc1
    buffer_store_dwordx4 v[60:63], v44, s[32:35], s49 offen offset:2176 sc1
    v_accvgpr_read_b32 v184, a32
    v_accvgpr_read_b32 v185, a33
    v_accvgpr_read_b32 v186, a34
    v_accvgpr_read_b32 v187, a35
    v_accvgpr_read_b32 v188, a36
    v_accvgpr_read_b32 v189, a37
    v_accvgpr_read_b32 v190, a38
    v_accvgpr_read_b32 v191, a39
    v_accvgpr_read_b32 v192, a40
    v_accvgpr_read_b32 v193, a41
    v_accvgpr_read_b32 v194, a42
    v_accvgpr_read_b32 v195, a43
    v_accvgpr_read_b32 v196, a44
    v_accvgpr_read_b32 v197, a45
    v_accvgpr_read_b32 v198, a46
    v_accvgpr_read_b32 v199, a47
    v_cvt_pk_bf16_f32 v64, v184, v185
    v_cvt_pk_bf16_f32 v65, v186, v187
    v_cvt_pk_bf16_f32 v66, v188, v189
    v_cvt_pk_bf16_f32 v67, v190, v191
    v_cvt_pk_bf16_f32 v68, v192, v193
    v_cvt_pk_bf16_f32 v69, v194, v195
    v_cvt_pk_bf16_f32 v70, v196, v197
    v_cvt_pk_bf16_f32 v71, v198, v199
    s_add_u32 s49, s49, 4096
    buffer_store_dwordx4 v[64:67], v44, s[32:35], s49 offen offset:0 sc1
    buffer_store_dwordx4 v[68:71], v44, s[32:35], s49 offen offset:128 sc1
    v_accvgpr_read_b32 v184, a48
    v_accvgpr_read_b32 v185, a49
    v_accvgpr_read_b32 v186, a50
    v_accvgpr_read_b32 v187, a51
    v_accvgpr_read_b32 v188, a52
    v_accvgpr_read_b32 v189, a53
    v_accvgpr_read_b32 v190, a54
    v_accvgpr_read_b32 v191, a55
    v_accvgpr_read_b32 v192, a56
    v_accvgpr_read_b32 v193, a57
    v_accvgpr_read_b32 v194, a58
    v_accvgpr_read_b32 v195, a59
    v_accvgpr_read_b32 v196, a60
    v_accvgpr_read_b32 v197, a61
    v_accvgpr_read_b32 v198, a62
    v_accvgpr_read_b32 v199, a63
    v_cvt_pk_bf16_f32 v72, v184, v185
    v_cvt_pk_bf16_f32 v73, v186, v187
    v_cvt_pk_bf16_f32 v74, v188, v189
    v_cvt_pk_bf16_f32 v75, v190, v191
    v_cvt_pk_bf16_f32 v76, v192, v193
    v_cvt_pk_bf16_f32 v77, v194, v195
    v_cvt_pk_bf16_f32 v78, v196, v197
    v_cvt_pk_bf16_f32 v79, v198, v199
    buffer_store_dwordx4 v[72:75], v44, s[32:35], s49 offen offset:2048 sc1
    buffer_store_dwordx4 v[76:79], v44, s[32:35], s49 offen offset:2176 sc1
    s_add_u32 s53, s53, s54
    s_mov_b32 s49, s53
    v_accvgpr_read_b32 v184, a64
    v_accvgpr_read_b32 v185, a65
    v_accvgpr_read_b32 v186, a66
    v_accvgpr_read_b32 v187, a67
    v_accvgpr_read_b32 v188, a68
    v_accvgpr_read_b32 v189, a69
    v_accvgpr_read_b32 v190, a70
    v_accvgpr_read_b32 v191, a71
    v_accvgpr_read_b32 v192, a72
    v_accvgpr_read_b32 v193, a73
    v_accvgpr_read_b32 v194, a74
    v_accvgpr_read_b32 v195, a75
    v_accvgpr_read_b32 v196, a76
    v_accvgpr_read_b32 v197, a77
    v_accvgpr_read_b32 v198, a78
    v_accvgpr_read_b32 v199, a79
    v_cvt_pk_bf16_f32 v48, v184, v185
    v_cvt_pk_bf16_f32 v49, v186, v187
    v_cvt_pk_bf16_f32 v50, v188, v189
    v_cvt_pk_bf16_f32 v51, v190, v191
    v_cvt_pk_bf16_f32 v52, v192, v193
    v_cvt_pk_bf16_f32 v53, v194, v195
    v_cvt_pk_bf16_f32 v54, v196, v197
    v_cvt_pk_bf16_f32 v55, v198, v199
    buffer_store_dwordx4 v[48:51], v44, s[32:35], s49 offen offset:0 sc1
    buffer_store_dwordx4 v[52:55], v44, s[32:35], s49 offen offset:128 sc1
    v_accvgpr_read_b32 v184, a80
    v_accvgpr_read_b32 v185, a81
    v_accvgpr_read_b32 v186, a82
    v_accvgpr_read_b32 v187, a83
    v_accvgpr_read_b32 v188, a84
    v_accvgpr_read_b32 v189, a85
    v_accvgpr_read_b32 v190, a86
    v_accvgpr_read_b32 v191, a87
    v_accvgpr_read_b32 v192, a88
    v_accvgpr_read_b32 v193, a89
    v_accvgpr_read_b32 v194, a90
    v_accvgpr_read_b32 v195, a91
    v_accvgpr_read_b32 v196, a92
    v_accvgpr_read_b32 v197, a93
    v_accvgpr_read_b32 v198, a94
    v_accvgpr_read_b32 v199, a95
    v_cvt_pk_bf16_f32 v56, v184, v185
    v_cvt_pk_bf16_f32 v57, v186, v187
    v_cvt_pk_bf16_f32 v58, v188, v189
    v_cvt_pk_bf16_f32 v59, v190, v191
    v_cvt_pk_bf16_f32 v60, v192, v193
    v_cvt_pk_bf16_f32 v61, v194, v195
    v_cvt_pk_bf16_f32 v62, v196, v197
    v_cvt_pk_bf16_f32 v63, v198, v199
    buffer_store_dwordx4 v[56:59], v44, s[32:35], s49 offen offset:2048 sc1
    buffer_store_dwordx4 v[60:63], v44, s[32:35], s49 offen offset:2176 sc1
    v_accvgpr_read_b32 v184, a96
    v_accvgpr_read_b32 v185, a97
    v_accvgpr_read_b32 v186, a98
    v_accvgpr_read_b32 v187, a99
    v_accvgpr_read_b32 v188, a100
    v_accvgpr_read_b32 v189, a101
    v_accvgpr_read_b32 v190, a102
    v_accvgpr_read_b32 v191, a103
    v_accvgpr_read_b32 v192, a104
    v_accvgpr_read_b32 v193, a105
    v_accvgpr_read_b32 v194, a106
    v_accvgpr_read_b32 v195, a107
    v_accvgpr_read_b32 v196, a108
    v_accvgpr_read_b32 v197, a109
    v_accvgpr_read_b32 v198, a110
    v_accvgpr_read_b32 v199, a111
    v_cvt_pk_bf16_f32 v64, v184, v185
    v_cvt_pk_bf16_f32 v65, v186, v187
    v_cvt_pk_bf16_f32 v66, v188, v189
    v_cvt_pk_bf16_f32 v67, v190, v191
    v_cvt_pk_bf16_f32 v68, v192, v193
    v_cvt_pk_bf16_f32 v69, v194, v195
    v_cvt_pk_bf16_f32 v70, v196, v197
    v_cvt_pk_bf16_f32 v71, v198, v199
    s_add_u32 s49, s49, 4096
    buffer_store_dwordx4 v[64:67], v44, s[32:35], s49 offen offset:0 sc1
    buffer_store_dwordx4 v[68:71], v44, s[32:35], s49 offen offset:128 sc1
    v_accvgpr_read_b32 v184, a112
    v_accvgpr_read_b32 v185, a113
    v_accvgpr_read_b32 v186, a114
    v_accvgpr_read_b32 v187, a115
    v_accvgpr_read_b32 v188, a116
    v_accvgpr_read_b32 v189, a117
    v_accvgpr_read_b32 v190, a118
    v_accvgpr_read_b32 v191, a119
    v_accvgpr_read_b32 v192, a120
    v_accvgpr_read_b32 v193, a121
    v_accvgpr_read_b32 v194, a122
    v_accvgpr_read_b32 v195, a123
    v_accvgpr_read_b32 v196, a124
    v_accvgpr_read_b32 v197, a125
    v_accvgpr_read_b32 v198, a126
    v_accvgpr_read_b32 v199, a127
    v_cvt_pk_bf16_f32 v72, v184, v185
    v_cvt_pk_bf16_f32 v73, v186, v187
    v_cvt_pk_bf16_f32 v74, v188, v189
    v_cvt_pk_bf16_f32 v75, v190, v191
    v_cvt_pk_bf16_f32 v76, v192, v193
    v_cvt_pk_bf16_f32 v77, v194, v195
    v_cvt_pk_bf16_f32 v78, v196, v197
    v_cvt_pk_bf16_f32 v79, v198, v199
    buffer_store_dwordx4 v[72:75], v44, s[32:35], s49 offen offset:2048 sc1
    buffer_store_dwordx4 v[76:79], v44, s[32:35], s49 offen offset:2176 sc1
    s_add_u32 s53, s53, s54
    s_mov_b32 s49, s53
    v_accvgpr_read_b32 v184, a128
    v_accvgpr_read_b32 v185, a129
    v_accvgpr_read_b32 v186, a130
    v_accvgpr_read_b32 v187, a131
    v_accvgpr_read_b32 v188, a132
    v_accvgpr_read_b32 v189, a133
    v_accvgpr_read_b32 v190, a134
    v_accvgpr_read_b32 v191, a135
    v_accvgpr_read_b32 v192, a136
    v_accvgpr_read_b32 v193, a137
    v_accvgpr_read_b32 v194, a138
    v_accvgpr_read_b32 v195, a139
    v_accvgpr_read_b32 v196, a140
    v_accvgpr_read_b32 v197, a141
    v_accvgpr_read_b32 v198, a142
    v_accvgpr_read_b32 v199, a143
    v_cvt_pk_bf16_f32 v48, v184, v185
    v_cvt_pk_bf16_f32 v49, v186, v187
    v_cvt_pk_bf16_f32 v50, v188, v189
    v_cvt_pk_bf16_f32 v51, v190, v191
    v_cvt_pk_bf16_f32 v52, v192, v193
    v_cvt_pk_bf16_f32 v53, v194, v195
    v_cvt_pk_bf16_f32 v54, v196, v197
    v_cvt_pk_bf16_f32 v55, v198, v199
    buffer_store_dwordx4 v[48:51], v44, s[32:35], s49 offen offset:0 sc1
    buffer_store_dwordx4 v[52:55], v44, s[32:35], s49 offen offset:128 sc1
    v_accvgpr_read_b32 v184, a144
    v_accvgpr_read_b32 v185, a145
    v_accvgpr_read_b32 v186, a146
    v_accvgpr_read_b32 v187, a147
    v_accvgpr_read_b32 v188, a148
    v_accvgpr_read_b32 v189, a149
    v_accvgpr_read_b32 v190, a150
    v_accvgpr_read_b32 v191, a151
    v_accvgpr_read_b32 v192, a152
    v_accvgpr_read_b32 v193, a153
    v_accvgpr_read_b32 v194, a154
    v_accvgpr_read_b32 v195, a155
    v_accvgpr_read_b32 v196, a156
    v_accvgpr_read_b32 v197, a157
    v_accvgpr_read_b32 v198, a158
    v_accvgpr_read_b32 v199, a159
    v_cvt_pk_bf16_f32 v56, v184, v185
    v_cvt_pk_bf16_f32 v57, v186, v187
    v_cvt_pk_bf16_f32 v58, v188, v189
    v_cvt_pk_bf16_f32 v59, v190, v191
    v_cvt_pk_bf16_f32 v60, v192, v193
    v_cvt_pk_bf16_f32 v61, v194, v195
    v_cvt_pk_bf16_f32 v62, v196, v197
    v_cvt_pk_bf16_f32 v63, v198, v199
    buffer_store_dwordx4 v[56:59], v44, s[32:35], s49 offen offset:2048 sc1
    buffer_store_dwordx4 v[60:63], v44, s[32:35], s49 offen offset:2176 sc1
    v_accvgpr_read_b32 v184, a160
    v_accvgpr_read_b32 v185, a161
    v_accvgpr_read_b32 v186, a162
    v_accvgpr_read_b32 v187, a163
    v_accvgpr_read_b32 v188, a164
    v_accvgpr_read_b32 v189, a165
    v_accvgpr_read_b32 v190, a166
    v_accvgpr_read_b32 v191, a167
    v_accvgpr_read_b32 v192, a168
    v_accvgpr_read_b32 v193, a169
    v_accvgpr_read_b32 v194, a170
    v_accvgpr_read_b32 v195, a171
    v_accvgpr_read_b32 v196, a172
    v_accvgpr_read_b32 v197, a173
    v_accvgpr_read_b32 v198, a174
    v_accvgpr_read_b32 v199, a175
    v_cvt_pk_bf16_f32 v64, v184, v185
    v_cvt_pk_bf16_f32 v65, v186, v187
    v_cvt_pk_bf16_f32 v66, v188, v189
    v_cvt_pk_bf16_f32 v67, v190, v191
    v_cvt_pk_bf16_f32 v68, v192, v193
    v_cvt_pk_bf16_f32 v69, v194, v195
    v_cvt_pk_bf16_f32 v70, v196, v197
    v_cvt_pk_bf16_f32 v71, v198, v199
    s_add_u32 s49, s49, 4096
    buffer_store_dwordx4 v[64:67], v44, s[32:35], s49 offen offset:0 sc1
    buffer_store_dwordx4 v[68:71], v44, s[32:35], s49 offen offset:128 sc1
    v_accvgpr_read_b32 v184, a176
    v_accvgpr_read_b32 v185, a177
    v_accvgpr_read_b32 v186, a178
    v_accvgpr_read_b32 v187, a179
    v_accvgpr_read_b32 v188, a180
    v_accvgpr_read_b32 v189, a181
    v_accvgpr_read_b32 v190, a182
    v_accvgpr_read_b32 v191, a183
    v_accvgpr_read_b32 v192, a184
    v_accvgpr_read_b32 v193, a185
    v_accvgpr_read_b32 v194, a186
    v_accvgpr_read_b32 v195, a187
    v_accvgpr_read_b32 v196, a188
    v_accvgpr_read_b32 v197, a189
    v_accvgpr_read_b32 v198, a190
    v_accvgpr_read_b32 v199, a191
    v_cvt_pk_bf16_f32 v72, v184, v185
    v_cvt_pk_bf16_f32 v73, v186, v187
    v_cvt_pk_bf16_f32 v74, v188, v189
    v_cvt_pk_bf16_f32 v75, v190, v191
    v_cvt_pk_bf16_f32 v76, v192, v193
    v_cvt_pk_bf16_f32 v77, v194, v195
    v_cvt_pk_bf16_f32 v78, v196, v197
    v_cvt_pk_bf16_f32 v79, v198, v199
    buffer_store_dwordx4 v[72:75], v44, s[32:35], s49 offen offset:2048 sc1
    buffer_store_dwordx4 v[76:79], v44, s[32:35], s49 offen offset:2176 sc1
    s_add_u32 s53, s53, s54
    s_mov_b32 s49, s53
    v_accvgpr_read_b32 v184, a192
    v_accvgpr_read_b32 v185, a193
    v_accvgpr_read_b32 v186, a194
    v_accvgpr_read_b32 v187, a195
    v_accvgpr_read_b32 v188, a196
    v_accvgpr_read_b32 v189, a197
    v_accvgpr_read_b32 v190, a198
    v_accvgpr_read_b32 v191, a199
    v_accvgpr_read_b32 v192, a200
    v_accvgpr_read_b32 v193, a201
    v_accvgpr_read_b32 v194, a202
    v_accvgpr_read_b32 v195, a203
    v_accvgpr_read_b32 v196, a204
    v_accvgpr_read_b32 v197, a205
    v_accvgpr_read_b32 v198, a206
    v_accvgpr_read_b32 v199, a207
    v_cvt_pk_bf16_f32 v48, v184, v185
    v_cvt_pk_bf16_f32 v49, v186, v187
    v_cvt_pk_bf16_f32 v50, v188, v189
    v_cvt_pk_bf16_f32 v51, v190, v191
    v_cvt_pk_bf16_f32 v52, v192, v193
    v_cvt_pk_bf16_f32 v53, v194, v195
    v_cvt_pk_bf16_f32 v54, v196, v197
    v_cvt_pk_bf16_f32 v55, v198, v199
    buffer_store_dwordx4 v[48:51], v44, s[32:35], s49 offen offset:0 sc1
    buffer_store_dwordx4 v[52:55], v44, s[32:35], s49 offen offset:128 sc1
    v_accvgpr_read_b32 v184, a208
    v_accvgpr_read_b32 v185, a209
    v_accvgpr_read_b32 v186, a210
    v_accvgpr_read_b32 v187, a211
    v_accvgpr_read_b32 v188, a212
    v_accvgpr_read_b32 v189, a213
    v_accvgpr_read_b32 v190, a214
    v_accvgpr_read_b32 v191, a215
    v_accvgpr_read_b32 v192, a216
    v_accvgpr_read_b32 v193, a217
    v_accvgpr_read_b32 v194, a218
    v_accvgpr_read_b32 v195, a219
    v_accvgpr_read_b32 v196, a220
    v_accvgpr_read_b32 v197, a221
    v_accvgpr_read_b32 v198, a222
    v_accvgpr_read_b32 v199, a223
    v_cvt_pk_bf16_f32 v56, v184, v185
    v_cvt_pk_bf16_f32 v57, v186, v187
    v_cvt_pk_bf16_f32 v58, v188, v189
    v_cvt_pk_bf16_f32 v59, v190, v191
    v_cvt_pk_bf16_f32 v60, v192, v193
    v_cvt_pk_bf16_f32 v61, v194, v195
    v_cvt_pk_bf16_f32 v62, v196, v197
    v_cvt_pk_bf16_f32 v63, v198, v199
    buffer_store_dwordx4 v[56:59], v44, s[32:35], s49 offen offset:2048 sc1
    buffer_store_dwordx4 v[60:63], v44, s[32:35], s49 offen offset:2176 sc1
    v_accvgpr_read_b32 v184, a224
    v_accvgpr_read_b32 v185, a225
    v_accvgpr_read_b32 v186, a226
    v_accvgpr_read_b32 v187, a227
    v_accvgpr_read_b32 v188, a228
    v_accvgpr_read_b32 v189, a229
    v_accvgpr_read_b32 v190, a230
    v_accvgpr_read_b32 v191, a231
    v_accvgpr_read_b32 v192, a232
    v_accvgpr_read_b32 v193, a233
    v_accvgpr_read_b32 v194, a234
    v_accvgpr_read_b32 v195, a235
    v_accvgpr_read_b32 v196, a236
    v_accvgpr_read_b32 v197, a237
    v_accvgpr_read_b32 v198, a238
    v_accvgpr_read_b32 v199, a239
    v_cvt_pk_bf16_f32 v64, v184, v185
    v_cvt_pk_bf16_f32 v65, v186, v187
    v_cvt_pk_bf16_f32 v66, v188, v189
    v_cvt_pk_bf16_f32 v67, v190, v191
    v_cvt_pk_bf16_f32 v68, v192, v193
    v_cvt_pk_bf16_f32 v69, v194, v195
    v_cvt_pk_bf16_f32 v70, v196, v197
    v_cvt_pk_bf16_f32 v71, v198, v199
    s_add_u32 s49, s49, 4096
    buffer_store_dwordx4 v[64:67], v44, s[32:35], s49 offen offset:0 sc1
    buffer_store_dwordx4 v[68:71], v44, s[32:35], s49 offen offset:128 sc1
    v_accvgpr_read_b32 v184, a240
    v_accvgpr_read_b32 v185, a241
    v_accvgpr_read_b32 v186, a242
    v_accvgpr_read_b32 v187, a243
    v_accvgpr_read_b32 v188, a244
    v_accvgpr_read_b32 v189, a245
    v_accvgpr_read_b32 v190, a246
    v_accvgpr_read_b32 v191, a247
    v_accvgpr_read_b32 v192, a248
    v_accvgpr_read_b32 v193, a249
    v_accvgpr_read_b32 v194, a250
    v_accvgpr_read_b32 v195, a251
    v_accvgpr_read_b32 v196, a252
    v_accvgpr_read_b32 v197, a253
    v_accvgpr_read_b32 v198, a254
    v_accvgpr_read_b32 v199, a255
    v_cvt_pk_bf16_f32 v72, v184, v185
    v_cvt_pk_bf16_f32 v73, v186, v187
    v_cvt_pk_bf16_f32 v74, v188, v189
    v_cvt_pk_bf16_f32 v75, v190, v191
    v_cvt_pk_bf16_f32 v76, v192, v193
    v_cvt_pk_bf16_f32 v77, v194, v195
    v_cvt_pk_bf16_f32 v78, v196, v197
    v_cvt_pk_bf16_f32 v79, v198, v199
    buffer_store_dwordx4 v[72:75], v44, s[32:35], s49 offen offset:2048 sc1
    buffer_store_dwordx4 v[76:79], v44, s[32:35], s49 offen offset:2176 sc1
    s_branch mega_kernel_wdone
jobaattn_154:
    s_lshr_b32 s58, s47, 2
    s_add_u32 s58, s58, s62
    s_lshl_b32 s56, s58, 2
    s_add_u32 s49, s56, 176
    s_lshl_b32 s50, s58, 3
    s_add_u32 s50, s50, 10
    s_cmp_lg_u32 s44, 0
    s_cbranch_scc1 dd_191
    s_lshl_b32 s76, s49, 7
    s_lshl_b32 s77, 40, 7
    s_mov_b32 s52, 0
dw_190:
    buffer_load_dword v4, v6, s[32:35], s76 offen sc1
    buffer_load_dword v5, v6, s[32:35], s77 offen sc1
    s_add_u32 s52, s52, 1
    s_waitcnt vmcnt(0)
    v_cmp_gt_u32 vcc, 4, v4
    s_nop 0
    s_cbranch_vccnz dn_192
    v_cmp_gt_u32 vcc, s50, v5
    s_nop 0
    s_cbranch_vccz dd_191
dn_192:
    s_sleep 12
    s_cmp_lt_u32 s52, 200000
    s_cbranch_scc1 dw_190
dd_191:
    s_barrier
    s_lshl_b32 s56, s58, 2
    s_add_u32 s56, s56, 208
    s_mov_b32 s57, 1
    s_mov_b32 s48, 0
    s_and_b32 s49, s47, 3
    s_lshl_b32 s50, s45, 2
    s_add_u32 s49, s49, s50
    s_lshl_b32 s49, s49, 1
    s_and_b32 s50, s44, 1
    s_add_u32 s60, s49, s50
    s_lshl_b32 s49, s58, 8
    s_add_u32 s60, s60, s49
    s_lshr_b32 s49, s44, 1
    s_lshl_b32 s49, s49, 7
    s_add_u32 s60, s60, s49
    s_mov_b32 s61, 4
    v_add_u32 v242, 0x1000000, v2
    v_add_u32 v243, 0x2000000, v2
    v_add_u32 v244, 0x3000000, v2
    v_and_b32 v236, 7, v1
    v_lshlrev_b32 v236, 4, v236
    v_lshrrev_b32 v237, 5, v1
    v_lshl_add_u32 v236, v237, 8, v236
    v_add_u32 v236, 0x5000080, v236
    v_and_b32 v241, 15, v1
    v_lshlrev_b32 v241, 4, v241
    v_lshl_add_u32 v241, v237, 8, v241
    v_bfe_u32 v238, v1, 4, 1
    v_lshl_add_u32 v241, v238, 3, v241
    v_add_u32 v241, 0x5800000, v241
    s_add_u32 s51, s60, 0
    s_lshl_b32 s49, s51, 13
    s_add_u32 s50, s49, 4096
    s_lshl_b32 s51, s51, 12
    buffer_load_dwordx4 v[8:11], v2, s[32:35], s49 offen offset:0 sc1
    buffer_load_dwordx4 v[40:43], v242, s[32:35], s49 offen offset:0 sc1
    buffer_load_dwordx4 v[12:15], v2, s[32:35], s49 offen offset:1024 sc1
    buffer_load_dwordx4 v[44:47], v242, s[32:35], s49 offen offset:1024 sc1
    buffer_load_dwordx4 v[16:19], v2, s[32:35], s49 offen offset:2048 sc1
    buffer_load_dwordx4 v[48:51], v242, s[32:35], s49 offen offset:2048 sc1
    buffer_load_dwordx4 v[20:23], v2, s[32:35], s49 offen offset:3072 sc1
    buffer_load_dwordx4 v[52:55], v242, s[32:35], s49 offen offset:3072 sc1
    buffer_load_dwordx4 v[24:27], v2, s[32:35], s50 offen offset:0 sc1
    buffer_load_dwordx4 v[56:59], v242, s[32:35], s50 offen offset:0 sc1
    buffer_load_dwordx4 v[28:31], v2, s[32:35], s50 offen offset:1024 sc1
    buffer_load_dwordx4 v[60:63], v242, s[32:35], s50 offen offset:1024 sc1
    buffer_load_dwordx4 v[32:35], v2, s[32:35], s50 offen offset:2048 sc1
    buffer_load_dwordx4 v[64:67], v242, s[32:35], s50 offen offset:2048 sc1
    buffer_load_dwordx4 v[36:39], v2, s[32:35], s50 offen offset:3072 sc1
    buffer_load_dwordx4 v[68:71], v242, s[32:35], s50 offen offset:3072 sc1
    buffer_load_dwordx4 v[72:75], v236, s[32:35], s51 offen offset:0 sc1
    buffer_load_dwordx4 v[76:79], v236, s[32:35], s51 offen offset:512 sc1
    buffer_load_dwordx4 v[80:83], v236, s[32:35], s51 offen offset:1024 sc1
    buffer_load_dwordx4 v[84:87], v236, s[32:35], s51 offen offset:1536 sc1
    buffer_load_dwordx4 v[88:91], v236, s[32:35], s51 offen offset:2048 sc1
    buffer_load_dwordx4 v[92:95], v236, s[32:35], s51 offen offset:2560 sc1
    buffer_load_dwordx4 v[96:99], v236, s[32:35], s51 offen offset:3072 sc1
    buffer_load_dwordx4 v[100:103], v236, s[32:35], s51 offen offset:3584 sc1
    buffer_load_dwordx4 v[104:107], v243, s[32:35], s49 offen offset:0 sc1
    buffer_load_dwordx4 v[108:111], v243, s[32:35], s49 offen offset:1024 sc1
    buffer_load_dwordx4 v[112:115], v243, s[32:35], s49 offen offset:2048 sc1
    buffer_load_dwordx4 v[116:119], v243, s[32:35], s49 offen offset:3072 sc1
    buffer_load_dwordx4 v[120:123], v243, s[32:35], s50 offen offset:0 sc1
    buffer_load_dwordx4 v[124:127], v243, s[32:35], s50 offen offset:1024 sc1
    buffer_load_dwordx4 v[128:131], v243, s[32:35], s50 offen offset:2048 sc1
    buffer_load_dwordx4 v[132:135], v243, s[32:35], s50 offen offset:3072 sc1
    buffer_load_dwordx2 v[136:137], v241, s[32:35], s51 offen offset:0 sc1
    buffer_load_dwordx2 v[138:139], v241, s[32:35], s51 offen offset:1024 sc1
    buffer_load_dwordx2 v[140:141], v241, s[32:35], s51 offen offset:2048 sc1
    buffer_load_dwordx2 v[142:143], v241, s[32:35], s51 offen offset:3072 sc1
    v_lshlrev_b32 v237, 2, v237
    v_and_b32 v238, 31, v1
    v_sub_u32 v237, v238, v237
    v_mov_b32 v238, 0xf149f2ca
    v_cmp_le_i32 vcc, 0, v237
    s_nop 1
    v_cndmask_b32 v176, v238, 0, vcc
    v_cmp_le_i32 vcc, 1, v237
    s_nop 1
    v_cndmask_b32 v177, v238, 0, vcc
    v_cmp_le_i32 vcc, 2, v237
    s_nop 1
    v_cndmask_b32 v178, v238, 0, vcc
    v_cmp_le_i32 vcc, 3, v237
    s_nop 1
    v_cndmask_b32 v179, v238, 0, vcc
    v_cmp_le_i32 vcc, 8, v237
    s_nop 1
    v_cndmask_b32 v180, v238, 0, vcc
    v_cmp_le_i32 vcc, 9, v237
    s_nop 1
    v_cndmask_b32 v181, v238, 0, vcc
    v_cmp_le_i32 vcc, 10, v237
    s_nop 1
    v_cndmask_b32 v182, v238, 0, vcc
    v_cmp_le_i32 vcc, 11, v237
    s_nop 1
    v_cndmask_b32 v183, v238, 0, vcc
    v_cmp_le_i32 vcc, 16, v237
    s_nop 1
    v_cndmask_b32 v184, v238, 0, vcc
    v_cmp_le_i32 vcc, 17, v237
    s_nop 1
    v_cndmask_b32 v185, v238, 0, vcc
    v_cmp_le_i32 vcc, 18, v237
    s_nop 1
    v_cndmask_b32 v186, v238, 0, vcc
    v_cmp_le_i32 vcc, 19, v237
    s_nop 1
    v_cndmask_b32 v187, v238, 0, vcc
    v_cmp_le_i32 vcc, 24, v237
    s_nop 1
    v_cndmask_b32 v188, v238, 0, vcc
    v_cmp_le_i32 vcc, 25, v237
    s_nop 1
    v_cndmask_b32 v189, v238, 0, vcc
    v_cmp_le_i32 vcc, 26, v237
    s_nop 1
    v_cndmask_b32 v190, v238, 0, vcc
    v_cmp_le_i32 vcc, 27, v237
    s_nop 1
    v_cndmask_b32 v191, v238, 0, vcc
    s_mov_b32 s52, 0x3e0293ee
    s_waitcnt vmcnt(12)
    v_mfma_f32_32x32x16_bf16 v[144:159], v[40:43], v[8:11], v[176:191]
    v_mfma_f32_32x32x16_bf16 v[144:159], v[44:47], v[12:15], v[144:159]
    v_mfma_f32_32x32x16_bf16 v[144:159], v[48:51], v[16:19], v[144:159]
    v_mfma_f32_32x32x16_bf16 v[144:159], v[52:55], v[20:23], v[144:159]
    v_mfma_f32_32x32x16_bf16 v[144:159], v[56:59], v[24:27], v[144:159]
    v_mfma_f32_32x32x16_bf16 v[144:159], v[60:63], v[28:31], v[144:159]
    v_mfma_f32_32x32x16_bf16 v[144:159], v[64:67], v[32:35], v[144:159]
    v_mfma_f32_32x32x16_bf16 v[144:159], v[68:71], v[36:39], v[144:159]
    v_mfma_f32_32x32x16_bf16 v[160:175], v[72:75], v[8:11], 0
    v_mfma_f32_32x32x16_bf16 v[160:175], v[76:79], v[12:15], v[160:175]
    v_mfma_f32_32x32x16_bf16 v[160:175], v[80:83], v[16:19], v[160:175]
    v_mfma_f32_32x32x16_bf16 v[160:175], v[84:87], v[20:23], v[160:175]
    v_mfma_f32_32x32x16_bf16 v[160:175], v[88:91], v[24:27], v[160:175]
    v_mfma_f32_32x32x16_bf16 v[160:175], v[92:95], v[28:31], v[160:175]
    v_mfma_f32_32x32x16_bf16 v[160:175], v[96:99], v[32:35], v[160:175]
    v_mfma_f32_32x32x16_bf16 v[160:175], v[100:103], v[36:39], v[160:175]
    s_add_u32 s51, s60, 32
    s_lshl_b32 s49, s51, 13
    s_add_u32 s50, s49, 4096
    s_lshl_b32 s51, s51, 12
    buffer_load_dwordx4 a[0:3], v2, s[32:35], s49 offen offset:0 sc1
    buffer_load_dwordx4 a[32:35], v242, s[32:35], s49 offen offset:0 sc1
    buffer_load_dwordx4 a[4:7], v2, s[32:35], s49 offen offset:1024 sc1
    buffer_load_dwordx4 a[36:39], v242, s[32:35], s49 offen offset:1024 sc1
    buffer_load_dwordx4 a[8:11], v2, s[32:35], s49 offen offset:2048 sc1
    buffer_load_dwordx4 a[40:43], v242, s[32:35], s49 offen offset:2048 sc1
    buffer_load_dwordx4 a[12:15], v2, s[32:35], s49 offen offset:3072 sc1
    buffer_load_dwordx4 a[44:47], v242, s[32:35], s49 offen offset:3072 sc1
    buffer_load_dwordx4 a[16:19], v2, s[32:35], s50 offen offset:0 sc1
    buffer_load_dwordx4 a[48:51], v242, s[32:35], s50 offen offset:0 sc1
    buffer_load_dwordx4 a[20:23], v2, s[32:35], s50 offen offset:1024 sc1
    buffer_load_dwordx4 a[52:55], v242, s[32:35], s50 offen offset:1024 sc1
    buffer_load_dwordx4 a[24:27], v2, s[32:35], s50 offen offset:2048 sc1
    buffer_load_dwordx4 a[56:59], v242, s[32:35], s50 offen offset:2048 sc1
    buffer_load_dwordx4 a[28:31], v2, s[32:35], s50 offen offset:3072 sc1
    buffer_load_dwordx4 a[60:63], v242, s[32:35], s50 offen offset:3072 sc1
    buffer_load_dwordx4 a[64:67], v236, s[32:35], s51 offen offset:0 sc1
    buffer_load_dwordx4 a[68:71], v236, s[32:35], s51 offen offset:512 sc1
    buffer_load_dwordx4 a[72:75], v236, s[32:35], s51 offen offset:1024 sc1
    buffer_load_dwordx4 a[76:79], v236, s[32:35], s51 offen offset:1536 sc1
    buffer_load_dwordx4 a[80:83], v236, s[32:35], s51 offen offset:2048 sc1
    buffer_load_dwordx4 a[84:87], v236, s[32:35], s51 offen offset:2560 sc1
    buffer_load_dwordx4 a[88:91], v236, s[32:35], s51 offen offset:3072 sc1
    buffer_load_dwordx4 a[92:95], v236, s[32:35], s51 offen offset:3584 sc1
    buffer_load_dwordx4 a[96:99], v243, s[32:35], s49 offen offset:0 sc1
    buffer_load_dwordx4 a[100:103], v243, s[32:35], s49 offen offset:1024 sc1
    buffer_load_dwordx4 a[104:107], v243, s[32:35], s49 offen offset:2048 sc1
    buffer_load_dwordx4 a[108:111], v243, s[32:35], s49 offen offset:3072 sc1
    buffer_load_dwordx4 a[112:115], v243, s[32:35], s50 offen offset:0 sc1
    buffer_load_dwordx4 a[116:119], v243, s[32:35], s50 offen offset:1024 sc1
    buffer_load_dwordx4 a[120:123], v243, s[32:35], s50 offen offset:2048 sc1
    buffer_load_dwordx4 a[124:127], v243, s[32:35], s50 offen offset:3072 sc1
    buffer_load_dwordx2 a[128:129], v241, s[32:35], s51 offen offset:0 sc1
    buffer_load_dwordx2 a[130:131], v241, s[32:35], s51 offen offset:1024 sc1
    buffer_load_dwordx2 a[132:133], v241, s[32:35], s51 offen offset:2048 sc1
    buffer_load_dwordx2 a[134:135], v241, s[32:35], s51 offen offset:3072 sc1
    v_max3_f32 v239, v144, v145, v146
    v_max3_f32 v240, v147, v148, v149
    v_max3_f32 v239, v239, v150, v151
    v_max3_f32 v240, v240, v152, v153
    v_max3_f32 v239, v239, v154, v155
    v_max3_f32 v240, v240, v156, v157
    v_max3_f32 v239, v239, v158, v159
    v_max3_f32 v240, v240, v160, v161
    v_max3_f32 v239, v239, v162, v163
    v_max_f32 v239, v239, v240
    v_mov_b32 v240, v239
    s_nop 1
    v_permlane32_swap_b32 v239, v240
    v_max_f32 v239, v239, v240
    v_mul_f32 v239, s52, v239
    v_fma_f32 v144, v144, s52, -v239
    v_fma_f32 v145, v145, s52, -v239
    v_fma_f32 v146, v146, s52, -v239
    v_fma_f32 v147, v147, s52, -v239
    v_fma_f32 v148, v148, s52, -v239
    v_fma_f32 v149, v149, s52, -v239
    v_fma_f32 v150, v150, s52, -v239
    v_fma_f32 v151, v151, s52, -v239
    v_fma_f32 v152, v152, s52, -v239
    v_fma_f32 v153, v153, s52, -v239
    v_fma_f32 v154, v154, s52, -v239
    v_fma_f32 v155, v155, s52, -v239
    v_fma_f32 v156, v156, s52, -v239
    v_fma_f32 v157, v157, s52, -v239
    v_fma_f32 v158, v158, s52, -v239
    v_fma_f32 v159, v159, s52, -v239
    v_fma_f32 v160, v160, s52, -v239
    v_fma_f32 v161, v161, s52, -v239
    v_fma_f32 v162, v162, s52, -v239
    v_fma_f32 v163, v163, s52, -v239
    v_exp_f32 v144, v144
    v_exp_f32 v145, v145
    v_exp_f32 v146, v146
    v_exp_f32 v147, v147
    v_exp_f32 v148, v148
    v_exp_f32 v149, v149
    v_exp_f32 v150, v150
    v_exp_f32 v151, v151
    v_exp_f32 v152, v152
    v_exp_f32 v153, v153
    v_exp_f32 v154, v154
    v_exp_f32 v155, v155
    v_exp_f32 v156, v156
    v_exp_f32 v157, v157
    v_exp_f32 v158, v158
    v_exp_f32 v159, v159
    v_exp_f32 v160, v160
    v_exp_f32 v161, v161
    v_exp_f32 v162, v162
    v_exp_f32 v163, v163
    v_add_f32 v239, v144, v145
    v_add_f32 v240, v146, v147
    v_add_f32 v239, v239, v148
    v_add_f32 v240, v240, v149
    v_add_f32 v239, v239, v150
    v_add_f32 v240, v240, v151
    v_add_f32 v239, v239, v152
    v_add_f32 v240, v240, v153
    v_add_f32 v239, v239, v154
    v_add_f32 v240, v240, v155
    v_add_f32 v239, v239, v156
    v_add_f32 v240, v240, v157
    v_add_f32 v239, v239, v158
    v_add_f32 v240, v240, v159
    v_add_f32 v239, v239, v160
    v_add_f32 v240, v240, v161
    v_add_f32 v239, v239, v162
    v_add_f32 v240, v240, v163
    v_add_f32 v239, v239, v240
    v_mov_b32 v240, v239
    s_nop 1
    v_permlane32_swap_b32 v239, v240
    v_add_f32 v239, v239, v240
    v_rcp_f32 v239, v239
    s_nop 0
    v_mul_f32 v144, v144, v239
    v_mul_f32 v145, v145, v239
    v_mul_f32 v146, v146, v239
    v_mul_f32 v147, v147, v239
    v_mul_f32 v148, v148, v239
    v_mul_f32 v149, v149, v239
    v_mul_f32 v150, v150, v239
    v_mul_f32 v151, v151, v239
    v_mul_f32 v152, v152, v239
    v_mul_f32 v153, v153, v239
    v_mul_f32 v154, v154, v239
    v_mul_f32 v155, v155, v239
    v_mul_f32 v156, v156, v239
    v_mul_f32 v157, v157, v239
    v_mul_f32 v158, v158, v239
    v_mul_f32 v159, v159, v239
    v_mul_f32 v160, v160, v239
    v_mul_f32 v161, v161, v239
    v_mul_f32 v162, v162, v239
    v_mul_f32 v163, v163, v239
    v_cvt_pk_bf16_f32 v224, v144, v145
    v_cvt_pk_bf16_f32 v225, v146, v147
    v_cvt_pk_bf16_f32 v226, v148, v149
    v_cvt_pk_bf16_f32 v227, v150, v151
    v_cvt_pk_bf16_f32 v228, v152, v153
    v_cvt_pk_bf16_f32 v229, v154, v155
    v_cvt_pk_bf16_f32 v230, v156, v157
    v_cvt_pk_bf16_f32 v231, v158, v159
    v_cvt_pk_bf16_f32 v232, v160, v161
    v_cvt_pk_bf16_f32 v233, v162, v163
    s_add_u32 s51, s60, 0
    s_lshl_b32 s49, s51, 13
    s_add_u32 s50, s49, 4096
    s_waitcnt vmcnt(36)
    v_mfma_f32_32x32x16_bf16 v[192:207], v[104:107], v[224:227], 0
    v_mfma_f32_32x32x16_bf16 v[192:207], v[108:111], v[228:231], v[192:207]
    v_mfma_f32_32x32x8_bf16 v[192:207], v[136:137], v[232:233], v[192:207]
    v_mfma_f32_32x32x16_bf16 v[208:223], v[112:115], v[224:227], 0
    v_mfma_f32_32x32x16_bf16 v[208:223], v[116:119], v[228:231], v[208:223]
    v_mfma_f32_32x32x8_bf16 v[208:223], v[138:139], v[232:233], v[208:223]
    s_nop 8
    v_cvt_pk_bf16_f32 v152, v192, v193
    v_cvt_pk_bf16_f32 v153, v194, v195
    v_cvt_pk_bf16_f32 v154, v196, v197
    v_cvt_pk_bf16_f32 v155, v198, v199
    v_cvt_pk_bf16_f32 v156, v200, v201
    v_cvt_pk_bf16_f32 v157, v202, v203
    v_cvt_pk_bf16_f32 v158, v204, v205
    v_cvt_pk_bf16_f32 v159, v206, v207
    buffer_store_dwordx4 v[152:155], v244, s[32:35], s49 offen offset:0 sc1
    buffer_store_dwordx4 v[156:159], v244, s[32:35], s49 offen offset:1024 sc1
    v_mfma_f32_32x32x16_bf16 v[192:207], v[120:123], v[224:227], 0
    v_mfma_f32_32x32x16_bf16 v[192:207], v[124:127], v[228:231], v[192:207]
    v_mfma_f32_32x32x8_bf16 v[192:207], v[140:141], v[232:233], v[192:207]
    v_cvt_pk_bf16_f32 v144, v208, v209
    v_cvt_pk_bf16_f32 v145, v210, v211
    v_cvt_pk_bf16_f32 v146, v212, v213
    v_cvt_pk_bf16_f32 v147, v214, v215
    v_cvt_pk_bf16_f32 v148, v216, v217
    v_cvt_pk_bf16_f32 v149, v218, v219
    v_cvt_pk_bf16_f32 v150, v220, v221
    v_cvt_pk_bf16_f32 v151, v222, v223
    buffer_store_dwordx4 v[144:147], v244, s[32:35], s49 offen offset:2048 sc1
    buffer_store_dwordx4 v[148:151], v244, s[32:35], s49 offen offset:3072 sc1
    v_mfma_f32_32x32x16_bf16 v[208:223], v[128:131], v[224:227], 0
    v_mfma_f32_32x32x16_bf16 v[208:223], v[132:135], v[228:231], v[208:223]
    v_mfma_f32_32x32x8_bf16 v[208:223], v[142:143], v[232:233], v[208:223]
    v_cvt_pk_bf16_f32 v152, v192, v193
    v_cvt_pk_bf16_f32 v153, v194, v195
    v_cvt_pk_bf16_f32 v154, v196, v197
    v_cvt_pk_bf16_f32 v155, v198, v199
    v_cvt_pk_bf16_f32 v156, v200, v201
    v_cvt_pk_bf16_f32 v157, v202, v203
    v_cvt_pk_bf16_f32 v158, v204, v205
    v_cvt_pk_bf16_f32 v159, v206, v207
    buffer_store_dwordx4 v[152:155], v244, s[32:35], s50 offen offset:0 sc1
    buffer_store_dwordx4 v[156:159], v244, s[32:35], s50 offen offset:1024 sc1
    s_nop 1
    v_cvt_pk_bf16_f32 v144, v208, v209
    v_cvt_pk_bf16_f32 v145, v210, v211
    v_cvt_pk_bf16_f32 v146, v212, v213
    v_cvt_pk_bf16_f32 v147, v214, v215
    v_cvt_pk_bf16_f32 v148, v216, v217
    v_cvt_pk_bf16_f32 v149, v218, v219
    v_cvt_pk_bf16_f32 v150, v220, v221
    v_cvt_pk_bf16_f32 v151, v222, v223
    buffer_store_dwordx4 v[144:147], v244, s[32:35], s50 offen offset:2048 sc1
    buffer_store_dwordx4 v[148:151], v244, s[32:35], s50 offen offset:3072 sc1
    s_waitcnt vmcnt(8)
    v_mfma_f32_32x32x16_bf16 v[144:159], a[32:35], a[0:3], v[176:191]
    v_mfma_f32_32x32x16_bf16 v[144:159], a[36:39], a[4:7], v[144:159]
    v_mfma_f32_32x32x16_bf16 v[144:159], a[40:43], a[8:11], v[144:159]
    v_mfma_f32_32x32x16_bf16 v[144:159], a[44:47], a[12:15], v[144:159]
    v_mfma_f32_32x32x16_bf16 v[144:159], a[48:51], a[16:19], v[144:159]
    v_mfma_f32_32x32x16_bf16 v[144:159], a[52:55], a[20:23], v[144:159]
    v_mfma_f32_32x32x16_bf16 v[144:159], a[56:59], a[24:27], v[144:159]
    v_mfma_f32_32x32x16_bf16 v[144:159], a[60:63], a[28:31], v[144:159]
    v_mfma_f32_32x32x16_bf16 v[160:175], a[64:67], a[0:3], 0
    v_mfma_f32_32x32x16_bf16 v[160:175], a[68:71], a[4:7], v[160:175]
    v_mfma_f32_32x32x16_bf16 v[160:175], a[72:75], a[8:11], v[160:175]
    v_mfma_f32_32x32x16_bf16 v[160:175], a[76:79], a[12:15], v[160:175]
    v_mfma_f32_32x32x16_bf16 v[160:175], a[80:83], a[16:19], v[160:175]
    v_mfma_f32_32x32x16_bf16 v[160:175], a[84:87], a[20:23], v[160:175]
    v_mfma_f32_32x32x16_bf16 v[160:175], a[88:91], a[24:27], v[160:175]
    v_mfma_f32_32x32x16_bf16 v[160:175], a[92:95], a[28:31], v[160:175]
    s_add_u32 s51, s60, 64
    s_lshl_b32 s49, s51, 13
    s_add_u32 s50, s49, 4096
    s_lshl_b32 s51, s51, 12
    buffer_load_dwordx4 v[8:11], v2, s[32:35], s49 offen offset:0 sc1
    buffer_load_dwordx4 v[40:43], v242, s[32:35], s49 offen offset:0 sc1
    buffer_load_dwordx4 v[12:15], v2, s[32:35], s49 offen offset:1024 sc1
    buffer_load_dwordx4 v[44:47], v242, s[32:35], s49 offen offset:1024 sc1
    buffer_load_dwordx4 v[16:19], v2, s[32:35], s49 offen offset:2048 sc1
    buffer_load_dwordx4 v[48:51], v242, s[32:35], s49 offen offset:2048 sc1
    buffer_load_dwordx4 v[20:23], v2, s[32:35], s49 offen offset:3072 sc1
    buffer_load_dwordx4 v[52:55], v242, s[32:35], s49 offen offset:3072 sc1
    buffer_load_dwordx4 v[24:27], v2, s[32:35], s50 offen offset:0 sc1
    buffer_load_dwordx4 v[56:59], v242, s[32:35], s50 offen offset:0 sc1
    buffer_load_dwordx4 v[28:31], v2, s[32:35], s50 offen offset:1024 sc1
    buffer_load_dwordx4 v[60:63], v242, s[32:35], s50 offen offset:1024 sc1
    buffer_load_dwordx4 v[32:35], v2, s[32:35], s50 offen offset:2048 sc1
    buffer_load_dwordx4 v[64:67], v242, s[32:35], s50 offen offset:2048 sc1
    buffer_load_dwordx4 v[36:39], v2, s[32:35], s50 offen offset:3072 sc1
    buffer_load_dwordx4 v[68:71], v242, s[32:35], s50 offen offset:3072 sc1
    buffer_load_dwordx4 v[72:75], v236, s[32:35], s51 offen offset:0 sc1
    buffer_load_dwordx4 v[76:79], v236, s[32:35], s51 offen offset:512 sc1
    buffer_load_dwordx4 v[80:83], v236, s[32:35], s51 offen offset:1024 sc1
    buffer_load_dwordx4 v[84:87], v236, s[32:35], s51 offen offset:1536 sc1
    buffer_load_dwordx4 v[88:91], v236, s[32:35], s51 offen offset:2048 sc1
    buffer_load_dwordx4 v[92:95], v236, s[32:35], s51 offen offset:2560 sc1
    buffer_load_dwordx4 v[96:99], v236, s[32:35], s51 offen offset:3072 sc1
    buffer_load_dwordx4 v[100:103], v236, s[32:35], s51 offen offset:3584 sc1
    buffer_load_dwordx4 v[104:107], v243, s[32:35], s49 offen offset:0 sc1
    buffer_load_dwordx4 v[108:111], v243, s[32:35], s49 offen offset:1024 sc1
    buffer_load_dwordx4 v[112:115], v243, s[32:35], s49 offen offset:2048 sc1
    buffer_load_dwordx4 v[116:119], v243, s[32:35], s49 offen offset:3072 sc1
    buffer_load_dwordx4 v[120:123], v243, s[32:35], s50 offen offset:0 sc1
    buffer_load_dwordx4 v[124:127], v243, s[32:35], s50 offen offset:1024 sc1
    buffer_load_dwordx4 v[128:131], v243, s[32:35], s50 offen offset:2048 sc1
    buffer_load_dwordx4 v[132:135], v243, s[32:35], s50 offen offset:3072 sc1
    buffer_load_dwordx2 v[136:137], v241, s[32:35], s51 offen offset:0 sc1
    buffer_load_dwordx2 v[138:139], v241, s[32:35], s51 offen offset:1024 sc1
    buffer_load_dwordx2 v[140:141], v241, s[32:35], s51 offen offset:2048 sc1
    buffer_load_dwordx2 v[142:143], v241, s[32:35], s51 offen offset:3072 sc1
    v_max3_f32 v239, v144, v145, v146
    v_max3_f32 v240, v147, v148, v149
    v_max3_f32 v239, v239, v150, v151
    v_max3_f32 v240, v240, v152, v153
    v_max3_f32 v239, v239, v154, v155
    v_max3_f32 v240, v240, v156, v157
    v_max3_f32 v239, v239, v158, v159
    v_max3_f32 v240, v240, v160, v161
    v_max3_f32 v239, v239, v162, v163
    v_max_f32 v239, v239, v240
    v_mov_b32 v240, v239
    s_nop 1
    v_permlane32_swap_b32 v239, v240
    v_max_f32 v239, v239, v240
    v_mul_f32 v239, s52, v239
    v_fma_f32 v144, v144, s52, -v239
    v_fma_f32 v145, v145, s52, -v239
    v_fma_f32 v146, v146, s52, -v239
    v_fma_f32 v147, v147, s52, -v239
    v_fma_f32 v148, v148, s52, -v239
    v_fma_f32 v149, v149, s52, -v239
    v_fma_f32 v150, v150, s52, -v239
    v_fma_f32 v151, v151, s52, -v239
    v_fma_f32 v152, v152, s52, -v239
    v_fma_f32 v153, v153, s52, -v239
    v_fma_f32 v154, v154, s52, -v239
    v_fma_f32 v155, v155, s52, -v239
    v_fma_f32 v156, v156, s52, -v239
    v_fma_f32 v157, v157, s52, -v239
    v_fma_f32 v158, v158, s52, -v239
    v_fma_f32 v159, v159, s52, -v239
    v_fma_f32 v160, v160, s52, -v239
    v_fma_f32 v161, v161, s52, -v239
    v_fma_f32 v162, v162, s52, -v239
    v_fma_f32 v163, v163, s52, -v239
    v_exp_f32 v144, v144
    v_exp_f32 v145, v145
    v_exp_f32 v146, v146
    v_exp_f32 v147, v147
    v_exp_f32 v148, v148
    v_exp_f32 v149, v149
    v_exp_f32 v150, v150
    v_exp_f32 v151, v151
    v_exp_f32 v152, v152
    v_exp_f32 v153, v153
    v_exp_f32 v154, v154
    v_exp_f32 v155, v155
    v_exp_f32 v156, v156
    v_exp_f32 v157, v157
    v_exp_f32 v158, v158
    v_exp_f32 v159, v159
    v_exp_f32 v160, v160
    v_exp_f32 v161, v161
    v_exp_f32 v162, v162
    v_exp_f32 v163, v163
    v_add_f32 v239, v144, v145
    v_add_f32 v240, v146, v147
    v_add_f32 v239, v239, v148
    v_add_f32 v240, v240, v149
    v_add_f32 v239, v239, v150
    v_add_f32 v240, v240, v151
    v_add_f32 v239, v239, v152
    v_add_f32 v240, v240, v153
    v_add_f32 v239, v239, v154
    v_add_f32 v240, v240, v155
    v_add_f32 v239, v239, v156
    v_add_f32 v240, v240, v157
    v_add_f32 v239, v239, v158
    v_add_f32 v240, v240, v159
    v_add_f32 v239, v239, v160
    v_add_f32 v240, v240, v161
    v_add_f32 v239, v239, v162
    v_add_f32 v240, v240, v163
    v_add_f32 v239, v239, v240
    v_mov_b32 v240, v239
    s_nop 1
    v_permlane32_swap_b32 v239, v240
    v_add_f32 v239, v239, v240
    v_rcp_f32 v239, v239
    s_nop 0
    v_mul_f32 v144, v144, v239
    v_mul_f32 v145, v145, v239
    v_mul_f32 v146, v146, v239
    v_mul_f32 v147, v147, v239
    v_mul_f32 v148, v148, v239
    v_mul_f32 v149, v149, v239
    v_mul_f32 v150, v150, v239
    v_mul_f32 v151, v151, v239
    v_mul_f32 v152, v152, v239
    v_mul_f32 v153, v153, v239
    v_mul_f32 v154, v154, v239
    v_mul_f32 v155, v155, v239
    v_mul_f32 v156, v156, v239
    v_mul_f32 v157, v157, v239
    v_mul_f32 v158, v158, v239
    v_mul_f32 v159, v159, v239
    v_mul_f32 v160, v160, v239
    v_mul_f32 v161, v161, v239
    v_mul_f32 v162, v162, v239
    v_mul_f32 v163, v163, v239
    v_cvt_pk_bf16_f32 v224, v144, v145
    v_cvt_pk_bf16_f32 v225, v146, v147
    v_cvt_pk_bf16_f32 v226, v148, v149
    v_cvt_pk_bf16_f32 v227, v150, v151
    v_cvt_pk_bf16_f32 v228, v152, v153
    v_cvt_pk_bf16_f32 v229, v154, v155
    v_cvt_pk_bf16_f32 v230, v156, v157
    v_cvt_pk_bf16_f32 v231, v158, v159
    v_cvt_pk_bf16_f32 v232, v160, v161
    v_cvt_pk_bf16_f32 v233, v162, v163
    s_add_u32 s51, s60, 32
    s_lshl_b32 s49, s51, 13
    s_add_u32 s50, s49, 4096
    v_mfma_f32_32x32x16_bf16 v[192:207], a[96:99], v[224:227], 0
    v_mfma_f32_32x32x16_bf16 v[192:207], a[100:103], v[228:231], v[192:207]
    v_mfma_f32_32x32x8_bf16 v[192:207], a[128:129], v[232:233], v[192:207]
    v_mfma_f32_32x32x16_bf16 v[208:223], a[104:107], v[224:227], 0
    v_mfma_f32_32x32x16_bf16 v[208:223], a[108:111], v[228:231], v[208:223]
    v_mfma_f32_32x32x8_bf16 v[208:223], a[130:131], v[232:233], v[208:223]
    s_nop 8
    v_cvt_pk_bf16_f32 v152, v192, v193
    v_cvt_pk_bf16_f32 v153, v194, v195
    v_cvt_pk_bf16_f32 v154, v196, v197
    v_cvt_pk_bf16_f32 v155, v198, v199
    v_cvt_pk_bf16_f32 v156, v200, v201
    v_cvt_pk_bf16_f32 v157, v202, v203
    v_cvt_pk_bf16_f32 v158, v204, v205
    v_cvt_pk_bf16_f32 v159, v206, v207
    buffer_store_dwordx4 v[152:155], v244, s[32:35], s49 offen offset:0 sc1
    buffer_store_dwordx4 v[156:159], v244, s[32:35], s49 offen offset:1024 sc1
    v_mfma_f32_32x32x16_bf16 v[192:207], a[112:115], v[224:227], 0
    v_mfma_f32_32x32x16_bf16 v[192:207], a[116:119], v[228:231], v[192:207]
    v_mfma_f32_32x32x8_bf16 v[192:207], a[132:133], v[232:233], v[192:207]
    v_cvt_pk_bf16_f32 v144, v208, v209
    v_cvt_pk_bf16_f32 v145, v210, v211
    v_cvt_pk_bf16_f32 v146, v212, v213
    v_cvt_pk_bf16_f32 v147, v214, v215
    v_cvt_pk_bf16_f32 v148, v216, v217
    v_cvt_pk_bf16_f32 v149, v218, v219
    v_cvt_pk_bf16_f32 v150, v220, v221
    v_cvt_pk_bf16_f32 v151, v222, v223
    buffer_store_dwordx4 v[144:147], v244, s[32:35], s49 offen offset:2048 sc1
    buffer_store_dwordx4 v[148:151], v244, s[32:35], s49 offen offset:3072 sc1
    v_mfma_f32_32x32x16_bf16 v[208:223], a[120:123], v[224:227], 0
    v_mfma_f32_32x32x16_bf16 v[208:223], a[124:127], v[228:231], v[208:223]
    v_mfma_f32_32x32x8_bf16 v[208:223], a[134:135], v[232:233], v[208:223]
    v_cvt_pk_bf16_f32 v152, v192, v193
    v_cvt_pk_bf16_f32 v153, v194, v195
    v_cvt_pk_bf16_f32 v154, v196, v197
    v_cvt_pk_bf16_f32 v155, v198, v199
    v_cvt_pk_bf16_f32 v156, v200, v201
    v_cvt_pk_bf16_f32 v157, v202, v203
    v_cvt_pk_bf16_f32 v158, v204, v205
    v_cvt_pk_bf16_f32 v159, v206, v207
    buffer_store_dwordx4 v[152:155], v244, s[32:35], s50 offen offset:0 sc1
    buffer_store_dwordx4 v[156:159], v244, s[32:35], s50 offen offset:1024 sc1
    s_nop 1
    v_cvt_pk_bf16_f32 v144, v208, v209
    v_cvt_pk_bf16_f32 v145, v210, v211
    v_cvt_pk_bf16_f32 v146, v212, v213
    v_cvt_pk_bf16_f32 v147, v214, v215
    v_cvt_pk_bf16_f32 v148, v216, v217
    v_cvt_pk_bf16_f32 v149, v218, v219
    v_cvt_pk_bf16_f32 v150, v220, v221
    v_cvt_pk_bf16_f32 v151, v222, v223
    buffer_store_dwordx4 v[144:147], v244, s[32:35], s50 offen offset:2048 sc1
    buffer_store_dwordx4 v[148:151], v244, s[32:35], s50 offen offset:3072 sc1
    s_waitcnt vmcnt(8)
    v_mfma_f32_32x32x16_bf16 v[144:159], v[40:43], v[8:11], v[176:191]
    v_mfma_f32_32x32x16_bf16 v[144:159], v[44:47], v[12:15], v[144:159]
    v_mfma_f32_32x32x16_bf16 v[144:159], v[48:51], v[16:19], v[144:159]
    v_mfma_f32_32x32x16_bf16 v[144:159], v[52:55], v[20:23], v[144:159]
    v_mfma_f32_32x32x16_bf16 v[144:159], v[56:59], v[24:27], v[144:159]
    v_mfma_f32_32x32x16_bf16 v[144:159], v[60:63], v[28:31], v[144:159]
    v_mfma_f32_32x32x16_bf16 v[144:159], v[64:67], v[32:35], v[144:159]
    v_mfma_f32_32x32x16_bf16 v[144:159], v[68:71], v[36:39], v[144:159]
    v_mfma_f32_32x32x16_bf16 v[160:175], v[72:75], v[8:11], 0
    v_mfma_f32_32x32x16_bf16 v[160:175], v[76:79], v[12:15], v[160:175]
    v_mfma_f32_32x32x16_bf16 v[160:175], v[80:83], v[16:19], v[160:175]
    v_mfma_f32_32x32x16_bf16 v[160:175], v[84:87], v[20:23], v[160:175]
    v_mfma_f32_32x32x16_bf16 v[160:175], v[88:91], v[24:27], v[160:175]
    v_mfma_f32_32x32x16_bf16 v[160:175], v[92:95], v[28:31], v[160:175]
    v_mfma_f32_32x32x16_bf16 v[160:175], v[96:99], v[32:35], v[160:175]
    v_mfma_f32_32x32x16_bf16 v[160:175], v[100:103], v[36:39], v[160:175]
    s_add_u32 s51, s60, 96
    s_lshl_b32 s49, s51, 13
    s_add_u32 s50, s49, 4096
    s_lshl_b32 s51, s51, 12
    buffer_load_dwordx4 a[0:3], v2, s[32:35], s49 offen offset:0 sc1
    buffer_load_dwordx4 a[32:35], v242, s[32:35], s49 offen offset:0 sc1
    buffer_load_dwordx4 a[4:7], v2, s[32:35], s49 offen offset:1024 sc1
    buffer_load_dwordx4 a[36:39], v242, s[32:35], s49 offen offset:1024 sc1
    buffer_load_dwordx4 a[8:11], v2, s[32:35], s49 offen offset:2048 sc1
    buffer_load_dwordx4 a[40:43], v242, s[32:35], s49 offen offset:2048 sc1
    buffer_load_dwordx4 a[12:15], v2, s[32:35], s49 offen offset:3072 sc1
    buffer_load_dwordx4 a[44:47], v242, s[32:35], s49 offen offset:3072 sc1
    buffer_load_dwordx4 a[16:19], v2, s[32:35], s50 offen offset:0 sc1
    buffer_load_dwordx4 a[48:51], v242, s[32:35], s50 offen offset:0 sc1
    buffer_load_dwordx4 a[20:23], v2, s[32:35], s50 offen offset:1024 sc1
    buffer_load_dwordx4 a[52:55], v242, s[32:35], s50 offen offset:1024 sc1
    buffer_load_dwordx4 a[24:27], v2, s[32:35], s50 offen offset:2048 sc1
    buffer_load_dwordx4 a[56:59], v242, s[32:35], s50 offen offset:2048 sc1
    buffer_load_dwordx4 a[28:31], v2, s[32:35], s50 offen offset:3072 sc1
    buffer_load_dwordx4 a[60:63], v242, s[32:35], s50 offen offset:3072 sc1
    buffer_load_dwordx4 a[64:67], v236, s[32:35], s51 offen offset:0 sc1
    buffer_load_dwordx4 a[68:71], v236, s[32:35], s51 offen offset:512 sc1
    buffer_load_dwordx4 a[72:75], v236, s[32:35], s51 offen offset:1024 sc1
    buffer_load_dwordx4 a[76:79], v236, s[32:35], s51 offen offset:1536 sc1
    buffer_load_dwordx4 a[80:83], v236, s[32:35], s51 offen offset:2048 sc1
    buffer_load_dwordx4 a[84:87], v236, s[32:35], s51 offen offset:2560 sc1
    buffer_load_dwordx4 a[88:91], v236, s[32:35], s51 offen offset:3072 sc1
    buffer_load_dwordx4 a[92:95], v236, s[32:35], s51 offen offset:3584 sc1
    buffer_load_dwordx4 a[96:99], v243, s[32:35], s49 offen offset:0 sc1
    buffer_load_dwordx4 a[100:103], v243, s[32:35], s49 offen offset:1024 sc1
    buffer_load_dwordx4 a[104:107], v243, s[32:35], s49 offen offset:2048 sc1
    buffer_load_dwordx4 a[108:111], v243, s[32:35], s49 offen offset:3072 sc1
    buffer_load_dwordx4 a[112:115], v243, s[32:35], s50 offen offset:0 sc1
    buffer_load_dwordx4 a[116:119], v243, s[32:35], s50 offen offset:1024 sc1
    buffer_load_dwordx4 a[120:123], v243, s[32:35], s50 offen offset:2048 sc1
    buffer_load_dwordx4 a[124:127], v243, s[32:35], s50 offen offset:3072 sc1
    buffer_load_dwordx2 a[128:129], v241, s[32:35], s51 offen offset:0 sc1
    buffer_load_dwordx2 a[130:131], v241, s[32:35], s51 offen offset:1024 sc1
    buffer_load_dwordx2 a[132:133], v241, s[32:35], s51 offen offset:2048 sc1
    buffer_load_dwordx2 a[134:135], v241, s[32:35], s51 offen offset:3072 sc1
    v_max3_f32 v239, v144, v145, v146
    v_max3_f32 v240, v147, v148, v149
    v_max3_f32 v239, v239, v150, v151
    v_max3_f32 v240, v240, v152, v153
    v_max3_f32 v239, v239, v154, v155
    v_max3_f32 v240, v240, v156, v157
    v_max3_f32 v239, v239, v158, v159
    v_max3_f32 v240, v240, v160, v161
    v_max3_f32 v239, v239, v162, v163
    v_max_f32 v239, v239, v240
    v_mov_b32 v240, v239
    s_nop 1
    v_permlane32_swap_b32 v239, v240
    v_max_f32 v239, v239, v240
    v_mul_f32 v239, s52, v239
    v_fma_f32 v144, v144, s52, -v239
    v_fma_f32 v145, v145, s52, -v239
    v_fma_f32 v146, v146, s52, -v239
    v_fma_f32 v147, v147, s52, -v239
    v_fma_f32 v148, v148, s52, -v239
    v_fma_f32 v149, v149, s52, -v239
    v_fma_f32 v150, v150, s52, -v239
    v_fma_f32 v151, v151, s52, -v239
    v_fma_f32 v152, v152, s52, -v239
    v_fma_f32 v153, v153, s52, -v239
    v_fma_f32 v154, v154, s52, -v239
    v_fma_f32 v155, v155, s52, -v239
    v_fma_f32 v156, v156, s52, -v239
    v_fma_f32 v157, v157, s52, -v239
    v_fma_f32 v158, v158, s52, -v239
    v_fma_f32 v159, v159, s52, -v239
    v_fma_f32 v160, v160, s52, -v239
    v_fma_f32 v161, v161, s52, -v239
    v_fma_f32 v162, v162, s52, -v239
    v_fma_f32 v163, v163, s52, -v239
    v_exp_f32 v144, v144
    v_exp_f32 v145, v145
    v_exp_f32 v146, v146
    v_exp_f32 v147, v147
    v_exp_f32 v148, v148
    v_exp_f32 v149, v149
    v_exp_f32 v150, v150
    v_exp_f32 v151, v151
    v_exp_f32 v152, v152
    v_exp_f32 v153, v153
    v_exp_f32 v154, v154
    v_exp_f32 v155, v155
    v_exp_f32 v156, v156
    v_exp_f32 v157, v157
    v_exp_f32 v158, v158
    v_exp_f32 v159, v159
    v_exp_f32 v160, v160
    v_exp_f32 v161, v161
    v_exp_f32 v162, v162
    v_exp_f32 v163, v163
    v_add_f32 v239, v144, v145
    v_add_f32 v240, v146, v147
    v_add_f32 v239, v239, v148
    v_add_f32 v240, v240, v149
    v_add_f32 v239, v239, v150
    v_add_f32 v240, v240, v151
    v_add_f32 v239, v239, v152
    v_add_f32 v240, v240, v153
    v_add_f32 v239, v239, v154
    v_add_f32 v240, v240, v155
    v_add_f32 v239, v239, v156
    v_add_f32 v240, v240, v157
    v_add_f32 v239, v239, v158
    v_add_f32 v240, v240, v159
    v_add_f32 v239, v239, v160
    v_add_f32 v240, v240, v161
    v_add_f32 v239, v239, v162
    v_add_f32 v240, v240, v163
    v_add_f32 v239, v239, v240
    v_mov_b32 v240, v239
    s_nop 1
    v_permlane32_swap_b32 v239, v240
    v_add_f32 v239, v239, v240
    v_rcp_f32 v239, v239
    s_nop 0
    v_mul_f32 v144, v144, v239
    v_mul_f32 v145, v145, v239
    v_mul_f32 v146, v146, v239
    v_mul_f32 v147, v147, v239
    v_mul_f32 v148, v148, v239
    v_mul_f32 v149, v149, v239
    v_mul_f32 v150, v150, v239
    v_mul_f32 v151, v151, v239
    v_mul_f32 v152, v152, v239
    v_mul_f32 v153, v153, v239
    v_mul_f32 v154, v154, v239
    v_mul_f32 v155, v155, v239
    v_mul_f32 v156, v156, v239
    v_mul_f32 v157, v157, v239
    v_mul_f32 v158, v158, v239
    v_mul_f32 v159, v159, v239
    v_mul_f32 v160, v160, v239
    v_mul_f32 v161, v161, v239
    v_mul_f32 v162, v162, v239
    v_mul_f32 v163, v163, v239
    v_cvt_pk_bf16_f32 v224, v144, v145
    v_cvt_pk_bf16_f32 v225, v146, v147
    v_cvt_pk_bf16_f32 v226, v148, v149
    v_cvt_pk_bf16_f32 v227, v150, v151
    v_cvt_pk_bf16_f32 v228, v152, v153
    v_cvt_pk_bf16_f32 v229, v154, v155
    v_cvt_pk_bf16_f32 v230, v156, v157
    v_cvt_pk_bf16_f32 v231, v158, v159
    v_cvt_pk_bf16_f32 v232, v160, v161
    v_cvt_pk_bf16_f32 v233, v162, v163
    s_add_u32 s51, s60, 64
    s_lshl_b32 s49, s51, 13
    s_add_u32 s50, s49, 4096
    v_mfma_f32_32x32x16_bf16 v[192:207], v[104:107], v[224:227], 0
    v_mfma_f32_32x32x16_bf16 v[192:207], v[108:111], v[228:231], v[192:207]
    v_mfma_f32_32x32x8_bf16 v[192:207], v[136:137], v[232:233], v[192:207]
    v_mfma_f32_32x32x16_bf16 v[208:223], v[112:115], v[224:227], 0
    v_mfma_f32_32x32x16_bf16 v[208:223], v[116:119], v[228:231], v[208:223]
    v_mfma_f32_32x32x8_bf16 v[208:223], v[138:139], v[232:233], v[208:223]
    s_nop 8
    v_cvt_pk_bf16_f32 v152, v192, v193
    v_cvt_pk_bf16_f32 v153, v194, v195
    v_cvt_pk_bf16_f32 v154, v196, v197
    v_cvt_pk_bf16_f32 v155, v198, v199
    v_cvt_pk_bf16_f32 v156, v200, v201
    v_cvt_pk_bf16_f32 v157, v202, v203
    v_cvt_pk_bf16_f32 v158, v204, v205
    v_cvt_pk_bf16_f32 v159, v206, v207
    buffer_store_dwordx4 v[152:155], v244, s[32:35], s49 offen offset:0 sc1
    buffer_store_dwordx4 v[156:159], v244, s[32:35], s49 offen offset:1024 sc1
    v_mfma_f32_32x32x16_bf16 v[192:207], v[120:123], v[224:227], 0
    v_mfma_f32_32x32x16_bf16 v[192:207], v[124:127], v[228:231], v[192:207]
    v_mfma_f32_32x32x8_bf16 v[192:207], v[140:141], v[232:233], v[192:207]
    v_cvt_pk_bf16_f32 v144, v208, v209
    v_cvt_pk_bf16_f32 v145, v210, v211
    v_cvt_pk_bf16_f32 v146, v212, v213
    v_cvt_pk_bf16_f32 v147, v214, v215
    v_cvt_pk_bf16_f32 v148, v216, v217
    v_cvt_pk_bf16_f32 v149, v218, v219
    v_cvt_pk_bf16_f32 v150, v220, v221
    v_cvt_pk_bf16_f32 v151, v222, v223
    buffer_store_dwordx4 v[144:147], v244, s[32:35], s49 offen offset:2048 sc1
    buffer_store_dwordx4 v[148:151], v244, s[32:35], s49 offen offset:3072 sc1
    v_mfma_f32_32x32x16_bf16 v[208:223], v[128:131], v[224:227], 0
    v_mfma_f32_32x32x16_bf16 v[208:223], v[132:135], v[228:231], v[208:223]
    v_mfma_f32_32x32x8_bf16 v[208:223], v[142:143], v[232:233], v[208:223]
    v_cvt_pk_bf16_f32 v152, v192, v193
    v_cvt_pk_bf16_f32 v153, v194, v195
    v_cvt_pk_bf16_f32 v154, v196, v197
    v_cvt_pk_bf16_f32 v155, v198, v199
    v_cvt_pk_bf16_f32 v156, v200, v201
    v_cvt_pk_bf16_f32 v157, v202, v203
    v_cvt_pk_bf16_f32 v158, v204, v205
    v_cvt_pk_bf16_f32 v159, v206, v207
    buffer_store_dwordx4 v[152:155], v244, s[32:35], s50 offen offset:0 sc1
    buffer_store_dwordx4 v[156:159], v244, s[32:35], s50 offen offset:1024 sc1
    s_nop 1
    v_cvt_pk_bf16_f32 v144, v208, v209
    v_cvt_pk_bf16_f32 v145, v210, v211
    v_cvt_pk_bf16_f32 v146, v212, v213
    v_cvt_pk_bf16_f32 v147, v214, v215
    v_cvt_pk_bf16_f32 v148, v216, v217
    v_cvt_pk_bf16_f32 v149, v218, v219
    v_cvt_pk_bf16_f32 v150, v220, v221
    v_cvt_pk_bf16_f32 v151, v222, v223
    buffer_store_dwordx4 v[144:147], v244, s[32:35], s50 offen offset:2048 sc1
    buffer_store_dwordx4 v[148:151], v244, s[32:35], s50 offen offset:3072 sc1
    s_waitcnt vmcnt(8)
    v_mfma_f32_32x32x16_bf16 v[144:159], a[32:35], a[0:3], v[176:191]
    v_mfma_f32_32x32x16_bf16 v[144:159], a[36:39], a[4:7], v[144:159]
    v_mfma_f32_32x32x16_bf16 v[144:159], a[40:43], a[8:11], v[144:159]
    v_mfma_f32_32x32x16_bf16 v[144:159], a[44:47], a[12:15], v[144:159]
    v_mfma_f32_32x32x16_bf16 v[144:159], a[48:51], a[16:19], v[144:159]
    v_mfma_f32_32x32x16_bf16 v[144:159], a[52:55], a[20:23], v[144:159]
    v_mfma_f32_32x32x16_bf16 v[144:159], a[56:59], a[24:27], v[144:159]
    v_mfma_f32_32x32x16_bf16 v[144:159], a[60:63], a[28:31], v[144:159]
    v_mfma_f32_32x32x16_bf16 v[160:175], a[64:67], a[0:3], 0
    v_mfma_f32_32x32x16_bf16 v[160:175], a[68:71], a[4:7], v[160:175]
    v_mfma_f32_32x32x16_bf16 v[160:175], a[72:75], a[8:11], v[160:175]
    v_mfma_f32_32x32x16_bf16 v[160:175], a[76:79], a[12:15], v[160:175]
    v_mfma_f32_32x32x16_bf16 v[160:175], a[80:83], a[16:19], v[160:175]
    v_mfma_f32_32x32x16_bf16 v[160:175], a[84:87], a[20:23], v[160:175]
    v_mfma_f32_32x32x16_bf16 v[160:175], a[88:91], a[24:27], v[160:175]
    v_mfma_f32_32x32x16_bf16 v[160:175], a[92:95], a[28:31], v[160:175]
    s_nop 11
    s_cmp_eq_u32 s69, 0
    s_cbranch_scc1 et_193
    s_mov_b32 s75, 1
    s_cmp_lg_u32 s44, 0
    s_cbranch_scc1 et_193
    s_lshl_b32 s76, s46, 7
    s_add_u32 s76, s76, 0x6402000
    v_mov_b32 v4, s76
    v_mov_b32 v7, 1
    s_mov_b64 exec, 1
    buffer_atomic_add v7, v4, s[32:35], 0 offen sc0 sc1
    s_mov_b64 exec, -1
et_193:
    v_max3_f32 v239, v144, v145, v146
    v_max3_f32 v240, v147, v148, v149
    v_max3_f32 v239, v239, v150, v151
    v_max3_f32 v240, v240, v152, v153
    v_max3_f32 v239, v239, v154, v155
    v_max3_f32 v240, v240, v156, v157
    v_max3_f32 v239, v239, v158, v159
    v_max3_f32 v240, v240, v160, v161
    v_max3_f32 v239, v239, v162, v163
    v_max_f32 v239, v239, v240
    v_mov_b32 v240, v239
    s_nop 1
    v_permlane32_swap_b32 v239, v240
    v_max_f32 v239, v239, v240
    v_mul_f32 v239, s52, v239
    v_fma_f32 v144, v144, s52, -v239
    v_fma_f32 v145, v145, s52, -v239
    v_fma_f32 v146, v146, s52, -v239
    v_fma_f32 v147, v147, s52, -v239
    v_fma_f32 v148, v148, s52, -v239
    v_fma_f32 v149, v149, s52, -v239
    v_fma_f32 v150, v150, s52, -v239
    v_fma_f32 v151, v151, s52, -v239
    v_fma_f32 v152, v152, s52, -v239
    v_fma_f32 v153, v153, s52, -v239
    v_fma_f32 v154, v154, s52, -v239
    v_fma_f32 v155, v155, s52, -v239
    v_fma_f32 v156, v156, s52, -v239
    v_fma_f32 v157, v157, s52, -v239
    v_fma_f32 v158, v158, s52, -v239
    v_fma_f32 v159, v159, s52, -v239
    v_fma_f32 v160, v160, s52, -v239
    v_fma_f32 v161, v161, s52, -v239
    v_fma_f32 v162, v162, s52, -v239
    v_fma_f32 v163, v163, s52, -v239
    v_exp_f32 v144, v144
    v_exp_f32 v145, v145
    v_exp_f32 v146, v146
    v_exp_f32 v147, v147
    v_exp_f32 v148, v148
    v_exp_f32 v149, v149
    v_exp_f32 v150, v150
    v_exp_f32 v151, v151
    v_exp_f32 v152, v152
    v_exp_f32 v153, v153
    v_exp_f32 v154, v154
    v_exp_f32 v155, v155
    v_exp_f32 v156, v156
    v_exp_f32 v157, v157
    v_exp_f32 v158, v158
    v_exp_f32 v159, v159
    v_exp_f32 v160, v160
    v_exp_f32 v161, v161
    v_exp_f32 v162, v162
    v_exp_f32 v163, v163
    v_add_f32 v239, v144, v145
    v_add_f32 v240, v146, v147
    v_add_f32 v239, v239, v148
    v_add_f32 v240, v240, v149
    v_add_f32 v239, v239, v150
    v_add_f32 v240, v240, v151
    v_add_f32 v239, v239, v152
    v_add_f32 v240, v240, v153
    v_add_f32 v239, v239, v154
    v_add_f32 v240, v240, v155
    v_add_f32 v239, v239, v156
    v_add_f32 v240, v240, v157
    v_add_f32 v239, v239, v158
    v_add_f32 v240, v240, v159
    v_add_f32 v239, v239, v160
    v_add_f32 v240, v240, v161
    v_add_f32 v239, v239, v162
    v_add_f32 v240, v240, v163
    v_add_f32 v239, v239, v240
    v_mov_b32 v240, v239
    s_nop 1
    v_permlane32_swap_b32 v239, v240
    v_add_f32 v239, v239, v240
    v_rcp_f32 v239, v239
    s_nop 0
    v_mul_f32 v144, v144, v239
    v_mul_f32 v145, v145, v239
    v_mul_f32 v146, v146, v239
    v_mul_f32 v147, v147, v239
    v_mul_f32 v148, v148, v239
    v_mul_f32 v149, v149, v239
    v_mul_f32 v150, v150, v239
    v_mul_f32 v151, v151, v239
    v_mul_f32 v152, v152, v239
    v_mul_f32 v153, v153, v239
    v_mul_f32 v154, v154, v239
    v_mul_f32 v155, v155, v239
    v_mul_f32 v156, v156, v239
    v_mul_f32 v157, v157, v239
    v_mul_f32 v158, v158, v239
    v_mul_f32 v159, v159, v239
    v_mul_f32 v160, v160, v239
    v_mul_f32 v161, v161, v239
    v_mul_f32 v162, v162, v239
    v_mul_f32 v163, v163, v239
    v_cvt_pk_bf16_f32 v224, v144, v145
    v_cvt_pk_bf16_f32 v225, v146, v147
    v_cvt_pk_bf16_f32 v226, v148, v149
    v_cvt_pk_bf16_f32 v227, v150, v151
    v_cvt_pk_bf16_f32 v228, v152, v153
    v_cvt_pk_bf16_f32 v229, v154, v155
    v_cvt_pk_bf16_f32 v230, v156, v157
    v_cvt_pk_bf16_f32 v231, v158, v159
    v_cvt_pk_bf16_f32 v232, v160, v161
    v_cvt_pk_bf16_f32 v233, v162, v163
    s_add_u32 s51, s60, 96
    s_lshl_b32 s49, s51, 13
    s_add_u32 s50, s49, 4096
    v_mfma_f32_32x32x16_bf16 v[192:207], a[96:99], v[224:227], 0
    v_mfma_f32_32x32x16_bf16 v[192:207], a[100:103], v[228:231], v[192:207]
    v_mfma_f32_32x32x8_bf16 v[192:207], a[128:129], v[232:233], v[192:207]
    v_mfma_f32_32x32x16_bf16 v[208:223], a[104:107], v[224:227], 0
    v_mfma_f32_32x32x16_bf16 v[208:223], a[108:111], v[228:231], v[208:223]
    v_mfma_f32_32x32x8_bf16 v[208:223], a[130:131], v[232:233], v[208:223]
    s_nop 8
    v_cvt_pk_bf16_f32 v152, v192, v193
    v_cvt_pk_bf16_f32 v153, v194, v195
    v_cvt_pk_bf16_f32 v154, v196, v197
    v_cvt_pk_bf16_f32 v155, v198, v199
    v_cvt_pk_bf16_f32 v156, v200, v201
    v_cvt_pk_bf16_f32 v157, v202, v203
    v_cvt_pk_bf16_f32 v158, v204, v205
    v_cvt_pk_bf16_f32 v159, v206, v207
    buffer_store_dwordx4 v[152:155], v244, s[32:35], s49 offen offset:0 sc1
    buffer_store_dwordx4 v[156:159], v244, s[32:35], s49 offen offset:1024 sc1
    v_mfma_f32_32x32x16_bf16 v[192:207], a[112:115], v[224:227], 0
    v_mfma_f32_32x32x16_bf16 v[192:207], a[116:119], v[228:231], v[192:207]
    v_mfma_f32_32x32x8_bf16 v[192:207], a[132:133], v[232:233], v[192:207]
    v_cvt_pk_bf16_f32 v144, v208, v209
    v_cvt_pk_bf16_f32 v145, v210, v211
    v_cvt_pk_bf16_f32 v146, v212, v213
    v_cvt_pk_bf16_f32 v147, v214, v215
    v_cvt_pk_bf16_f32 v148, v216, v217
    v_cvt_pk_bf16_f32 v149, v218, v219
    v_cvt_pk_bf16_f32 v150, v220, v221
    v_cvt_pk_bf16_f32 v151, v222, v223
    buffer_store_dwordx4 v[144:147], v244, s[32:35], s49 offen offset:2048 sc1
    buffer_store_dwordx4 v[148:151], v244, s[32:35], s49 offen offset:3072 sc1
    v_mfma_f32_32x32x16_bf16 v[208:223], a[120:123], v[224:227], 0
    v_mfma_f32_32x32x16_bf16 v[208:223], a[124:127], v[228:231], v[208:223]
    v_mfma_f32_32x32x8_bf16 v[208:223], a[134:135], v[232:233], v[208:223]
    v_cvt_pk_bf16_f32 v152, v192, v193
    v_cvt_pk_bf16_f32 v153, v194, v195
    v_cvt_pk_bf16_f32 v154, v196, v197
    v_cvt_pk_bf16_f32 v155, v198, v199
    v_cvt_pk_bf16_f32 v156, v200, v201
    v_cvt_pk_bf16_f32 v157, v202, v203
    v_cvt_pk_bf16_f32 v158, v204, v205
    v_cvt_pk_bf16_f32 v159, v206, v207
    buffer_store_dwordx4 v[152:155], v244, s[32:35], s50 offen offset:0 sc1
    buffer_store_dwordx4 v[156:159], v244, s[32:35], s50 offen offset:1024 sc1
    s_nop 1
    v_cvt_pk_bf16_f32 v144, v208, v209
    v_cvt_pk_bf16_f32 v145, v210, v211
    v_cvt_pk_bf16_f32 v146, v212, v213
    v_cvt_pk_bf16_f32 v147, v214, v215
    v_cvt_pk_bf16_f32 v148, v216, v217
    v_cvt_pk_bf16_f32 v149, v218, v219
    v_cvt_pk_bf16_f32 v150, v220, v221
    v_cvt_pk_bf16_f32 v151, v222, v223
    buffer_store_dwordx4 v[144:147], v244, s[32:35], s50 offen offset:2048 sc1
    buffer_store_dwordx4 v[148:151], v244, s[32:35], s50 offen offset:3072 sc1
    s_branch mega_kernel_wdone
jobaattn1_156:
    s_lshr_b32 s58, s62, 2
    s_lshl_b32 s56, s58, 2
    s_lshl_b32 s60, s62, 1
    s_lshr_b32 s49, s47, 1
    s_add_u32 s60, s60, s49
    s_add_u32 s54, s60, 3
    s_mov_b32 s53, 40
    s_cmp_gt_u32 s60, 60
    s_cselect_b32 s54, 32, s54
    s_cselect_b32 s53, 44, s53
    s_add_u32 s49, s56, 80
    s_add_u32 s50, s56, 176
    s_cmp_lg_u32 s44, 0
    s_cbranch_scc1 dd_195
    s_lshl_b32 s76, s49, 7
    s_lshl_b32 s77, s50, 7
    s_mov_b32 s52, 0
dw_194:
    buffer_load_dword v4, v6, s[32:35], s76 offen sc1
    buffer_load_dword v5, v6, s[32:35], s77 offen sc1
    s_add_u32 s52, s52, 1
    s_waitcnt vmcnt(0)
    v_cmp_gt_u32 vcc, 32, v4
    s_nop 0
    s_cbranch_vccnz dn_196
    v_cmp_gt_u32 vcc, 4, v5
    s_nop 0
    s_cbranch_vccz dd_195
dn_196:
    s_sleep 12
    s_cmp_lt_u32 s52, 200000
    s_cbranch_scc1 dw_194
dd_195:
    s_barrier
    s_add_u32 s56, s56, 208
    s_and_b32 s49, s60, 7
    s_lshl_b32 s49, s49, 2
    s_lshl_b32 s57, 1, s49
    s_lshl_b32 s60, s60, 5
    s_lshl_b32 s49, s45, 3
    s_add_u32 s60, s60, s49
    s_and_b32 s49, s47, 1
    s_lshl_b32 s49, s49, 2
    s_add_u32 s60, s60, s49
    s_add_u32 s60, s60, s44
    s_mov_b32 s48, 0
    s_lshl_b32 s49, s60, 13
    s_add_u32 s50, s49, 4096
    v_add_u32 v179, 0x1000000, v2
    v_add_u32 v180, 0x2000000, v2
    buffer_load_dwordx4 v[8:11], v2, s[32:35], s49 offen offset:0 sc1
    buffer_load_dwordx4 v[40:43], v179, s[32:35], s49 offen offset:0 sc1
    buffer_load_dwordx4 v[12:15], v2, s[32:35], s49 offen offset:1024 sc1
    buffer_load_dwordx4 v[44:47], v179, s[32:35], s49 offen offset:1024 sc1
    buffer_load_dwordx4 v[16:19], v2, s[32:35], s49 offen offset:2048 sc1
    buffer_load_dwordx4 v[48:51], v179, s[32:35], s49 offen offset:2048 sc1
    buffer_load_dwordx4 v[20:23], v2, s[32:35], s49 offen offset:3072 sc1
    buffer_load_dwordx4 v[52:55], v179, s[32:35], s49 offen offset:3072 sc1
    buffer_load_dwordx4 v[24:27], v2, s[32:35], s50 offen offset:0 sc1
    buffer_load_dwordx4 v[56:59], v179, s[32:35], s50 offen offset:0 sc1
    buffer_load_dwordx4 v[28:31], v2, s[32:35], s50 offen offset:1024 sc1
    buffer_load_dwordx4 v[60:63], v179, s[32:35], s50 offen offset:1024 sc1
    buffer_load_dwordx4 v[32:35], v2, s[32:35], s50 offen offset:2048 sc1
    buffer_load_dwordx4 v[64:67], v179, s[32:35], s50 offen offset:2048 sc1
    buffer_load_dwordx4 v[36:39], v2, s[32:35], s50 offen offset:3072 sc1
    buffer_load_dwordx4 v[68:71], v179, s[32:35], s50 offen offset:3072 sc1
    buffer_load_dwordx4 v[104:107], v180, s[32:35], s49 offen offset:0 sc1
    buffer_load_dwordx4 v[108:111], v180, s[32:35], s49 offen offset:1024 sc1
    buffer_load_dwordx4 v[112:115], v180, s[32:35], s49 offen offset:2048 sc1
    buffer_load_dwordx4 v[116:119], v180, s[32:35], s49 offen offset:3072 sc1
    buffer_load_dwordx4 v[120:123], v180, s[32:35], s50 offen offset:0 sc1
    buffer_load_dwordx4 v[124:127], v180, s[32:35], s50 offen offset:1024 sc1
    buffer_load_dwordx4 v[128:131], v180, s[32:35], s50 offen offset:2048 sc1
    buffer_load_dwordx4 v[132:135], v180, s[32:35], s50 offen offset:3072 sc1
    v_and_b32 v176, 7, v1
    v_lshlrev_b32 v176, 4, v176
    v_lshrrev_b32 v177, 5, v1
    v_lshl_add_u32 v176, v177, 8, v176
    v_and_b32 v181, 15, v1
    v_lshlrev_b32 v181, 4, v181
    v_lshl_add_u32 v181, v177, 8, v181
    v_bfe_u32 v178, v1, 4, 1
    v_lshl_add_u32 v181, v178, 3, v181
    v_lshlrev_b32 v177, 2, v177
    v_and_b32 v178, 31, v1
    v_sub_u32 v177, v178, v177
    v_mov_b32 v178, 0xf149f2ca
    v_cmp_le_i32 vcc, 0, v177
    s_nop 1
    v_cndmask_b32 v144, v178, 0, vcc
    v_cmp_le_i32 vcc, 1, v177
    s_nop 1
    v_cndmask_b32 v145, v178, 0, vcc
    v_cmp_le_i32 vcc, 2, v177
    s_nop 1
    v_cndmask_b32 v146, v178, 0, vcc
    v_cmp_le_i32 vcc, 3, v177
    s_nop 1
    v_cndmask_b32 v147, v178, 0, vcc
    v_cmp_le_i32 vcc, 8, v177
    s_nop 1
    v_cndmask_b32 v148, v178, 0, vcc
    v_cmp_le_i32 vcc, 9, v177
    s_nop 1
    v_cndmask_b32 v149, v178, 0, vcc
    v_cmp_le_i32 vcc, 10, v177
    s_nop 1
    v_cndmask_b32 v150, v178, 0, vcc
    v_cmp_le_i32 vcc, 11, v177
    s_nop 1
    v_cndmask_b32 v151, v178, 0, vcc
    v_cmp_le_i32 vcc, 16, v177
    s_nop 1
    v_cndmask_b32 v152, v178, 0, vcc
    v_cmp_le_i32 vcc, 17, v177
    s_nop 1
    v_cndmask_b32 v153, v178, 0, vcc
    v_cmp_le_i32 vcc, 18, v177
    s_nop 1
    v_cndmask_b32 v154, v178, 0, vcc
    v_cmp_le_i32 vcc, 19, v177
    s_nop 1
    v_cndmask_b32 v155, v178, 0, vcc
    v_cmp_le_i32 vcc, 24, v177
    s_nop 1
    v_cndmask_b32 v156, v178, 0, vcc
    v_cmp_le_i32 vcc, 25, v177
    s_nop 1
    v_cndmask_b32 v157, v178, 0, vcc
    v_cmp_le_i32 vcc, 26, v177
    s_nop 1
    v_cndmask_b32 v158, v178, 0, vcc
    v_cmp_le_i32 vcc, 27, v177
    s_nop 1
    v_cndmask_b32 v159, v178, 0, vcc
    s_waitcnt vmcnt(22)
    s_nop 0
    v_mfma_f32_32x32x16_bf16 v[144:159], v[40:43], v[8:11], v[144:159]
    s_waitcnt vmcnt(20)
    v_mfma_f32_32x32x16_bf16 v[144:159], v[44:47], v[12:15], v[144:159]
    s_waitcnt vmcnt(18)
    v_mfma_f32_32x32x16_bf16 v[144:159], v[48:51], v[16:19], v[144:159]
    s_waitcnt vmcnt(16)
    v_mfma_f32_32x32x16_bf16 v[144:159], v[52:55], v[20:23], v[144:159]
    s_waitcnt vmcnt(14)
    v_mfma_f32_32x32x16_bf16 v[144:159], v[56:59], v[24:27], v[144:159]
    s_waitcnt vmcnt(12)
    v_mfma_f32_32x32x16_bf16 v[144:159], v[60:63], v[28:31], v[144:159]
    s_waitcnt vmcnt(10)
    v_mfma_f32_32x32x16_bf16 v[144:159], v[64:67], v[32:35], v[144:159]
    s_waitcnt vmcnt(8)
    v_mfma_f32_32x32x16_bf16 v[144:159], v[68:71], v[36:39], v[144:159]
    s_cmp_lg_u32 s44, 0
    s_cbranch_scc1 dd_198
    s_lshl_b32 s76, s53, 7
    s_mov_b32 s52, 0
dw_197:
    buffer_load_dword v5, v6, s[32:35], s76 offen sc1
    s_add_u32 s52, s52, 1
    s_waitcnt vmcnt(0)
    v_cmp_gt_u32 vcc, s54, v5
    s_nop 0
    s_cbranch_vccz dd_198
    s_sleep 4
    s_cmp_lt_u32 s52, 200000
    s_cbranch_scc1 dw_197
dd_198:
    s_barrier
    s_nop 11
    s_cmp_eq_u32 s69, 0
    s_cbranch_scc1 et_199
    s_mov_b32 s75, 1
    s_cmp_lg_u32 s44, 0
    s_cbranch_scc1 et_199
    s_lshl_b32 s76, s46, 7
    s_add_u32 s76, s76, 0x6402000
    v_mov_b32 v4, s76
    v_mov_b32 v7, 1
    s_mov_b64 exec, 1
    buffer_atomic_add v7, v4, s[32:35], 0 offen sc0 sc1
    s_mov_b64 exec, -1
et_199:
    s_lshl_b32 s51, s60, 12
    s_add_u32 s52, s51, 0x5800000
    s_add_u32 s51, s51, 0x5000000
    buffer_load_dwordx4 v[72:75], v176, s[32:35], s51 offen offset:128 sc1
    buffer_load_dwordx4 v[76:79], v176, s[32:35], s51 offen offset:640 sc1
    buffer_load_dwordx4 v[80:83], v176, s[32:35], s51 offen offset:1152 sc1
    buffer_load_dwordx4 v[84:87], v176, s[32:35], s51 offen offset:1664 sc1
    buffer_load_dwordx4 v[88:91], v176, s[32:35], s51 offen offset:2176 sc1
    buffer_load_dwordx4 v[92:95], v176, s[32:35], s51 offen offset:2688 sc1
    buffer_load_dwordx4 v[96:99], v176, s[32:35], s51 offen offset:3200 sc1
    buffer_load_dwordx4 v[100:103], v176, s[32:35], s51 offen offset:3712 sc1
    buffer_load_dwordx2 v[136:137], v181, s[32:35], s52 offen offset:0 sc1
    buffer_load_dwordx2 v[138:139], v181, s[32:35], s52 offen offset:1024 sc1
    buffer_load_dwordx2 v[140:141], v181, s[32:35], s52 offen offset:2048 sc1
    buffer_load_dwordx2 v[142:143], v181, s[32:35], s52 offen offset:3072 sc1
    s_waitcnt vmcnt(11)
    v_mfma_f32_32x32x16_bf16 v[160:175], v[72:75], v[8:11], 0
    s_waitcnt vmcnt(10)
    v_mfma_f32_32x32x16_bf16 v[160:175], v[76:79], v[12:15], v[160:175]
    s_waitcnt vmcnt(9)
    v_mfma_f32_32x32x16_bf16 v[160:175], v[80:83], v[16:19], v[160:175]
    s_waitcnt vmcnt(8)
    v_mfma_f32_32x32x16_bf16 v[160:175], v[84:87], v[20:23], v[160:175]
    s_waitcnt vmcnt(7)
    v_mfma_f32_32x32x16_bf16 v[160:175], v[88:91], v[24:27], v[160:175]
    s_waitcnt vmcnt(6)
    v_mfma_f32_32x32x16_bf16 v[160:175], v[92:95], v[28:31], v[160:175]
    s_waitcnt vmcnt(5)
    v_mfma_f32_32x32x16_bf16 v[160:175], v[96:99], v[32:35], v[160:175]
    s_waitcnt vmcnt(4)
    v_mfma_f32_32x32x16_bf16 v[160:175], v[100:103], v[36:39], v[160:175]
    v_max3_f32 v179, v144, v145, v146
    v_max3_f32 v180, v147, v148, v149
    v_max3_f32 v179, v179, v150, v151
    v_max3_f32 v180, v180, v152, v153
    v_max3_f32 v179, v179, v154, v155
    v_max3_f32 v180, v180, v156, v157
    v_max3_f32 v179, v179, v158, v159
    s_nop 4
    v_max3_f32 v180, v180, v160, v161
    v_max3_f32 v179, v179, v162, v163
    v_max_f32 v179, v179, v180
    v_mov_b32 v180, v179
    s_nop 1
    v_permlane32_swap_b32 v179, v180
    v_max_f32 v179, v179, v180
    s_mov_b32 s51, 0x3e0293ee
    v_mul_f32 v179, s51, v179
    v_fma_f32 v144, v144, s51, -v179
    v_fma_f32 v145, v145, s51, -v179
    v_fma_f32 v146, v146, s51, -v179
    v_fma_f32 v147, v147, s51, -v179
    v_fma_f32 v148, v148, s51, -v179
    v_fma_f32 v149, v149, s51, -v179
    v_fma_f32 v150, v150, s51, -v179
    v_fma_f32 v151, v151, s51, -v179
    v_fma_f32 v152, v152, s51, -v179
    v_fma_f32 v153, v153, s51, -v179
    v_fma_f32 v154, v154, s51, -v179
    v_fma_f32 v155, v155, s51, -v179
    v_fma_f32 v156, v156, s51, -v179
    v_fma_f32 v157, v157, s51, -v179
    v_fma_f32 v158, v158, s51, -v179
    v_fma_f32 v159, v159, s51, -v179
    v_fma_f32 v160, v160, s51, -v179
    v_fma_f32 v161, v161, s51, -v179
    v_fma_f32 v162, v162, s51, -v179
    v_fma_f32 v163, v163, s51, -v179
    v_exp_f32 v144, v144
    v_exp_f32 v145, v145
    v_exp_f32 v146, v146
    v_exp_f32 v147, v147
    v_exp_f32 v148, v148
    v_exp_f32 v149, v149
    v_exp_f32 v150, v150
    v_exp_f32 v151, v151
    v_exp_f32 v152, v152
    v_exp_f32 v153, v153
    v_exp_f32 v154, v154
    v_exp_f32 v155, v155
    v_exp_f32 v156, v156
    v_exp_f32 v157, v157
    v_exp_f32 v158, v158
    v_exp_f32 v159, v159
    v_exp_f32 v160, v160
    v_exp_f32 v161, v161
    v_exp_f32 v162, v162
    v_exp_f32 v163, v163
    v_add_f32 v179, v144, v145
    v_add_f32 v180, v146, v147
    v_add_f32 v179, v179, v148
    v_add_f32 v180, v180, v149
    v_add_f32 v179, v179, v150
    v_add_f32 v180, v180, v151
    v_add_f32 v179, v179, v152
    v_add_f32 v180, v180, v153
    v_add_f32 v179, v179, v154
    v_add_f32 v180, v180, v155
    v_add_f32 v179, v179, v156
    v_add_f32 v180, v180, v157
    v_add_f32 v179, v179, v158
    v_add_f32 v180, v180, v159
    v_add_f32 v179, v179, v160
    v_add_f32 v180, v180, v161
    v_add_f32 v179, v179, v162
    v_add_f32 v180, v180, v163
    v_add_f32 v179, v179, v180
    v_mov_b32 v180, v179
    s_nop 1
    v_permlane32_swap_b32 v179, v180
    v_add_f32 v179, v179, v180
    v_rcp_f32 v179, v179
    s_nop 0
    v_mul_f32 v144, v144, v179
    v_mul_f32 v145, v145, v179
    v_mul_f32 v146, v146, v179
    v_mul_f32 v147, v147, v179
    v_mul_f32 v148, v148, v179
    v_mul_f32 v149, v149, v179
    v_mul_f32 v150, v150, v179
    v_mul_f32 v151, v151, v179
    v_mul_f32 v152, v152, v179
    v_mul_f32 v153, v153, v179
    v_mul_f32 v154, v154, v179
    v_mul_f32 v155, v155, v179
    v_mul_f32 v156, v156, v179
    v_mul_f32 v157, v157, v179
    v_mul_f32 v158, v158, v179
    v_mul_f32 v159, v159, v179
    v_mul_f32 v160, v160, v179
    v_mul_f32 v161, v161, v179
    v_mul_f32 v162, v162, v179
    v_mul_f32 v163, v163, v179
    v_cvt_pk_bf16_f32 v72, v144, v145
    v_cvt_pk_bf16_f32 v73, v146, v147
    v_cvt_pk_bf16_f32 v74, v148, v149
    v_cvt_pk_bf16_f32 v75, v150, v151
    v_cvt_pk_bf16_f32 v76, v152, v153
    v_cvt_pk_bf16_f32 v77, v154, v155
    v_cvt_pk_bf16_f32 v78, v156, v157
    v_cvt_pk_bf16_f32 v79, v158, v159
    v_cvt_pk_bf16_f32 v80, v160, v161
    v_cvt_pk_bf16_f32 v81, v162, v163
    s_waitcnt vmcnt(0)
    v_mfma_f32_32x32x16_bf16 v[8:23], v[104:107], v[72:75], 0
    v_mfma_f32_32x32x16_bf16 v[8:23], v[108:111], v[76:79], v[8:23]
    v_mfma_f32_32x32x8_bf16 v[8:23], v[136:137], v[80:81], v[8:23]
    v_mfma_f32_32x32x16_bf16 v[24:39], v[112:115], v[72:75], 0
    v_mfma_f32_32x32x16_bf16 v[24:39], v[116:119], v[76:79], v[24:39]
    v_mfma_f32_32x32x8_bf16 v[24:39], v[138:139], v[80:81], v[24:39]
    v_mfma_f32_32x32x16_bf16 v[40:55], v[120:123], v[72:75], 0
    v_mfma_f32_32x32x16_bf16 v[40:55], v[124:127], v[76:79], v[40:55]
    v_mfma_f32_32x32x8_bf16 v[40:55], v[140:141], v[80:81], v[40:55]
    v_mfma_f32_32x32x16_bf16 v[56:71], v[128:131], v[72:75], 0
    v_mfma_f32_32x32x16_bf16 v[56:71], v[132:135], v[76:79], v[56:71]
    v_mfma_f32_32x32x8_bf16 v[56:71], v[142:143], v[80:81], v[56:71]
    v_add_u32 v179, 0x3000000, v2
    s_nop 1
    v_cvt_pk_bf16_f32 v88, v8, v9
    v_cvt_pk_bf16_f32 v89, v10, v11
    v_cvt_pk_bf16_f32 v90, v12, v13
    v_cvt_pk_bf16_f32 v91, v14, v15
    v_cvt_pk_bf16_f32 v92, v16, v17
    v_cvt_pk_bf16_f32 v93, v18, v19
    v_cvt_pk_bf16_f32 v94, v20, v21
    v_cvt_pk_bf16_f32 v95, v22, v23
    buffer_store_dwordx4 v[88:91], v179, s[32:35], s49 offen offset:0 sc1
    buffer_store_dwordx4 v[92:95], v179, s[32:35], s49 offen offset:1024 sc1
    v_cvt_pk_bf16_f32 v96, v24, v25
    v_cvt_pk_bf16_f32 v97, v26, v27
    v_cvt_pk_bf16_f32 v98, v28, v29
    v_cvt_pk_bf16_f32 v99, v30, v31
    v_cvt_pk_bf16_f32 v100, v32, v33
    v_cvt_pk_bf16_f32 v101, v34, v35
    v_cvt_pk_bf16_f32 v102, v36, v37
    v_cvt_pk_bf16_f32 v103, v38, v39
    buffer_store_dwordx4 v[96:99], v179, s[32:35], s49 offen offset:2048 sc1
    buffer_store_dwordx4 v[100:103], v179, s[32:35], s49 offen offset:3072 sc1
    v_cvt_pk_bf16_f32 v88, v40, v41
    v_cvt_pk_bf16_f32 v89, v42, v43
    v_cvt_pk_bf16_f32 v90, v44, v45
    v_cvt_pk_bf16_f32 v91, v46, v47
    v_cvt_pk_bf16_f32 v92, v48, v49
    v_cvt_pk_bf16_f32 v93, v50, v51
    v_cvt_pk_bf16_f32 v94, v52, v53
    v_cvt_pk_bf16_f32 v95, v54, v55
    buffer_store_dwordx4 v[88:91], v179, s[32:35], s50 offen offset:0 sc1
    buffer_store_dwordx4 v[92:95], v179, s[32:35], s50 offen offset:1024 sc1
    v_cvt_pk_bf16_f32 v96, v56, v57
    v_cvt_pk_bf16_f32 v97, v58, v59
    v_cvt_pk_bf16_f32 v98, v60, v61
    v_cvt_pk_bf16_f32 v99, v62, v63
    v_cvt_pk_bf16_f32 v100, v64, v65
    v_cvt_pk_bf16_f32 v101, v66, v67
    v_cvt_pk_bf16_f32 v102, v68, v69
    v_cvt_pk_bf16_f32 v103, v70, v71
    buffer_store_dwordx4 v[96:99], v179, s[32:35], s50 offen offset:2048 sc1
    buffer_store_dwordx4 v[100:103], v179, s[32:35], s50 offen offset:3072 sc1
    s_branch mega_kernel_wdone
jobaoute_158:
    s_cmp_lg_u32 s44, 0
    s_cbranch_scc1 dd_201
    s_lshl_b32 s76, 48, 7
    s_mov_b32 s52, 0
dw_200:
    buffer_load_dword v5, v6, s[32:35], s76 offen sc1
    s_add_u32 s52, s52, 1
    s_waitcnt vmcnt(0)
    v_cmp_gt_u32 vcc, 32, v5
    s_nop 0
    s_cbranch_vccz dd_201
    s_sleep 12
    s_cmp_lt_u32 s52, 200000
    s_cbranch_scc1 dw_200
dd_201:
    s_barrier
    s_lshr_b32 s58, s47, 3
    s_add_u32 s58, s58, s62
    s_lshl_b32 s59, s45, 3
    s_and_b32 s49, s47, 7
    s_add_u32 s59, s59, s49
    s_mov_b32 s57, 0
    s_mov_b32 s48, 0
    s_lshl_b32 s49, s44, 16
    s_lshl_b32 s53, s58, 18
    s_add_u32 s53, s53, s49
    s_add_u32 s53, s53, 0x3000000
    s_lshl_b32 s54, s59, 18
    s_add_u32 s54, s54, s49
    s_add_u32 s54, s54, 0x6800000
    s_mov_b32 s60, 0
    v_lshlrev_b32 v11, 7, v1
    s_add_u32 s61, s54, s60
    s_add_u32 s60, s60, 4096
    s_and_b32 s60, s60, 0xffff
    buffer_load_dwordx4 a[0:3], v2, s[32:35], s61 offen offset:0 sc1
    buffer_load_dwordx4 a[4:7], v2, s[32:35], s61 offen offset:1024 sc1
    buffer_load_dwordx4 a[8:11], v2, s[32:35], s61 offen offset:2048 sc1
    buffer_load_dwordx4 a[12:15], v2, s[32:35], s61 offen offset:3072 sc1
    s_add_u32 s61, s54, s60
    s_add_u32 s60, s60, 4096
    s_and_b32 s60, s60, 0xffff
    buffer_load_dwordx4 a[16:19], v2, s[32:35], s61 offen offset:0 sc1
    buffer_load_dwordx4 a[20:23], v2, s[32:35], s61 offen offset:1024 sc1
    buffer_load_dwordx4 a[24:27], v2, s[32:35], s61 offen offset:2048 sc1
    buffer_load_dwordx4 a[28:31], v2, s[32:35], s61 offen offset:3072 sc1
    s_add_u32 s61, s54, s60
    s_add_u32 s60, s60, 4096
    s_and_b32 s60, s60, 0xffff
    buffer_load_dwordx4 a[32:35], v2, s[32:35], s61 offen offset:0 sc1
    buffer_load_dwordx4 a[36:39], v2, s[32:35], s61 offen offset:1024 sc1
    buffer_load_dwordx4 a[40:43], v2, s[32:35], s61 offen offset:2048 sc1
    buffer_load_dwordx4 a[44:47], v2, s[32:35], s61 offen offset:3072 sc1
    s_add_u32 s61, s54, s60
    s_add_u32 s60, s60, 4096
    s_and_b32 s60, s60, 0xffff
    buffer_load_dwordx4 a[48:51], v2, s[32:35], s61 offen offset:0 sc1
    buffer_load_dwordx4 a[52:55], v2, s[32:35], s61 offen offset:1024 sc1
    buffer_load_dwordx4 a[56:59], v2, s[32:35], s61 offen offset:2048 sc1
    buffer_load_dwordx4 a[60:63], v2, s[32:35], s61 offen offset:3072 sc1
    s_add_u32 s61, s54, s60
    s_add_u32 s60, s60, 4096
    s_and_b32 s60, s60, 0xffff
    buffer_load_dwordx4 a[64:67], v2, s[32:35], s61 offen offset:0 sc1
    buffer_load_dwordx4 a[68:71], v2, s[32:35], s61 offen offset:1024 sc1
    buffer_load_dwordx4 a[72:75], v2, s[32:35], s61 offen offset:2048 sc1
    buffer_load_dwordx4 a[76:79], v2, s[32:35], s61 offen offset:3072 sc1
    s_add_u32 s61, s54, s60
    s_add_u32 s60, s60, 4096
    s_and_b32 s60, s60, 0xffff
    buffer_load_dwordx4 a[80:83], v2, s[32:35], s61 offen offset:0 sc1
    buffer_load_dwordx4 a[84:87], v2, s[32:35], s61 offen offset:1024 sc1
    buffer_load_dwordx4 a[88:91], v2, s[32:35], s61 offen offset:2048 sc1
    buffer_load_dwordx4 a[92:95], v2, s[32:35], s61 offen offset:3072 sc1
    s_add_u32 s61, s54, s60
    s_add_u32 s60, s60, 4096
    s_and_b32 s60, s60, 0xffff
    buffer_load_dwordx4 a[96:99], v2, s[32:35], s61 offen offset:0 sc1
    buffer_load_dwordx4 a[100:103], v2, s[32:35], s61 offen offset:1024 sc1
    buffer_load_dwordx4 a[104:107], v2, s[32:35], s61 offen offset:2048 sc1
    buffer_load_dwordx4 a[108:111], v2, s[32:35], s61 offen offset:3072 sc1
    s_add_u32 s61, s54, s60
    s_add_u32 s60, s60, 4096
    s_and_b32 s60, s60, 0xffff
    buffer_load_dwordx4 a[112:115], v2, s[32:35], s61 offen offset:0 sc1
    buffer_load_dwordx4 a[116:119], v2, s[32:35], s61 offen offset:1024 sc1
    buffer_load_dwordx4 a[120:123], v2, s[32:35], s61 offen offset:2048 sc1
    buffer_load_dwordx4 a[124:127], v2, s[32:35], s61 offen offset:3072 sc1
    s_add_u32 s61, s54, s60
    s_add_u32 s60, s60, 4096
    s_and_b32 s60, s60, 0xffff
    buffer_load_dwordx4 a[128:131], v2, s[32:35], s61 offen offset:0 sc1
    buffer_load_dwordx4 a[132:135], v2, s[32:35], s61 offen offset:1024 sc1
    buffer_load_dwordx4 a[136:139], v2, s[32:35], s61 offen offset:2048 sc1
    buffer_load_dwordx4 a[140:143], v2, s[32:35], s61 offen offset:3072 sc1
    s_add_u32 s61, s54, s60
    s_add_u32 s60, s60, 4096
    s_and_b32 s60, s60, 0xffff
    buffer_load_dwordx4 a[144:147], v2, s[32:35], s61 offen offset:0 sc1
    buffer_load_dwordx4 a[148:151], v2, s[32:35], s61 offen offset:1024 sc1
    buffer_load_dwordx4 a[152:155], v2, s[32:35], s61 offen offset:2048 sc1
    buffer_load_dwordx4 a[156:159], v2, s[32:35], s61 offen offset:3072 sc1
    s_add_u32 s61, s54, s60
    s_add_u32 s60, s60, 4096
    s_and_b32 s60, s60, 0xffff
    buffer_load_dwordx4 a[160:163], v2, s[32:35], s61 offen offset:0 sc1
    buffer_load_dwordx4 a[164:167], v2, s[32:35], s61 offen offset:1024 sc1
    buffer_load_dwordx4 a[168:171], v2, s[32:35], s61 offen offset:2048 sc1
    buffer_load_dwordx4 a[172:175], v2, s[32:35], s61 offen offset:3072 sc1
    s_add_u32 s61, s54, s60
    s_add_u32 s60, s60, 4096
    s_and_b32 s60, s60, 0xffff
    buffer_load_dwordx4 a[176:179], v2, s[32:35], s61 offen offset:0 sc1
    buffer_load_dwordx4 a[180:183], v2, s[32:35], s61 offen offset:1024 sc1
    buffer_load_dwordx4 a[184:187], v2, s[32:35], s61 offen offset:2048 sc1
    buffer_load_dwordx4 a[188:191], v2, s[32:35], s61 offen offset:3072 sc1
    s_add_u32 s61, s54, s60
    s_add_u32 s60, s60, 4096
    s_and_b32 s60, s60, 0xffff
    buffer_load_dwordx4 a[192:195], v2, s[32:35], s61 offen offset:0 sc1
    buffer_load_dwordx4 a[196:199], v2, s[32:35], s61 offen offset:1024 sc1
    buffer_load_dwordx4 a[200:203], v2, s[32:35], s61 offen offset:2048 sc1
    buffer_load_dwordx4 a[204:207], v2, s[32:35], s61 offen offset:3072 sc1
    s_add_u32 s61, s54, s60
    s_add_u32 s60, s60, 4096
    s_and_b32 s60, s60, 0xffff
    buffer_load_dwordx4 a[208:211], v2, s[32:35], s61 offen offset:0 sc1
    buffer_load_dwordx4 a[212:215], v2, s[32:35], s61 offen offset:1024 sc1
    buffer_load_dwordx4 a[216:219], v2, s[32:35], s61 offen offset:2048 sc1
    buffer_load_dwordx4 a[220:223], v2, s[32:35], s61 offen offset:3072 sc1
    s_add_u32 s61, s54, s60
    s_add_u32 s60, s60, 4096
    s_and_b32 s60, s60, 0xffff
    buffer_load_dwordx4 a[224:227], v2, s[32:35], s61 offen offset:0 sc1
    buffer_load_dwordx4 a[228:231], v2, s[32:35], s61 offen offset:1024 sc1
    buffer_load_dwordx4 a[232:235], v2, s[32:35], s61 offen offset:2048 sc1
    buffer_load_dwordx4 a[236:239], v2, s[32:35], s61 offen offset:3072 sc1
    s_add_u32 s61, s54, s60
    s_add_u32 s60, s60, 4096
    s_and_b32 s60, s60, 0xffff
    buffer_load_dwordx4 a[240:243], v2, s[32:35], s61 offen offset:0 sc1
    buffer_load_dwordx4 a[244:247], v2, s[32:35], s61 offen offset:1024 sc1
    buffer_load_dwordx4 a[248:251], v2, s[32:35], s61 offen offset:2048 sc1
    buffer_load_dwordx4 a[252:255], v2, s[32:35], s61 offen offset:3072 sc1
    v_and_b32 v9, 31, v1
    v_lshlrev_b32 v9, 12, v9
    v_lshrrev_b32 v8, 5, v1
    v_lshl_add_u32 v9, v8, 3, v9
    s_waitcnt vmcnt(0)
    s_lshr_b32 s49, s58, 3
    s_lshl_b32 s49, s49, 2
    s_add_u32 s49, s49, 208
    s_and_b32 s50, s58, 7
    s_lshl_b32 s50, s50, 2
    s_cmp_lg_u32 s44, 0
    s_cbranch_scc1 dd_203
    s_lshl_b32 s76, s49, 7
    s_mov_b32 s52, 0
dw_202:
    buffer_load_dword v5, v6, s[32:35], s76 offen sc1
    s_add_u32 s52, s52, 1
    s_waitcnt vmcnt(0)
    v_bfe_u32 v5, v5, s50, 4
    v_cmp_gt_u32 vcc, 2, v5
    s_nop 0
    s_cbranch_vccz dd_203
    s_sleep 4
    s_cmp_lt_u32 s52, 200000
    s_cbranch_scc1 dw_202
dd_203:
    s_barrier
    s_nop 11
    s_cmp_eq_u32 s69, 0
    s_cbranch_scc1 et_204
    s_mov_b32 s75, 1
    s_cmp_lg_u32 s44, 0
    s_cbranch_scc1 et_204
    s_lshl_b32 s76, s46, 7
    s_add_u32 s76, s76, 0x6402000
    v_mov_b32 v4, s76
    v_mov_b32 v7, 1
    s_mov_b64 exec, 1
    buffer_atomic_add v7, v4, s[32:35], 0 offen sc0 sc1
    s_mov_b64 exec, -1
et_204:
    s_add_u32 s61, s53, s60
    s_add_u32 s60, s60, 4096
    s_and_b32 s60, s60, 0xffff
    buffer_load_dwordx4 v[28:31], v2, s[32:35], s61 offen offset:0 sc1
    buffer_load_dwordx4 v[32:35], v2, s[32:35], s61 offen offset:1024 sc1
    buffer_load_dwordx4 v[36:39], v2, s[32:35], s61 offen offset:2048 sc1
    buffer_load_dwordx4 v[40:43], v2, s[32:35], s61 offen offset:3072 sc1
    s_add_u32 s61, s53, s60
    s_add_u32 s60, s60, 4096
    s_and_b32 s60, s60, 0xffff
    buffer_load_dwordx4 v[44:47], v2, s[32:35], s61 offen offset:0 sc1
    buffer_load_dwordx4 v[48:51], v2, s[32:35], s61 offen offset:1024 sc1
    buffer_load_dwordx4 v[52:55], v2, s[32:35], s61 offen offset:2048 sc1
    buffer_load_dwordx4 v[56:59], v2, s[32:35], s61 offen offset:3072 sc1
    s_add_u32 s61, s53, s60
    s_add_u32 s60, s60, 4096
    s_and_b32 s60, s60, 0xffff
    buffer_load_dwordx4 v[60:63], v2, s[32:35], s61 offen offset:0 sc1
    buffer_load_dwordx4 v[64:67], v2, s[32:35], s61 offen offset:1024 sc1
    buffer_load_dwordx4 v[68:71], v2, s[32:35], s61 offen offset:2048 sc1
    buffer_load_dwordx4 v[72:75], v2, s[32:35], s61 offen offset:3072 sc1
    s_add_u32 s61, s53, s60
    s_add_u32 s60, s60, 4096
    s_and_b32 s60, s60, 0xffff
    buffer_load_dwordx4 v[76:79], v2, s[32:35], s61 offen offset:0 sc1
    buffer_load_dwordx4 v[80:83], v2, s[32:35], s61 offen offset:1024 sc1
    buffer_load_dwordx4 v[84:87], v2, s[32:35], s61 offen offset:2048 sc1
    buffer_load_dwordx4 v[88:91], v2, s[32:35], s61 offen offset:3072 sc1
    s_add_u32 s61, s53, s60
    s_add_u32 s60, s60, 4096
    s_and_b32 s60, s60, 0xffff
    buffer_load_dwordx4 v[92:95], v2, s[32:35], s61 offen offset:0 sc1
    buffer_load_dwordx4 v[96:99], v2, s[32:35], s61 offen offset:1024 sc1
    buffer_load_dwordx4 v[100:103], v2, s[32:35], s61 offen offset:2048 sc1
    buffer_load_dwordx4 v[104:107], v2, s[32:35], s61 offen offset:3072 sc1
    s_add_u32 s61, s53, s60
    s_add_u32 s60, s60, 4096
    s_and_b32 s60, s60, 0xffff
    buffer_load_dwordx4 v[108:111], v2, s[32:35], s61 offen offset:0 sc1
    buffer_load_dwordx4 v[112:115], v2, s[32:35], s61 offen offset:1024 sc1
    buffer_load_dwordx4 v[116:119], v2, s[32:35], s61 offen offset:2048 sc1
    buffer_load_dwordx4 v[120:123], v2, s[32:35], s61 offen offset:3072 sc1
    s_add_u32 s61, s53, s60
    s_add_u32 s60, s60, 4096
    s_and_b32 s60, s60, 0xffff
    buffer_load_dwordx4 v[124:127], v2, s[32:35], s61 offen offset:0 sc1
    buffer_load_dwordx4 v[128:131], v2, s[32:35], s61 offen offset:1024 sc1
    buffer_load_dwordx4 v[132:135], v2, s[32:35], s61 offen offset:2048 sc1
    buffer_load_dwordx4 v[136:139], v2, s[32:35], s61 offen offset:3072 sc1
    s_add_u32 s61, s53, s60
    s_add_u32 s60, s60, 4096
    s_and_b32 s60, s60, 0xffff
    buffer_load_dwordx4 v[140:143], v2, s[32:35], s61 offen offset:0 sc1
    buffer_load_dwordx4 v[144:147], v2, s[32:35], s61 offen offset:1024 sc1
    buffer_load_dwordx4 v[148:151], v2, s[32:35], s61 offen offset:2048 sc1
    buffer_load_dwordx4 v[152:155], v2, s[32:35], s61 offen offset:3072 sc1
    s_add_u32 s61, s53, s60
    s_add_u32 s60, s60, 4096
    s_and_b32 s60, s60, 0xffff
    buffer_load_dwordx4 v[156:159], v2, s[32:35], s61 offen offset:0 sc1
    buffer_load_dwordx4 v[160:163], v2, s[32:35], s61 offen offset:1024 sc1
    buffer_load_dwordx4 v[164:167], v2, s[32:35], s61 offen offset:2048 sc1
    buffer_load_dwordx4 v[168:171], v2, s[32:35], s61 offen offset:3072 sc1
    s_add_u32 s61, s53, s60
    s_add_u32 s60, s60, 4096
    s_and_b32 s60, s60, 0xffff
    buffer_load_dwordx4 v[172:175], v2, s[32:35], s61 offen offset:0 sc1
    buffer_load_dwordx4 v[176:179], v2, s[32:35], s61 offen offset:1024 sc1
    buffer_load_dwordx4 v[180:183], v2, s[32:35], s61 offen offset:2048 sc1
    buffer_load_dwordx4 v[184:187], v2, s[32:35], s61 offen offset:3072 sc1
    s_add_u32 s61, s53, s60
    s_add_u32 s60, s60, 4096
    s_and_b32 s60, s60, 0xffff
    buffer_load_dwordx4 v[188:191], v2, s[32:35], s61 offen offset:0 sc1
    buffer_load_dwordx4 v[192:195], v2, s[32:35], s61 offen offset:1024 sc1
    buffer_load_dwordx4 v[196:199], v2, s[32:35], s61 offen offset:2048 sc1
    buffer_load_dwordx4 v[200:203], v2, s[32:35], s61 offen offset:3072 sc1
    s_add_u32 s61, s53, s60
    s_add_u32 s60, s60, 4096
    s_and_b32 s60, s60, 0xffff
    buffer_load_dwordx4 v[204:207], v2, s[32:35], s61 offen offset:0 sc1
    buffer_load_dwordx4 v[208:211], v2, s[32:35], s61 offen offset:1024 sc1
    buffer_load_dwordx4 v[212:215], v2, s[32:35], s61 offen offset:2048 sc1
    buffer_load_dwordx4 v[216:219], v2, s[32:35], s61 offen offset:3072 sc1
    s_add_u32 s61, s53, s60
    s_add_u32 s60, s60, 4096
    s_and_b32 s60, s60, 0xffff
    buffer_load_dwordx4 v[220:223], v2, s[32:35], s61 offen offset:0 sc1
    buffer_load_dwordx4 v[224:227], v2, s[32:35], s61 offen offset:1024 sc1
    buffer_load_dwordx4 v[228:231], v2, s[32:35], s61 offen offset:2048 sc1
    buffer_load_dwordx4 v[232:235], v2, s[32:35], s61 offen offset:3072 sc1
    s_add_u32 s61, s53, s60
    s_add_u32 s60, s60, 4096
    s_and_b32 s60, s60, 0xffff
    buffer_load_dwordx4 v[236:239], v2, s[32:35], s61 offen offset:0 sc1
    buffer_load_dwordx4 v[240:243], v2, s[32:35], s61 offen offset:1024 sc1
    s_waitcnt vmcnt(53)
    v_mfma_f32_32x32x16_bf16 v[12:27], a[0:3], v[28:31], 0
    buffer_load_dwordx4 v[28:31], v2, s[32:35], s61 offen offset:2048 sc1
    s_waitcnt vmcnt(53)
    v_mfma_f32_32x32x16_bf16 v[12:27], a[4:7], v[32:35], v[12:27]
    buffer_load_dwordx4 v[32:35], v2, s[32:35], s61 offen offset:3072 sc1
    s_waitcnt vmcnt(53)
    v_mfma_f32_32x32x16_bf16 v[12:27], a[8:11], v[36:39], v[12:27]
    s_add_u32 s61, s53, s60
    s_add_u32 s60, s60, 4096
    s_and_b32 s60, s60, 0xffff
    buffer_load_dwordx4 v[36:39], v2, s[32:35], s61 offen offset:0 sc1
    s_waitcnt vmcnt(53)
    v_mfma_f32_32x32x16_bf16 v[12:27], a[12:15], v[40:43], v[12:27]
    buffer_load_dwordx4 v[40:43], v2, s[32:35], s61 offen offset:1024 sc1
    s_waitcnt vmcnt(53)
    v_mfma_f32_32x32x16_bf16 v[12:27], a[16:19], v[44:47], v[12:27]
    buffer_load_dwordx4 v[44:47], v2, s[32:35], s61 offen offset:2048 sc1
    s_waitcnt vmcnt(53)
    v_mfma_f32_32x32x16_bf16 v[12:27], a[20:23], v[48:51], v[12:27]
    buffer_load_dwordx4 v[48:51], v2, s[32:35], s61 offen offset:3072 sc1
    s_waitcnt vmcnt(53)
    v_mfma_f32_32x32x16_bf16 v[12:27], a[24:27], v[52:55], v[12:27]
    s_add_u32 s61, s53, s60
    s_add_u32 s60, s60, 4096
    s_and_b32 s60, s60, 0xffff
    buffer_load_dwordx4 v[52:55], v2, s[32:35], s61 offen offset:0 sc1
    s_waitcnt vmcnt(53)
    v_mfma_f32_32x32x16_bf16 v[12:27], a[28:31], v[56:59], v[12:27]
    buffer_load_dwordx4 v[56:59], v2, s[32:35], s61 offen offset:1024 sc1
    s_waitcnt vmcnt(53)
    v_mfma_f32_32x32x16_bf16 v[12:27], a[32:35], v[60:63], v[12:27]
    buffer_load_dwordx4 v[60:63], v2, s[32:35], s61 offen offset:2048 sc1
    s_waitcnt vmcnt(53)
    v_mfma_f32_32x32x16_bf16 v[12:27], a[36:39], v[64:67], v[12:27]
    buffer_load_dwordx4 v[64:67], v2, s[32:35], s61 offen offset:3072 sc1
    s_waitcnt vmcnt(53)
    v_mfma_f32_32x32x16_bf16 v[12:27], a[40:43], v[68:71], v[12:27]
    s_waitcnt vmcnt(52)
    v_mfma_f32_32x32x16_bf16 v[12:27], a[44:47], v[72:75], v[12:27]
    s_waitcnt vmcnt(51)
    v_mfma_f32_32x32x16_bf16 v[12:27], a[48:51], v[76:79], v[12:27]
    s_waitcnt vmcnt(50)
    v_mfma_f32_32x32x16_bf16 v[12:27], a[52:55], v[80:83], v[12:27]
    s_waitcnt vmcnt(49)
    v_mfma_f32_32x32x16_bf16 v[12:27], a[56:59], v[84:87], v[12:27]
    s_waitcnt vmcnt(48)
    v_mfma_f32_32x32x16_bf16 v[12:27], a[60:63], v[88:91], v[12:27]
    s_waitcnt vmcnt(47)
    v_mfma_f32_32x32x16_bf16 v[12:27], a[64:67], v[92:95], v[12:27]
    s_waitcnt vmcnt(46)
    v_mfma_f32_32x32x16_bf16 v[12:27], a[68:71], v[96:99], v[12:27]
    s_waitcnt vmcnt(45)
    v_mfma_f32_32x32x16_bf16 v[12:27], a[72:75], v[100:103], v[12:27]
    s_waitcnt vmcnt(44)
    v_mfma_f32_32x32x16_bf16 v[12:27], a[76:79], v[104:107], v[12:27]
    s_waitcnt vmcnt(43)
    v_mfma_f32_32x32x16_bf16 v[12:27], a[80:83], v[108:111], v[12:27]
    s_waitcnt vmcnt(42)
    v_mfma_f32_32x32x16_bf16 v[12:27], a[84:87], v[112:115], v[12:27]
    s_waitcnt vmcnt(41)
    v_mfma_f32_32x32x16_bf16 v[12:27], a[88:91], v[116:119], v[12:27]
    s_waitcnt vmcnt(40)
    v_mfma_f32_32x32x16_bf16 v[12:27], a[92:95], v[120:123], v[12:27]
    s_waitcnt vmcnt(39)
    v_mfma_f32_32x32x16_bf16 v[12:27], a[96:99], v[124:127], v[12:27]
    s_waitcnt vmcnt(38)
    v_mfma_f32_32x32x16_bf16 v[12:27], a[100:103], v[128:131], v[12:27]
    s_waitcnt vmcnt(37)
    v_mfma_f32_32x32x16_bf16 v[12:27], a[104:107], v[132:135], v[12:27]
    s_waitcnt vmcnt(36)
    v_mfma_f32_32x32x16_bf16 v[12:27], a[108:111], v[136:139], v[12:27]
    s_waitcnt vmcnt(35)
    v_mfma_f32_32x32x16_bf16 v[12:27], a[112:115], v[140:143], v[12:27]
    s_waitcnt vmcnt(34)
    v_mfma_f32_32x32x16_bf16 v[12:27], a[116:119], v[144:147], v[12:27]
    s_waitcnt vmcnt(33)
    v_mfma_f32_32x32x16_bf16 v[12:27], a[120:123], v[148:151], v[12:27]
    s_waitcnt vmcnt(32)
    v_mfma_f32_32x32x16_bf16 v[12:27], a[124:127], v[152:155], v[12:27]
    s_waitcnt vmcnt(31)
    v_mfma_f32_32x32x16_bf16 v[12:27], a[128:131], v[156:159], v[12:27]
    s_waitcnt vmcnt(30)
    v_mfma_f32_32x32x16_bf16 v[12:27], a[132:135], v[160:163], v[12:27]
    s_waitcnt vmcnt(29)
    v_mfma_f32_32x32x16_bf16 v[12:27], a[136:139], v[164:167], v[12:27]
    s_waitcnt vmcnt(28)
    v_mfma_f32_32x32x16_bf16 v[12:27], a[140:143], v[168:171], v[12:27]
    s_waitcnt vmcnt(27)
    v_mfma_f32_32x32x16_bf16 v[12:27], a[144:147], v[172:175], v[12:27]
    s_waitcnt vmcnt(26)
    v_mfma_f32_32x32x16_bf16 v[12:27], a[148:151], v[176:179], v[12:27]
    s_waitcnt vmcnt(25)
    v_mfma_f32_32x32x16_bf16 v[12:27], a[152:155], v[180:183], v[12:27]
    s_waitcnt vmcnt(24)
    v_mfma_f32_32x32x16_bf16 v[12:27], a[156:159], v[184:187], v[12:27]
    s_waitcnt vmcnt(23)
    v_mfma_f32_32x32x16_bf16 v[12:27], a[160:163], v[188:191], v[12:27]
    s_waitcnt vmcnt(22)
    v_mfma_f32_32x32x16_bf16 v[12:27], a[164:167], v[192:195], v[12:27]
    s_waitcnt vmcnt(21)
    v_mfma_f32_32x32x16_bf16 v[12:27], a[168:171], v[196:199], v[12:27]
    s_waitcnt vmcnt(20)
    v_mfma_f32_32x32x16_bf16 v[12:27], a[172:175], v[200:203], v[12:27]
    s_waitcnt vmcnt(19)
    v_mfma_f32_32x32x16_bf16 v[12:27], a[176:179], v[204:207], v[12:27]
    s_waitcnt vmcnt(18)
    v_mfma_f32_32x32x16_bf16 v[12:27], a[180:183], v[208:211], v[12:27]
    s_waitcnt vmcnt(17)
    v_mfma_f32_32x32x16_bf16 v[12:27], a[184:187], v[212:215], v[12:27]
    s_waitcnt vmcnt(16)
    v_mfma_f32_32x32x16_bf16 v[12:27], a[188:191], v[216:219], v[12:27]
    s_waitcnt vmcnt(15)
    v_mfma_f32_32x32x16_bf16 v[12:27], a[192:195], v[220:223], v[12:27]
    s_waitcnt vmcnt(14)
    v_mfma_f32_32x32x16_bf16 v[12:27], a[196:199], v[224:227], v[12:27]
    s_waitcnt vmcnt(13)
    v_mfma_f32_32x32x16_bf16 v[12:27], a[200:203], v[228:231], v[12:27]
    s_waitcnt vmcnt(12)
    v_mfma_f32_32x32x16_bf16 v[12:27], a[204:207], v[232:235], v[12:27]
    s_waitcnt vmcnt(11)
    v_mfma_f32_32x32x16_bf16 v[12:27], a[208:211], v[236:239], v[12:27]
    s_waitcnt vmcnt(10)
    v_mfma_f32_32x32x16_bf16 v[12:27], a[212:215], v[240:243], v[12:27]
    s_waitcnt vmcnt(9)
    v_mfma_f32_32x32x16_bf16 v[12:27], a[216:219], v[28:31], v[12:27]
    s_waitcnt vmcnt(8)
    v_mfma_f32_32x32x16_bf16 v[12:27], a[220:223], v[32:35], v[12:27]
    s_waitcnt vmcnt(7)
    v_mfma_f32_32x32x16_bf16 v[12:27], a[224:227], v[36:39], v[12:27]
    s_waitcnt vmcnt(6)
    v_mfma_f32_32x32x16_bf16 v[12:27], a[228:231], v[40:43], v[12:27]
    s_waitcnt vmcnt(5)
    v_mfma_f32_32x32x16_bf16 v[12:27], a[232:235], v[44:47], v[12:27]
    s_waitcnt vmcnt(4)
    v_mfma_f32_32x32x16_bf16 v[12:27], a[236:239], v[48:51], v[12:27]
    s_waitcnt vmcnt(3)
    v_mfma_f32_32x32x16_bf16 v[12:27], a[240:243], v[52:55], v[12:27]
    s_waitcnt vmcnt(2)
    v_mfma_f32_32x32x16_bf16 v[12:27], a[244:247], v[56:59], v[12:27]
    s_waitcnt vmcnt(1)
    v_mfma_f32_32x32x16_bf16 v[12:27], a[248:251], v[60:63], v[12:27]
    s_waitcnt vmcnt(0)
    v_mfma_f32_32x32x16_bf16 v[12:27], a[252:255], v[64:67], v[12:27]
    s_lshl_b32 s49, s44, 12
    v_add_u32 v8, s49, v2
    s_nop 9
    ds_write_b128 v8, v[12:15] offset:0
    ds_write_b128 v8, v[16:19] offset:1024
    ds_write_b128 v8, v[20:23] offset:2048
    ds_write_b128 v8, v[24:27] offset:3072
    s_lshl_b32 s49, s44, 10
    v_add_u32 v8, s49, v2
    s_waitcnt lgkmcnt(0)
    s_barrier
    ds_read_b128 v[28:31], v8 offset:0
    ds_read_b128 v[32:35], v8 offset:4096
    ds_read_b128 v[36:39], v8 offset:8192
    ds_read_b128 v[40:43], v8 offset:12288
    s_lshl_b32 s49, s58, 17
    s_lshl_b32 s53, s59, 6
    s_add_u32 s49, s49, s53
    s_lshl_b32 s53, s44, 4
    s_add_u32 s49, s49, s53
    s_waitcnt lgkmcnt(0)
    v_pk_add_f32 v[28:29], v[28:29], v[32:33]
    v_pk_add_f32 v[36:37], v[36:37], v[40:41]
    v_pk_add_f32 v[30:31], v[30:31], v[34:35]
    v_pk_add_f32 v[38:39], v[38:39], v[42:43]
    v_pk_add_f32 v[28:29], v[28:29], v[36:37]
    v_pk_add_f32 v[30:31], v[30:31], v[38:39]
    v_cvt_pk_bf16_f32 v44, v28, v29
    v_cvt_pk_bf16_f32 v45, v30, v31
    buffer_store_dwordx2 v[44:45], v9, s[40:43], s49 offen
    s_branch mega_kernel_wdone
jobaoutd_157:
    s_lshr_b32 s49, s62, 2
    s_lshl_b32 s49, s49, 2
    s_add_u32 s49, s49, 208
    s_and_b32 s50, s62, 3
    s_lshl_b32 s50, s50, 3
    s_cmp_lg_u32 s44, 0
    s_cbranch_scc1 dd_206
    s_lshl_b32 s76, 48, 7
    s_lshl_b32 s77, s49, 7
    s_mov_b32 s52, 0
dw_205:
    buffer_load_dword v4, v6, s[32:35], s76 offen sc1
    buffer_load_dword v5, v6, s[32:35], s77 offen sc1
    s_add_u32 s52, s52, 1
    s_waitcnt vmcnt(0)
    v_bfe_u32 v5, v5, s50, 8
    v_cmp_gt_u32 vcc, 32, v4
    s_nop 0
    s_cbranch_vccnz dn_207
    v_cmp_gt_u32 vcc, 0x22, v5
    s_nop 0
    s_cbranch_vccz dd_206
dn_207:
    s_sleep 12
    s_cmp_lt_u32 s52, 200000
    s_cbranch_scc1 dw_205
dd_206:
    s_barrier
    s_lshl_b32 s58, s62, 1
    s_lshl_b32 s59, s45, 3
    s_add_u32 s59, s59, s47
    s_mov_b32 s57, 0
    s_mov_b32 s48, 0
    s_lshl_b32 s49, s44, 16
    s_lshl_b32 s53, s58, 18
    s_add_u32 s53, s53, s49
    s_add_u32 s53, s53, 0x3000000
    s_add_u32 s54, s53, 262144
    s_lshl_b32 s60, s59, 18
    s_add_u32 s60, s60, s49
    s_add_u32 s60, s60, 0x6800000
    s_mov_b32 s50, 0
    v_add_u32 v9, s50, v2
    s_add_u32 s50, s50, 4096
    s_and_b32 s50, s50, 0xffff
    buffer_load_dwordx4 v[44:47], v9, s[32:35], s60 offen offset:0 sc1
    buffer_load_dwordx4 v[48:51], v9, s[32:35], s53 offen offset:0 sc1
    buffer_load_dwordx4 v[52:55], v9, s[32:35], s54 offen offset:0 sc1
    buffer_load_dwordx4 v[56:59], v9, s[32:35], s60 offen offset:1024 sc1
    buffer_load_dwordx4 v[60:63], v9, s[32:35], s53 offen offset:1024 sc1
    buffer_load_dwordx4 v[64:67], v9, s[32:35], s54 offen offset:1024 sc1
    buffer_load_dwordx4 v[68:71], v9, s[32:35], s60 offen offset:2048 sc1
    buffer_load_dwordx4 v[72:75], v9, s[32:35], s53 offen offset:2048 sc1
    buffer_load_dwordx4 v[76:79], v9, s[32:35], s54 offen offset:2048 sc1
    buffer_load_dwordx4 v[80:83], v9, s[32:35], s60 offen offset:3072 sc1
    buffer_load_dwordx4 v[84:87], v9, s[32:35], s53 offen offset:3072 sc1
    buffer_load_dwordx4 v[88:91], v9, s[32:35], s54 offen offset:3072 sc1
    v_add_u32 v9, s50, v2
    s_add_u32 s50, s50, 4096
    s_and_b32 s50, s50, 0xffff
    buffer_load_dwordx4 v[92:95], v9, s[32:35], s60 offen offset:0 sc1
    buffer_load_dwordx4 v[96:99], v9, s[32:35], s53 offen offset:0 sc1
    buffer_load_dwordx4 v[100:103], v9, s[32:35], s54 offen offset:0 sc1
    buffer_load_dwordx4 v[104:107], v9, s[32:35], s60 offen offset:1024 sc1
    buffer_load_dwordx4 v[108:111], v9, s[32:35], s53 offen offset:1024 sc1
    buffer_load_dwordx4 v[112:115], v9, s[32:35], s54 offen offset:1024 sc1
    buffer_load_dwordx4 v[116:119], v9, s[32:35], s60 offen offset:2048 sc1
    buffer_load_dwordx4 v[120:123], v9, s[32:35], s53 offen offset:2048 sc1
    buffer_load_dwordx4 v[124:127], v9, s[32:35], s54 offen offset:2048 sc1
    buffer_load_dwordx4 v[128:131], v9, s[32:35], s60 offen offset:3072 sc1
    buffer_load_dwordx4 v[132:135], v9, s[32:35], s53 offen offset:3072 sc1
    buffer_load_dwordx4 v[136:139], v9, s[32:35], s54 offen offset:3072 sc1
    v_add_u32 v9, s50, v2
    s_add_u32 s50, s50, 4096
    s_and_b32 s50, s50, 0xffff
    buffer_load_dwordx4 v[140:143], v9, s[32:35], s60 offen offset:0 sc1
    buffer_load_dwordx4 v[144:147], v9, s[32:35], s53 offen offset:0 sc1
    buffer_load_dwordx4 v[148:151], v9, s[32:35], s54 offen offset:0 sc1
    buffer_load_dwordx4 v[152:155], v9, s[32:35], s60 offen offset:1024 sc1
    buffer_load_dwordx4 v[156:159], v9, s[32:35], s53 offen offset:1024 sc1
    buffer_load_dwordx4 v[160:163], v9, s[32:35], s54 offen offset:1024 sc1
    buffer_load_dwordx4 v[164:167], v9, s[32:35], s60 offen offset:2048 sc1
    buffer_load_dwordx4 v[168:171], v9, s[32:35], s53 offen offset:2048 sc1
    buffer_load_dwordx4 v[172:175], v9, s[32:35], s54 offen offset:2048 sc1
    buffer_load_dwordx4 v[176:179], v9, s[32:35], s60 offen offset:3072 sc1
    buffer_load_dwordx4 v[180:183], v9, s[32:35], s53 offen offset:3072 sc1
    buffer_load_dwordx4 v[184:187], v9, s[32:35], s54 offen offset:3072 sc1
    v_add_u32 v9, s50, v2
    s_add_u32 s50, s50, 4096
    s_and_b32 s50, s50, 0xffff
    buffer_load_dwordx4 v[188:191], v9, s[32:35], s60 offen offset:0 sc1
    buffer_load_dwordx4 v[192:195], v9, s[32:35], s53 offen offset:0 sc1
    buffer_load_dwordx4 v[196:199], v9, s[32:35], s54 offen offset:0 sc1
    buffer_load_dwordx4 v[200:203], v9, s[32:35], s60 offen offset:1024 sc1
    buffer_load_dwordx4 v[204:207], v9, s[32:35], s53 offen offset:1024 sc1
    buffer_load_dwordx4 v[208:211], v9, s[32:35], s54 offen offset:1024 sc1
    buffer_load_dwordx4 v[212:215], v9, s[32:35], s60 offen offset:2048 sc1
    buffer_load_dwordx4 v[216:219], v9, s[32:35], s53 offen offset:2048 sc1
    buffer_load_dwordx4 v[220:223], v9, s[32:35], s54 offen offset:2048 sc1
    buffer_load_dwordx4 v[224:227], v9, s[32:35], s60 offen offset:3072 sc1
    buffer_load_dwordx4 v[228:231], v9, s[32:35], s53 offen offset:3072 sc1
    buffer_load_dwordx4 v[232:235], v9, s[32:35], s54 offen offset:3072 sc1
    s_waitcnt vmcnt(36)
    v_mfma_f32_32x32x16_bf16 v[12:27], v[44:47], v[48:51], 0
    v_mfma_f32_32x32x16_bf16 v[28:43], v[44:47], v[52:55], 0
    v_mfma_f32_32x32x16_bf16 v[12:27], v[56:59], v[60:63], v[12:27]
    v_mfma_f32_32x32x16_bf16 v[28:43], v[56:59], v[64:67], v[28:43]
    v_mfma_f32_32x32x16_bf16 v[12:27], v[68:71], v[72:75], v[12:27]
    v_mfma_f32_32x32x16_bf16 v[28:43], v[68:71], v[76:79], v[28:43]
    v_mfma_f32_32x32x16_bf16 v[12:27], v[80:83], v[84:87], v[12:27]
    v_mfma_f32_32x32x16_bf16 v[28:43], v[80:83], v[88:91], v[28:43]
    v_add_u32 v9, s50, v2
    s_add_u32 s50, s50, 4096
    s_and_b32 s50, s50, 0xffff
    buffer_load_dwordx4 v[44:47], v9, s[32:35], s60 offen offset:0 sc1
    buffer_load_dwordx4 v[48:51], v9, s[32:35], s53 offen offset:0 sc1
    buffer_load_dwordx4 v[52:55], v9, s[32:35], s54 offen offset:0 sc1
    buffer_load_dwordx4 v[56:59], v9, s[32:35], s60 offen offset:1024 sc1
    buffer_load_dwordx4 v[60:63], v9, s[32:35], s53 offen offset:1024 sc1
    buffer_load_dwordx4 v[64:67], v9, s[32:35], s54 offen offset:1024 sc1
    buffer_load_dwordx4 v[68:71], v9, s[32:35], s60 offen offset:2048 sc1
    buffer_load_dwordx4 v[72:75], v9, s[32:35], s53 offen offset:2048 sc1
    buffer_load_dwordx4 v[76:79], v9, s[32:35], s54 offen offset:2048 sc1
    buffer_load_dwordx4 v[80:83], v9, s[32:35], s60 offen offset:3072 sc1
    buffer_load_dwordx4 v[84:87], v9, s[32:35], s53 offen offset:3072 sc1
    buffer_load_dwordx4 v[88:91], v9, s[32:35], s54 offen offset:3072 sc1
    s_waitcnt vmcnt(36)
    v_mfma_f32_32x32x16_bf16 v[12:27], v[92:95], v[96:99], v[12:27]
    v_mfma_f32_32x32x16_bf16 v[28:43], v[92:95], v[100:103], v[28:43]
    v_mfma_f32_32x32x16_bf16 v[12:27], v[104:107], v[108:111], v[12:27]
    v_mfma_f32_32x32x16_bf16 v[28:43], v[104:107], v[112:115], v[28:43]
    v_mfma_f32_32x32x16_bf16 v[12:27], v[116:119], v[120:123], v[12:27]
    v_mfma_f32_32x32x16_bf16 v[28:43], v[116:119], v[124:127], v[28:43]
    v_mfma_f32_32x32x16_bf16 v[12:27], v[128:131], v[132:135], v[12:27]
    v_mfma_f32_32x32x16_bf16 v[28:43], v[128:131], v[136:139], v[28:43]
    v_add_u32 v9, s50, v2
    s_add_u32 s50, s50, 4096
    s_and_b32 s50, s50, 0xffff
    buffer_load_dwordx4 v[92:95], v9, s[32:35], s60 offen offset:0 sc1
    buffer_load_dwordx4 v[96:99], v9, s[32:35], s53 offen offset:0 sc1
    buffer_load_dwordx4 v[100:103], v9, s[32:35], s54 offen offset:0 sc1
    buffer_load_dwordx4 v[104:107], v9, s[32:35], s60 offen offset:1024 sc1
    buffer_load_dwordx4 v[108:111], v9, s[32:35], s53 offen offset:1024 sc1
    buffer_load_dwordx4 v[112:115], v9, s[32:35], s54 offen offset:1024 sc1
    buffer_load_dwordx4 v[116:119], v9, s[32:35], s60 offen offset:2048 sc1
    buffer_load_dwordx4 v[120:123], v9, s[32:35], s53 offen offset:2048 sc1
    buffer_load_dwordx4 v[124:127], v9, s[32:35], s54 offen offset:2048 sc1
    buffer_load_dwordx4 v[128:131], v9, s[32:35], s60 offen offset:3072 sc1
    buffer_load_dwordx4 v[132:135], v9, s[32:35], s53 offen offset:3072 sc1
    buffer_load_dwordx4 v[136:139], v9, s[32:35], s54 offen offset:3072 sc1
    s_waitcnt vmcnt(36)
    v_mfma_f32_32x32x16_bf16 v[12:27], v[140:143], v[144:147], v[12:27]
    v_mfma_f32_32x32x16_bf16 v[28:43], v[140:143], v[148:151], v[28:43]
    v_mfma_f32_32x32x16_bf16 v[12:27], v[152:155], v[156:159], v[12:27]
    v_mfma_f32_32x32x16_bf16 v[28:43], v[152:155], v[160:163], v[28:43]
    v_mfma_f32_32x32x16_bf16 v[12:27], v[164:167], v[168:171], v[12:27]
    v_mfma_f32_32x32x16_bf16 v[28:43], v[164:167], v[172:175], v[28:43]
    v_mfma_f32_32x32x16_bf16 v[12:27], v[176:179], v[180:183], v[12:27]
    v_mfma_f32_32x32x16_bf16 v[28:43], v[176:179], v[184:187], v[28:43]
    v_add_u32 v9, s50, v2
    s_add_u32 s50, s50, 4096
    s_and_b32 s50, s50, 0xffff
    buffer_load_dwordx4 v[140:143], v9, s[32:35], s60 offen offset:0 sc1
    buffer_load_dwordx4 v[144:147], v9, s[32:35], s53 offen offset:0 sc1
    buffer_load_dwordx4 v[148:151], v9, s[32:35], s54 offen offset:0 sc1
    buffer_load_dwordx4 v[152:155], v9, s[32:35], s60 offen offset:1024 sc1
    buffer_load_dwordx4 v[156:159], v9, s[32:35], s53 offen offset:1024 sc1
    buffer_load_dwordx4 v[160:163], v9, s[32:35], s54 offen offset:1024 sc1
    buffer_load_dwordx4 v[164:167], v9, s[32:35], s60 offen offset:2048 sc1
    buffer_load_dwordx4 v[168:171], v9, s[32:35], s53 offen offset:2048 sc1
    buffer_load_dwordx4 v[172:175], v9, s[32:35], s54 offen offset:2048 sc1
    buffer_load_dwordx4 v[176:179], v9, s[32:35], s60 offen offset:3072 sc1
    buffer_load_dwordx4 v[180:183], v9, s[32:35], s53 offen offset:3072 sc1
    buffer_load_dwordx4 v[184:187], v9, s[32:35], s54 offen offset:3072 sc1
    s_waitcnt vmcnt(36)
    v_mfma_f32_32x32x16_bf16 v[12:27], v[188:191], v[192:195], v[12:27]
    v_mfma_f32_32x32x16_bf16 v[28:43], v[188:191], v[196:199], v[28:43]
    v_mfma_f32_32x32x16_bf16 v[12:27], v[200:203], v[204:207], v[12:27]
    v_mfma_f32_32x32x16_bf16 v[28:43], v[200:203], v[208:211], v[28:43]
    v_mfma_f32_32x32x16_bf16 v[12:27], v[212:215], v[216:219], v[12:27]
    v_mfma_f32_32x32x16_bf16 v[28:43], v[212:215], v[220:223], v[28:43]
    v_mfma_f32_32x32x16_bf16 v[12:27], v[224:227], v[228:231], v[12:27]
    v_mfma_f32_32x32x16_bf16 v[28:43], v[224:227], v[232:235], v[28:43]
    v_add_u32 v9, s50, v2
    s_add_u32 s50, s50, 4096
    s_and_b32 s50, s50, 0xffff
    buffer_load_dwordx4 v[188:191], v9, s[32:35], s60 offen offset:0 sc1
    buffer_load_dwordx4 v[192:195], v9, s[32:35], s53 offen offset:0 sc1
    buffer_load_dwordx4 v[196:199], v9, s[32:35], s54 offen offset:0 sc1
    buffer_load_dwordx4 v[200:203], v9, s[32:35], s60 offen offset:1024 sc1
    buffer_load_dwordx4 v[204:207], v9, s[32:35], s53 offen offset:1024 sc1
    buffer_load_dwordx4 v[208:211], v9, s[32:35], s54 offen offset:1024 sc1
    buffer_load_dwordx4 v[212:215], v9, s[32:35], s60 offen offset:2048 sc1
    buffer_load_dwordx4 v[216:219], v9, s[32:35], s53 offen offset:2048 sc1
    buffer_load_dwordx4 v[220:223], v9, s[32:35], s54 offen offset:2048 sc1
    buffer_load_dwordx4 v[224:227], v9, s[32:35], s60 offen offset:3072 sc1
    buffer_load_dwordx4 v[228:231], v9, s[32:35], s53 offen offset:3072 sc1
    buffer_load_dwordx4 v[232:235], v9, s[32:35], s54 offen offset:3072 sc1
    s_waitcnt vmcnt(36)
    v_mfma_f32_32x32x16_bf16 v[12:27], v[44:47], v[48:51], v[12:27]
    v_mfma_f32_32x32x16_bf16 v[28:43], v[44:47], v[52:55], v[28:43]
    v_mfma_f32_32x32x16_bf16 v[12:27], v[56:59], v[60:63], v[12:27]
    v_mfma_f32_32x32x16_bf16 v[28:43], v[56:59], v[64:67], v[28:43]
    v_mfma_f32_32x32x16_bf16 v[12:27], v[68:71], v[72:75], v[12:27]
    v_mfma_f32_32x32x16_bf16 v[28:43], v[68:71], v[76:79], v[28:43]
    v_mfma_f32_32x32x16_bf16 v[12:27], v[80:83], v[84:87], v[12:27]
    v_mfma_f32_32x32x16_bf16 v[28:43], v[80:83], v[88:91], v[28:43]
    v_add_u32 v9, s50, v2
    s_add_u32 s50, s50, 4096
    s_and_b32 s50, s50, 0xffff
    buffer_load_dwordx4 v[44:47], v9, s[32:35], s60 offen offset:0 sc1
    buffer_load_dwordx4 v[48:51], v9, s[32:35], s53 offen offset:0 sc1
    buffer_load_dwordx4 v[52:55], v9, s[32:35], s54 offen offset:0 sc1
    buffer_load_dwordx4 v[56:59], v9, s[32:35], s60 offen offset:1024 sc1
    buffer_load_dwordx4 v[60:63], v9, s[32:35], s53 offen offset:1024 sc1
    buffer_load_dwordx4 v[64:67], v9, s[32:35], s54 offen offset:1024 sc1
    buffer_load_dwordx4 v[68:71], v9, s[32:35], s60 offen offset:2048 sc1
    buffer_load_dwordx4 v[72:75], v9, s[32:35], s53 offen offset:2048 sc1
    buffer_load_dwordx4 v[76:79], v9, s[32:35], s54 offen offset:2048 sc1
    buffer_load_dwordx4 v[80:83], v9, s[32:35], s60 offen offset:3072 sc1
    buffer_load_dwordx4 v[84:87], v9, s[32:35], s53 offen offset:3072 sc1
    buffer_load_dwordx4 v[88:91], v9, s[32:35], s54 offen offset:3072 sc1
    s_waitcnt vmcnt(36)
    v_mfma_f32_32x32x16_bf16 v[12:27], v[92:95], v[96:99], v[12:27]
    v_mfma_f32_32x32x16_bf16 v[28:43], v[92:95], v[100:103], v[28:43]
    v_mfma_f32_32x32x16_bf16 v[12:27], v[104:107], v[108:111], v[12:27]
    v_mfma_f32_32x32x16_bf16 v[28:43], v[104:107], v[112:115], v[28:43]
    v_mfma_f32_32x32x16_bf16 v[12:27], v[116:119], v[120:123], v[12:27]
    v_mfma_f32_32x32x16_bf16 v[28:43], v[116:119], v[124:127], v[28:43]
    v_mfma_f32_32x32x16_bf16 v[12:27], v[128:131], v[132:135], v[12:27]
    v_mfma_f32_32x32x16_bf16 v[28:43], v[128:131], v[136:139], v[28:43]
    v_add_u32 v9, s50, v2
    s_add_u32 s50, s50, 4096
    s_and_b32 s50, s50, 0xffff
    buffer_load_dwordx4 v[92:95], v9, s[32:35], s60 offen offset:0 sc1
    buffer_load_dwordx4 v[96:99], v9, s[32:35], s53 offen offset:0 sc1
    buffer_load_dwordx4 v[100:103], v9, s[32:35], s54 offen offset:0 sc1
    buffer_load_dwordx4 v[104:107], v9, s[32:35], s60 offen offset:1024 sc1
    buffer_load_dwordx4 v[108:111], v9, s[32:35], s53 offen offset:1024 sc1
    buffer_load_dwordx4 v[112:115], v9, s[32:35], s54 offen offset:1024 sc1
    buffer_load_dwordx4 v[116:119], v9, s[32:35], s60 offen offset:2048 sc1
    buffer_load_dwordx4 v[120:123], v9, s[32:35], s53 offen offset:2048 sc1
    buffer_load_dwordx4 v[124:127], v9, s[32:35], s54 offen offset:2048 sc1
    buffer_load_dwordx4 v[128:131], v9, s[32:35], s60 offen offset:3072 sc1
    buffer_load_dwordx4 v[132:135], v9, s[32:35], s53 offen offset:3072 sc1
    buffer_load_dwordx4 v[136:139], v9, s[32:35], s54 offen offset:3072 sc1
    s_waitcnt vmcnt(36)
    v_mfma_f32_32x32x16_bf16 v[12:27], v[140:143], v[144:147], v[12:27]
    v_mfma_f32_32x32x16_bf16 v[28:43], v[140:143], v[148:151], v[28:43]
    v_mfma_f32_32x32x16_bf16 v[12:27], v[152:155], v[156:159], v[12:27]
    v_mfma_f32_32x32x16_bf16 v[28:43], v[152:155], v[160:163], v[28:43]
    v_mfma_f32_32x32x16_bf16 v[12:27], v[164:167], v[168:171], v[12:27]
    v_mfma_f32_32x32x16_bf16 v[28:43], v[164:167], v[172:175], v[28:43]
    v_mfma_f32_32x32x16_bf16 v[12:27], v[176:179], v[180:183], v[12:27]
    v_mfma_f32_32x32x16_bf16 v[28:43], v[176:179], v[184:187], v[28:43]
    v_add_u32 v9, s50, v2
    s_add_u32 s50, s50, 4096
    s_and_b32 s50, s50, 0xffff
    buffer_load_dwordx4 v[140:143], v9, s[32:35], s60 offen offset:0 sc1
    buffer_load_dwordx4 v[144:147], v9, s[32:35], s53 offen offset:0 sc1
    buffer_load_dwordx4 v[148:151], v9, s[32:35], s54 offen offset:0 sc1
    buffer_load_dwordx4 v[152:155], v9, s[32:35], s60 offen offset:1024 sc1
    buffer_load_dwordx4 v[156:159], v9, s[32:35], s53 offen offset:1024 sc1
    buffer_load_dwordx4 v[160:163], v9, s[32:35], s54 offen offset:1024 sc1
    buffer_load_dwordx4 v[164:167], v9, s[32:35], s60 offen offset:2048 sc1
    buffer_load_dwordx4 v[168:171], v9, s[32:35], s53 offen offset:2048 sc1
    buffer_load_dwordx4 v[172:175], v9, s[32:35], s54 offen offset:2048 sc1
    buffer_load_dwordx4 v[176:179], v9, s[32:35], s60 offen offset:3072 sc1
    buffer_load_dwordx4 v[180:183], v9, s[32:35], s53 offen offset:3072 sc1
    buffer_load_dwordx4 v[184:187], v9, s[32:35], s54 offen offset:3072 sc1
    s_waitcnt vmcnt(36)
    v_mfma_f32_32x32x16_bf16 v[12:27], v[188:191], v[192:195], v[12:27]
    v_mfma_f32_32x32x16_bf16 v[28:43], v[188:191], v[196:199], v[28:43]
    v_mfma_f32_32x32x16_bf16 v[12:27], v[200:203], v[204:207], v[12:27]
    v_mfma_f32_32x32x16_bf16 v[28:43], v[200:203], v[208:211], v[28:43]
    v_mfma_f32_32x32x16_bf16 v[12:27], v[212:215], v[216:219], v[12:27]
    v_mfma_f32_32x32x16_bf16 v[28:43], v[212:215], v[220:223], v[28:43]
    v_mfma_f32_32x32x16_bf16 v[12:27], v[224:227], v[228:231], v[12:27]
    v_mfma_f32_32x32x16_bf16 v[28:43], v[224:227], v[232:235], v[28:43]
    v_add_u32 v9, s50, v2
    s_add_u32 s50, s50, 4096
    s_and_b32 s50, s50, 0xffff
    buffer_load_dwordx4 v[188:191], v9, s[32:35], s60 offen offset:0 sc1
    buffer_load_dwordx4 v[192:195], v9, s[32:35], s53 offen offset:0 sc1
    buffer_load_dwordx4 v[196:199], v9, s[32:35], s54 offen offset:0 sc1
    buffer_load_dwordx4 v[200:203], v9, s[32:35], s60 offen offset:1024 sc1
    buffer_load_dwordx4 v[204:207], v9, s[32:35], s53 offen offset:1024 sc1
    buffer_load_dwordx4 v[208:211], v9, s[32:35], s54 offen offset:1024 sc1
    buffer_load_dwordx4 v[212:215], v9, s[32:35], s60 offen offset:2048 sc1
    buffer_load_dwordx4 v[216:219], v9, s[32:35], s53 offen offset:2048 sc1
    buffer_load_dwordx4 v[220:223], v9, s[32:35], s54 offen offset:2048 sc1
    buffer_load_dwordx4 v[224:227], v9, s[32:35], s60 offen offset:3072 sc1
    buffer_load_dwordx4 v[228:231], v9, s[32:35], s53 offen offset:3072 sc1
    buffer_load_dwordx4 v[232:235], v9, s[32:35], s54 offen offset:3072 sc1
    s_waitcnt vmcnt(36)
    v_mfma_f32_32x32x16_bf16 v[12:27], v[44:47], v[48:51], v[12:27]
    v_mfma_f32_32x32x16_bf16 v[28:43], v[44:47], v[52:55], v[28:43]
    v_mfma_f32_32x32x16_bf16 v[12:27], v[56:59], v[60:63], v[12:27]
    v_mfma_f32_32x32x16_bf16 v[28:43], v[56:59], v[64:67], v[28:43]
    v_mfma_f32_32x32x16_bf16 v[12:27], v[68:71], v[72:75], v[12:27]
    v_mfma_f32_32x32x16_bf16 v[28:43], v[68:71], v[76:79], v[28:43]
    v_mfma_f32_32x32x16_bf16 v[12:27], v[80:83], v[84:87], v[12:27]
    v_mfma_f32_32x32x16_bf16 v[28:43], v[80:83], v[88:91], v[28:43]
    v_add_u32 v9, s50, v2
    s_add_u32 s50, s50, 4096
    s_and_b32 s50, s50, 0xffff
    buffer_load_dwordx4 v[44:47], v9, s[32:35], s60 offen offset:0 sc1
    buffer_load_dwordx4 v[48:51], v9, s[32:35], s53 offen offset:0 sc1
    buffer_load_dwordx4 v[52:55], v9, s[32:35], s54 offen offset:0 sc1
    buffer_load_dwordx4 v[56:59], v9, s[32:35], s60 offen offset:1024 sc1
    buffer_load_dwordx4 v[60:63], v9, s[32:35], s53 offen offset:1024 sc1
    buffer_load_dwordx4 v[64:67], v9, s[32:35], s54 offen offset:1024 sc1
    buffer_load_dwordx4 v[68:71], v9, s[32:35], s60 offen offset:2048 sc1
    buffer_load_dwordx4 v[72:75], v9, s[32:35], s53 offen offset:2048 sc1
    buffer_load_dwordx4 v[76:79], v9, s[32:35], s54 offen offset:2048 sc1
    buffer_load_dwordx4 v[80:83], v9, s[32:35], s60 offen offset:3072 sc1
    buffer_load_dwordx4 v[84:87], v9, s[32:35], s53 offen offset:3072 sc1
    buffer_load_dwordx4 v[88:91], v9, s[32:35], s54 offen offset:3072 sc1
    s_waitcnt vmcnt(36)
    v_mfma_f32_32x32x16_bf16 v[12:27], v[92:95], v[96:99], v[12:27]
    v_mfma_f32_32x32x16_bf16 v[28:43], v[92:95], v[100:103], v[28:43]
    v_mfma_f32_32x32x16_bf16 v[12:27], v[104:107], v[108:111], v[12:27]
    v_mfma_f32_32x32x16_bf16 v[28:43], v[104:107], v[112:115], v[28:43]
    v_mfma_f32_32x32x16_bf16 v[12:27], v[116:119], v[120:123], v[12:27]
    v_mfma_f32_32x32x16_bf16 v[28:43], v[116:119], v[124:127], v[28:43]
    v_mfma_f32_32x32x16_bf16 v[12:27], v[128:131], v[132:135], v[12:27]
    v_mfma_f32_32x32x16_bf16 v[28:43], v[128:131], v[136:139], v[28:43]
    v_add_u32 v9, s50, v2
    s_add_u32 s50, s50, 4096
    s_and_b32 s50, s50, 0xffff
    buffer_load_dwordx4 v[92:95], v9, s[32:35], s60 offen offset:0 sc1
    buffer_load_dwordx4 v[96:99], v9, s[32:35], s53 offen offset:0 sc1
    buffer_load_dwordx4 v[100:103], v9, s[32:35], s54 offen offset:0 sc1
    buffer_load_dwordx4 v[104:107], v9, s[32:35], s60 offen offset:1024 sc1
    buffer_load_dwordx4 v[108:111], v9, s[32:35], s53 offen offset:1024 sc1
    buffer_load_dwordx4 v[112:115], v9, s[32:35], s54 offen offset:1024 sc1
    buffer_load_dwordx4 v[116:119], v9, s[32:35], s60 offen offset:2048 sc1
    buffer_load_dwordx4 v[120:123], v9, s[32:35], s53 offen offset:2048 sc1
    buffer_load_dwordx4 v[124:127], v9, s[32:35], s54 offen offset:2048 sc1
    buffer_load_dwordx4 v[128:131], v9, s[32:35], s60 offen offset:3072 sc1
    buffer_load_dwordx4 v[132:135], v9, s[32:35], s53 offen offset:3072 sc1
    buffer_load_dwordx4 v[136:139], v9, s[32:35], s54 offen offset:3072 sc1
    s_waitcnt vmcnt(36)
    v_mfma_f32_32x32x16_bf16 v[12:27], v[140:143], v[144:147], v[12:27]
    v_mfma_f32_32x32x16_bf16 v[28:43], v[140:143], v[148:151], v[28:43]
    v_mfma_f32_32x32x16_bf16 v[12:27], v[152:155], v[156:159], v[12:27]
    v_mfma_f32_32x32x16_bf16 v[28:43], v[152:155], v[160:163], v[28:43]
    v_mfma_f32_32x32x16_bf16 v[12:27], v[164:167], v[168:171], v[12:27]
    v_mfma_f32_32x32x16_bf16 v[28:43], v[164:167], v[172:175], v[28:43]
    v_mfma_f32_32x32x16_bf16 v[12:27], v[176:179], v[180:183], v[12:27]
    v_mfma_f32_32x32x16_bf16 v[28:43], v[176:179], v[184:187], v[28:43]
    v_add_u32 v9, s50, v2
    s_add_u32 s50, s50, 4096
    s_and_b32 s50, s50, 0xffff
    buffer_load_dwordx4 v[140:143], v9, s[32:35], s60 offen offset:0 sc1
    buffer_load_dwordx4 v[144:147], v9, s[32:35], s53 offen offset:0 sc1
    buffer_load_dwordx4 v[148:151], v9, s[32:35], s54 offen offset:0 sc1
    buffer_load_dwordx4 v[152:155], v9, s[32:35], s60 offen offset:1024 sc1
    buffer_load_dwordx4 v[156:159], v9, s[32:35], s53 offen offset:1024 sc1
    buffer_load_dwordx4 v[160:163], v9, s[32:35], s54 offen offset:1024 sc1
    buffer_load_dwordx4 v[164:167], v9, s[32:35], s60 offen offset:2048 sc1
    buffer_load_dwordx4 v[168:171], v9, s[32:35], s53 offen offset:2048 sc1
    buffer_load_dwordx4 v[172:175], v9, s[32:35], s54 offen offset:2048 sc1
    buffer_load_dwordx4 v[176:179], v9, s[32:35], s60 offen offset:3072 sc1
    buffer_load_dwordx4 v[180:183], v9, s[32:35], s53 offen offset:3072 sc1
    buffer_load_dwordx4 v[184:187], v9, s[32:35], s54 offen offset:3072 sc1
    s_waitcnt vmcnt(36)
    v_mfma_f32_32x32x16_bf16 v[12:27], v[188:191], v[192:195], v[12:27]
    v_mfma_f32_32x32x16_bf16 v[28:43], v[188:191], v[196:199], v[28:43]
    v_mfma_f32_32x32x16_bf16 v[12:27], v[200:203], v[204:207], v[12:27]
    v_mfma_f32_32x32x16_bf16 v[28:43], v[200:203], v[208:211], v[28:43]
    v_mfma_f32_32x32x16_bf16 v[12:27], v[212:215], v[216:219], v[12:27]
    v_mfma_f32_32x32x16_bf16 v[28:43], v[212:215], v[220:223], v[28:43]
    v_mfma_f32_32x32x16_bf16 v[12:27], v[224:227], v[228:231], v[12:27]
    v_mfma_f32_32x32x16_bf16 v[28:43], v[224:227], v[232:235], v[28:43]
    v_add_u32 v9, s50, v2
    s_add_u32 s50, s50, 4096
    s_and_b32 s50, s50, 0xffff
    buffer_load_dwordx4 v[188:191], v9, s[32:35], s60 offen offset:0 sc1
    buffer_load_dwordx4 v[192:195], v9, s[32:35], s53 offen offset:0 sc1
    buffer_load_dwordx4 v[196:199], v9, s[32:35], s54 offen offset:0 sc1
    buffer_load_dwordx4 v[200:203], v9, s[32:35], s60 offen offset:1024 sc1
    buffer_load_dwordx4 v[204:207], v9, s[32:35], s53 offen offset:1024 sc1
    buffer_load_dwordx4 v[208:211], v9, s[32:35], s54 offen offset:1024 sc1
    buffer_load_dwordx4 v[212:215], v9, s[32:35], s60 offen offset:2048 sc1
    buffer_load_dwordx4 v[216:219], v9, s[32:35], s53 offen offset:2048 sc1
    buffer_load_dwordx4 v[220:223], v9, s[32:35], s54 offen offset:2048 sc1
    buffer_load_dwordx4 v[224:227], v9, s[32:35], s60 offen offset:3072 sc1
    buffer_load_dwordx4 v[228:231], v9, s[32:35], s53 offen offset:3072 sc1
    buffer_load_dwordx4 v[232:235], v9, s[32:35], s54 offen offset:3072 sc1
    s_waitcnt vmcnt(36)
    v_mfma_f32_32x32x16_bf16 v[12:27], v[44:47], v[48:51], v[12:27]
    v_mfma_f32_32x32x16_bf16 v[28:43], v[44:47], v[52:55], v[28:43]
    v_mfma_f32_32x32x16_bf16 v[12:27], v[56:59], v[60:63], v[12:27]
    v_mfma_f32_32x32x16_bf16 v[28:43], v[56:59], v[64:67], v[28:43]
    v_mfma_f32_32x32x16_bf16 v[12:27], v[68:71], v[72:75], v[12:27]
    v_mfma_f32_32x32x16_bf16 v[28:43], v[68:71], v[76:79], v[28:43]
    v_mfma_f32_32x32x16_bf16 v[12:27], v[80:83], v[84:87], v[12:27]
    v_mfma_f32_32x32x16_bf16 v[28:43], v[80:83], v[88:91], v[28:43]
    s_waitcnt vmcnt(24)
    v_mfma_f32_32x32x16_bf16 v[12:27], v[92:95], v[96:99], v[12:27]
    v_mfma_f32_32x32x16_bf16 v[28:43], v[92:95], v[100:103], v[28:43]
    v_mfma_f32_32x32x16_bf16 v[12:27], v[104:107], v[108:111], v[12:27]
    v_mfma_f32_32x32x16_bf16 v[28:43], v[104:107], v[112:115], v[28:43]
    v_mfma_f32_32x32x16_bf16 v[12:27], v[116:119], v[120:123], v[12:27]
    v_mfma_f32_32x32x16_bf16 v[28:43], v[116:119], v[124:127], v[28:43]
    v_mfma_f32_32x32x16_bf16 v[12:27], v[128:131], v[132:135], v[12:27]
    v_mfma_f32_32x32x16_bf16 v[28:43], v[128:131], v[136:139], v[28:43]
    s_waitcnt vmcnt(12)
    v_mfma_f32_32x32x16_bf16 v[12:27], v[140:143], v[144:147], v[12:27]
    v_mfma_f32_32x32x16_bf16 v[28:43], v[140:143], v[148:151], v[28:43]
    v_mfma_f32_32x32x16_bf16 v[12:27], v[152:155], v[156:159], v[12:27]
    v_mfma_f32_32x32x16_bf16 v[28:43], v[152:155], v[160:163], v[28:43]
    v_mfma_f32_32x32x16_bf16 v[12:27], v[164:167], v[168:171], v[12:27]
    v_mfma_f32_32x32x16_bf16 v[28:43], v[164:167], v[172:175], v[28:43]
    v_mfma_f32_32x32x16_bf16 v[12:27], v[176:179], v[180:183], v[12:27]
    v_mfma_f32_32x32x16_bf16 v[28:43], v[176:179], v[184:187], v[28:43]
    s_waitcnt vmcnt(0)
    v_mfma_f32_32x32x16_bf16 v[12:27], v[188:191], v[192:195], v[12:27]
    v_mfma_f32_32x32x16_bf16 v[28:43], v[188:191], v[196:199], v[28:43]
    v_mfma_f32_32x32x16_bf16 v[12:27], v[200:203], v[204:207], v[12:27]
    v_mfma_f32_32x32x16_bf16 v[28:43], v[200:203], v[208:211], v[28:43]
    v_mfma_f32_32x32x16_bf16 v[12:27], v[212:215], v[216:219], v[12:27]
    v_mfma_f32_32x32x16_bf16 v[28:43], v[212:215], v[220:223], v[28:43]
    v_mfma_f32_32x32x16_bf16 v[12:27], v[224:227], v[228:231], v[12:27]
    v_mfma_f32_32x32x16_bf16 v[28:43], v[224:227], v[232:235], v[28:43]
    s_nop 11
    s_cmp_eq_u32 s69, 0
    s_cbranch_scc1 et_208
    s_mov_b32 s75, 1
    s_cmp_lg_u32 s44, 0
    s_cbranch_scc1 et_208
    s_lshl_b32 s76, s46, 7
    s_add_u32 s76, s76, 0x6402000
    v_mov_b32 v4, s76
    v_mov_b32 v7, 1
    s_mov_b64 exec, 1
    buffer_atomic_add v7, v4, s[32:35], 0 offen sc0 sc1
    s_mov_b64 exec, -1
et_208:
    s_mul_i32 s49, s44, 8192
    v_add_u32 v8, s49, v2
    ds_write_b128 v8, v[12:15] offset:0
    ds_write_b128 v8, v[16:19] offset:1024
    ds_write_b128 v8, v[20:23] offset:2048
    ds_write_b128 v8, v[24:27] offset:3072
    ds_write_b128 v8, v[28:31] offset:4096
    ds_write_b128 v8, v[32:35] offset:5120
    ds_write_b128 v8, v[36:39] offset:6144
    ds_write_b128 v8, v[40:43] offset:7168
    s_lshl_b32 s49, s44, 11
    v_add_u32 v8, s49, v2
    s_waitcnt lgkmcnt(0)
    s_barrier
    ds_read_b128 v[44:47], v8 offset:0
    ds_read_b128 v[48:51], v8 offset:1024
    ds_read_b128 v[52:55], v8 offset:8192
    ds_read_b128 v[56:59], v8 offset:9216
    ds_read_b128 v[60:63], v8 offset:16384
    ds_read_b128 v[64:67], v8 offset:17408
    ds_read_b128 v[68:71], v8 offset:24576
    ds_read_b128 v[72:75], v8 offset:25600
    s_lshr_b32 s50, s44, 1
    s_add_u32 s49, s58, s50
    s_lshl_b32 s49, s49, 17
    s_lshl_b32 s50, s59, 6
    s_add_u32 s49, s49, s50
    s_and_b32 s50, s44, 1
    s_lshl_b32 s50, s50, 5
    s_add_u32 s49, s49, s50
    s_waitcnt lgkmcnt(0)
    v_add_f32 v44, v44, v52
    v_add_f32 v60, v60, v68
    v_add_f32 v45, v45, v53
    v_add_f32 v61, v61, v69
    v_add_f32 v46, v46, v54
    v_add_f32 v62, v62, v70
    v_add_f32 v47, v47, v55
    v_add_f32 v63, v63, v71
    v_add_f32 v48, v48, v56
    v_add_f32 v64, v64, v72
    v_add_f32 v49, v49, v57
    v_add_f32 v65, v65, v73
    v_add_f32 v50, v50, v58
    v_add_f32 v66, v66, v74
    v_add_f32 v51, v51, v59
    v_add_f32 v67, v67, v75
    v_add_f32 v44, v44, v60
    v_add_f32 v45, v45, v61
    v_add_f32 v46, v46, v62
    v_add_f32 v47, v47, v63
    v_add_f32 v48, v48, v64
    v_add_f32 v49, v49, v65
    v_add_f32 v50, v50, v66
    v_add_f32 v51, v51, v67
    v_cvt_pk_bf16_f32 v76, v44, v45
    v_cvt_pk_bf16_f32 v77, v46, v47
    v_cvt_pk_bf16_f32 v78, v48, v49
    v_cvt_pk_bf16_f32 v79, v50, v51
    s_nop 0
    v_permlane32_swap_b32 v76, v78
    v_permlane32_swap_b32 v77, v79
    buffer_store_dwordx4 v[76:79], v3, s[40:43], s49 offen
    s_branch mega_kernel_wdone
jobbattn_151:
    s_add_u32 s47, s47, s62
    s_lshr_b32 s58, s47, 2
    s_lshl_b32 s56, s58, 2
    s_add_u32 s50, s56, 112
    s_add_u32 s49, s56, 108
    s_max_u32 s49, s49, 112
    s_cmp_lg_u32 s44, 0
    s_cbranch_scc1 dd_210
    s_lshl_b32 s76, s49, 7
    s_lshl_b32 s77, s50, 7
    s_mov_b32 s52, 0
dw_209:
    buffer_load_dword v4, v6, s[32:35], s76 offen sc1
    buffer_load_dword v5, v6, s[32:35], s77 offen sc1
    s_add_u32 s52, s52, 1
    s_waitcnt vmcnt(0)
    v_cmp_gt_u32 vcc, 3, v4
    s_nop 0
    s_cbranch_vccnz dn_211
    v_cmp_gt_u32 vcc, 3, v5
    s_nop 0
    s_cbranch_vccz dd_210
dn_211:
    s_sleep 12
    s_cmp_lt_u32 s52, 200000
    s_cbranch_scc1 dw_209
dd_210:
    s_barrier
    s_lshl_b32 s56, s58, 2
    s_add_u32 s56, s56, 144
    s_mov_b32 s57, 1
    s_mov_b32 s48, 0
    s_and_b32 s49, s47, 3
    s_lshl_b32 s50, s45, 2
    s_add_u32 s49, s49, s50
    s_lshl_b32 s49, s49, 1
    s_and_b32 s50, s44, 1
    s_add_u32 s60, s49, s50
    s_lshl_b32 s49, s58, 8
    s_add_u32 s60, s60, s49
    s_lshr_b32 s49, s44, 1
    s_lshl_b32 s49, s49, 7
    s_add_u32 s60, s60, s49
    s_mov_b32 s61, 4
    s_lshl_b32 s49, s60, 11
    s_lshr_b32 s50, s60, 5
    s_and_b32 s51, s60, 31
    s_lshl_b32 s51, s51, 11
    v_add_u32 v218, 0x4000000, v2
    v_add_u32 v220, 0x4400000, v2
    v_add_u32 v220, s51, v220
    v_add_u32 v221, 0x400000, v220
    v_add_u32 v222, 0x4c00000, v2
    s_add_u32 s52, s49, 0
    buffer_load_dwordx4 a[192:195], v218, s[32:35], s52 offen offset:0 sc1
    buffer_load_dwordx4 a[196:199], v218, s[32:35], s52 offen offset:1024 sc1
    s_add_i32 s52, s50, -8
    s_max_i32 s52, s52, 0
    s_lshl_b32 s52, s52, 16
    buffer_load_dwordx4 a[0:3], v220, s[32:35], s52 offen offset:0 sc1
    buffer_load_dwordx4 a[4:7], v220, s[32:35], s52 offen offset:1024 sc1
    s_add_i32 s52, s50, -7
    s_max_i32 s52, s52, 0
    s_lshl_b32 s52, s52, 16
    buffer_load_dwordx4 a[8:11], v220, s[32:35], s52 offen offset:0 sc1
    buffer_load_dwordx4 a[12:15], v220, s[32:35], s52 offen offset:1024 sc1
    s_add_i32 s52, s50, -6
    s_max_i32 s52, s52, 0
    s_lshl_b32 s52, s52, 16
    buffer_load_dwordx4 a[16:19], v220, s[32:35], s52 offen offset:0 sc1
    buffer_load_dwordx4 a[20:23], v220, s[32:35], s52 offen offset:1024 sc1
    s_add_i32 s52, s50, -5
    s_max_i32 s52, s52, 0
    s_lshl_b32 s52, s52, 16
    buffer_load_dwordx4 a[24:27], v220, s[32:35], s52 offen offset:0 sc1
    buffer_load_dwordx4 a[28:31], v220, s[32:35], s52 offen offset:1024 sc1
    s_add_i32 s52, s50, -4
    s_max_i32 s52, s52, 0
    s_lshl_b32 s52, s52, 16
    buffer_load_dwordx4 a[32:35], v220, s[32:35], s52 offen offset:0 sc1
    buffer_load_dwordx4 a[36:39], v220, s[32:35], s52 offen offset:1024 sc1
    s_add_i32 s52, s50, -3
    s_max_i32 s52, s52, 0
    s_lshl_b32 s52, s52, 16
    buffer_load_dwordx4 a[40:43], v220, s[32:35], s52 offen offset:0 sc1
    buffer_load_dwordx4 a[44:47], v220, s[32:35], s52 offen offset:1024 sc1
    s_add_i32 s52, s50, -2
    s_max_i32 s52, s52, 0
    s_lshl_b32 s52, s52, 16
    buffer_load_dwordx4 a[48:51], v220, s[32:35], s52 offen offset:0 sc1
    buffer_load_dwordx4 a[52:55], v220, s[32:35], s52 offen offset:1024 sc1
    s_add_i32 s52, s50, -1
    s_max_i32 s52, s52, 0
    s_lshl_b32 s52, s52, 16
    buffer_load_dwordx4 a[56:59], v220, s[32:35], s52 offen offset:0 sc1
    buffer_load_dwordx4 a[60:63], v220, s[32:35], s52 offen offset:1024 sc1
    s_add_i32 s52, s50, 0
    s_max_i32 s52, s52, 0
    s_lshl_b32 s52, s52, 16
    buffer_load_dwordx4 a[64:67], v220, s[32:35], s52 offen offset:0 sc1
    buffer_load_dwordx4 a[68:71], v220, s[32:35], s52 offen offset:1024 sc1
    s_add_i32 s52, s50, -8
    s_max_i32 s52, s52, 0
    s_lshl_b32 s52, s52, 16
    buffer_load_dwordx4 a[96:99], v221, s[32:35], s52 offen offset:0 sc1
    buffer_load_dwordx4 a[100:103], v221, s[32:35], s52 offen offset:1024 sc1
    s_add_i32 s52, s50, -7
    s_max_i32 s52, s52, 0
    s_lshl_b32 s52, s52, 16
    buffer_load_dwordx4 a[104:107], v221, s[32:35], s52 offen offset:0 sc1
    buffer_load_dwordx4 a[108:111], v221, s[32:35], s52 offen offset:1024 sc1
    s_add_i32 s52, s50, -6
    s_max_i32 s52, s52, 0
    s_lshl_b32 s52, s52, 16
    buffer_load_dwordx4 a[112:115], v221, s[32:35], s52 offen offset:0 sc1
    buffer_load_dwordx4 a[116:119], v221, s[32:35], s52 offen offset:1024 sc1
    s_add_i32 s52, s50, -5
    s_max_i32 s52, s52, 0
    s_lshl_b32 s52, s52, 16
    buffer_load_dwordx4 a[120:123], v221, s[32:35], s52 offen offset:0 sc1
    buffer_load_dwordx4 a[124:127], v221, s[32:35], s52 offen offset:1024 sc1
    s_add_i32 s52, s50, -4
    s_max_i32 s52, s52, 0
    s_lshl_b32 s52, s52, 16
    buffer_load_dwordx4 a[128:131], v221, s[32:35], s52 offen offset:0 sc1
    buffer_load_dwordx4 a[132:135], v221, s[32:35], s52 offen offset:1024 sc1
    s_add_i32 s52, s50, -3
    s_max_i32 s52, s52, 0
    s_lshl_b32 s52, s52, 16
    buffer_load_dwordx4 a[136:139], v221, s[32:35], s52 offen offset:0 sc1
    buffer_load_dwordx4 a[140:143], v221, s[32:35], s52 offen offset:1024 sc1
    s_add_i32 s52, s50, -2
    s_max_i32 s52, s52, 0
    s_lshl_b32 s52, s52, 16
    buffer_load_dwordx4 a[144:147], v221, s[32:35], s52 offen offset:0 sc1
    buffer_load_dwordx4 a[148:151], v221, s[32:35], s52 offen offset:1024 sc1
    s_add_i32 s52, s50, -1
    s_max_i32 s52, s52, 0
    s_lshl_b32 s52, s52, 16
    buffer_load_dwordx4 a[152:155], v221, s[32:35], s52 offen offset:0 sc1
    buffer_load_dwordx4 a[156:159], v221, s[32:35], s52 offen offset:1024 sc1
    s_add_i32 s52, s50, 0
    s_max_i32 s52, s52, 0
    s_lshl_b32 s52, s52, 16
    buffer_load_dwordx4 a[160:163], v221, s[32:35], s52 offen offset:0 sc1
    buffer_load_dwordx4 a[164:167], v221, s[32:35], s52 offen offset:1024 sc1
    s_add_u32 s52, s49, 65536
    buffer_load_dwordx4 a[200:203], v218, s[32:35], s52 offen offset:0 sc1
    buffer_load_dwordx4 a[204:207], v218, s[32:35], s52 offen offset:1024 sc1
    s_add_i32 s52, s50, 1
    s_max_i32 s52, s52, 0
    s_lshl_b32 s52, s52, 16
    buffer_load_dwordx4 a[72:75], v220, s[32:35], s52 offen offset:0 sc1
    buffer_load_dwordx4 a[76:79], v220, s[32:35], s52 offen offset:1024 sc1
    s_add_i32 s52, s50, 1
    s_max_i32 s52, s52, 0
    s_lshl_b32 s52, s52, 16
    buffer_load_dwordx4 a[168:171], v221, s[32:35], s52 offen offset:0 sc1
    buffer_load_dwordx4 a[172:175], v221, s[32:35], s52 offen offset:1024 sc1
    s_add_u32 s52, s49, 131072
    buffer_load_dwordx4 a[208:211], v218, s[32:35], s52 offen offset:0 sc1
    buffer_load_dwordx4 a[212:215], v218, s[32:35], s52 offen offset:1024 sc1
    s_add_i32 s52, s50, 2
    s_max_i32 s52, s52, 0
    s_lshl_b32 s52, s52, 16
    buffer_load_dwordx4 a[80:83], v220, s[32:35], s52 offen offset:0 sc1
    buffer_load_dwordx4 a[84:87], v220, s[32:35], s52 offen offset:1024 sc1
    s_add_i32 s52, s50, 2
    s_max_i32 s52, s52, 0
    s_lshl_b32 s52, s52, 16
    buffer_load_dwordx4 a[176:179], v221, s[32:35], s52 offen offset:0 sc1
    buffer_load_dwordx4 a[180:183], v221, s[32:35], s52 offen offset:1024 sc1
    s_add_u32 s52, s49, 196608
    buffer_load_dwordx4 a[216:219], v218, s[32:35], s52 offen offset:0 sc1
    buffer_load_dwordx4 a[220:223], v218, s[32:35], s52 offen offset:1024 sc1
    s_add_i32 s52, s50, 3
    s_max_i32 s52, s52, 0
    s_lshl_b32 s52, s52, 16
    buffer_load_dwordx4 a[88:91], v220, s[32:35], s52 offen offset:0 sc1
    buffer_load_dwordx4 a[92:95], v220, s[32:35], s52 offen offset:1024 sc1
    s_add_i32 s52, s50, 3
    s_max_i32 s52, s52, 0
    s_lshl_b32 s52, s52, 16
    buffer_load_dwordx4 a[184:187], v221, s[32:35], s52 offen offset:0 sc1
    buffer_load_dwordx4 a[188:191], v221, s[32:35], s52 offen offset:1024 sc1
    v_lshrrev_b32 v216, 5, v1
    v_lshlrev_b32 v216, 2, v216
    v_and_b32 v217, 31, v1
    v_sub_u32 v216, v217, v216
    v_mov_b32 v217, 0xf149f2ca
    v_cmp_gt_i32 vcc, 0, v216
    s_nop 1
    v_cndmask_b32 v152, v217, 0, vcc
    v_cmp_gt_i32 vcc, 1, v216
    s_nop 1
    v_cndmask_b32 v153, v217, 0, vcc
    v_cmp_gt_i32 vcc, 2, v216
    s_nop 1
    v_cndmask_b32 v154, v217, 0, vcc
    v_cmp_gt_i32 vcc, 3, v216
    s_nop 1
    v_cndmask_b32 v155, v217, 0, vcc
    v_cmp_gt_i32 vcc, 8, v216
    s_nop 1
    v_cndmask_b32 v156, v217, 0, vcc
    v_cmp_gt_i32 vcc, 9, v216
    s_nop 1
    v_cndmask_b32 v157, v217, 0, vcc
    v_cmp_gt_i32 vcc, 10, v216
    s_nop 1
    v_cndmask_b32 v158, v217, 0, vcc
    v_cmp_gt_i32 vcc, 11, v216
    s_nop 1
    v_cndmask_b32 v159, v217, 0, vcc
    v_cmp_gt_i32 vcc, 16, v216
    s_nop 1
    v_cndmask_b32 v160, v217, 0, vcc
    v_cmp_gt_i32 vcc, 17, v216
    s_nop 1
    v_cndmask_b32 v161, v217, 0, vcc
    v_cmp_gt_i32 vcc, 18, v216
    s_nop 1
    v_cndmask_b32 v162, v217, 0, vcc
    v_cmp_gt_i32 vcc, 19, v216
    s_nop 1
    v_cndmask_b32 v163, v217, 0, vcc
    v_cmp_gt_i32 vcc, 24, v216
    s_nop 1
    v_cndmask_b32 v164, v217, 0, vcc
    v_cmp_gt_i32 vcc, 25, v216
    s_nop 1
    v_cndmask_b32 v165, v217, 0, vcc
    v_cmp_gt_i32 vcc, 26, v216
    s_nop 1
    v_cndmask_b32 v166, v217, 0, vcc
    v_cmp_gt_i32 vcc, 27, v216
    s_nop 1
    v_cndmask_b32 v167, v217, 0, vcc
    v_cmp_le_i32 vcc, 0, v216
    s_nop 1
    v_cndmask_b32 v168, v217, 0, vcc
    v_cmp_le_i32 vcc, 1, v216
    s_nop 1
    v_cndmask_b32 v169, v217, 0, vcc
    v_cmp_le_i32 vcc, 2, v216
    s_nop 1
    v_cndmask_b32 v170, v217, 0, vcc
    v_cmp_le_i32 vcc, 3, v216
    s_nop 1
    v_cndmask_b32 v171, v217, 0, vcc
    v_cmp_le_i32 vcc, 8, v216
    s_nop 1
    v_cndmask_b32 v172, v217, 0, vcc
    v_cmp_le_i32 vcc, 9, v216
    s_nop 1
    v_cndmask_b32 v173, v217, 0, vcc
    v_cmp_le_i32 vcc, 10, v216
    s_nop 1
    v_cndmask_b32 v174, v217, 0, vcc
    v_cmp_le_i32 vcc, 11, v216
    s_nop 1
    v_cndmask_b32 v175, v217, 0, vcc
    v_cmp_le_i32 vcc, 16, v216
    s_nop 1
    v_cndmask_b32 v176, v217, 0, vcc
    v_cmp_le_i32 vcc, 17, v216
    s_nop 1
    v_cndmask_b32 v177, v217, 0, vcc
    v_cmp_le_i32 vcc, 18, v216
    s_nop 1
    v_cndmask_b32 v178, v217, 0, vcc
    v_cmp_le_i32 vcc, 19, v216
    s_nop 1
    v_cndmask_b32 v179, v217, 0, vcc
    v_cmp_le_i32 vcc, 24, v216
    s_nop 1
    v_cndmask_b32 v180, v217, 0, vcc
    v_cmp_le_i32 vcc, 25, v216
    s_nop 1
    v_cndmask_b32 v181, v217, 0, vcc
    v_cmp_le_i32 vcc, 26, v216
    s_nop 1
    v_cndmask_b32 v182, v217, 0, vcc
    v_cmp_le_i32 vcc, 27, v216
    s_nop 1
    v_cndmask_b32 v183, v217, 0, vcc
    v_mov_b32 v212, 0x3e8293ee
    s_waitcnt vmcnt(52)
    v_mfma_f32_32x32x16_bf16 v[8:23], a[0:3], a[192:195], v[152:167]
    v_mfma_f32_32x32x16_bf16 v[8:23], a[4:7], a[196:199], v[8:23]
    s_waitcnt vmcnt(50)
    v_mfma_f32_32x32x16_bf16 v[24:39], a[8:11], a[192:195], 0
    v_mfma_f32_32x32x16_bf16 v[24:39], a[12:15], a[196:199], v[24:39]
    s_waitcnt vmcnt(48)
    v_mfma_f32_32x32x16_bf16 v[40:55], a[16:19], a[192:195], 0
    v_mfma_f32_32x32x16_bf16 v[40:55], a[20:23], a[196:199], v[40:55]
    s_nop 5
    v_max3_f32 v218, v8, v9, v10
    v_max3_f32 v219, v11, v12, v13
    v_max3_f32 v218, v218, v14, v15
    v_max3_f32 v219, v219, v16, v17
    v_max3_f32 v218, v218, v18, v19
    v_max3_f32 v219, v219, v20, v21
    v_max3_f32 v218, v218, v22, v23
    s_waitcnt vmcnt(46)
    v_mfma_f32_32x32x16_bf16 v[56:71], a[24:27], a[192:195], 0
    v_mfma_f32_32x32x16_bf16 v[56:71], a[28:31], a[196:199], v[56:71]
    v_max3_f32 v218, v218, v24, v25
    v_max3_f32 v219, v219, v26, v27
    v_max3_f32 v218, v218, v28, v29
    v_max3_f32 v219, v219, v30, v31
    v_max3_f32 v218, v218, v32, v33
    v_max3_f32 v219, v219, v34, v35
    v_max3_f32 v218, v218, v36, v37
    v_max3_f32 v219, v219, v38, v39
    s_waitcnt vmcnt(44)
    v_mfma_f32_32x32x16_bf16 v[72:87], a[32:35], a[192:195], 0
    v_mfma_f32_32x32x16_bf16 v[72:87], a[36:39], a[196:199], v[72:87]
    v_max3_f32 v218, v218, v40, v41
    v_max3_f32 v219, v219, v42, v43
    v_max3_f32 v218, v218, v44, v45
    v_max3_f32 v219, v219, v46, v47
    v_max3_f32 v218, v218, v48, v49
    v_max3_f32 v219, v219, v50, v51
    v_max3_f32 v218, v218, v52, v53
    v_max3_f32 v219, v219, v54, v55
    s_waitcnt vmcnt(42)
    v_mfma_f32_32x32x16_bf16 v[88:103], a[40:43], a[192:195], 0
    v_mfma_f32_32x32x16_bf16 v[88:103], a[44:47], a[196:199], v[88:103]
    v_max3_f32 v218, v218, v56, v57
    v_max3_f32 v219, v219, v58, v59
    v_max3_f32 v218, v218, v60, v61
    v_max3_f32 v219, v219, v62, v63
    v_max3_f32 v218, v218, v64, v65
    v_max3_f32 v219, v219, v66, v67
    v_max3_f32 v218, v218, v68, v69
    v_max3_f32 v219, v219, v70, v71
    s_waitcnt vmcnt(40)
    v_mfma_f32_32x32x16_bf16 v[104:119], a[48:51], a[192:195], 0
    v_mfma_f32_32x32x16_bf16 v[104:119], a[52:55], a[196:199], v[104:119]
    v_max3_f32 v218, v218, v72, v73
    v_max3_f32 v219, v219, v74, v75
    v_max3_f32 v218, v218, v76, v77
    v_max3_f32 v219, v219, v78, v79
    v_max3_f32 v218, v218, v80, v81
    v_max3_f32 v219, v219, v82, v83
    v_max3_f32 v218, v218, v84, v85
    v_max3_f32 v219, v219, v86, v87
    s_waitcnt vmcnt(38)
    v_mfma_f32_32x32x16_bf16 v[120:135], a[56:59], a[192:195], 0
    v_mfma_f32_32x32x16_bf16 v[120:135], a[60:63], a[196:199], v[120:135]
    v_max3_f32 v218, v218, v88, v89
    v_max3_f32 v219, v219, v90, v91
    v_max3_f32 v218, v218, v92, v93
    v_max3_f32 v219, v219, v94, v95
    v_max3_f32 v218, v218, v96, v97
    v_max3_f32 v219, v219, v98, v99
    v_max3_f32 v218, v218, v100, v101
    v_max3_f32 v219, v219, v102, v103
    s_waitcnt vmcnt(36)
    v_mfma_f32_32x32x16_bf16 v[136:151], a[64:67], a[192:195], v[168:183]
    v_mfma_f32_32x32x16_bf16 v[136:151], a[68:71], a[196:199], v[136:151]
    v_max3_f32 v218, v218, v104, v105
    v_max3_f32 v219, v219, v106, v107
    v_max3_f32 v218, v218, v108, v109
    v_max3_f32 v219, v219, v110, v111
    v_max3_f32 v218, v218, v112, v113
    v_max3_f32 v219, v219, v114, v115
    v_max3_f32 v218, v218, v116, v117
    v_max3_f32 v219, v219, v118, v119
    s_cmp_lt_u32 s50, 8
    s_cbranch_scc1 bfix_213
    v_max3_f32 v218, v218, v120, v121
    v_max3_f32 v219, v219, v122, v123
    v_max3_f32 v218, v218, v124, v125
    v_max3_f32 v219, v219, v126, v127
    v_max3_f32 v218, v218, v128, v129
    v_max3_f32 v219, v219, v130, v131
    v_max3_f32 v218, v218, v132, v133
    v_max3_f32 v219, v219, v134, v135
    v_max3_f32 v218, v218, v136, v137
    v_max3_f32 v219, v219, v138, v139
    v_max3_f32 v218, v218, v140, v141
    v_max3_f32 v219, v219, v142, v143
    v_max3_f32 v218, v218, v144, v145
    v_max3_f32 v219, v219, v146, v147
    v_max3_f32 v218, v218, v148, v149
    v_max3_f32 v219, v219, v150, v151
    v_max_f32 v218, v218, v219
    s_branch bok_212
bfix_213:
    s_nop 15
    s_cmp_ge_u32 s50, 8
    s_cbranch_scc1 bf2_214
    v_mov_b32 v8, v217
    v_mov_b32 v9, v217
    v_mov_b32 v10, v217
    v_mov_b32 v11, v217
    v_mov_b32 v12, v217
    v_mov_b32 v13, v217
    v_mov_b32 v14, v217
    v_mov_b32 v15, v217
    v_mov_b32 v16, v217
    v_mov_b32 v17, v217
    v_mov_b32 v18, v217
    v_mov_b32 v19, v217
    v_mov_b32 v20, v217
    v_mov_b32 v21, v217
    v_mov_b32 v22, v217
    v_mov_b32 v23, v217
    s_cmp_ge_u32 s50, 7
    s_cbranch_scc1 bf2_214
    v_mov_b32 v24, v217
    v_mov_b32 v25, v217
    v_mov_b32 v26, v217
    v_mov_b32 v27, v217
    v_mov_b32 v28, v217
    v_mov_b32 v29, v217
    v_mov_b32 v30, v217
    v_mov_b32 v31, v217
    v_mov_b32 v32, v217
    v_mov_b32 v33, v217
    v_mov_b32 v34, v217
    v_mov_b32 v35, v217
    v_mov_b32 v36, v217
    v_mov_b32 v37, v217
    v_mov_b32 v38, v217
    v_mov_b32 v39, v217
    s_cmp_ge_u32 s50, 6
    s_cbranch_scc1 bf2_214
    v_mov_b32 v40, v217
    v_mov_b32 v41, v217
    v_mov_b32 v42, v217
    v_mov_b32 v43, v217
    v_mov_b32 v44, v217
    v_mov_b32 v45, v217
    v_mov_b32 v46, v217
    v_mov_b32 v47, v217
    v_mov_b32 v48, v217
    v_mov_b32 v49, v217
    v_mov_b32 v50, v217
    v_mov_b32 v51, v217
    v_mov_b32 v52, v217
    v_mov_b32 v53, v217
    v_mov_b32 v54, v217
    v_mov_b32 v55, v217
    s_cmp_ge_u32 s50, 5
    s_cbranch_scc1 bf2_214
    v_mov_b32 v56, v217
    v_mov_b32 v57, v217
    v_mov_b32 v58, v217
    v_mov_b32 v59, v217
    v_mov_b32 v60, v217
    v_mov_b32 v61, v217
    v_mov_b32 v62, v217
    v_mov_b32 v63, v217
    v_mov_b32 v64, v217
    v_mov_b32 v65, v217
    v_mov_b32 v66, v217
    v_mov_b32 v67, v217
    v_mov_b32 v68, v217
    v_mov_b32 v69, v217
    v_mov_b32 v70, v217
    v_mov_b32 v71, v217
    s_cmp_ge_u32 s50, 4
    s_cbranch_scc1 bf2_214
    v_mov_b32 v72, v217
    v_mov_b32 v73, v217
    v_mov_b32 v74, v217
    v_mov_b32 v75, v217
    v_mov_b32 v76, v217
    v_mov_b32 v77, v217
    v_mov_b32 v78, v217
    v_mov_b32 v79, v217
    v_mov_b32 v80, v217
    v_mov_b32 v81, v217
    v_mov_b32 v82, v217
    v_mov_b32 v83, v217
    v_mov_b32 v84, v217
    v_mov_b32 v85, v217
    v_mov_b32 v86, v217
    v_mov_b32 v87, v217
    s_cmp_ge_u32 s50, 3
    s_cbranch_scc1 bf2_214
    v_mov_b32 v88, v217
    v_mov_b32 v89, v217
    v_mov_b32 v90, v217
    v_mov_b32 v91, v217
    v_mov_b32 v92, v217
    v_mov_b32 v93, v217
    v_mov_b32 v94, v217
    v_mov_b32 v95, v217
    v_mov_b32 v96, v217
    v_mov_b32 v97, v217
    v_mov_b32 v98, v217
    v_mov_b32 v99, v217
    v_mov_b32 v100, v217
    v_mov_b32 v101, v217
    v_mov_b32 v102, v217
    v_mov_b32 v103, v217
    s_cmp_ge_u32 s50, 2
    s_cbranch_scc1 bf2_214
    v_mov_b32 v104, v217
    v_mov_b32 v105, v217
    v_mov_b32 v106, v217
    v_mov_b32 v107, v217
    v_mov_b32 v108, v217
    v_mov_b32 v109, v217
    v_mov_b32 v110, v217
    v_mov_b32 v111, v217
    v_mov_b32 v112, v217
    v_mov_b32 v113, v217
    v_mov_b32 v114, v217
    v_mov_b32 v115, v217
    v_mov_b32 v116, v217
    v_mov_b32 v117, v217
    v_mov_b32 v118, v217
    v_mov_b32 v119, v217
    s_cmp_ge_u32 s50, 1
    s_cbranch_scc1 bf2_214
    v_mov_b32 v120, v217
    v_mov_b32 v121, v217
    v_mov_b32 v122, v217
    v_mov_b32 v123, v217
    v_mov_b32 v124, v217
    v_mov_b32 v125, v217
    v_mov_b32 v126, v217
    v_mov_b32 v127, v217
    v_mov_b32 v128, v217
    v_mov_b32 v129, v217
    v_mov_b32 v130, v217
    v_mov_b32 v131, v217
    v_mov_b32 v132, v217
    v_mov_b32 v133, v217
    v_mov_b32 v134, v217
    v_mov_b32 v135, v217
bf2_214:
    v_max3_f32 v218, v8, v9, v10
    v_max3_f32 v219, v11, v12, v13
    v_max3_f32 v218, v218, v14, v15
    v_max3_f32 v219, v219, v16, v17
    v_max3_f32 v218, v218, v18, v19
    v_max3_f32 v219, v219, v20, v21
    v_max3_f32 v218, v218, v22, v23
    v_max3_f32 v219, v219, v24, v25
    v_max3_f32 v218, v218, v26, v27
    v_max3_f32 v219, v219, v28, v29
    v_max3_f32 v218, v218, v30, v31
    v_max3_f32 v219, v219, v32, v33
    v_max3_f32 v218, v218, v34, v35
    v_max3_f32 v219, v219, v36, v37
    v_max3_f32 v218, v218, v38, v39
    v_max3_f32 v219, v219, v40, v41
    v_max3_f32 v218, v218, v42, v43
    v_max3_f32 v219, v219, v44, v45
    v_max3_f32 v218, v218, v46, v47
    v_max3_f32 v219, v219, v48, v49
    v_max3_f32 v218, v218, v50, v51
    v_max3_f32 v219, v219, v52, v53
    v_max3_f32 v218, v218, v54, v55
    v_max3_f32 v219, v219, v56, v57
    v_max3_f32 v218, v218, v58, v59
    v_max3_f32 v219, v219, v60, v61
    v_max3_f32 v218, v218, v62, v63
    v_max3_f32 v219, v219, v64, v65
    v_max3_f32 v218, v218, v66, v67
    v_max3_f32 v219, v219, v68, v69
    v_max3_f32 v218, v218, v70, v71
    v_max3_f32 v219, v219, v72, v73
    v_max3_f32 v218, v218, v74, v75
    v_max3_f32 v219, v219, v76, v77
    v_max3_f32 v218, v218, v78, v79
    v_max3_f32 v219, v219, v80, v81
    v_max3_f32 v218, v218, v82, v83
    v_max3_f32 v219, v219, v84, v85
    v_max3_f32 v218, v218, v86, v87
    v_max3_f32 v219, v219, v88, v89
    v_max3_f32 v218, v218, v90, v91
    v_max3_f32 v219, v219, v92, v93
    v_max3_f32 v218, v218, v94, v95
    v_max3_f32 v219, v219, v96, v97
    v_max3_f32 v218, v218, v98, v99
    v_max3_f32 v219, v219, v100, v101
    v_max3_f32 v218, v218, v102, v103
    v_max3_f32 v219, v219, v104, v105
    v_max3_f32 v218, v218, v106, v107
    v_max3_f32 v219, v219, v108, v109
    v_max3_f32 v218, v218, v110, v111
    v_max3_f32 v219, v219, v112, v113
    v_max3_f32 v218, v218, v114, v115
    v_max3_f32 v219, v219, v116, v117
    v_max3_f32 v218, v218, v118, v119
    v_max3_f32 v219, v219, v120, v121
    v_max3_f32 v218, v218, v122, v123
    v_max3_f32 v219, v219, v124, v125
    v_max3_f32 v218, v218, v126, v127
    v_max3_f32 v219, v219, v128, v129
    v_max3_f32 v218, v218, v130, v131
    v_max3_f32 v219, v219, v132, v133
    v_max3_f32 v218, v218, v134, v135
    v_max3_f32 v219, v219, v136, v137
    v_max3_f32 v218, v218, v138, v139
    v_max3_f32 v219, v219, v140, v141
    v_max3_f32 v218, v218, v142, v143
    v_max3_f32 v219, v219, v144, v145
    v_max3_f32 v218, v218, v146, v147
    v_max3_f32 v219, v219, v148, v149
    v_max3_f32 v218, v218, v150, v151
    v_max_f32 v218, v218, v219
bok_212:
    v_mov_b32 v219, v218
    s_nop 1
    v_permlane32_swap_b32 v218, v219
    v_max_f32 v218, v218, v219
    v_mul_f32 v214, v212, -v218
    v_pk_fma_f32 v[8:9], v[8:9], v[212:213], v[214:215] op_sel_hi:[1,0,0]
    v_pk_fma_f32 v[10:11], v[10:11], v[212:213], v[214:215] op_sel_hi:[1,0,0]
    v_pk_fma_f32 v[12:13], v[12:13], v[212:213], v[214:215] op_sel_hi:[1,0,0]
    v_pk_fma_f32 v[14:15], v[14:15], v[212:213], v[214:215] op_sel_hi:[1,0,0]
    v_pk_fma_f32 v[16:17], v[16:17], v[212:213], v[214:215] op_sel_hi:[1,0,0]
    v_pk_fma_f32 v[18:19], v[18:19], v[212:213], v[214:215] op_sel_hi:[1,0,0]
    v_pk_fma_f32 v[20:21], v[20:21], v[212:213], v[214:215] op_sel_hi:[1,0,0]
    v_pk_fma_f32 v[22:23], v[22:23], v[212:213], v[214:215] op_sel_hi:[1,0,0]
    v_exp_f32 v8, v8
    v_exp_f32 v9, v9
    v_exp_f32 v10, v10
    v_exp_f32 v11, v11
    v_exp_f32 v12, v12
    v_exp_f32 v13, v13
    v_exp_f32 v14, v14
    v_exp_f32 v15, v15
    v_exp_f32 v16, v16
    v_exp_f32 v17, v17
    v_exp_f32 v18, v18
    v_exp_f32 v19, v19
    v_exp_f32 v20, v20
    v_exp_f32 v21, v21
    v_exp_f32 v22, v22
    v_exp_f32 v23, v23
    v_pk_add_f32 v[208:209], v[8:9], 0
    v_pk_add_f32 v[210:211], v[10:11], 0
    v_pk_add_f32 v[208:209], v[208:209], v[12:13]
    v_pk_add_f32 v[210:211], v[210:211], v[14:15]
    v_pk_add_f32 v[208:209], v[208:209], v[16:17]
    v_pk_add_f32 v[210:211], v[210:211], v[18:19]
    v_pk_add_f32 v[208:209], v[208:209], v[20:21]
    v_pk_add_f32 v[210:211], v[210:211], v[22:23]
    v_cvt_pk_bf16_f32 v8, v8, v9
    v_cvt_pk_bf16_f32 v9, v10, v11
    v_cvt_pk_bf16_f32 v10, v12, v13
    v_cvt_pk_bf16_f32 v11, v14, v15
    v_cvt_pk_bf16_f32 v12, v16, v17
    v_cvt_pk_bf16_f32 v13, v18, v19
    v_cvt_pk_bf16_f32 v14, v20, v21
    v_cvt_pk_bf16_f32 v15, v22, v23
    v_pk_fma_f32 v[24:25], v[24:25], v[212:213], v[214:215] op_sel_hi:[1,0,0]
    v_pk_fma_f32 v[26:27], v[26:27], v[212:213], v[214:215] op_sel_hi:[1,0,0]
    v_pk_fma_f32 v[28:29], v[28:29], v[212:213], v[214:215] op_sel_hi:[1,0,0]
    v_pk_fma_f32 v[30:31], v[30:31], v[212:213], v[214:215] op_sel_hi:[1,0,0]
    v_pk_fma_f32 v[32:33], v[32:33], v[212:213], v[214:215] op_sel_hi:[1,0,0]
    v_pk_fma_f32 v[34:35], v[34:35], v[212:213], v[214:215] op_sel_hi:[1,0,0]
    v_pk_fma_f32 v[36:37], v[36:37], v[212:213], v[214:215] op_sel_hi:[1,0,0]
    v_pk_fma_f32 v[38:39], v[38:39], v[212:213], v[214:215] op_sel_hi:[1,0,0]
    s_waitcnt vmcnt(34)
    v_mfma_f32_32x32x16_bf16 v[184:199], a[96:99], v[8:11], 0
    v_exp_f32 v24, v24
    v_exp_f32 v25, v25
    v_exp_f32 v26, v26
    v_exp_f32 v27, v27
    v_exp_f32 v28, v28
    v_exp_f32 v29, v29
    v_exp_f32 v30, v30
    v_exp_f32 v31, v31
    v_mfma_f32_32x32x16_bf16 v[184:199], a[100:103], v[12:15], v[184:199]
    v_exp_f32 v32, v32
    v_exp_f32 v33, v33
    v_exp_f32 v34, v34
    v_exp_f32 v35, v35
    v_exp_f32 v36, v36
    v_exp_f32 v37, v37
    v_exp_f32 v38, v38
    v_exp_f32 v39, v39
    v_pk_add_f32 v[208:209], v[208:209], v[24:25]
    v_pk_add_f32 v[210:211], v[210:211], v[26:27]
    v_pk_add_f32 v[208:209], v[208:209], v[28:29]
    v_pk_add_f32 v[210:211], v[210:211], v[30:31]
    v_pk_add_f32 v[208:209], v[208:209], v[32:33]
    v_pk_add_f32 v[210:211], v[210:211], v[34:35]
    v_pk_add_f32 v[208:209], v[208:209], v[36:37]
    v_pk_add_f32 v[210:211], v[210:211], v[38:39]
    v_cvt_pk_bf16_f32 v24, v24, v25
    v_cvt_pk_bf16_f32 v25, v26, v27
    v_cvt_pk_bf16_f32 v26, v28, v29
    v_cvt_pk_bf16_f32 v27, v30, v31
    v_cvt_pk_bf16_f32 v28, v32, v33
    v_cvt_pk_bf16_f32 v29, v34, v35
    v_cvt_pk_bf16_f32 v30, v36, v37
    v_cvt_pk_bf16_f32 v31, v38, v39
    v_pk_fma_f32 v[40:41], v[40:41], v[212:213], v[214:215] op_sel_hi:[1,0,0]
    v_pk_fma_f32 v[42:43], v[42:43], v[212:213], v[214:215] op_sel_hi:[1,0,0]
    v_pk_fma_f32 v[44:45], v[44:45], v[212:213], v[214:215] op_sel_hi:[1,0,0]
    v_pk_fma_f32 v[46:47], v[46:47], v[212:213], v[214:215] op_sel_hi:[1,0,0]
    v_pk_fma_f32 v[48:49], v[48:49], v[212:213], v[214:215] op_sel_hi:[1,0,0]
    v_pk_fma_f32 v[50:51], v[50:51], v[212:213], v[214:215] op_sel_hi:[1,0,0]
    v_pk_fma_f32 v[52:53], v[52:53], v[212:213], v[214:215] op_sel_hi:[1,0,0]
    v_pk_fma_f32 v[54:55], v[54:55], v[212:213], v[214:215] op_sel_hi:[1,0,0]
    s_waitcnt vmcnt(32)
    v_mfma_f32_32x32x16_bf16 v[184:199], a[104:107], v[24:27], v[184:199]
    v_exp_f32 v40, v40
    v_exp_f32 v41, v41
    v_exp_f32 v42, v42
    v_exp_f32 v43, v43
    v_exp_f32 v44, v44
    v_exp_f32 v45, v45
    v_exp_f32 v46, v46
    v_exp_f32 v47, v47
    v_mfma_f32_32x32x16_bf16 v[184:199], a[108:111], v[28:31], v[184:199]
    v_exp_f32 v48, v48
    v_exp_f32 v49, v49
    v_exp_f32 v50, v50
    v_exp_f32 v51, v51
    v_exp_f32 v52, v52
    v_exp_f32 v53, v53
    v_exp_f32 v54, v54
    v_exp_f32 v55, v55
    v_pk_add_f32 v[208:209], v[208:209], v[40:41]
    v_pk_add_f32 v[210:211], v[210:211], v[42:43]
    v_pk_add_f32 v[208:209], v[208:209], v[44:45]
    v_pk_add_f32 v[210:211], v[210:211], v[46:47]
    v_pk_add_f32 v[208:209], v[208:209], v[48:49]
    v_pk_add_f32 v[210:211], v[210:211], v[50:51]
    v_pk_add_f32 v[208:209], v[208:209], v[52:53]
    v_pk_add_f32 v[210:211], v[210:211], v[54:55]
    v_cvt_pk_bf16_f32 v40, v40, v41
    v_cvt_pk_bf16_f32 v41, v42, v43
    v_cvt_pk_bf16_f32 v42, v44, v45
    v_cvt_pk_bf16_f32 v43, v46, v47
    v_cvt_pk_bf16_f32 v44, v48, v49
    v_cvt_pk_bf16_f32 v45, v50, v51
    v_cvt_pk_bf16_f32 v46, v52, v53
    v_cvt_pk_bf16_f32 v47, v54, v55
    v_pk_fma_f32 v[56:57], v[56:57], v[212:213], v[214:215] op_sel_hi:[1,0,0]
    v_pk_fma_f32 v[58:59], v[58:59], v[212:213], v[214:215] op_sel_hi:[1,0,0]
    v_pk_fma_f32 v[60:61], v[60:61], v[212:213], v[214:215] op_sel_hi:[1,0,0]
    v_pk_fma_f32 v[62:63], v[62:63], v[212:213], v[214:215] op_sel_hi:[1,0,0]
    v_pk_fma_f32 v[64:65], v[64:65], v[212:213], v[214:215] op_sel_hi:[1,0,0]
    v_pk_fma_f32 v[66:67], v[66:67], v[212:213], v[214:215] op_sel_hi:[1,0,0]
    v_pk_fma_f32 v[68:69], v[68:69], v[212:213], v[214:215] op_sel_hi:[1,0,0]
    v_pk_fma_f32 v[70:71], v[70:71], v[212:213], v[214:215] op_sel_hi:[1,0,0]
    s_waitcnt vmcnt(30)
    v_mfma_f32_32x32x16_bf16 v[184:199], a[112:115], v[40:43], v[184:199]
    v_exp_f32 v56, v56
    v_exp_f32 v57, v57
    v_exp_f32 v58, v58
    v_exp_f32 v59, v59
    v_exp_f32 v60, v60
    v_exp_f32 v61, v61
    v_exp_f32 v62, v62
    v_exp_f32 v63, v63
    v_mfma_f32_32x32x16_bf16 v[184:199], a[116:119], v[44:47], v[184:199]
    v_exp_f32 v64, v64
    v_exp_f32 v65, v65
    v_exp_f32 v66, v66
    v_exp_f32 v67, v67
    v_exp_f32 v68, v68
    v_exp_f32 v69, v69
    v_exp_f32 v70, v70
    v_exp_f32 v71, v71
    v_pk_add_f32 v[208:209], v[208:209], v[56:57]
    v_pk_add_f32 v[210:211], v[210:211], v[58:59]
    v_pk_add_f32 v[208:209], v[208:209], v[60:61]
    v_pk_add_f32 v[210:211], v[210:211], v[62:63]
    v_pk_add_f32 v[208:209], v[208:209], v[64:65]
    v_pk_add_f32 v[210:211], v[210:211], v[66:67]
    v_pk_add_f32 v[208:209], v[208:209], v[68:69]
    v_pk_add_f32 v[210:211], v[210:211], v[70:71]
    v_cvt_pk_bf16_f32 v56, v56, v57
    v_cvt_pk_bf16_f32 v57, v58, v59
    v_cvt_pk_bf16_f32 v58, v60, v61
    v_cvt_pk_bf16_f32 v59, v62, v63
    v_cvt_pk_bf16_f32 v60, v64, v65
    v_cvt_pk_bf16_f32 v61, v66, v67
    v_cvt_pk_bf16_f32 v62, v68, v69
    v_cvt_pk_bf16_f32 v63, v70, v71
    v_pk_fma_f32 v[72:73], v[72:73], v[212:213], v[214:215] op_sel_hi:[1,0,0]
    v_pk_fma_f32 v[74:75], v[74:75], v[212:213], v[214:215] op_sel_hi:[1,0,0]
    v_pk_fma_f32 v[76:77], v[76:77], v[212:213], v[214:215] op_sel_hi:[1,0,0]
    v_pk_fma_f32 v[78:79], v[78:79], v[212:213], v[214:215] op_sel_hi:[1,0,0]
    v_pk_fma_f32 v[80:81], v[80:81], v[212:213], v[214:215] op_sel_hi:[1,0,0]
    v_pk_fma_f32 v[82:83], v[82:83], v[212:213], v[214:215] op_sel_hi:[1,0,0]
    v_pk_fma_f32 v[84:85], v[84:85], v[212:213], v[214:215] op_sel_hi:[1,0,0]
    v_pk_fma_f32 v[86:87], v[86:87], v[212:213], v[214:215] op_sel_hi:[1,0,0]
    s_waitcnt vmcnt(28)
    v_mfma_f32_32x32x16_bf16 v[184:199], a[120:123], v[56:59], v[184:199]
    v_exp_f32 v72, v72
    v_exp_f32 v73, v73
    v_exp_f32 v74, v74
    v_exp_f32 v75, v75
    v_exp_f32 v76, v76
    v_exp_f32 v77, v77
    v_exp_f32 v78, v78
    v_exp_f32 v79, v79
    v_mfma_f32_32x32x16_bf16 v[184:199], a[124:127], v[60:63], v[184:199]
    v_exp_f32 v80, v80
    v_exp_f32 v81, v81
    v_exp_f32 v82, v82
    v_exp_f32 v83, v83
    v_exp_f32 v84, v84
    v_exp_f32 v85, v85
    v_exp_f32 v86, v86
    v_exp_f32 v87, v87
    v_pk_add_f32 v[208:209], v[208:209], v[72:73]
    v_pk_add_f32 v[210:211], v[210:211], v[74:75]
    v_pk_add_f32 v[208:209], v[208:209], v[76:77]
    v_pk_add_f32 v[210:211], v[210:211], v[78:79]
    v_pk_add_f32 v[208:209], v[208:209], v[80:81]
    v_pk_add_f32 v[210:211], v[210:211], v[82:83]
    v_pk_add_f32 v[208:209], v[208:209], v[84:85]
    v_pk_add_f32 v[210:211], v[210:211], v[86:87]
    v_cvt_pk_bf16_f32 v72, v72, v73
    v_cvt_pk_bf16_f32 v73, v74, v75
    v_cvt_pk_bf16_f32 v74, v76, v77
    v_cvt_pk_bf16_f32 v75, v78, v79
    v_cvt_pk_bf16_f32 v76, v80, v81
    v_cvt_pk_bf16_f32 v77, v82, v83
    v_cvt_pk_bf16_f32 v78, v84, v85
    v_cvt_pk_bf16_f32 v79, v86, v87
    v_pk_fma_f32 v[88:89], v[88:89], v[212:213], v[214:215] op_sel_hi:[1,0,0]
    v_pk_fma_f32 v[90:91], v[90:91], v[212:213], v[214:215] op_sel_hi:[1,0,0]
    v_pk_fma_f32 v[92:93], v[92:93], v[212:213], v[214:215] op_sel_hi:[1,0,0]
    v_pk_fma_f32 v[94:95], v[94:95], v[212:213], v[214:215] op_sel_hi:[1,0,0]
    v_pk_fma_f32 v[96:97], v[96:97], v[212:213], v[214:215] op_sel_hi:[1,0,0]
    v_pk_fma_f32 v[98:99], v[98:99], v[212:213], v[214:215] op_sel_hi:[1,0,0]
    v_pk_fma_f32 v[100:101], v[100:101], v[212:213], v[214:215] op_sel_hi:[1,0,0]
    v_pk_fma_f32 v[102:103], v[102:103], v[212:213], v[214:215] op_sel_hi:[1,0,0]
    s_waitcnt vmcnt(26)
    v_mfma_f32_32x32x16_bf16 v[184:199], a[128:131], v[72:75], v[184:199]
    v_exp_f32 v88, v88
    v_exp_f32 v89, v89
    v_exp_f32 v90, v90
    v_exp_f32 v91, v91
    v_exp_f32 v92, v92
    v_exp_f32 v93, v93
    v_exp_f32 v94, v94
    v_exp_f32 v95, v95
    v_mfma_f32_32x32x16_bf16 v[184:199], a[132:135], v[76:79], v[184:199]
    v_exp_f32 v96, v96
    v_exp_f32 v97, v97
    v_exp_f32 v98, v98
    v_exp_f32 v99, v99
    v_exp_f32 v100, v100
    v_exp_f32 v101, v101
    v_exp_f32 v102, v102
    v_exp_f32 v103, v103
    v_pk_add_f32 v[208:209], v[208:209], v[88:89]
    v_pk_add_f32 v[210:211], v[210:211], v[90:91]
    v_pk_add_f32 v[208:209], v[208:209], v[92:93]
    v_pk_add_f32 v[210:211], v[210:211], v[94:95]
    v_pk_add_f32 v[208:209], v[208:209], v[96:97]
    v_pk_add_f32 v[210:211], v[210:211], v[98:99]
    v_pk_add_f32 v[208:209], v[208:209], v[100:101]
    v_pk_add_f32 v[210:211], v[210:211], v[102:103]
    v_cvt_pk_bf16_f32 v88, v88, v89
    v_cvt_pk_bf16_f32 v89, v90, v91
    v_cvt_pk_bf16_f32 v90, v92, v93
    v_cvt_pk_bf16_f32 v91, v94, v95
    v_cvt_pk_bf16_f32 v92, v96, v97
    v_cvt_pk_bf16_f32 v93, v98, v99
    v_cvt_pk_bf16_f32 v94, v100, v101
    v_cvt_pk_bf16_f32 v95, v102, v103
    v_pk_fma_f32 v[104:105], v[104:105], v[212:213], v[214:215] op_sel_hi:[1,0,0]
    v_pk_fma_f32 v[106:107], v[106:107], v[212:213], v[214:215] op_sel_hi:[1,0,0]
    v_pk_fma_f32 v[108:109], v[108:109], v[212:213], v[214:215] op_sel_hi:[1,0,0]
    v_pk_fma_f32 v[110:111], v[110:111], v[212:213], v[214:215] op_sel_hi:[1,0,0]
    v_pk_fma_f32 v[112:113], v[112:113], v[212:213], v[214:215] op_sel_hi:[1,0,0]
    v_pk_fma_f32 v[114:115], v[114:115], v[212:213], v[214:215] op_sel_hi:[1,0,0]
    v_pk_fma_f32 v[116:117], v[116:117], v[212:213], v[214:215] op_sel_hi:[1,0,0]
    v_pk_fma_f32 v[118:119], v[118:119], v[212:213], v[214:215] op_sel_hi:[1,0,0]
    s_waitcnt vmcnt(24)
    v_mfma_f32_32x32x16_bf16 v[184:199], a[136:139], v[88:91], v[184:199]
    v_exp_f32 v104, v104
    v_exp_f32 v105, v105
    v_exp_f32 v106, v106
    v_exp_f32 v107, v107
    v_exp_f32 v108, v108
    v_exp_f32 v109, v109
    v_exp_f32 v110, v110
    v_exp_f32 v111, v111
    v_mfma_f32_32x32x16_bf16 v[184:199], a[140:143], v[92:95], v[184:199]
    v_exp_f32 v112, v112
    v_exp_f32 v113, v113
    v_exp_f32 v114, v114
    v_exp_f32 v115, v115
    v_exp_f32 v116, v116
    v_exp_f32 v117, v117
    v_exp_f32 v118, v118
    v_exp_f32 v119, v119
    v_pk_add_f32 v[208:209], v[208:209], v[104:105]
    v_pk_add_f32 v[210:211], v[210:211], v[106:107]
    v_pk_add_f32 v[208:209], v[208:209], v[108:109]
    v_pk_add_f32 v[210:211], v[210:211], v[110:111]
    v_pk_add_f32 v[208:209], v[208:209], v[112:113]
    v_pk_add_f32 v[210:211], v[210:211], v[114:115]
    v_pk_add_f32 v[208:209], v[208:209], v[116:117]
    v_pk_add_f32 v[210:211], v[210:211], v[118:119]
    v_cvt_pk_bf16_f32 v104, v104, v105
    v_cvt_pk_bf16_f32 v105, v106, v107
    v_cvt_pk_bf16_f32 v106, v108, v109
    v_cvt_pk_bf16_f32 v107, v110, v111
    v_cvt_pk_bf16_f32 v108, v112, v113
    v_cvt_pk_bf16_f32 v109, v114, v115
    v_cvt_pk_bf16_f32 v110, v116, v117
    v_cvt_pk_bf16_f32 v111, v118, v119
    v_pk_fma_f32 v[120:121], v[120:121], v[212:213], v[214:215] op_sel_hi:[1,0,0]
    v_pk_fma_f32 v[122:123], v[122:123], v[212:213], v[214:215] op_sel_hi:[1,0,0]
    v_pk_fma_f32 v[124:125], v[124:125], v[212:213], v[214:215] op_sel_hi:[1,0,0]
    v_pk_fma_f32 v[126:127], v[126:127], v[212:213], v[214:215] op_sel_hi:[1,0,0]
    v_pk_fma_f32 v[128:129], v[128:129], v[212:213], v[214:215] op_sel_hi:[1,0,0]
    v_pk_fma_f32 v[130:131], v[130:131], v[212:213], v[214:215] op_sel_hi:[1,0,0]
    v_pk_fma_f32 v[132:133], v[132:133], v[212:213], v[214:215] op_sel_hi:[1,0,0]
    v_pk_fma_f32 v[134:135], v[134:135], v[212:213], v[214:215] op_sel_hi:[1,0,0]
    s_waitcnt vmcnt(22)
    v_mfma_f32_32x32x16_bf16 v[184:199], a[144:147], v[104:107], v[184:199]
    v_exp_f32 v120, v120
    v_exp_f32 v121, v121
    v_exp_f32 v122, v122
    v_exp_f32 v123, v123
    v_exp_f32 v124, v124
    v_exp_f32 v125, v125
    v_exp_f32 v126, v126
    v_exp_f32 v127, v127
    v_mfma_f32_32x32x16_bf16 v[184:199], a[148:151], v[108:111], v[184:199]
    v_exp_f32 v128, v128
    v_exp_f32 v129, v129
    v_exp_f32 v130, v130
    v_exp_f32 v131, v131
    v_exp_f32 v132, v132
    v_exp_f32 v133, v133
    v_exp_f32 v134, v134
    v_exp_f32 v135, v135
    v_pk_add_f32 v[208:209], v[208:209], v[120:121]
    v_pk_add_f32 v[210:211], v[210:211], v[122:123]
    v_pk_add_f32 v[208:209], v[208:209], v[124:125]
    v_pk_add_f32 v[210:211], v[210:211], v[126:127]
    v_pk_add_f32 v[208:209], v[208:209], v[128:129]
    v_pk_add_f32 v[210:211], v[210:211], v[130:131]
    v_pk_add_f32 v[208:209], v[208:209], v[132:133]
    v_pk_add_f32 v[210:211], v[210:211], v[134:135]
    v_cvt_pk_bf16_f32 v120, v120, v121
    v_cvt_pk_bf16_f32 v121, v122, v123
    v_cvt_pk_bf16_f32 v122, v124, v125
    v_cvt_pk_bf16_f32 v123, v126, v127
    v_cvt_pk_bf16_f32 v124, v128, v129
    v_cvt_pk_bf16_f32 v125, v130, v131
    v_cvt_pk_bf16_f32 v126, v132, v133
    v_cvt_pk_bf16_f32 v127, v134, v135
    v_pk_fma_f32 v[136:137], v[136:137], v[212:213], v[214:215] op_sel_hi:[1,0,0]
    v_pk_fma_f32 v[138:139], v[138:139], v[212:213], v[214:215] op_sel_hi:[1,0,0]
    v_pk_fma_f32 v[140:141], v[140:141], v[212:213], v[214:215] op_sel_hi:[1,0,0]
    v_pk_fma_f32 v[142:143], v[142:143], v[212:213], v[214:215] op_sel_hi:[1,0,0]
    v_pk_fma_f32 v[144:145], v[144:145], v[212:213], v[214:215] op_sel_hi:[1,0,0]
    v_pk_fma_f32 v[146:147], v[146:147], v[212:213], v[214:215] op_sel_hi:[1,0,0]
    v_pk_fma_f32 v[148:149], v[148:149], v[212:213], v[214:215] op_sel_hi:[1,0,0]
    v_pk_fma_f32 v[150:151], v[150:151], v[212:213], v[214:215] op_sel_hi:[1,0,0]
    s_waitcnt vmcnt(20)
    v_mfma_f32_32x32x16_bf16 v[184:199], a[152:155], v[120:123], v[184:199]
    v_exp_f32 v136, v136
    v_exp_f32 v137, v137
    v_exp_f32 v138, v138
    v_exp_f32 v139, v139
    v_exp_f32 v140, v140
    v_exp_f32 v141, v141
    v_exp_f32 v142, v142
    v_exp_f32 v143, v143
    v_mfma_f32_32x32x16_bf16 v[184:199], a[156:159], v[124:127], v[184:199]
    v_exp_f32 v144, v144
    v_exp_f32 v145, v145
    v_exp_f32 v146, v146
    v_exp_f32 v147, v147
    v_exp_f32 v148, v148
    v_exp_f32 v149, v149
    v_exp_f32 v150, v150
    v_exp_f32 v151, v151
    v_pk_add_f32 v[208:209], v[208:209], v[136:137]
    v_pk_add_f32 v[210:211], v[210:211], v[138:139]
    v_pk_add_f32 v[208:209], v[208:209], v[140:141]
    v_pk_add_f32 v[210:211], v[210:211], v[142:143]
    v_pk_add_f32 v[208:209], v[208:209], v[144:145]
    v_pk_add_f32 v[210:211], v[210:211], v[146:147]
    v_pk_add_f32 v[208:209], v[208:209], v[148:149]
    v_pk_add_f32 v[210:211], v[210:211], v[150:151]
    v_cvt_pk_bf16_f32 v136, v136, v137
    v_cvt_pk_bf16_f32 v137, v138, v139
    v_cvt_pk_bf16_f32 v138, v140, v141
    v_cvt_pk_bf16_f32 v139, v142, v143
    v_cvt_pk_bf16_f32 v140, v144, v145
    v_cvt_pk_bf16_f32 v141, v146, v147
    v_cvt_pk_bf16_f32 v142, v148, v149
    v_cvt_pk_bf16_f32 v143, v150, v151
    s_waitcnt vmcnt(18)
    v_pk_add_f32 v[208:209], v[208:209], v[210:211]
    v_mfma_f32_32x32x16_bf16 v[184:199], a[160:163], v[136:139], v[184:199]
    v_mfma_f32_32x32x16_bf16 v[184:199], a[164:167], v[140:143], v[184:199]
    v_add_f32 v208, v208, v209
    v_mov_b32 v209, v208
    s_nop 1
    v_permlane32_swap_b32 v208, v209
    v_add_f32 v208, v208, v209
    v_rcp_f32 v208, v208
    s_add_u32 s52, s49, 0
    s_nop 3
    v_pk_mul_f32 v[184:185], v[184:185], v[208:209] op_sel_hi:[1,0]
    v_pk_mul_f32 v[186:187], v[186:187], v[208:209] op_sel_hi:[1,0]
    v_pk_mul_f32 v[188:189], v[188:189], v[208:209] op_sel_hi:[1,0]
    v_pk_mul_f32 v[190:191], v[190:191], v[208:209] op_sel_hi:[1,0]
    v_pk_mul_f32 v[192:193], v[192:193], v[208:209] op_sel_hi:[1,0]
    v_pk_mul_f32 v[194:195], v[194:195], v[208:209] op_sel_hi:[1,0]
    v_pk_mul_f32 v[196:197], v[196:197], v[208:209] op_sel_hi:[1,0]
    v_pk_mul_f32 v[198:199], v[198:199], v[208:209] op_sel_hi:[1,0]
    v_cvt_pk_bf16_f32 v200, v184, v185
    v_cvt_pk_bf16_f32 v201, v186, v187
    v_cvt_pk_bf16_f32 v202, v188, v189
    v_cvt_pk_bf16_f32 v203, v190, v191
    v_cvt_pk_bf16_f32 v204, v192, v193
    v_cvt_pk_bf16_f32 v205, v194, v195
    v_cvt_pk_bf16_f32 v206, v196, v197
    v_cvt_pk_bf16_f32 v207, v198, v199
    buffer_store_dwordx4 v[200:203], v222, s[32:35], s52 offen offset:0 sc1
    buffer_store_dwordx4 v[204:207], v222, s[32:35], s52 offen offset:1024 sc1
    s_waitcnt vmcnt(18)
    v_mfma_f32_32x32x16_bf16 v[8:23], a[8:11], a[200:203], v[152:167]
    v_mfma_f32_32x32x16_bf16 v[8:23], a[12:15], a[204:207], v[8:23]
    v_mfma_f32_32x32x16_bf16 v[24:39], a[16:19], a[200:203], 0
    v_mfma_f32_32x32x16_bf16 v[24:39], a[20:23], a[204:207], v[24:39]
    v_mfma_f32_32x32x16_bf16 v[40:55], a[24:27], a[200:203], 0
    v_mfma_f32_32x32x16_bf16 v[40:55], a[28:31], a[204:207], v[40:55]
    s_nop 7
    v_max3_f32 v218, v8, v9, v10
    v_max3_f32 v219, v11, v12, v13
    v_max3_f32 v218, v218, v14, v15
    v_max3_f32 v219, v219, v16, v17
    v_max3_f32 v218, v218, v18, v19
    v_max3_f32 v219, v219, v20, v21
    v_max3_f32 v218, v218, v22, v23
    v_mfma_f32_32x32x16_bf16 v[56:71], a[32:35], a[200:203], 0
    v_mfma_f32_32x32x16_bf16 v[56:71], a[36:39], a[204:207], v[56:71]
    v_max3_f32 v218, v218, v24, v25
    v_max3_f32 v219, v219, v26, v27
    v_max3_f32 v218, v218, v28, v29
    v_max3_f32 v219, v219, v30, v31
    v_max3_f32 v218, v218, v32, v33
    v_max3_f32 v219, v219, v34, v35
    v_max3_f32 v218, v218, v36, v37
    v_max3_f32 v219, v219, v38, v39
    v_mfma_f32_32x32x16_bf16 v[72:87], a[40:43], a[200:203], 0
    v_mfma_f32_32x32x16_bf16 v[72:87], a[44:47], a[204:207], v[72:87]
    v_max3_f32 v218, v218, v40, v41
    v_max3_f32 v219, v219, v42, v43
    v_max3_f32 v218, v218, v44, v45
    v_max3_f32 v219, v219, v46, v47
    v_max3_f32 v218, v218, v48, v49
    v_max3_f32 v219, v219, v50, v51
    v_max3_f32 v218, v218, v52, v53
    v_max3_f32 v219, v219, v54, v55
    v_mfma_f32_32x32x16_bf16 v[88:103], a[48:51], a[200:203], 0
    v_mfma_f32_32x32x16_bf16 v[88:103], a[52:55], a[204:207], v[88:103]
    v_max3_f32 v218, v218, v56, v57
    v_max3_f32 v219, v219, v58, v59
    v_max3_f32 v218, v218, v60, v61
    v_max3_f32 v219, v219, v62, v63
    v_max3_f32 v218, v218, v64, v65
    v_max3_f32 v219, v219, v66, v67
    v_max3_f32 v218, v218, v68, v69
    v_max3_f32 v219, v219, v70, v71
    v_mfma_f32_32x32x16_bf16 v[104:119], a[56:59], a[200:203], 0
    v_mfma_f32_32x32x16_bf16 v[104:119], a[60:63], a[204:207], v[104:119]
    v_max3_f32 v218, v218, v72, v73
    v_max3_f32 v219, v219, v74, v75
    v_max3_f32 v218, v218, v76, v77
    v_max3_f32 v219, v219, v78, v79
    v_max3_f32 v218, v218, v80, v81
    v_max3_f32 v219, v219, v82, v83
    v_max3_f32 v218, v218, v84, v85
    v_max3_f32 v219, v219, v86, v87
    v_mfma_f32_32x32x16_bf16 v[120:135], a[64:67], a[200:203], 0
    v_mfma_f32_32x32x16_bf16 v[120:135], a[68:71], a[204:207], v[120:135]
    v_max3_f32 v218, v218, v88, v89
    v_max3_f32 v219, v219, v90, v91
    v_max3_f32 v218, v218, v92, v93
    v_max3_f32 v219, v219, v94, v95
    v_max3_f32 v218, v218, v96, v97
    v_max3_f32 v219, v219, v98, v99
    v_max3_f32 v218, v218, v100, v101
    v_max3_f32 v219, v219, v102, v103
    s_waitcnt vmcnt(16)
    v_mfma_f32_32x32x16_bf16 v[136:151], a[72:75], a[200:203], v[168:183]
    v_mfma_f32_32x32x16_bf16 v[136:151], a[76:79], a[204:207], v[136:151]
    v_max3_f32 v218, v218, v104, v105
    v_max3_f32 v219, v219, v106, v107
    v_max3_f32 v218, v218, v108, v109
    v_max3_f32 v219, v219, v110, v111
    v_max3_f32 v218, v218, v112, v113
    v_max3_f32 v219, v219, v114, v115
    v_max3_f32 v218, v218, v116, v117
    v_max3_f32 v219, v219, v118, v119
    s_cmp_lt_u32 s50, 8
    s_cbranch_scc1 bfix_216
    v_max3_f32 v218, v218, v120, v121
    v_max3_f32 v219, v219, v122, v123
    v_max3_f32 v218, v218, v124, v125
    v_max3_f32 v219, v219, v126, v127
    v_max3_f32 v218, v218, v128, v129
    v_max3_f32 v219, v219, v130, v131
    v_max3_f32 v218, v218, v132, v133
    v_max3_f32 v219, v219, v134, v135
    v_max3_f32 v218, v218, v136, v137
    v_max3_f32 v219, v219, v138, v139
    v_max3_f32 v218, v218, v140, v141
    v_max3_f32 v219, v219, v142, v143
    v_max3_f32 v218, v218, v144, v145
    v_max3_f32 v219, v219, v146, v147
    v_max3_f32 v218, v218, v148, v149
    v_max3_f32 v219, v219, v150, v151
    v_max_f32 v218, v218, v219
    s_branch bok_215
bfix_216:
    s_nop 15
    s_cmp_ge_u32 s50, 7
    s_cbranch_scc1 bf2_217
    v_mov_b32 v8, v217
    v_mov_b32 v9, v217
    v_mov_b32 v10, v217
    v_mov_b32 v11, v217
    v_mov_b32 v12, v217
    v_mov_b32 v13, v217
    v_mov_b32 v14, v217
    v_mov_b32 v15, v217
    v_mov_b32 v16, v217
    v_mov_b32 v17, v217
    v_mov_b32 v18, v217
    v_mov_b32 v19, v217
    v_mov_b32 v20, v217
    v_mov_b32 v21, v217
    v_mov_b32 v22, v217
    v_mov_b32 v23, v217
    s_cmp_ge_u32 s50, 6
    s_cbranch_scc1 bf2_217
    v_mov_b32 v24, v217
    v_mov_b32 v25, v217
    v_mov_b32 v26, v217
    v_mov_b32 v27, v217
    v_mov_b32 v28, v217
    v_mov_b32 v29, v217
    v_mov_b32 v30, v217
    v_mov_b32 v31, v217
    v_mov_b32 v32, v217
    v_mov_b32 v33, v217
    v_mov_b32 v34, v217
    v_mov_b32 v35, v217
    v_mov_b32 v36, v217
    v_mov_b32 v37, v217
    v_mov_b32 v38, v217
    v_mov_b32 v39, v217
    s_cmp_ge_u32 s50, 5
    s_cbranch_scc1 bf2_217
    v_mov_b32 v40, v217
    v_mov_b32 v41, v217
    v_mov_b32 v42, v217
    v_mov_b32 v43, v217
    v_mov_b32 v44, v217
    v_mov_b32 v45, v217
    v_mov_b32 v46, v217
    v_mov_b32 v47, v217
    v_mov_b32 v48, v217
    v_mov_b32 v49, v217
    v_mov_b32 v50, v217
    v_mov_b32 v51, v217
    v_mov_b32 v52, v217
    v_mov_b32 v53, v217
    v_mov_b32 v54, v217
    v_mov_b32 v55, v217
    s_cmp_ge_u32 s50, 4
    s_cbranch_scc1 bf2_217
    v_mov_b32 v56, v217
    v_mov_b32 v57, v217
    v_mov_b32 v58, v217
    v_mov_b32 v59, v217
    v_mov_b32 v60, v217
    v_mov_b32 v61, v217
    v_mov_b32 v62, v217
    v_mov_b32 v63, v217
    v_mov_b32 v64, v217
    v_mov_b32 v65, v217
    v_mov_b32 v66, v217
    v_mov_b32 v67, v217
    v_mov_b32 v68, v217
    v_mov_b32 v69, v217
    v_mov_b32 v70, v217
    v_mov_b32 v71, v217
    s_cmp_ge_u32 s50, 3
    s_cbranch_scc1 bf2_217
    v_mov_b32 v72, v217
    v_mov_b32 v73, v217
    v_mov_b32 v74, v217
    v_mov_b32 v75, v217
    v_mov_b32 v76, v217
    v_mov_b32 v77, v217
    v_mov_b32 v78, v217
    v_mov_b32 v79, v217
    v_mov_b32 v80, v217
    v_mov_b32 v81, v217
    v_mov_b32 v82, v217
    v_mov_b32 v83, v217
    v_mov_b32 v84, v217
    v_mov_b32 v85, v217
    v_mov_b32 v86, v217
    v_mov_b32 v87, v217
    s_cmp_ge_u32 s50, 2
    s_cbranch_scc1 bf2_217
    v_mov_b32 v88, v217
    v_mov_b32 v89, v217
    v_mov_b32 v90, v217
    v_mov_b32 v91, v217
    v_mov_b32 v92, v217
    v_mov_b32 v93, v217
    v_mov_b32 v94, v217
    v_mov_b32 v95, v217
    v_mov_b32 v96, v217
    v_mov_b32 v97, v217
    v_mov_b32 v98, v217
    v_mov_b32 v99, v217
    v_mov_b32 v100, v217
    v_mov_b32 v101, v217
    v_mov_b32 v102, v217
    v_mov_b32 v103, v217
    s_cmp_ge_u32 s50, 1
    s_cbranch_scc1 bf2_217
    v_mov_b32 v104, v217
    v_mov_b32 v105, v217
    v_mov_b32 v106, v217
    v_mov_b32 v107, v217
    v_mov_b32 v108, v217
    v_mov_b32 v109, v217
    v_mov_b32 v110, v217
    v_mov_b32 v111, v217
    v_mov_b32 v112, v217
    v_mov_b32 v113, v217
    v_mov_b32 v114, v217
    v_mov_b32 v115, v217
    v_mov_b32 v116, v217
    v_mov_b32 v117, v217
    v_mov_b32 v118, v217
    v_mov_b32 v119, v217
    s_cmp_ge_u32 s50, 0
    s_cbranch_scc1 bf2_217
    v_mov_b32 v120, v217
    v_mov_b32 v121, v217
    v_mov_b32 v122, v217
    v_mov_b32 v123, v217
    v_mov_b32 v124, v217
    v_mov_b32 v125, v217
    v_mov_b32 v126, v217
    v_mov_b32 v127, v217
    v_mov_b32 v128, v217
    v_mov_b32 v129, v217
    v_mov_b32 v130, v217
    v_mov_b32 v131, v217
    v_mov_b32 v132, v217
    v_mov_b32 v133, v217
    v_mov_b32 v134, v217
    v_mov_b32 v135, v217
bf2_217:
    v_max3_f32 v218, v8, v9, v10
    v_max3_f32 v219, v11, v12, v13
    v_max3_f32 v218, v218, v14, v15
    v_max3_f32 v219, v219, v16, v17
    v_max3_f32 v218, v218, v18, v19
    v_max3_f32 v219, v219, v20, v21
    v_max3_f32 v218, v218, v22, v23
    v_max3_f32 v219, v219, v24, v25
    v_max3_f32 v218, v218, v26, v27
    v_max3_f32 v219, v219, v28, v29
    v_max3_f32 v218, v218, v30, v31
    v_max3_f32 v219, v219, v32, v33
    v_max3_f32 v218, v218, v34, v35
    v_max3_f32 v219, v219, v36, v37
    v_max3_f32 v218, v218, v38, v39
    v_max3_f32 v219, v219, v40, v41
    v_max3_f32 v218, v218, v42, v43
    v_max3_f32 v219, v219, v44, v45
    v_max3_f32 v218, v218, v46, v47
    v_max3_f32 v219, v219, v48, v49
    v_max3_f32 v218, v218, v50, v51
    v_max3_f32 v219, v219, v52, v53
    v_max3_f32 v218, v218, v54, v55
    v_max3_f32 v219, v219, v56, v57
    v_max3_f32 v218, v218, v58, v59
    v_max3_f32 v219, v219, v60, v61
    v_max3_f32 v218, v218, v62, v63
    v_max3_f32 v219, v219, v64, v65
    v_max3_f32 v218, v218, v66, v67
    v_max3_f32 v219, v219, v68, v69
    v_max3_f32 v218, v218, v70, v71
    v_max3_f32 v219, v219, v72, v73
    v_max3_f32 v218, v218, v74, v75
    v_max3_f32 v219, v219, v76, v77
    v_max3_f32 v218, v218, v78, v79
    v_max3_f32 v219, v219, v80, v81
    v_max3_f32 v218, v218, v82, v83
    v_max3_f32 v219, v219, v84, v85
    v_max3_f32 v218, v218, v86, v87
    v_max3_f32 v219, v219, v88, v89
    v_max3_f32 v218, v218, v90, v91
    v_max3_f32 v219, v219, v92, v93
    v_max3_f32 v218, v218, v94, v95
    v_max3_f32 v219, v219, v96, v97
    v_max3_f32 v218, v218, v98, v99
    v_max3_f32 v219, v219, v100, v101
    v_max3_f32 v218, v218, v102, v103
    v_max3_f32 v219, v219, v104, v105
    v_max3_f32 v218, v218, v106, v107
    v_max3_f32 v219, v219, v108, v109
    v_max3_f32 v218, v218, v110, v111
    v_max3_f32 v219, v219, v112, v113
    v_max3_f32 v218, v218, v114, v115
    v_max3_f32 v219, v219, v116, v117
    v_max3_f32 v218, v218, v118, v119
    v_max3_f32 v219, v219, v120, v121
    v_max3_f32 v218, v218, v122, v123
    v_max3_f32 v219, v219, v124, v125
    v_max3_f32 v218, v218, v126, v127
    v_max3_f32 v219, v219, v128, v129
    v_max3_f32 v218, v218, v130, v131
    v_max3_f32 v219, v219, v132, v133
    v_max3_f32 v218, v218, v134, v135
    v_max3_f32 v219, v219, v136, v137
    v_max3_f32 v218, v218, v138, v139
    v_max3_f32 v219, v219, v140, v141
    v_max3_f32 v218, v218, v142, v143
    v_max3_f32 v219, v219, v144, v145
    v_max3_f32 v218, v218, v146, v147
    v_max3_f32 v219, v219, v148, v149
    v_max3_f32 v218, v218, v150, v151
    v_max_f32 v218, v218, v219
bok_215:
    v_mov_b32 v219, v218
    s_nop 1
    v_permlane32_swap_b32 v218, v219
    v_max_f32 v218, v218, v219
    v_mul_f32 v214, v212, -v218
    v_pk_fma_f32 v[8:9], v[8:9], v[212:213], v[214:215] op_sel_hi:[1,0,0]
    v_pk_fma_f32 v[10:11], v[10:11], v[212:213], v[214:215] op_sel_hi:[1,0,0]
    v_pk_fma_f32 v[12:13], v[12:13], v[212:213], v[214:215] op_sel_hi:[1,0,0]
    v_pk_fma_f32 v[14:15], v[14:15], v[212:213], v[214:215] op_sel_hi:[1,0,0]
    v_pk_fma_f32 v[16:17], v[16:17], v[212:213], v[214:215] op_sel_hi:[1,0,0]
    v_pk_fma_f32 v[18:19], v[18:19], v[212:213], v[214:215] op_sel_hi:[1,0,0]
    v_pk_fma_f32 v[20:21], v[20:21], v[212:213], v[214:215] op_sel_hi:[1,0,0]
    v_pk_fma_f32 v[22:23], v[22:23], v[212:213], v[214:215] op_sel_hi:[1,0,0]
    v_exp_f32 v8, v8
    v_exp_f32 v9, v9
    v_exp_f32 v10, v10
    v_exp_f32 v11, v11
    v_exp_f32 v12, v12
    v_exp_f32 v13, v13
    v_exp_f32 v14, v14
    v_exp_f32 v15, v15
    v_exp_f32 v16, v16
    v_exp_f32 v17, v17
    v_exp_f32 v18, v18
    v_exp_f32 v19, v19
    v_exp_f32 v20, v20
    v_exp_f32 v21, v21
    v_exp_f32 v22, v22
    v_exp_f32 v23, v23
    v_pk_add_f32 v[208:209], v[8:9], 0
    v_pk_add_f32 v[210:211], v[10:11], 0
    v_pk_add_f32 v[208:209], v[208:209], v[12:13]
    v_pk_add_f32 v[210:211], v[210:211], v[14:15]
    v_pk_add_f32 v[208:209], v[208:209], v[16:17]
    v_pk_add_f32 v[210:211], v[210:211], v[18:19]
    v_pk_add_f32 v[208:209], v[208:209], v[20:21]
    v_pk_add_f32 v[210:211], v[210:211], v[22:23]
    v_cvt_pk_bf16_f32 v8, v8, v9
    v_cvt_pk_bf16_f32 v9, v10, v11
    v_cvt_pk_bf16_f32 v10, v12, v13
    v_cvt_pk_bf16_f32 v11, v14, v15
    v_cvt_pk_bf16_f32 v12, v16, v17
    v_cvt_pk_bf16_f32 v13, v18, v19
    v_cvt_pk_bf16_f32 v14, v20, v21
    v_cvt_pk_bf16_f32 v15, v22, v23
    v_pk_fma_f32 v[24:25], v[24:25], v[212:213], v[214:215] op_sel_hi:[1,0,0]
    v_pk_fma_f32 v[26:27], v[26:27], v[212:213], v[214:215] op_sel_hi:[1,0,0]
    v_pk_fma_f32 v[28:29], v[28:29], v[212:213], v[214:215] op_sel_hi:[1,0,0]
    v_pk_fma_f32 v[30:31], v[30:31], v[212:213], v[214:215] op_sel_hi:[1,0,0]
    v_pk_fma_f32 v[32:33], v[32:33], v[212:213], v[214:215] op_sel_hi:[1,0,0]
    v_pk_fma_f32 v[34:35], v[34:35], v[212:213], v[214:215] op_sel_hi:[1,0,0]
    v_pk_fma_f32 v[36:37], v[36:37], v[212:213], v[214:215] op_sel_hi:[1,0,0]
    v_pk_fma_f32 v[38:39], v[38:39], v[212:213], v[214:215] op_sel_hi:[1,0,0]
    v_mfma_f32_32x32x16_bf16 v[184:199], a[104:107], v[8:11], 0
    v_exp_f32 v24, v24
    v_exp_f32 v25, v25
    v_exp_f32 v26, v26
    v_exp_f32 v27, v27
    v_exp_f32 v28, v28
    v_exp_f32 v29, v29
    v_exp_f32 v30, v30
    v_exp_f32 v31, v31
    v_mfma_f32_32x32x16_bf16 v[184:199], a[108:111], v[12:15], v[184:199]
    v_exp_f32 v32, v32
    v_exp_f32 v33, v33
    v_exp_f32 v34, v34
    v_exp_f32 v35, v35
    v_exp_f32 v36, v36
    v_exp_f32 v37, v37
    v_exp_f32 v38, v38
    v_exp_f32 v39, v39
    v_pk_add_f32 v[208:209], v[208:209], v[24:25]
    v_pk_add_f32 v[210:211], v[210:211], v[26:27]
    v_pk_add_f32 v[208:209], v[208:209], v[28:29]
    v_pk_add_f32 v[210:211], v[210:211], v[30:31]
    v_pk_add_f32 v[208:209], v[208:209], v[32:33]
    v_pk_add_f32 v[210:211], v[210:211], v[34:35]
    v_pk_add_f32 v[208:209], v[208:209], v[36:37]
    v_pk_add_f32 v[210:211], v[210:211], v[38:39]
    v_cvt_pk_bf16_f32 v24, v24, v25
    v_cvt_pk_bf16_f32 v25, v26, v27
    v_cvt_pk_bf16_f32 v26, v28, v29
    v_cvt_pk_bf16_f32 v27, v30, v31
    v_cvt_pk_bf16_f32 v28, v32, v33
    v_cvt_pk_bf16_f32 v29, v34, v35
    v_cvt_pk_bf16_f32 v30, v36, v37
    v_cvt_pk_bf16_f32 v31, v38, v39
    v_pk_fma_f32 v[40:41], v[40:41], v[212:213], v[214:215] op_sel_hi:[1,0,0]
    v_pk_fma_f32 v[42:43], v[42:43], v[212:213], v[214:215] op_sel_hi:[1,0,0]
    v_pk_fma_f32 v[44:45], v[44:45], v[212:213], v[214:215] op_sel_hi:[1,0,0]
    v_pk_fma_f32 v[46:47], v[46:47], v[212:213], v[214:215] op_sel_hi:[1,0,0]
    v_pk_fma_f32 v[48:49], v[48:49], v[212:213], v[214:215] op_sel_hi:[1,0,0]
    v_pk_fma_f32 v[50:51], v[50:51], v[212:213], v[214:215] op_sel_hi:[1,0,0]
    v_pk_fma_f32 v[52:53], v[52:53], v[212:213], v[214:215] op_sel_hi:[1,0,0]
    v_pk_fma_f32 v[54:55], v[54:55], v[212:213], v[214:215] op_sel_hi:[1,0,0]
    v_mfma_f32_32x32x16_bf16 v[184:199], a[112:115], v[24:27], v[184:199]
    v_exp_f32 v40, v40
    v_exp_f32 v41, v41
    v_exp_f32 v42, v42
    v_exp_f32 v43, v43
    v_exp_f32 v44, v44
    v_exp_f32 v45, v45
    v_exp_f32 v46, v46
    v_exp_f32 v47, v47
    v_mfma_f32_32x32x16_bf16 v[184:199], a[116:119], v[28:31], v[184:199]
    v_exp_f32 v48, v48
    v_exp_f32 v49, v49
    v_exp_f32 v50, v50
    v_exp_f32 v51, v51
    v_exp_f32 v52, v52
    v_exp_f32 v53, v53
    v_exp_f32 v54, v54
    v_exp_f32 v55, v55
    v_pk_add_f32 v[208:209], v[208:209], v[40:41]
    v_pk_add_f32 v[210:211], v[210:211], v[42:43]
    v_pk_add_f32 v[208:209], v[208:209], v[44:45]
    v_pk_add_f32 v[210:211], v[210:211], v[46:47]
    v_pk_add_f32 v[208:209], v[208:209], v[48:49]
    v_pk_add_f32 v[210:211], v[210:211], v[50:51]
    v_pk_add_f32 v[208:209], v[208:209], v[52:53]
    v_pk_add_f32 v[210:211], v[210:211], v[54:55]
    v_cvt_pk_bf16_f32 v40, v40, v41
    v_cvt_pk_bf16_f32 v41, v42, v43
    v_cvt_pk_bf16_f32 v42, v44, v45
    v_cvt_pk_bf16_f32 v43, v46, v47
    v_cvt_pk_bf16_f32 v44, v48, v49
    v_cvt_pk_bf16_f32 v45, v50, v51
    v_cvt_pk_bf16_f32 v46, v52, v53
    v_cvt_pk_bf16_f32 v47, v54, v55
    v_pk_fma_f32 v[56:57], v[56:57], v[212:213], v[214:215] op_sel_hi:[1,0,0]
    v_pk_fma_f32 v[58:59], v[58:59], v[212:213], v[214:215] op_sel_hi:[1,0,0]
    v_pk_fma_f32 v[60:61], v[60:61], v[212:213], v[214:215] op_sel_hi:[1,0,0]
    v_pk_fma_f32 v[62:63], v[62:63], v[212:213], v[214:215] op_sel_hi:[1,0,0]
    v_pk_fma_f32 v[64:65], v[64:65], v[212:213], v[214:215] op_sel_hi:[1,0,0]
    v_pk_fma_f32 v[66:67], v[66:67], v[212:213], v[214:215] op_sel_hi:[1,0,0]
    v_pk_fma_f32 v[68:69], v[68:69], v[212:213], v[214:215] op_sel_hi:[1,0,0]
    v_pk_fma_f32 v[70:71], v[70:71], v[212:213], v[214:215] op_sel_hi:[1,0,0]
    v_mfma_f32_32x32x16_bf16 v[184:199], a[120:123], v[40:43], v[184:199]
    v_exp_f32 v56, v56
    v_exp_f32 v57, v57
    v_exp_f32 v58, v58
    v_exp_f32 v59, v59
    v_exp_f32 v60, v60
    v_exp_f32 v61, v61
    v_exp_f32 v62, v62
    v_exp_f32 v63, v63
    v_mfma_f32_32x32x16_bf16 v[184:199], a[124:127], v[44:47], v[184:199]
    v_exp_f32 v64, v64
    v_exp_f32 v65, v65
    v_exp_f32 v66, v66
    v_exp_f32 v67, v67
    v_exp_f32 v68, v68
    v_exp_f32 v69, v69
    v_exp_f32 v70, v70
    v_exp_f32 v71, v71
    v_pk_add_f32 v[208:209], v[208:209], v[56:57]
    v_pk_add_f32 v[210:211], v[210:211], v[58:59]
    v_pk_add_f32 v[208:209], v[208:209], v[60:61]
    v_pk_add_f32 v[210:211], v[210:211], v[62:63]
    v_pk_add_f32 v[208:209], v[208:209], v[64:65]
    v_pk_add_f32 v[210:211], v[210:211], v[66:67]
    v_pk_add_f32 v[208:209], v[208:209], v[68:69]
    v_pk_add_f32 v[210:211], v[210:211], v[70:71]
    v_cvt_pk_bf16_f32 v56, v56, v57
    v_cvt_pk_bf16_f32 v57, v58, v59
    v_cvt_pk_bf16_f32 v58, v60, v61
    v_cvt_pk_bf16_f32 v59, v62, v63
    v_cvt_pk_bf16_f32 v60, v64, v65
    v_cvt_pk_bf16_f32 v61, v66, v67
    v_cvt_pk_bf16_f32 v62, v68, v69
    v_cvt_pk_bf16_f32 v63, v70, v71
    v_pk_fma_f32 v[72:73], v[72:73], v[212:213], v[214:215] op_sel_hi:[1,0,0]
    v_pk_fma_f32 v[74:75], v[74:75], v[212:213], v[214:215] op_sel_hi:[1,0,0]
    v_pk_fma_f32 v[76:77], v[76:77], v[212:213], v[214:215] op_sel_hi:[1,0,0]
    v_pk_fma_f32 v[78:79], v[78:79], v[212:213], v[214:215] op_sel_hi:[1,0,0]
    v_pk_fma_f32 v[80:81], v[80:81], v[212:213], v[214:215] op_sel_hi:[1,0,0]
    v_pk_fma_f32 v[82:83], v[82:83], v[212:213], v[214:215] op_sel_hi:[1,0,0]
    v_pk_fma_f32 v[84:85], v[84:85], v[212:213], v[214:215] op_sel_hi:[1,0,0]
    v_pk_fma_f32 v[86:87], v[86:87], v[212:213], v[214:215] op_sel_hi:[1,0,0]
    v_mfma_f32_32x32x16_bf16 v[184:199], a[128:131], v[56:59], v[184:199]
    v_exp_f32 v72, v72
    v_exp_f32 v73, v73
    v_exp_f32 v74, v74
    v_exp_f32 v75, v75
    v_exp_f32 v76, v76
    v_exp_f32 v77, v77
    v_exp_f32 v78, v78
    v_exp_f32 v79, v79
    v_mfma_f32_32x32x16_bf16 v[184:199], a[132:135], v[60:63], v[184:199]
    v_exp_f32 v80, v80
    v_exp_f32 v81, v81
    v_exp_f32 v82, v82
    v_exp_f32 v83, v83
    v_exp_f32 v84, v84
    v_exp_f32 v85, v85
    v_exp_f32 v86, v86
    v_exp_f32 v87, v87
    v_pk_add_f32 v[208:209], v[208:209], v[72:73]
    v_pk_add_f32 v[210:211], v[210:211], v[74:75]
    v_pk_add_f32 v[208:209], v[208:209], v[76:77]
    v_pk_add_f32 v[210:211], v[210:211], v[78:79]
    v_pk_add_f32 v[208:209], v[208:209], v[80:81]
    v_pk_add_f32 v[210:211], v[210:211], v[82:83]
    v_pk_add_f32 v[208:209], v[208:209], v[84:85]
    v_pk_add_f32 v[210:211], v[210:211], v[86:87]
    v_cvt_pk_bf16_f32 v72, v72, v73
    v_cvt_pk_bf16_f32 v73, v74, v75
    v_cvt_pk_bf16_f32 v74, v76, v77
    v_cvt_pk_bf16_f32 v75, v78, v79
    v_cvt_pk_bf16_f32 v76, v80, v81
    v_cvt_pk_bf16_f32 v77, v82, v83
    v_cvt_pk_bf16_f32 v78, v84, v85
    v_cvt_pk_bf16_f32 v79, v86, v87
    v_pk_fma_f32 v[88:89], v[88:89], v[212:213], v[214:215] op_sel_hi:[1,0,0]
    v_pk_fma_f32 v[90:91], v[90:91], v[212:213], v[214:215] op_sel_hi:[1,0,0]
    v_pk_fma_f32 v[92:93], v[92:93], v[212:213], v[214:215] op_sel_hi:[1,0,0]
    v_pk_fma_f32 v[94:95], v[94:95], v[212:213], v[214:215] op_sel_hi:[1,0,0]
    v_pk_fma_f32 v[96:97], v[96:97], v[212:213], v[214:215] op_sel_hi:[1,0,0]
    v_pk_fma_f32 v[98:99], v[98:99], v[212:213], v[214:215] op_sel_hi:[1,0,0]
    v_pk_fma_f32 v[100:101], v[100:101], v[212:213], v[214:215] op_sel_hi:[1,0,0]
    v_pk_fma_f32 v[102:103], v[102:103], v[212:213], v[214:215] op_sel_hi:[1,0,0]
    v_mfma_f32_32x32x16_bf16 v[184:199], a[136:139], v[72:75], v[184:199]
    v_exp_f32 v88, v88
    v_exp_f32 v89, v89
    v_exp_f32 v90, v90
    v_exp_f32 v91, v91
    v_exp_f32 v92, v92
    v_exp_f32 v93, v93
    v_exp_f32 v94, v94
    v_exp_f32 v95, v95
    v_mfma_f32_32x32x16_bf16 v[184:199], a[140:143], v[76:79], v[184:199]
    v_exp_f32 v96, v96
    v_exp_f32 v97, v97
    v_exp_f32 v98, v98
    v_exp_f32 v99, v99
    v_exp_f32 v100, v100
    v_exp_f32 v101, v101
    v_exp_f32 v102, v102
    v_exp_f32 v103, v103
    v_pk_add_f32 v[208:209], v[208:209], v[88:89]
    v_pk_add_f32 v[210:211], v[210:211], v[90:91]
    v_pk_add_f32 v[208:209], v[208:209], v[92:93]
    v_pk_add_f32 v[210:211], v[210:211], v[94:95]
    v_pk_add_f32 v[208:209], v[208:209], v[96:97]
    v_pk_add_f32 v[210:211], v[210:211], v[98:99]
    v_pk_add_f32 v[208:209], v[208:209], v[100:101]
    v_pk_add_f32 v[210:211], v[210:211], v[102:103]
    v_cvt_pk_bf16_f32 v88, v88, v89
    v_cvt_pk_bf16_f32 v89, v90, v91
    v_cvt_pk_bf16_f32 v90, v92, v93
    v_cvt_pk_bf16_f32 v91, v94, v95
    v_cvt_pk_bf16_f32 v92, v96, v97
    v_cvt_pk_bf16_f32 v93, v98, v99
    v_cvt_pk_bf16_f32 v94, v100, v101
    v_cvt_pk_bf16_f32 v95, v102, v103
    v_pk_fma_f32 v[104:105], v[104:105], v[212:213], v[214:215] op_sel_hi:[1,0,0]
    v_pk_fma_f32 v[106:107], v[106:107], v[212:213], v[214:215] op_sel_hi:[1,0,0]
    v_pk_fma_f32 v[108:109], v[108:109], v[212:213], v[214:215] op_sel_hi:[1,0,0]
    v_pk_fma_f32 v[110:111], v[110:111], v[212:213], v[214:215] op_sel_hi:[1,0,0]
    v_pk_fma_f32 v[112:113], v[112:113], v[212:213], v[214:215] op_sel_hi:[1,0,0]
    v_pk_fma_f32 v[114:115], v[114:115], v[212:213], v[214:215] op_sel_hi:[1,0,0]
    v_pk_fma_f32 v[116:117], v[116:117], v[212:213], v[214:215] op_sel_hi:[1,0,0]
    v_pk_fma_f32 v[118:119], v[118:119], v[212:213], v[214:215] op_sel_hi:[1,0,0]
    v_mfma_f32_32x32x16_bf16 v[184:199], a[144:147], v[88:91], v[184:199]
    v_exp_f32 v104, v104
    v_exp_f32 v105, v105
    v_exp_f32 v106, v106
    v_exp_f32 v107, v107
    v_exp_f32 v108, v108
    v_exp_f32 v109, v109
    v_exp_f32 v110, v110
    v_exp_f32 v111, v111
    v_mfma_f32_32x32x16_bf16 v[184:199], a[148:151], v[92:95], v[184:199]
    v_exp_f32 v112, v112
    v_exp_f32 v113, v113
    v_exp_f32 v114, v114
    v_exp_f32 v115, v115
    v_exp_f32 v116, v116
    v_exp_f32 v117, v117
    v_exp_f32 v118, v118
    v_exp_f32 v119, v119
    v_pk_add_f32 v[208:209], v[208:209], v[104:105]
    v_pk_add_f32 v[210:211], v[210:211], v[106:107]
    v_pk_add_f32 v[208:209], v[208:209], v[108:109]
    v_pk_add_f32 v[210:211], v[210:211], v[110:111]
    v_pk_add_f32 v[208:209], v[208:209], v[112:113]
    v_pk_add_f32 v[210:211], v[210:211], v[114:115]
    v_pk_add_f32 v[208:209], v[208:209], v[116:117]
    v_pk_add_f32 v[210:211], v[210:211], v[118:119]
    v_cvt_pk_bf16_f32 v104, v104, v105
    v_cvt_pk_bf16_f32 v105, v106, v107
    v_cvt_pk_bf16_f32 v106, v108, v109
    v_cvt_pk_bf16_f32 v107, v110, v111
    v_cvt_pk_bf16_f32 v108, v112, v113
    v_cvt_pk_bf16_f32 v109, v114, v115
    v_cvt_pk_bf16_f32 v110, v116, v117
    v_cvt_pk_bf16_f32 v111, v118, v119
    v_pk_fma_f32 v[120:121], v[120:121], v[212:213], v[214:215] op_sel_hi:[1,0,0]
    v_pk_fma_f32 v[122:123], v[122:123], v[212:213], v[214:215] op_sel_hi:[1,0,0]
    v_pk_fma_f32 v[124:125], v[124:125], v[212:213], v[214:215] op_sel_hi:[1,0,0]
    v_pk_fma_f32 v[126:127], v[126:127], v[212:213], v[214:215] op_sel_hi:[1,0,0]
    v_pk_fma_f32 v[128:129], v[128:129], v[212:213], v[214:215] op_sel_hi:[1,0,0]
    v_pk_fma_f32 v[130:131], v[130:131], v[212:213], v[214:215] op_sel_hi:[1,0,0]
    v_pk_fma_f32 v[132:133], v[132:133], v[212:213], v[214:215] op_sel_hi:[1,0,0]
    v_pk_fma_f32 v[134:135], v[134:135], v[212:213], v[214:215] op_sel_hi:[1,0,0]
    v_mfma_f32_32x32x16_bf16 v[184:199], a[152:155], v[104:107], v[184:199]
    v_exp_f32 v120, v120
    v_exp_f32 v121, v121
    v_exp_f32 v122, v122
    v_exp_f32 v123, v123
    v_exp_f32 v124, v124
    v_exp_f32 v125, v125
    v_exp_f32 v126, v126
    v_exp_f32 v127, v127
    v_mfma_f32_32x32x16_bf16 v[184:199], a[156:159], v[108:111], v[184:199]
    v_exp_f32 v128, v128
    v_exp_f32 v129, v129
    v_exp_f32 v130, v130
    v_exp_f32 v131, v131
    v_exp_f32 v132, v132
    v_exp_f32 v133, v133
    v_exp_f32 v134, v134
    v_exp_f32 v135, v135
    v_pk_add_f32 v[208:209], v[208:209], v[120:121]
    v_pk_add_f32 v[210:211], v[210:211], v[122:123]
    v_pk_add_f32 v[208:209], v[208:209], v[124:125]
    v_pk_add_f32 v[210:211], v[210:211], v[126:127]
    v_pk_add_f32 v[208:209], v[208:209], v[128:129]
    v_pk_add_f32 v[210:211], v[210:211], v[130:131]
    v_pk_add_f32 v[208:209], v[208:209], v[132:133]
    v_pk_add_f32 v[210:211], v[210:211], v[134:135]
    v_cvt_pk_bf16_f32 v120, v120, v121
    v_cvt_pk_bf16_f32 v121, v122, v123
    v_cvt_pk_bf16_f32 v122, v124, v125
    v_cvt_pk_bf16_f32 v123, v126, v127
    v_cvt_pk_bf16_f32 v124, v128, v129
    v_cvt_pk_bf16_f32 v125, v130, v131
    v_cvt_pk_bf16_f32 v126, v132, v133
    v_cvt_pk_bf16_f32 v127, v134, v135
    v_pk_fma_f32 v[136:137], v[136:137], v[212:213], v[214:215] op_sel_hi:[1,0,0]
    v_pk_fma_f32 v[138:139], v[138:139], v[212:213], v[214:215] op_sel_hi:[1,0,0]
    v_pk_fma_f32 v[140:141], v[140:141], v[212:213], v[214:215] op_sel_hi:[1,0,0]
    v_pk_fma_f32 v[142:143], v[142:143], v[212:213], v[214:215] op_sel_hi:[1,0,0]
    v_pk_fma_f32 v[144:145], v[144:145], v[212:213], v[214:215] op_sel_hi:[1,0,0]
    v_pk_fma_f32 v[146:147], v[146:147], v[212:213], v[214:215] op_sel_hi:[1,0,0]
    v_pk_fma_f32 v[148:149], v[148:149], v[212:213], v[214:215] op_sel_hi:[1,0,0]
    v_pk_fma_f32 v[150:151], v[150:151], v[212:213], v[214:215] op_sel_hi:[1,0,0]
    v_mfma_f32_32x32x16_bf16 v[184:199], a[160:163], v[120:123], v[184:199]
    v_exp_f32 v136, v136
    v_exp_f32 v137, v137
    v_exp_f32 v138, v138
    v_exp_f32 v139, v139
    v_exp_f32 v140, v140
    v_exp_f32 v141, v141
    v_exp_f32 v142, v142
    v_exp_f32 v143, v143
    v_mfma_f32_32x32x16_bf16 v[184:199], a[164:167], v[124:127], v[184:199]
    v_exp_f32 v144, v144
    v_exp_f32 v145, v145
    v_exp_f32 v146, v146
    v_exp_f32 v147, v147
    v_exp_f32 v148, v148
    v_exp_f32 v149, v149
    v_exp_f32 v150, v150
    v_exp_f32 v151, v151
    v_pk_add_f32 v[208:209], v[208:209], v[136:137]
    v_pk_add_f32 v[210:211], v[210:211], v[138:139]
    v_pk_add_f32 v[208:209], v[208:209], v[140:141]
    v_pk_add_f32 v[210:211], v[210:211], v[142:143]
    v_pk_add_f32 v[208:209], v[208:209], v[144:145]
    v_pk_add_f32 v[210:211], v[210:211], v[146:147]
    v_pk_add_f32 v[208:209], v[208:209], v[148:149]
    v_pk_add_f32 v[210:211], v[210:211], v[150:151]
    v_cvt_pk_bf16_f32 v136, v136, v137
    v_cvt_pk_bf16_f32 v137, v138, v139
    v_cvt_pk_bf16_f32 v138, v140, v141
    v_cvt_pk_bf16_f32 v139, v142, v143
    v_cvt_pk_bf16_f32 v140, v144, v145
    v_cvt_pk_bf16_f32 v141, v146, v147
    v_cvt_pk_bf16_f32 v142, v148, v149
    v_cvt_pk_bf16_f32 v143, v150, v151
    s_waitcnt vmcnt(14)
    v_pk_add_f32 v[208:209], v[208:209], v[210:211]
    v_mfma_f32_32x32x16_bf16 v[184:199], a[168:171], v[136:139], v[184:199]
    v_mfma_f32_32x32x16_bf16 v[184:199], a[172:175], v[140:143], v[184:199]
    v_add_f32 v208, v208, v209
    v_mov_b32 v209, v208
    s_nop 1
    v_permlane32_swap_b32 v208, v209
    v_add_f32 v208, v208, v209
    v_rcp_f32 v208, v208
    s_add_u32 s52, s49, 65536
    s_nop 3
    v_pk_mul_f32 v[184:185], v[184:185], v[208:209] op_sel_hi:[1,0]
    v_pk_mul_f32 v[186:187], v[186:187], v[208:209] op_sel_hi:[1,0]
    v_pk_mul_f32 v[188:189], v[188:189], v[208:209] op_sel_hi:[1,0]
    v_pk_mul_f32 v[190:191], v[190:191], v[208:209] op_sel_hi:[1,0]
    v_pk_mul_f32 v[192:193], v[192:193], v[208:209] op_sel_hi:[1,0]
    v_pk_mul_f32 v[194:195], v[194:195], v[208:209] op_sel_hi:[1,0]
    v_pk_mul_f32 v[196:197], v[196:197], v[208:209] op_sel_hi:[1,0]
    v_pk_mul_f32 v[198:199], v[198:199], v[208:209] op_sel_hi:[1,0]
    v_cvt_pk_bf16_f32 v200, v184, v185
    v_cvt_pk_bf16_f32 v201, v186, v187
    v_cvt_pk_bf16_f32 v202, v188, v189
    v_cvt_pk_bf16_f32 v203, v190, v191
    v_cvt_pk_bf16_f32 v204, v192, v193
    v_cvt_pk_bf16_f32 v205, v194, v195
    v_cvt_pk_bf16_f32 v206, v196, v197
    v_cvt_pk_bf16_f32 v207, v198, v199
    buffer_store_dwordx4 v[200:203], v222, s[32:35], s52 offen offset:0 sc1
    buffer_store_dwordx4 v[204:207], v222, s[32:35], s52 offen offset:1024 sc1
    s_waitcnt vmcnt(14)
    v_mfma_f32_32x32x16_bf16 v[8:23], a[16:19], a[208:211], v[152:167]
    v_mfma_f32_32x32x16_bf16 v[8:23], a[20:23], a[212:215], v[8:23]
    v_mfma_f32_32x32x16_bf16 v[24:39], a[24:27], a[208:211], 0
    v_mfma_f32_32x32x16_bf16 v[24:39], a[28:31], a[212:215], v[24:39]
    v_mfma_f32_32x32x16_bf16 v[40:55], a[32:35], a[208:211], 0
    v_mfma_f32_32x32x16_bf16 v[40:55], a[36:39], a[212:215], v[40:55]
    s_nop 7
    v_max3_f32 v218, v8, v9, v10
    v_max3_f32 v219, v11, v12, v13
    v_max3_f32 v218, v218, v14, v15
    v_max3_f32 v219, v219, v16, v17
    v_max3_f32 v218, v218, v18, v19
    v_max3_f32 v219, v219, v20, v21
    v_max3_f32 v218, v218, v22, v23
    v_mfma_f32_32x32x16_bf16 v[56:71], a[40:43], a[208:211], 0
    v_mfma_f32_32x32x16_bf16 v[56:71], a[44:47], a[212:215], v[56:71]
    v_max3_f32 v218, v218, v24, v25
    v_max3_f32 v219, v219, v26, v27
    v_max3_f32 v218, v218, v28, v29
    v_max3_f32 v219, v219, v30, v31
    v_max3_f32 v218, v218, v32, v33
    v_max3_f32 v219, v219, v34, v35
    v_max3_f32 v218, v218, v36, v37
    v_max3_f32 v219, v219, v38, v39
    v_mfma_f32_32x32x16_bf16 v[72:87], a[48:51], a[208:211], 0
    v_mfma_f32_32x32x16_bf16 v[72:87], a[52:55], a[212:215], v[72:87]
    v_max3_f32 v218, v218, v40, v41
    v_max3_f32 v219, v219, v42, v43
    v_max3_f32 v218, v218, v44, v45
    v_max3_f32 v219, v219, v46, v47
    v_max3_f32 v218, v218, v48, v49
    v_max3_f32 v219, v219, v50, v51
    v_max3_f32 v218, v218, v52, v53
    v_max3_f32 v219, v219, v54, v55
    v_mfma_f32_32x32x16_bf16 v[88:103], a[56:59], a[208:211], 0
    v_mfma_f32_32x32x16_bf16 v[88:103], a[60:63], a[212:215], v[88:103]
    v_max3_f32 v218, v218, v56, v57
    v_max3_f32 v219, v219, v58, v59
    v_max3_f32 v218, v218, v60, v61
    v_max3_f32 v219, v219, v62, v63
    v_max3_f32 v218, v218, v64, v65
    v_max3_f32 v219, v219, v66, v67
    v_max3_f32 v218, v218, v68, v69
    v_max3_f32 v219, v219, v70, v71
    v_mfma_f32_32x32x16_bf16 v[104:119], a[64:67], a[208:211], 0
    v_mfma_f32_32x32x16_bf16 v[104:119], a[68:71], a[212:215], v[104:119]
    v_max3_f32 v218, v218, v72, v73
    v_max3_f32 v219, v219, v74, v75
    v_max3_f32 v218, v218, v76, v77
    v_max3_f32 v219, v219, v78, v79
    v_max3_f32 v218, v218, v80, v81
    v_max3_f32 v219, v219, v82, v83
    v_max3_f32 v218, v218, v84, v85
    v_max3_f32 v219, v219, v86, v87
    v_mfma_f32_32x32x16_bf16 v[120:135], a[72:75], a[208:211], 0
    v_mfma_f32_32x32x16_bf16 v[120:135], a[76:79], a[212:215], v[120:135]
    v_max3_f32 v218, v218, v88, v89
    v_max3_f32 v219, v219, v90, v91
    v_max3_f32 v218, v218, v92, v93
    v_max3_f32 v219, v219, v94, v95
    v_max3_f32 v218, v218, v96, v97
    v_max3_f32 v219, v219, v98, v99
    v_max3_f32 v218, v218, v100, v101
    v_max3_f32 v219, v219, v102, v103
    s_waitcnt vmcnt(12)
    v_mfma_f32_32x32x16_bf16 v[136:151], a[80:83], a[208:211], v[168:183]
    v_mfma_f32_32x32x16_bf16 v[136:151], a[84:87], a[212:215], v[136:151]
    v_max3_f32 v218, v218, v104, v105
    v_max3_f32 v219, v219, v106, v107
    v_max3_f32 v218, v218, v108, v109
    v_max3_f32 v219, v219, v110, v111
    v_max3_f32 v218, v218, v112, v113
    v_max3_f32 v219, v219, v114, v115
    v_max3_f32 v218, v218, v116, v117
    v_max3_f32 v219, v219, v118, v119
    s_cmp_lt_u32 s50, 8
    s_cbranch_scc1 bfix_219
    v_max3_f32 v218, v218, v120, v121
    v_max3_f32 v219, v219, v122, v123
    v_max3_f32 v218, v218, v124, v125
    v_max3_f32 v219, v219, v126, v127
    v_max3_f32 v218, v218, v128, v129
    v_max3_f32 v219, v219, v130, v131
    v_max3_f32 v218, v218, v132, v133
    v_max3_f32 v219, v219, v134, v135
    v_max3_f32 v218, v218, v136, v137
    v_max3_f32 v219, v219, v138, v139
    v_max3_f32 v218, v218, v140, v141
    v_max3_f32 v219, v219, v142, v143
    v_max3_f32 v218, v218, v144, v145
    v_max3_f32 v219, v219, v146, v147
    v_max3_f32 v218, v218, v148, v149
    v_max3_f32 v219, v219, v150, v151
    v_max_f32 v218, v218, v219
    s_branch bok_218
bfix_219:
    s_nop 15
    s_cmp_ge_u32 s50, 6
    s_cbranch_scc1 bf2_220
    v_mov_b32 v8, v217
    v_mov_b32 v9, v217
    v_mov_b32 v10, v217
    v_mov_b32 v11, v217
    v_mov_b32 v12, v217
    v_mov_b32 v13, v217
    v_mov_b32 v14, v217
    v_mov_b32 v15, v217
    v_mov_b32 v16, v217
    v_mov_b32 v17, v217
    v_mov_b32 v18, v217
    v_mov_b32 v19, v217
    v_mov_b32 v20, v217
    v_mov_b32 v21, v217
    v_mov_b32 v22, v217
    v_mov_b32 v23, v217
    s_cmp_ge_u32 s50, 5
    s_cbranch_scc1 bf2_220
    v_mov_b32 v24, v217
    v_mov_b32 v25, v217
    v_mov_b32 v26, v217
    v_mov_b32 v27, v217
    v_mov_b32 v28, v217
    v_mov_b32 v29, v217
    v_mov_b32 v30, v217
    v_mov_b32 v31, v217
    v_mov_b32 v32, v217
    v_mov_b32 v33, v217
    v_mov_b32 v34, v217
    v_mov_b32 v35, v217
    v_mov_b32 v36, v217
    v_mov_b32 v37, v217
    v_mov_b32 v38, v217
    v_mov_b32 v39, v217
    s_cmp_ge_u32 s50, 4
    s_cbranch_scc1 bf2_220
    v_mov_b32 v40, v217
    v_mov_b32 v41, v217
    v_mov_b32 v42, v217
    v_mov_b32 v43, v217
    v_mov_b32 v44, v217
    v_mov_b32 v45, v217
    v_mov_b32 v46, v217
    v_mov_b32 v47, v217
    v_mov_b32 v48, v217
    v_mov_b32 v49, v217
    v_mov_b32 v50, v217
    v_mov_b32 v51, v217
    v_mov_b32 v52, v217
    v_mov_b32 v53, v217
    v_mov_b32 v54, v217
    v_mov_b32 v55, v217
    s_cmp_ge_u32 s50, 3
    s_cbranch_scc1 bf2_220
    v_mov_b32 v56, v217
    v_mov_b32 v57, v217
    v_mov_b32 v58, v217
    v_mov_b32 v59, v217
    v_mov_b32 v60, v217
    v_mov_b32 v61, v217
    v_mov_b32 v62, v217
    v_mov_b32 v63, v217
    v_mov_b32 v64, v217
    v_mov_b32 v65, v217
    v_mov_b32 v66, v217
    v_mov_b32 v67, v217
    v_mov_b32 v68, v217
    v_mov_b32 v69, v217
    v_mov_b32 v70, v217
    v_mov_b32 v71, v217
    s_cmp_ge_u32 s50, 2
    s_cbranch_scc1 bf2_220
    v_mov_b32 v72, v217
    v_mov_b32 v73, v217
    v_mov_b32 v74, v217
    v_mov_b32 v75, v217
    v_mov_b32 v76, v217
    v_mov_b32 v77, v217
    v_mov_b32 v78, v217
    v_mov_b32 v79, v217
    v_mov_b32 v80, v217
    v_mov_b32 v81, v217
    v_mov_b32 v82, v217
    v_mov_b32 v83, v217
    v_mov_b32 v84, v217
    v_mov_b32 v85, v217
    v_mov_b32 v86, v217
    v_mov_b32 v87, v217
    s_cmp_ge_u32 s50, 1
    s_cbranch_scc1 bf2_220
    v_mov_b32 v88, v217
    v_mov_b32 v89, v217
    v_mov_b32 v90, v217
    v_mov_b32 v91, v217
    v_mov_b32 v92, v217
    v_mov_b32 v93, v217
    v_mov_b32 v94, v217
    v_mov_b32 v95, v217
    v_mov_b32 v96, v217
    v_mov_b32 v97, v217
    v_mov_b32 v98, v217
    v_mov_b32 v99, v217
    v_mov_b32 v100, v217
    v_mov_b32 v101, v217
    v_mov_b32 v102, v217
    v_mov_b32 v103, v217
    s_cmp_ge_u32 s50, 0
    s_cbranch_scc1 bf2_220
    v_mov_b32 v104, v217
    v_mov_b32 v105, v217
    v_mov_b32 v106, v217
    v_mov_b32 v107, v217
    v_mov_b32 v108, v217
    v_mov_b32 v109, v217
    v_mov_b32 v110, v217
    v_mov_b32 v111, v217
    v_mov_b32 v112, v217
    v_mov_b32 v113, v217
    v_mov_b32 v114, v217
    v_mov_b32 v115, v217
    v_mov_b32 v116, v217
    v_mov_b32 v117, v217
    v_mov_b32 v118, v217
    v_mov_b32 v119, v217
    s_cmp_ge_u32 s50, 0
    s_cbranch_scc1 bf2_220
    v_mov_b32 v120, v217
    v_mov_b32 v121, v217
    v_mov_b32 v122, v217
    v_mov_b32 v123, v217
    v_mov_b32 v124, v217
    v_mov_b32 v125, v217
    v_mov_b32 v126, v217
    v_mov_b32 v127, v217
    v_mov_b32 v128, v217
    v_mov_b32 v129, v217
    v_mov_b32 v130, v217
    v_mov_b32 v131, v217
    v_mov_b32 v132, v217
    v_mov_b32 v133, v217
    v_mov_b32 v134, v217
    v_mov_b32 v135, v217
bf2_220:
    v_max3_f32 v218, v8, v9, v10
    v_max3_f32 v219, v11, v12, v13
    v_max3_f32 v218, v218, v14, v15
    v_max3_f32 v219, v219, v16, v17
    v_max3_f32 v218, v218, v18, v19
    v_max3_f32 v219, v219, v20, v21
    v_max3_f32 v218, v218, v22, v23
    v_max3_f32 v219, v219, v24, v25
    v_max3_f32 v218, v218, v26, v27
    v_max3_f32 v219, v219, v28, v29
    v_max3_f32 v218, v218, v30, v31
    v_max3_f32 v219, v219, v32, v33
    v_max3_f32 v218, v218, v34, v35
    v_max3_f32 v219, v219, v36, v37
    v_max3_f32 v218, v218, v38, v39
    v_max3_f32 v219, v219, v40, v41
    v_max3_f32 v218, v218, v42, v43
    v_max3_f32 v219, v219, v44, v45
    v_max3_f32 v218, v218, v46, v47
    v_max3_f32 v219, v219, v48, v49
    v_max3_f32 v218, v218, v50, v51
    v_max3_f32 v219, v219, v52, v53
    v_max3_f32 v218, v218, v54, v55
    v_max3_f32 v219, v219, v56, v57
    v_max3_f32 v218, v218, v58, v59
    v_max3_f32 v219, v219, v60, v61
    v_max3_f32 v218, v218, v62, v63
    v_max3_f32 v219, v219, v64, v65
    v_max3_f32 v218, v218, v66, v67
    v_max3_f32 v219, v219, v68, v69
    v_max3_f32 v218, v218, v70, v71
    v_max3_f32 v219, v219, v72, v73
    v_max3_f32 v218, v218, v74, v75
    v_max3_f32 v219, v219, v76, v77
    v_max3_f32 v218, v218, v78, v79
    v_max3_f32 v219, v219, v80, v81
    v_max3_f32 v218, v218, v82, v83
    v_max3_f32 v219, v219, v84, v85
    v_max3_f32 v218, v218, v86, v87
    v_max3_f32 v219, v219, v88, v89
    v_max3_f32 v218, v218, v90, v91
    v_max3_f32 v219, v219, v92, v93
    v_max3_f32 v218, v218, v94, v95
    v_max3_f32 v219, v219, v96, v97
    v_max3_f32 v218, v218, v98, v99
    v_max3_f32 v219, v219, v100, v101
    v_max3_f32 v218, v218, v102, v103
    v_max3_f32 v219, v219, v104, v105
    v_max3_f32 v218, v218, v106, v107
    v_max3_f32 v219, v219, v108, v109
    v_max3_f32 v218, v218, v110, v111
    v_max3_f32 v219, v219, v112, v113
    v_max3_f32 v218, v218, v114, v115
    v_max3_f32 v219, v219, v116, v117
    v_max3_f32 v218, v218, v118, v119
    v_max3_f32 v219, v219, v120, v121
    v_max3_f32 v218, v218, v122, v123
    v_max3_f32 v219, v219, v124, v125
    v_max3_f32 v218, v218, v126, v127
    v_max3_f32 v219, v219, v128, v129
    v_max3_f32 v218, v218, v130, v131
    v_max3_f32 v219, v219, v132, v133
    v_max3_f32 v218, v218, v134, v135
    v_max3_f32 v219, v219, v136, v137
    v_max3_f32 v218, v218, v138, v139
    v_max3_f32 v219, v219, v140, v141
    v_max3_f32 v218, v218, v142, v143
    v_max3_f32 v219, v219, v144, v145
    v_max3_f32 v218, v218, v146, v147
    v_max3_f32 v219, v219, v148, v149
    v_max3_f32 v218, v218, v150, v151
    v_max_f32 v218, v218, v219
bok_218:
    v_mov_b32 v219, v218
    s_nop 1
    v_permlane32_swap_b32 v218, v219
    v_max_f32 v218, v218, v219
    v_mul_f32 v214, v212, -v218
    v_pk_fma_f32 v[8:9], v[8:9], v[212:213], v[214:215] op_sel_hi:[1,0,0]
    v_pk_fma_f32 v[10:11], v[10:11], v[212:213], v[214:215] op_sel_hi:[1,0,0]
    v_pk_fma_f32 v[12:13], v[12:13], v[212:213], v[214:215] op_sel_hi:[1,0,0]
    v_pk_fma_f32 v[14:15], v[14:15], v[212:213], v[214:215] op_sel_hi:[1,0,0]
    v_pk_fma_f32 v[16:17], v[16:17], v[212:213], v[214:215] op_sel_hi:[1,0,0]
    v_pk_fma_f32 v[18:19], v[18:19], v[212:213], v[214:215] op_sel_hi:[1,0,0]
    v_pk_fma_f32 v[20:21], v[20:21], v[212:213], v[214:215] op_sel_hi:[1,0,0]
    v_pk_fma_f32 v[22:23], v[22:23], v[212:213], v[214:215] op_sel_hi:[1,0,0]
    v_exp_f32 v8, v8
    v_exp_f32 v9, v9
    v_exp_f32 v10, v10
    v_exp_f32 v11, v11
    v_exp_f32 v12, v12
    v_exp_f32 v13, v13
    v_exp_f32 v14, v14
    v_exp_f32 v15, v15
    v_exp_f32 v16, v16
    v_exp_f32 v17, v17
    v_exp_f32 v18, v18
    v_exp_f32 v19, v19
    v_exp_f32 v20, v20
    v_exp_f32 v21, v21
    v_exp_f32 v22, v22
    v_exp_f32 v23, v23
    v_pk_add_f32 v[208:209], v[8:9], 0
    v_pk_add_f32 v[210:211], v[10:11], 0
    v_pk_add_f32 v[208:209], v[208:209], v[12:13]
    v_pk_add_f32 v[210:211], v[210:211], v[14:15]
    v_pk_add_f32 v[208:209], v[208:209], v[16:17]
    v_pk_add_f32 v[210:211], v[210:211], v[18:19]
    v_pk_add_f32 v[208:209], v[208:209], v[20:21]
    v_pk_add_f32 v[210:211], v[210:211], v[22:23]
    v_cvt_pk_bf16_f32 v8, v8, v9
    v_cvt_pk_bf16_f32 v9, v10, v11
    v_cvt_pk_bf16_f32 v10, v12, v13
    v_cvt_pk_bf16_f32 v11, v14, v15
    v_cvt_pk_bf16_f32 v12, v16, v17
    v_cvt_pk_bf16_f32 v13, v18, v19
    v_cvt_pk_bf16_f32 v14, v20, v21
    v_cvt_pk_bf16_f32 v15, v22, v23
    v_pk_fma_f32 v[24:25], v[24:25], v[212:213], v[214:215] op_sel_hi:[1,0,0]
    v_pk_fma_f32 v[26:27], v[26:27], v[212:213], v[214:215] op_sel_hi:[1,0,0]
    v_pk_fma_f32 v[28:29], v[28:29], v[212:213], v[214:215] op_sel_hi:[1,0,0]
    v_pk_fma_f32 v[30:31], v[30:31], v[212:213], v[214:215] op_sel_hi:[1,0,0]
    v_pk_fma_f32 v[32:33], v[32:33], v[212:213], v[214:215] op_sel_hi:[1,0,0]
    v_pk_fma_f32 v[34:35], v[34:35], v[212:213], v[214:215] op_sel_hi:[1,0,0]
    v_pk_fma_f32 v[36:37], v[36:37], v[212:213], v[214:215] op_sel_hi:[1,0,0]
    v_pk_fma_f32 v[38:39], v[38:39], v[212:213], v[214:215] op_sel_hi:[1,0,0]
    v_mfma_f32_32x32x16_bf16 v[184:199], a[112:115], v[8:11], 0
    v_exp_f32 v24, v24
    v_exp_f32 v25, v25
    v_exp_f32 v26, v26
    v_exp_f32 v27, v27
    v_exp_f32 v28, v28
    v_exp_f32 v29, v29
    v_exp_f32 v30, v30
    v_exp_f32 v31, v31
    v_mfma_f32_32x32x16_bf16 v[184:199], a[116:119], v[12:15], v[184:199]
    v_exp_f32 v32, v32
    v_exp_f32 v33, v33
    v_exp_f32 v34, v34
    v_exp_f32 v35, v35
    v_exp_f32 v36, v36
    v_exp_f32 v37, v37
    v_exp_f32 v38, v38
    v_exp_f32 v39, v39
    v_pk_add_f32 v[208:209], v[208:209], v[24:25]
    v_pk_add_f32 v[210:211], v[210:211], v[26:27]
    v_pk_add_f32 v[208:209], v[208:209], v[28:29]
    v_pk_add_f32 v[210:211], v[210:211], v[30:31]
    v_pk_add_f32 v[208:209], v[208:209], v[32:33]
    v_pk_add_f32 v[210:211], v[210:211], v[34:35]
    v_pk_add_f32 v[208:209], v[208:209], v[36:37]
    v_pk_add_f32 v[210:211], v[210:211], v[38:39]
    v_cvt_pk_bf16_f32 v24, v24, v25
    v_cvt_pk_bf16_f32 v25, v26, v27
    v_cvt_pk_bf16_f32 v26, v28, v29
    v_cvt_pk_bf16_f32 v27, v30, v31
    v_cvt_pk_bf16_f32 v28, v32, v33
    v_cvt_pk_bf16_f32 v29, v34, v35
    v_cvt_pk_bf16_f32 v30, v36, v37
    v_cvt_pk_bf16_f32 v31, v38, v39
    v_pk_fma_f32 v[40:41], v[40:41], v[212:213], v[214:215] op_sel_hi:[1,0,0]
    v_pk_fma_f32 v[42:43], v[42:43], v[212:213], v[214:215] op_sel_hi:[1,0,0]
    v_pk_fma_f32 v[44:45], v[44:45], v[212:213], v[214:215] op_sel_hi:[1,0,0]
    v_pk_fma_f32 v[46:47], v[46:47], v[212:213], v[214:215] op_sel_hi:[1,0,0]
    v_pk_fma_f32 v[48:49], v[48:49], v[212:213], v[214:215] op_sel_hi:[1,0,0]
    v_pk_fma_f32 v[50:51], v[50:51], v[212:213], v[214:215] op_sel_hi:[1,0,0]
    v_pk_fma_f32 v[52:53], v[52:53], v[212:213], v[214:215] op_sel_hi:[1,0,0]
    v_pk_fma_f32 v[54:55], v[54:55], v[212:213], v[214:215] op_sel_hi:[1,0,0]
    v_mfma_f32_32x32x16_bf16 v[184:199], a[120:123], v[24:27], v[184:199]
    v_exp_f32 v40, v40
    v_exp_f32 v41, v41
    v_exp_f32 v42, v42
    v_exp_f32 v43, v43
    v_exp_f32 v44, v44
    v_exp_f32 v45, v45
    v_exp_f32 v46, v46
    v_exp_f32 v47, v47
    v_mfma_f32_32x32x16_bf16 v[184:199], a[124:127], v[28:31], v[184:199]
    v_exp_f32 v48, v48
    v_exp_f32 v49, v49
    v_exp_f32 v50, v50
    v_exp_f32 v51, v51
    v_exp_f32 v52, v52
    v_exp_f32 v53, v53
    v_exp_f32 v54, v54
    v_exp_f32 v55, v55
    v_pk_add_f32 v[208:209], v[208:209], v[40:41]
    v_pk_add_f32 v[210:211], v[210:211], v[42:43]
    v_pk_add_f32 v[208:209], v[208:209], v[44:45]
    v_pk_add_f32 v[210:211], v[210:211], v[46:47]
    v_pk_add_f32 v[208:209], v[208:209], v[48:49]
    v_pk_add_f32 v[210:211], v[210:211], v[50:51]
    v_pk_add_f32 v[208:209], v[208:209], v[52:53]
    v_pk_add_f32 v[210:211], v[210:211], v[54:55]
    v_cvt_pk_bf16_f32 v40, v40, v41
    v_cvt_pk_bf16_f32 v41, v42, v43
    v_cvt_pk_bf16_f32 v42, v44, v45
    v_cvt_pk_bf16_f32 v43, v46, v47
    v_cvt_pk_bf16_f32 v44, v48, v49
    v_cvt_pk_bf16_f32 v45, v50, v51
    v_cvt_pk_bf16_f32 v46, v52, v53
    v_cvt_pk_bf16_f32 v47, v54, v55
    v_pk_fma_f32 v[56:57], v[56:57], v[212:213], v[214:215] op_sel_hi:[1,0,0]
    v_pk_fma_f32 v[58:59], v[58:59], v[212:213], v[214:215] op_sel_hi:[1,0,0]
    v_pk_fma_f32 v[60:61], v[60:61], v[212:213], v[214:215] op_sel_hi:[1,0,0]
    v_pk_fma_f32 v[62:63], v[62:63], v[212:213], v[214:215] op_sel_hi:[1,0,0]
    v_pk_fma_f32 v[64:65], v[64:65], v[212:213], v[214:215] op_sel_hi:[1,0,0]
    v_pk_fma_f32 v[66:67], v[66:67], v[212:213], v[214:215] op_sel_hi:[1,0,0]
    v_pk_fma_f32 v[68:69], v[68:69], v[212:213], v[214:215] op_sel_hi:[1,0,0]
    v_pk_fma_f32 v[70:71], v[70:71], v[212:213], v[214:215] op_sel_hi:[1,0,0]
    v_mfma_f32_32x32x16_bf16 v[184:199], a[128:131], v[40:43], v[184:199]
    v_exp_f32 v56, v56
    v_exp_f32 v57, v57
    v_exp_f32 v58, v58
    v_exp_f32 v59, v59
    v_exp_f32 v60, v60
    v_exp_f32 v61, v61
    v_exp_f32 v62, v62
    v_exp_f32 v63, v63
    v_mfma_f32_32x32x16_bf16 v[184:199], a[132:135], v[44:47], v[184:199]
    v_exp_f32 v64, v64
    v_exp_f32 v65, v65
    v_exp_f32 v66, v66
    v_exp_f32 v67, v67
    v_exp_f32 v68, v68
    v_exp_f32 v69, v69
    v_exp_f32 v70, v70
    v_exp_f32 v71, v71
    v_pk_add_f32 v[208:209], v[208:209], v[56:57]
    v_pk_add_f32 v[210:211], v[210:211], v[58:59]
    v_pk_add_f32 v[208:209], v[208:209], v[60:61]
    v_pk_add_f32 v[210:211], v[210:211], v[62:63]
    v_pk_add_f32 v[208:209], v[208:209], v[64:65]
    v_pk_add_f32 v[210:211], v[210:211], v[66:67]
    v_pk_add_f32 v[208:209], v[208:209], v[68:69]
    v_pk_add_f32 v[210:211], v[210:211], v[70:71]
    v_cvt_pk_bf16_f32 v56, v56, v57
    v_cvt_pk_bf16_f32 v57, v58, v59
    v_cvt_pk_bf16_f32 v58, v60, v61
    v_cvt_pk_bf16_f32 v59, v62, v63
    v_cvt_pk_bf16_f32 v60, v64, v65
    v_cvt_pk_bf16_f32 v61, v66, v67
    v_cvt_pk_bf16_f32 v62, v68, v69
    v_cvt_pk_bf16_f32 v63, v70, v71
    v_pk_fma_f32 v[72:73], v[72:73], v[212:213], v[214:215] op_sel_hi:[1,0,0]
    v_pk_fma_f32 v[74:75], v[74:75], v[212:213], v[214:215] op_sel_hi:[1,0,0]
    v_pk_fma_f32 v[76:77], v[76:77], v[212:213], v[214:215] op_sel_hi:[1,0,0]
    v_pk_fma_f32 v[78:79], v[78:79], v[212:213], v[214:215] op_sel_hi:[1,0,0]
    v_pk_fma_f32 v[80:81], v[80:81], v[212:213], v[214:215] op_sel_hi:[1,0,0]
    v_pk_fma_f32 v[82:83], v[82:83], v[212:213], v[214:215] op_sel_hi:[1,0,0]
    v_pk_fma_f32 v[84:85], v[84:85], v[212:213], v[214:215] op_sel_hi:[1,0,0]
    v_pk_fma_f32 v[86:87], v[86:87], v[212:213], v[214:215] op_sel_hi:[1,0,0]
    v_mfma_f32_32x32x16_bf16 v[184:199], a[136:139], v[56:59], v[184:199]
    v_exp_f32 v72, v72
    v_exp_f32 v73, v73
    v_exp_f32 v74, v74
    v_exp_f32 v75, v75
    v_exp_f32 v76, v76
    v_exp_f32 v77, v77
    v_exp_f32 v78, v78
    v_exp_f32 v79, v79
    v_mfma_f32_32x32x16_bf16 v[184:199], a[140:143], v[60:63], v[184:199]
    v_exp_f32 v80, v80
    v_exp_f32 v81, v81
    v_exp_f32 v82, v82
    v_exp_f32 v83, v83
    v_exp_f32 v84, v84
    v_exp_f32 v85, v85
    v_exp_f32 v86, v86
    v_exp_f32 v87, v87
    v_pk_add_f32 v[208:209], v[208:209], v[72:73]
    v_pk_add_f32 v[210:211], v[210:211], v[74:75]
    v_pk_add_f32 v[208:209], v[208:209], v[76:77]
    v_pk_add_f32 v[210:211], v[210:211], v[78:79]
    v_pk_add_f32 v[208:209], v[208:209], v[80:81]
    v_pk_add_f32 v[210:211], v[210:211], v[82:83]
    v_pk_add_f32 v[208:209], v[208:209], v[84:85]
    v_pk_add_f32 v[210:211], v[210:211], v[86:87]
    v_cvt_pk_bf16_f32 v72, v72, v73
    v_cvt_pk_bf16_f32 v73, v74, v75
    v_cvt_pk_bf16_f32 v74, v76, v77
    v_cvt_pk_bf16_f32 v75, v78, v79
    v_cvt_pk_bf16_f32 v76, v80, v81
    v_cvt_pk_bf16_f32 v77, v82, v83
    v_cvt_pk_bf16_f32 v78, v84, v85
    v_cvt_pk_bf16_f32 v79, v86, v87
    v_pk_fma_f32 v[88:89], v[88:89], v[212:213], v[214:215] op_sel_hi:[1,0,0]
    v_pk_fma_f32 v[90:91], v[90:91], v[212:213], v[214:215] op_sel_hi:[1,0,0]
    v_pk_fma_f32 v[92:93], v[92:93], v[212:213], v[214:215] op_sel_hi:[1,0,0]
    v_pk_fma_f32 v[94:95], v[94:95], v[212:213], v[214:215] op_sel_hi:[1,0,0]
    v_pk_fma_f32 v[96:97], v[96:97], v[212:213], v[214:215] op_sel_hi:[1,0,0]
    v_pk_fma_f32 v[98:99], v[98:99], v[212:213], v[214:215] op_sel_hi:[1,0,0]
    v_pk_fma_f32 v[100:101], v[100:101], v[212:213], v[214:215] op_sel_hi:[1,0,0]
    v_pk_fma_f32 v[102:103], v[102:103], v[212:213], v[214:215] op_sel_hi:[1,0,0]
    v_mfma_f32_32x32x16_bf16 v[184:199], a[144:147], v[72:75], v[184:199]
    v_exp_f32 v88, v88
    v_exp_f32 v89, v89
    v_exp_f32 v90, v90
    v_exp_f32 v91, v91
    v_exp_f32 v92, v92
    v_exp_f32 v93, v93
    v_exp_f32 v94, v94
    v_exp_f32 v95, v95
    v_mfma_f32_32x32x16_bf16 v[184:199], a[148:151], v[76:79], v[184:199]
    v_exp_f32 v96, v96
    v_exp_f32 v97, v97
    v_exp_f32 v98, v98
    v_exp_f32 v99, v99
    v_exp_f32 v100, v100
    v_exp_f32 v101, v101
    v_exp_f32 v102, v102
    v_exp_f32 v103, v103
    v_pk_add_f32 v[208:209], v[208:209], v[88:89]
    v_pk_add_f32 v[210:211], v[210:211], v[90:91]
    v_pk_add_f32 v[208:209], v[208:209], v[92:93]
    v_pk_add_f32 v[210:211], v[210:211], v[94:95]
    v_pk_add_f32 v[208:209], v[208:209], v[96:97]
    v_pk_add_f32 v[210:211], v[210:211], v[98:99]
    v_pk_add_f32 v[208:209], v[208:209], v[100:101]
    v_pk_add_f32 v[210:211], v[210:211], v[102:103]
    v_cvt_pk_bf16_f32 v88, v88, v89
    v_cvt_pk_bf16_f32 v89, v90, v91
    v_cvt_pk_bf16_f32 v90, v92, v93
    v_cvt_pk_bf16_f32 v91, v94, v95
    v_cvt_pk_bf16_f32 v92, v96, v97
    v_cvt_pk_bf16_f32 v93, v98, v99
    v_cvt_pk_bf16_f32 v94, v100, v101
    v_cvt_pk_bf16_f32 v95, v102, v103
    v_pk_fma_f32 v[104:105], v[104:105], v[212:213], v[214:215] op_sel_hi:[1,0,0]
    v_pk_fma_f32 v[106:107], v[106:107], v[212:213], v[214:215] op_sel_hi:[1,0,0]
    v_pk_fma_f32 v[108:109], v[108:109], v[212:213], v[214:215] op_sel_hi:[1,0,0]
    v_pk_fma_f32 v[110:111], v[110:111], v[212:213], v[214:215] op_sel_hi:[1,0,0]
    v_pk_fma_f32 v[112:113], v[112:113], v[212:213], v[214:215] op_sel_hi:[1,0,0]
    v_pk_fma_f32 v[114:115], v[114:115], v[212:213], v[214:215] op_sel_hi:[1,0,0]
    v_pk_fma_f32 v[116:117], v[116:117], v[212:213], v[214:215] op_sel_hi:[1,0,0]
    v_pk_fma_f32 v[118:119], v[118:119], v[212:213], v[214:215] op_sel_hi:[1,0,0]
    v_mfma_f32_32x32x16_bf16 v[184:199], a[152:155], v[88:91], v[184:199]
    v_exp_f32 v104, v104
    v_exp_f32 v105, v105
    v_exp_f32 v106, v106
    v_exp_f32 v107, v107
    v_exp_f32 v108, v108
    v_exp_f32 v109, v109
    v_exp_f32 v110, v110
    v_exp_f32 v111, v111
    v_mfma_f32_32x32x16_bf16 v[184:199], a[156:159], v[92:95], v[184:199]
    v_exp_f32 v112, v112
    v_exp_f32 v113, v113
    v_exp_f32 v114, v114
    v_exp_f32 v115, v115
    v_exp_f32 v116, v116
    v_exp_f32 v117, v117
    v_exp_f32 v118, v118
    v_exp_f32 v119, v119
    v_pk_add_f32 v[208:209], v[208:209], v[104:105]
    v_pk_add_f32 v[210:211], v[210:211], v[106:107]
    v_pk_add_f32 v[208:209], v[208:209], v[108:109]
    v_pk_add_f32 v[210:211], v[210:211], v[110:111]
    v_pk_add_f32 v[208:209], v[208:209], v[112:113]
    v_pk_add_f32 v[210:211], v[210:211], v[114:115]
    v_pk_add_f32 v[208:209], v[208:209], v[116:117]
    v_pk_add_f32 v[210:211], v[210:211], v[118:119]
    v_cvt_pk_bf16_f32 v104, v104, v105
    v_cvt_pk_bf16_f32 v105, v106, v107
    v_cvt_pk_bf16_f32 v106, v108, v109
    v_cvt_pk_bf16_f32 v107, v110, v111
    v_cvt_pk_bf16_f32 v108, v112, v113
    v_cvt_pk_bf16_f32 v109, v114, v115
    v_cvt_pk_bf16_f32 v110, v116, v117
    v_cvt_pk_bf16_f32 v111, v118, v119
    v_pk_fma_f32 v[120:121], v[120:121], v[212:213], v[214:215] op_sel_hi:[1,0,0]
    v_pk_fma_f32 v[122:123], v[122:123], v[212:213], v[214:215] op_sel_hi:[1,0,0]
    v_pk_fma_f32 v[124:125], v[124:125], v[212:213], v[214:215] op_sel_hi:[1,0,0]
    v_pk_fma_f32 v[126:127], v[126:127], v[212:213], v[214:215] op_sel_hi:[1,0,0]
    v_pk_fma_f32 v[128:129], v[128:129], v[212:213], v[214:215] op_sel_hi:[1,0,0]
    v_pk_fma_f32 v[130:131], v[130:131], v[212:213], v[214:215] op_sel_hi:[1,0,0]
    v_pk_fma_f32 v[132:133], v[132:133], v[212:213], v[214:215] op_sel_hi:[1,0,0]
    v_pk_fma_f32 v[134:135], v[134:135], v[212:213], v[214:215] op_sel_hi:[1,0,0]
    v_mfma_f32_32x32x16_bf16 v[184:199], a[160:163], v[104:107], v[184:199]
    v_exp_f32 v120, v120
    v_exp_f32 v121, v121
    v_exp_f32 v122, v122
    v_exp_f32 v123, v123
    v_exp_f32 v124, v124
    v_exp_f32 v125, v125
    v_exp_f32 v126, v126
    v_exp_f32 v127, v127
    v_mfma_f32_32x32x16_bf16 v[184:199], a[164:167], v[108:111], v[184:199]
    v_exp_f32 v128, v128
    v_exp_f32 v129, v129
    v_exp_f32 v130, v130
    v_exp_f32 v131, v131
    v_exp_f32 v132, v132
    v_exp_f32 v133, v133
    v_exp_f32 v134, v134
    v_exp_f32 v135, v135
    v_pk_add_f32 v[208:209], v[208:209], v[120:121]
    v_pk_add_f32 v[210:211], v[210:211], v[122:123]
    v_pk_add_f32 v[208:209], v[208:209], v[124:125]
    v_pk_add_f32 v[210:211], v[210:211], v[126:127]
    v_pk_add_f32 v[208:209], v[208:209], v[128:129]
    v_pk_add_f32 v[210:211], v[210:211], v[130:131]
    v_pk_add_f32 v[208:209], v[208:209], v[132:133]
    v_pk_add_f32 v[210:211], v[210:211], v[134:135]
    v_cvt_pk_bf16_f32 v120, v120, v121
    v_cvt_pk_bf16_f32 v121, v122, v123
    v_cvt_pk_bf16_f32 v122, v124, v125
    v_cvt_pk_bf16_f32 v123, v126, v127
    v_cvt_pk_bf16_f32 v124, v128, v129
    v_cvt_pk_bf16_f32 v125, v130, v131
    v_cvt_pk_bf16_f32 v126, v132, v133
    v_cvt_pk_bf16_f32 v127, v134, v135
    v_pk_fma_f32 v[136:137], v[136:137], v[212:213], v[214:215] op_sel_hi:[1,0,0]
    v_pk_fma_f32 v[138:139], v[138:139], v[212:213], v[214:215] op_sel_hi:[1,0,0]
    v_pk_fma_f32 v[140:141], v[140:141], v[212:213], v[214:215] op_sel_hi:[1,0,0]
    v_pk_fma_f32 v[142:143], v[142:143], v[212:213], v[214:215] op_sel_hi:[1,0,0]
    v_pk_fma_f32 v[144:145], v[144:145], v[212:213], v[214:215] op_sel_hi:[1,0,0]
    v_pk_fma_f32 v[146:147], v[146:147], v[212:213], v[214:215] op_sel_hi:[1,0,0]
    v_pk_fma_f32 v[148:149], v[148:149], v[212:213], v[214:215] op_sel_hi:[1,0,0]
    v_pk_fma_f32 v[150:151], v[150:151], v[212:213], v[214:215] op_sel_hi:[1,0,0]
    v_mfma_f32_32x32x16_bf16 v[184:199], a[168:171], v[120:123], v[184:199]
    v_exp_f32 v136, v136
    v_exp_f32 v137, v137
    v_exp_f32 v138, v138
    v_exp_f32 v139, v139
    v_exp_f32 v140, v140
    v_exp_f32 v141, v141
    v_exp_f32 v142, v142
    v_exp_f32 v143, v143
    v_mfma_f32_32x32x16_bf16 v[184:199], a[172:175], v[124:127], v[184:199]
    v_exp_f32 v144, v144
    v_exp_f32 v145, v145
    v_exp_f32 v146, v146
    v_exp_f32 v147, v147
    v_exp_f32 v148, v148
    v_exp_f32 v149, v149
    v_exp_f32 v150, v150
    v_exp_f32 v151, v151
    v_pk_add_f32 v[208:209], v[208:209], v[136:137]
    v_pk_add_f32 v[210:211], v[210:211], v[138:139]
    v_pk_add_f32 v[208:209], v[208:209], v[140:141]
    v_pk_add_f32 v[210:211], v[210:211], v[142:143]
    v_pk_add_f32 v[208:209], v[208:209], v[144:145]
    v_pk_add_f32 v[210:211], v[210:211], v[146:147]
    v_pk_add_f32 v[208:209], v[208:209], v[148:149]
    v_pk_add_f32 v[210:211], v[210:211], v[150:151]
    v_cvt_pk_bf16_f32 v136, v136, v137
    v_cvt_pk_bf16_f32 v137, v138, v139
    v_cvt_pk_bf16_f32 v138, v140, v141
    v_cvt_pk_bf16_f32 v139, v142, v143
    v_cvt_pk_bf16_f32 v140, v144, v145
    v_cvt_pk_bf16_f32 v141, v146, v147
    v_cvt_pk_bf16_f32 v142, v148, v149
    v_cvt_pk_bf16_f32 v143, v150, v151
    s_waitcnt vmcnt(10)
    v_pk_add_f32 v[208:209], v[208:209], v[210:211]
    v_mfma_f32_32x32x16_bf16 v[184:199], a[176:179], v[136:139], v[184:199]
    v_mfma_f32_32x32x16_bf16 v[184:199], a[180:183], v[140:143], v[184:199]
    v_add_f32 v208, v208, v209
    v_mov_b32 v209, v208
    s_nop 1
    v_permlane32_swap_b32 v208, v209
    v_add_f32 v208, v208, v209
    v_rcp_f32 v208, v208
    s_add_u32 s52, s49, 131072
    s_nop 3
    v_pk_mul_f32 v[184:185], v[184:185], v[208:209] op_sel_hi:[1,0]
    v_pk_mul_f32 v[186:187], v[186:187], v[208:209] op_sel_hi:[1,0]
    v_pk_mul_f32 v[188:189], v[188:189], v[208:209] op_sel_hi:[1,0]
    v_pk_mul_f32 v[190:191], v[190:191], v[208:209] op_sel_hi:[1,0]
    v_pk_mul_f32 v[192:193], v[192:193], v[208:209] op_sel_hi:[1,0]
    v_pk_mul_f32 v[194:195], v[194:195], v[208:209] op_sel_hi:[1,0]
    v_pk_mul_f32 v[196:197], v[196:197], v[208:209] op_sel_hi:[1,0]
    v_pk_mul_f32 v[198:199], v[198:199], v[208:209] op_sel_hi:[1,0]
    v_cvt_pk_bf16_f32 v200, v184, v185
    v_cvt_pk_bf16_f32 v201, v186, v187
    v_cvt_pk_bf16_f32 v202, v188, v189
    v_cvt_pk_bf16_f32 v203, v190, v191
    v_cvt_pk_bf16_f32 v204, v192, v193
    v_cvt_pk_bf16_f32 v205, v194, v195
    v_cvt_pk_bf16_f32 v206, v196, v197
    v_cvt_pk_bf16_f32 v207, v198, v199
    buffer_store_dwordx4 v[200:203], v222, s[32:35], s52 offen offset:0 sc1
    buffer_store_dwordx4 v[204:207], v222, s[32:35], s52 offen offset:1024 sc1
    s_waitcnt vmcnt(10)
    v_mfma_f32_32x32x16_bf16 v[8:23], a[24:27], a[216:219], v[152:167]
    v_mfma_f32_32x32x16_bf16 v[8:23], a[28:31], a[220:223], v[8:23]
    v_mfma_f32_32x32x16_bf16 v[24:39], a[32:35], a[216:219], 0
    v_mfma_f32_32x32x16_bf16 v[24:39], a[36:39], a[220:223], v[24:39]
    v_mfma_f32_32x32x16_bf16 v[40:55], a[40:43], a[216:219], 0
    v_mfma_f32_32x32x16_bf16 v[40:55], a[44:47], a[220:223], v[40:55]
    s_nop 7
    v_max3_f32 v218, v8, v9, v10
    v_max3_f32 v219, v11, v12, v13
    v_max3_f32 v218, v218, v14, v15
    v_max3_f32 v219, v219, v16, v17
    v_max3_f32 v218, v218, v18, v19
    v_max3_f32 v219, v219, v20, v21
    v_max3_f32 v218, v218, v22, v23
    v_mfma_f32_32x32x16_bf16 v[56:71], a[48:51], a[216:219], 0
    v_mfma_f32_32x32x16_bf16 v[56:71], a[52:55], a[220:223], v[56:71]
    v_max3_f32 v218, v218, v24, v25
    v_max3_f32 v219, v219, v26, v27
    v_max3_f32 v218, v218, v28, v29
    v_max3_f32 v219, v219, v30, v31
    v_max3_f32 v218, v218, v32, v33
    v_max3_f32 v219, v219, v34, v35
    v_max3_f32 v218, v218, v36, v37
    v_max3_f32 v219, v219, v38, v39
    v_mfma_f32_32x32x16_bf16 v[72:87], a[56:59], a[216:219], 0
    v_mfma_f32_32x32x16_bf16 v[72:87], a[60:63], a[220:223], v[72:87]
    v_max3_f32 v218, v218, v40, v41
    v_max3_f32 v219, v219, v42, v43
    v_max3_f32 v218, v218, v44, v45
    v_max3_f32 v219, v219, v46, v47
    v_max3_f32 v218, v218, v48, v49
    v_max3_f32 v219, v219, v50, v51
    v_max3_f32 v218, v218, v52, v53
    v_max3_f32 v219, v219, v54, v55
    v_mfma_f32_32x32x16_bf16 v[88:103], a[64:67], a[216:219], 0
    v_mfma_f32_32x32x16_bf16 v[88:103], a[68:71], a[220:223], v[88:103]
    v_max3_f32 v218, v218, v56, v57
    v_max3_f32 v219, v219, v58, v59
    v_max3_f32 v218, v218, v60, v61
    v_max3_f32 v219, v219, v62, v63
    v_max3_f32 v218, v218, v64, v65
    v_max3_f32 v219, v219, v66, v67
    v_max3_f32 v218, v218, v68, v69
    v_max3_f32 v219, v219, v70, v71
    v_mfma_f32_32x32x16_bf16 v[104:119], a[72:75], a[216:219], 0
    v_mfma_f32_32x32x16_bf16 v[104:119], a[76:79], a[220:223], v[104:119]
    v_max3_f32 v218, v218, v72, v73
    v_max3_f32 v219, v219, v74, v75
    v_max3_f32 v218, v218, v76, v77
    v_max3_f32 v219, v219, v78, v79
    v_max3_f32 v218, v218, v80, v81
    v_max3_f32 v219, v219, v82, v83
    v_max3_f32 v218, v218, v84, v85
    v_max3_f32 v219, v219, v86, v87
    v_mfma_f32_32x32x16_bf16 v[120:135], a[80:83], a[216:219], 0
    v_mfma_f32_32x32x16_bf16 v[120:135], a[84:87], a[220:223], v[120:135]
    v_max3_f32 v218, v218, v88, v89
    v_max3_f32 v219, v219, v90, v91
    v_max3_f32 v218, v218, v92, v93
    v_max3_f32 v219, v219, v94, v95
    v_max3_f32 v218, v218, v96, v97
    v_max3_f32 v219, v219, v98, v99
    v_max3_f32 v218, v218, v100, v101
    v_max3_f32 v219, v219, v102, v103
    s_waitcnt vmcnt(8)
    v_mfma_f32_32x32x16_bf16 v[136:151], a[88:91], a[216:219], v[168:183]
    v_mfma_f32_32x32x16_bf16 v[136:151], a[92:95], a[220:223], v[136:151]
    v_max3_f32 v218, v218, v104, v105
    v_max3_f32 v219, v219, v106, v107
    v_max3_f32 v218, v218, v108, v109
    v_max3_f32 v219, v219, v110, v111
    v_max3_f32 v218, v218, v112, v113
    v_max3_f32 v219, v219, v114, v115
    v_max3_f32 v218, v218, v116, v117
    v_max3_f32 v219, v219, v118, v119
    s_cmp_lt_u32 s50, 8
    s_cbranch_scc1 bfix_222
    v_max3_f32 v218, v218, v120, v121
    v_max3_f32 v219, v219, v122, v123
    v_max3_f32 v218, v218, v124, v125
    v_max3_f32 v219, v219, v126, v127
    v_max3_f32 v218, v218, v128, v129
    v_max3_f32 v219, v219, v130, v131
    v_max3_f32 v218, v218, v132, v133
    v_max3_f32 v219, v219, v134, v135
    v_max3_f32 v218, v218, v136, v137
    v_max3_f32 v219, v219, v138, v139
    v_max3_f32 v218, v218, v140, v141
    v_max3_f32 v219, v219, v142, v143
    v_max3_f32 v218, v218, v144, v145
    v_max3_f32 v219, v219, v146, v147
    v_max3_f32 v218, v218, v148, v149
    v_max3_f32 v219, v219, v150, v151
    v_max_f32 v218, v218, v219
    s_branch bok_221
bfix_222:
    s_nop 15
    s_cmp_ge_u32 s50, 5
    s_cbranch_scc1 bf2_223
    v_mov_b32 v8, v217
    v_mov_b32 v9, v217
    v_mov_b32 v10, v217
    v_mov_b32 v11, v217
    v_mov_b32 v12, v217
    v_mov_b32 v13, v217
    v_mov_b32 v14, v217
    v_mov_b32 v15, v217
    v_mov_b32 v16, v217
    v_mov_b32 v17, v217
    v_mov_b32 v18, v217
    v_mov_b32 v19, v217
    v_mov_b32 v20, v217
    v_mov_b32 v21, v217
    v_mov_b32 v22, v217
    v_mov_b32 v23, v217
    s_cmp_ge_u32 s50, 4
    s_cbranch_scc1 bf2_223
    v_mov_b32 v24, v217
    v_mov_b32 v25, v217
    v_mov_b32 v26, v217
    v_mov_b32 v27, v217
    v_mov_b32 v28, v217
    v_mov_b32 v29, v217
    v_mov_b32 v30, v217
    v_mov_b32 v31, v217
    v_mov_b32 v32, v217
    v_mov_b32 v33, v217
    v_mov_b32 v34, v217
    v_mov_b32 v35, v217
    v_mov_b32 v36, v217
    v_mov_b32 v37, v217
    v_mov_b32 v38, v217
    v_mov_b32 v39, v217
    s_cmp_ge_u32 s50, 3
    s_cbranch_scc1 bf2_223
    v_mov_b32 v40, v217
    v_mov_b32 v41, v217
    v_mov_b32 v42, v217
    v_mov_b32 v43, v217
    v_mov_b32 v44, v217
    v_mov_b32 v45, v217
    v_mov_b32 v46, v217
    v_mov_b32 v47, v217
    v_mov_b32 v48, v217
    v_mov_b32 v49, v217
    v_mov_b32 v50, v217
    v_mov_b32 v51, v217
    v_mov_b32 v52, v217
    v_mov_b32 v53, v217
    v_mov_b32 v54, v217
    v_mov_b32 v55, v217
    s_cmp_ge_u32 s50, 2
    s_cbranch_scc1 bf2_223
    v_mov_b32 v56, v217
    v_mov_b32 v57, v217
    v_mov_b32 v58, v217
    v_mov_b32 v59, v217
    v_mov_b32 v60, v217
    v_mov_b32 v61, v217
    v_mov_b32 v62, v217
    v_mov_b32 v63, v217
    v_mov_b32 v64, v217
    v_mov_b32 v65, v217
    v_mov_b32 v66, v217
    v_mov_b32 v67, v217
    v_mov_b32 v68, v217
    v_mov_b32 v69, v217
    v_mov_b32 v70, v217
    v_mov_b32 v71, v217
    s_cmp_ge_u32 s50, 1
    s_cbranch_scc1 bf2_223
    v_mov_b32 v72, v217
    v_mov_b32 v73, v217
    v_mov_b32 v74, v217
    v_mov_b32 v75, v217
    v_mov_b32 v76, v217
    v_mov_b32 v77, v217
    v_mov_b32 v78, v217
    v_mov_b32 v79, v217
    v_mov_b32 v80, v217
    v_mov_b32 v81, v217
    v_mov_b32 v82, v217
    v_mov_b32 v83, v217
    v_mov_b32 v84, v217
    v_mov_b32 v85, v217
    v_mov_b32 v86, v217
    v_mov_b32 v87, v217
    s_cmp_ge_u32 s50, 0
    s_cbranch_scc1 bf2_223
    v_mov_b32 v88, v217
    v_mov_b32 v89, v217
    v_mov_b32 v90, v217
    v_mov_b32 v91, v217
    v_mov_b32 v92, v217
    v_mov_b32 v93, v217
    v_mov_b32 v94, v217
    v_mov_b32 v95, v217
    v_mov_b32 v96, v217
    v_mov_b32 v97, v217
    v_mov_b32 v98, v217
    v_mov_b32 v99, v217
    v_mov_b32 v100, v217
    v_mov_b32 v101, v217
    v_mov_b32 v102, v217
    v_mov_b32 v103, v217
    s_cmp_ge_u32 s50, 0
    s_cbranch_scc1 bf2_223
    v_mov_b32 v104, v217
    v_mov_b32 v105, v217
    v_mov_b32 v106, v217
    v_mov_b32 v107, v217
    v_mov_b32 v108, v217
    v_mov_b32 v109, v217
    v_mov_b32 v110, v217
    v_mov_b32 v111, v217
    v_mov_b32 v112, v217
    v_mov_b32 v113, v217
    v_mov_b32 v114, v217
    v_mov_b32 v115, v217
    v_mov_b32 v116, v217
    v_mov_b32 v117, v217
    v_mov_b32 v118, v217
    v_mov_b32 v119, v217
    s_cmp_ge_u32 s50, 0
    s_cbranch_scc1 bf2_223
    v_mov_b32 v120, v217
    v_mov_b32 v121, v217
    v_mov_b32 v122, v217
    v_mov_b32 v123, v217
    v_mov_b32 v124, v217
    v_mov_b32 v125, v217
    v_mov_b32 v126, v217
    v_mov_b32 v127, v217
    v_mov_b32 v128, v217
    v_mov_b32 v129, v217
    v_mov_b32 v130, v217
    v_mov_b32 v131, v217
    v_mov_b32 v132, v217
    v_mov_b32 v133, v217
    v_mov_b32 v134, v217
    v_mov_b32 v135, v217
bf2_223:
    v_max3_f32 v218, v8, v9, v10
    v_max3_f32 v219, v11, v12, v13
    v_max3_f32 v218, v218, v14, v15
    v_max3_f32 v219, v219, v16, v17
    v_max3_f32 v218, v218, v18, v19
    v_max3_f32 v219, v219, v20, v21
    v_max3_f32 v218, v218, v22, v23
    v_max3_f32 v219, v219, v24, v25
    v_max3_f32 v218, v218, v26, v27
    v_max3_f32 v219, v219, v28, v29
    v_max3_f32 v218, v218, v30, v31
    v_max3_f32 v219, v219, v32, v33
    v_max3_f32 v218, v218, v34, v35
    v_max3_f32 v219, v219, v36, v37
    v_max3_f32 v218, v218, v38, v39
    v_max3_f32 v219, v219, v40, v41
    v_max3_f32 v218, v218, v42, v43
    v_max3_f32 v219, v219, v44, v45
    v_max3_f32 v218, v218, v46, v47
    v_max3_f32 v219, v219, v48, v49
    v_max3_f32 v218, v218, v50, v51
    v_max3_f32 v219, v219, v52, v53
    v_max3_f32 v218, v218, v54, v55
    v_max3_f32 v219, v219, v56, v57
    v_max3_f32 v218, v218, v58, v59
    v_max3_f32 v219, v219, v60, v61
    v_max3_f32 v218, v218, v62, v63
    v_max3_f32 v219, v219, v64, v65
    v_max3_f32 v218, v218, v66, v67
    v_max3_f32 v219, v219, v68, v69
    v_max3_f32 v218, v218, v70, v71
    v_max3_f32 v219, v219, v72, v73
    v_max3_f32 v218, v218, v74, v75
    v_max3_f32 v219, v219, v76, v77
    v_max3_f32 v218, v218, v78, v79
    v_max3_f32 v219, v219, v80, v81
    v_max3_f32 v218, v218, v82, v83
    v_max3_f32 v219, v219, v84, v85
    v_max3_f32 v218, v218, v86, v87
    v_max3_f32 v219, v219, v88, v89
    v_max3_f32 v218, v218, v90, v91
    v_max3_f32 v219, v219, v92, v93
    v_max3_f32 v218, v218, v94, v95
    v_max3_f32 v219, v219, v96, v97
    v_max3_f32 v218, v218, v98, v99
    v_max3_f32 v219, v219, v100, v101
    v_max3_f32 v218, v218, v102, v103
    v_max3_f32 v219, v219, v104, v105
    v_max3_f32 v218, v218, v106, v107
    v_max3_f32 v219, v219, v108, v109
    v_max3_f32 v218, v218, v110, v111
    v_max3_f32 v219, v219, v112, v113
    v_max3_f32 v218, v218, v114, v115
    v_max3_f32 v219, v219, v116, v117
    v_max3_f32 v218, v218, v118, v119
    v_max3_f32 v219, v219, v120, v121
    v_max3_f32 v218, v218, v122, v123
    v_max3_f32 v219, v219, v124, v125
    v_max3_f32 v218, v218, v126, v127
    v_max3_f32 v219, v219, v128, v129
    v_max3_f32 v218, v218, v130, v131
    v_max3_f32 v219, v219, v132, v133
    v_max3_f32 v218, v218, v134, v135
    v_max3_f32 v219, v219, v136, v137
    v_max3_f32 v218, v218, v138, v139
    v_max3_f32 v219, v219, v140, v141
    v_max3_f32 v218, v218, v142, v143
    v_max3_f32 v219, v219, v144, v145
    v_max3_f32 v218, v218, v146, v147
    v_max3_f32 v219, v219, v148, v149
    v_max3_f32 v218, v218, v150, v151
    v_max_f32 v218, v218, v219
bok_221:
    s_nop 11
    s_cmp_eq_u32 s69, 0
    s_cbranch_scc1 et_224
    s_mov_b32 s75, 1
    s_cmp_lg_u32 s44, 0
    s_cbranch_scc1 et_224
    s_lshl_b32 s76, s46, 7
    s_add_u32 s76, s76, 0x6402000
    v_mov_b32 v4, s76
    v_mov_b32 v7, 1
    s_mov_b64 exec, 1
    buffer_atomic_add v7, v4, s[32:35], 0 offen sc0 sc1
    s_mov_b64 exec, -1
et_224:
    v_mov_b32 v219, v218
    s_nop 1
    v_permlane32_swap_b32 v218, v219
    v_max_f32 v218, v218, v219
    v_mul_f32 v214, v212, -v218
    v_pk_fma_f32 v[8:9], v[8:9], v[212:213], v[214:215] op_sel_hi:[1,0,0]
    v_pk_fma_f32 v[10:11], v[10:11], v[212:213], v[214:215] op_sel_hi:[1,0,0]
    v_pk_fma_f32 v[12:13], v[12:13], v[212:213], v[214:215] op_sel_hi:[1,0,0]
    v_pk_fma_f32 v[14:15], v[14:15], v[212:213], v[214:215] op_sel_hi:[1,0,0]
    v_pk_fma_f32 v[16:17], v[16:17], v[212:213], v[214:215] op_sel_hi:[1,0,0]
    v_pk_fma_f32 v[18:19], v[18:19], v[212:213], v[214:215] op_sel_hi:[1,0,0]
    v_pk_fma_f32 v[20:21], v[20:21], v[212:213], v[214:215] op_sel_hi:[1,0,0]
    v_pk_fma_f32 v[22:23], v[22:23], v[212:213], v[214:215] op_sel_hi:[1,0,0]
    v_exp_f32 v8, v8
    v_exp_f32 v9, v9
    v_exp_f32 v10, v10
    v_exp_f32 v11, v11
    v_exp_f32 v12, v12
    v_exp_f32 v13, v13
    v_exp_f32 v14, v14
    v_exp_f32 v15, v15
    v_exp_f32 v16, v16
    v_exp_f32 v17, v17
    v_exp_f32 v18, v18
    v_exp_f32 v19, v19
    v_exp_f32 v20, v20
    v_exp_f32 v21, v21
    v_exp_f32 v22, v22
    v_exp_f32 v23, v23
    v_pk_add_f32 v[208:209], v[8:9], 0
    v_pk_add_f32 v[210:211], v[10:11], 0
    v_pk_add_f32 v[208:209], v[208:209], v[12:13]
    v_pk_add_f32 v[210:211], v[210:211], v[14:15]
    v_pk_add_f32 v[208:209], v[208:209], v[16:17]
    v_pk_add_f32 v[210:211], v[210:211], v[18:19]
    v_pk_add_f32 v[208:209], v[208:209], v[20:21]
    v_pk_add_f32 v[210:211], v[210:211], v[22:23]
    v_cvt_pk_bf16_f32 v8, v8, v9
    v_cvt_pk_bf16_f32 v9, v10, v11
    v_cvt_pk_bf16_f32 v10, v12, v13
    v_cvt_pk_bf16_f32 v11, v14, v15
    v_cvt_pk_bf16_f32 v12, v16, v17
    v_cvt_pk_bf16_f32 v13, v18, v19
    v_cvt_pk_bf16_f32 v14, v20, v21
    v_cvt_pk_bf16_f32 v15, v22, v23
    v_pk_fma_f32 v[24:25], v[24:25], v[212:213], v[214:215] op_sel_hi:[1,0,0]
    v_pk_fma_f32 v[26:27], v[26:27], v[212:213], v[214:215] op_sel_hi:[1,0,0]
    v_pk_fma_f32 v[28:29], v[28:29], v[212:213], v[214:215] op_sel_hi:[1,0,0]
    v_pk_fma_f32 v[30:31], v[30:31], v[212:213], v[214:215] op_sel_hi:[1,0,0]
    v_pk_fma_f32 v[32:33], v[32:33], v[212:213], v[214:215] op_sel_hi:[1,0,0]
    v_pk_fma_f32 v[34:35], v[34:35], v[212:213], v[214:215] op_sel_hi:[1,0,0]
    v_pk_fma_f32 v[36:37], v[36:37], v[212:213], v[214:215] op_sel_hi:[1,0,0]
    v_pk_fma_f32 v[38:39], v[38:39], v[212:213], v[214:215] op_sel_hi:[1,0,0]
    v_mfma_f32_32x32x16_bf16 v[184:199], a[120:123], v[8:11], 0
    v_exp_f32 v24, v24
    v_exp_f32 v25, v25
    v_exp_f32 v26, v26
    v_exp_f32 v27, v27
    v_exp_f32 v28, v28
    v_exp_f32 v29, v29
    v_exp_f32 v30, v30
    v_exp_f32 v31, v31
    v_mfma_f32_32x32x16_bf16 v[184:199], a[124:127], v[12:15], v[184:199]
    v_exp_f32 v32, v32
    v_exp_f32 v33, v33
    v_exp_f32 v34, v34
    v_exp_f32 v35, v35
    v_exp_f32 v36, v36
    v_exp_f32 v37, v37
    v_exp_f32 v38, v38
    v_exp_f32 v39, v39
    v_pk_add_f32 v[208:209], v[208:209], v[24:25]
    v_pk_add_f32 v[210:211], v[210:211], v[26:27]
    v_pk_add_f32 v[208:209], v[208:209], v[28:29]
    v_pk_add_f32 v[210:211], v[210:211], v[30:31]
    v_pk_add_f32 v[208:209], v[208:209], v[32:33]
    v_pk_add_f32 v[210:211], v[210:211], v[34:35]
    v_pk_add_f32 v[208:209], v[208:209], v[36:37]
    v_pk_add_f32 v[210:211], v[210:211], v[38:39]
    v_cvt_pk_bf16_f32 v24, v24, v25
    v_cvt_pk_bf16_f32 v25, v26, v27
    v_cvt_pk_bf16_f32 v26, v28, v29
    v_cvt_pk_bf16_f32 v27, v30, v31
    v_cvt_pk_bf16_f32 v28, v32, v33
    v_cvt_pk_bf16_f32 v29, v34, v35
    v_cvt_pk_bf16_f32 v30, v36, v37
    v_cvt_pk_bf16_f32 v31, v38, v39
    v_pk_fma_f32 v[40:41], v[40:41], v[212:213], v[214:215] op_sel_hi:[1,0,0]
    v_pk_fma_f32 v[42:43], v[42:43], v[212:213], v[214:215] op_sel_hi:[1,0,0]
    v_pk_fma_f32 v[44:45], v[44:45], v[212:213], v[214:215] op_sel_hi:[1,0,0]
    v_pk_fma_f32 v[46:47], v[46:47], v[212:213], v[214:215] op_sel_hi:[1,0,0]
    v_pk_fma_f32 v[48:49], v[48:49], v[212:213], v[214:215] op_sel_hi:[1,0,0]
    v_pk_fma_f32 v[50:51], v[50:51], v[212:213], v[214:215] op_sel_hi:[1,0,0]
    v_pk_fma_f32 v[52:53], v[52:53], v[212:213], v[214:215] op_sel_hi:[1,0,0]
    v_pk_fma_f32 v[54:55], v[54:55], v[212:213], v[214:215] op_sel_hi:[1,0,0]
    v_mfma_f32_32x32x16_bf16 v[184:199], a[128:131], v[24:27], v[184:199]
    v_exp_f32 v40, v40
    v_exp_f32 v41, v41
    v_exp_f32 v42, v42
    v_exp_f32 v43, v43
    v_exp_f32 v44, v44
    v_exp_f32 v45, v45
    v_exp_f32 v46, v46
    v_exp_f32 v47, v47
    v_mfma_f32_32x32x16_bf16 v[184:199], a[132:135], v[28:31], v[184:199]
    v_exp_f32 v48, v48
    v_exp_f32 v49, v49
    v_exp_f32 v50, v50
    v_exp_f32 v51, v51
    v_exp_f32 v52, v52
    v_exp_f32 v53, v53
    v_exp_f32 v54, v54
    v_exp_f32 v55, v55
    v_pk_add_f32 v[208:209], v[208:209], v[40:41]
    v_pk_add_f32 v[210:211], v[210:211], v[42:43]
    v_pk_add_f32 v[208:209], v[208:209], v[44:45]
    v_pk_add_f32 v[210:211], v[210:211], v[46:47]
    v_pk_add_f32 v[208:209], v[208:209], v[48:49]
    v_pk_add_f32 v[210:211], v[210:211], v[50:51]
    v_pk_add_f32 v[208:209], v[208:209], v[52:53]
    v_pk_add_f32 v[210:211], v[210:211], v[54:55]
    v_cvt_pk_bf16_f32 v40, v40, v41
    v_cvt_pk_bf16_f32 v41, v42, v43
    v_cvt_pk_bf16_f32 v42, v44, v45
    v_cvt_pk_bf16_f32 v43, v46, v47
    v_cvt_pk_bf16_f32 v44, v48, v49
    v_cvt_pk_bf16_f32 v45, v50, v51
    v_cvt_pk_bf16_f32 v46, v52, v53
    v_cvt_pk_bf16_f32 v47, v54, v55
    v_pk_fma_f32 v[56:57], v[56:57], v[212:213], v[214:215] op_sel_hi:[1,0,0]
    v_pk_fma_f32 v[58:59], v[58:59], v[212:213], v[214:215] op_sel_hi:[1,0,0]
    v_pk_fma_f32 v[60:61], v[60:61], v[212:213], v[214:215] op_sel_hi:[1,0,0]
    v_pk_fma_f32 v[62:63], v[62:63], v[212:213], v[214:215] op_sel_hi:[1,0,0]
    v_pk_fma_f32 v[64:65], v[64:65], v[212:213], v[214:215] op_sel_hi:[1,0,0]
    v_pk_fma_f32 v[66:67], v[66:67], v[212:213], v[214:215] op_sel_hi:[1,0,0]
    v_pk_fma_f32 v[68:69], v[68:69], v[212:213], v[214:215] op_sel_hi:[1,0,0]
    v_pk_fma_f32 v[70:71], v[70:71], v[212:213], v[214:215] op_sel_hi:[1,0,0]
    v_mfma_f32_32x32x16_bf16 v[184:199], a[136:139], v[40:43], v[184:199]
    v_exp_f32 v56, v56
    v_exp_f32 v57, v57
    v_exp_f32 v58, v58
    v_exp_f32 v59, v59
    v_exp_f32 v60, v60
    v_exp_f32 v61, v61
    v_exp_f32 v62, v62
    v_exp_f32 v63, v63
    v_mfma_f32_32x32x16_bf16 v[184:199], a[140:143], v[44:47], v[184:199]
    v_exp_f32 v64, v64
    v_exp_f32 v65, v65
    v_exp_f32 v66, v66
    v_exp_f32 v67, v67
    v_exp_f32 v68, v68
    v_exp_f32 v69, v69
    v_exp_f32 v70, v70
    v_exp_f32 v71, v71
    v_pk_add_f32 v[208:209], v[208:209], v[56:57]
    v_pk_add_f32 v[210:211], v[210:211], v[58:59]
    v_pk_add_f32 v[208:209], v[208:209], v[60:61]
    v_pk_add_f32 v[210:211], v[210:211], v[62:63]
    v_pk_add_f32 v[208:209], v[208:209], v[64:65]
    v_pk_add_f32 v[210:211], v[210:211], v[66:67]
    v_pk_add_f32 v[208:209], v[208:209], v[68:69]
    v_pk_add_f32 v[210:211], v[210:211], v[70:71]
    v_cvt_pk_bf16_f32 v56, v56, v57
    v_cvt_pk_bf16_f32 v57, v58, v59
    v_cvt_pk_bf16_f32 v58, v60, v61
    v_cvt_pk_bf16_f32 v59, v62, v63
    v_cvt_pk_bf16_f32 v60, v64, v65
    v_cvt_pk_bf16_f32 v61, v66, v67
    v_cvt_pk_bf16_f32 v62, v68, v69
    v_cvt_pk_bf16_f32 v63, v70, v71
    v_pk_fma_f32 v[72:73], v[72:73], v[212:213], v[214:215] op_sel_hi:[1,0,0]
    v_pk_fma_f32 v[74:75], v[74:75], v[212:213], v[214:215] op_sel_hi:[1,0,0]
    v_pk_fma_f32 v[76:77], v[76:77], v[212:213], v[214:215] op_sel_hi:[1,0,0]
    v_pk_fma_f32 v[78:79], v[78:79], v[212:213], v[214:215] op_sel_hi:[1,0,0]
    v_pk_fma_f32 v[80:81], v[80:81], v[212:213], v[214:215] op_sel_hi:[1,0,0]
    v_pk_fma_f32 v[82:83], v[82:83], v[212:213], v[214:215] op_sel_hi:[1,0,0]
    v_pk_fma_f32 v[84:85], v[84:85], v[212:213], v[214:215] op_sel_hi:[1,0,0]
    v_pk_fma_f32 v[86:87], v[86:87], v[212:213], v[214:215] op_sel_hi:[1,0,0]
    v_mfma_f32_32x32x16_bf16 v[184:199], a[144:147], v[56:59], v[184:199]
    v_exp_f32 v72, v72
    v_exp_f32 v73, v73
    v_exp_f32 v74, v74
    v_exp_f32 v75, v75
    v_exp_f32 v76, v76
    v_exp_f32 v77, v77
    v_exp_f32 v78, v78
    v_exp_f32 v79, v79
    v_mfma_f32_32x32x16_bf16 v[184:199], a[148:151], v[60:63], v[184:199]
    v_exp_f32 v80, v80
    v_exp_f32 v81, v81
    v_exp_f32 v82, v82
    v_exp_f32 v83, v83
    v_exp_f32 v84, v84
    v_exp_f32 v85, v85
    v_exp_f32 v86, v86
    v_exp_f32 v87, v87
    v_pk_add_f32 v[208:209], v[208:209], v[72:73]
    v_pk_add_f32 v[210:211], v[210:211], v[74:75]
    v_pk_add_f32 v[208:209], v[208:209], v[76:77]
    v_pk_add_f32 v[210:211], v[210:211], v[78:79]
    v_pk_add_f32 v[208:209], v[208:209], v[80:81]
    v_pk_add_f32 v[210:211], v[210:211], v[82:83]
    v_pk_add_f32 v[208:209], v[208:209], v[84:85]
    v_pk_add_f32 v[210:211], v[210:211], v[86:87]
    v_cvt_pk_bf16_f32 v72, v72, v73
    v_cvt_pk_bf16_f32 v73, v74, v75
    v_cvt_pk_bf16_f32 v74, v76, v77
    v_cvt_pk_bf16_f32 v75, v78, v79
    v_cvt_pk_bf16_f32 v76, v80, v81
    v_cvt_pk_bf16_f32 v77, v82, v83
    v_cvt_pk_bf16_f32 v78, v84, v85
    v_cvt_pk_bf16_f32 v79, v86, v87
    v_pk_fma_f32 v[88:89], v[88:89], v[212:213], v[214:215] op_sel_hi:[1,0,0]
    v_pk_fma_f32 v[90:91], v[90:91], v[212:213], v[214:215] op_sel_hi:[1,0,0]
    v_pk_fma_f32 v[92:93], v[92:93], v[212:213], v[214:215] op_sel_hi:[1,0,0]
    v_pk_fma_f32 v[94:95], v[94:95], v[212:213], v[214:215] op_sel_hi:[1,0,0]
    v_pk_fma_f32 v[96:97], v[96:97], v[212:213], v[214:215] op_sel_hi:[1,0,0]
    v_pk_fma_f32 v[98:99], v[98:99], v[212:213], v[214:215] op_sel_hi:[1,0,0]
    v_pk_fma_f32 v[100:101], v[100:101], v[212:213], v[214:215] op_sel_hi:[1,0,0]
    v_pk_fma_f32 v[102:103], v[102:103], v[212:213], v[214:215] op_sel_hi:[1,0,0]
    v_mfma_f32_32x32x16_bf16 v[184:199], a[152:155], v[72:75], v[184:199]
    v_exp_f32 v88, v88
    v_exp_f32 v89, v89
    v_exp_f32 v90, v90
    v_exp_f32 v91, v91
    v_exp_f32 v92, v92
    v_exp_f32 v93, v93
    v_exp_f32 v94, v94
    v_exp_f32 v95, v95
    v_mfma_f32_32x32x16_bf16 v[184:199], a[156:159], v[76:79], v[184:199]
    v_exp_f32 v96, v96
    v_exp_f32 v97, v97
    v_exp_f32 v98, v98
    v_exp_f32 v99, v99
    v_exp_f32 v100, v100
    v_exp_f32 v101, v101
    v_exp_f32 v102, v102
    v_exp_f32 v103, v103
    v_pk_add_f32 v[208:209], v[208:209], v[88:89]
    v_pk_add_f32 v[210:211], v[210:211], v[90:91]
    v_pk_add_f32 v[208:209], v[208:209], v[92:93]
    v_pk_add_f32 v[210:211], v[210:211], v[94:95]
    v_pk_add_f32 v[208:209], v[208:209], v[96:97]
    v_pk_add_f32 v[210:211], v[210:211], v[98:99]
    v_pk_add_f32 v[208:209], v[208:209], v[100:101]
    v_pk_add_f32 v[210:211], v[210:211], v[102:103]
    v_cvt_pk_bf16_f32 v88, v88, v89
    v_cvt_pk_bf16_f32 v89, v90, v91
    v_cvt_pk_bf16_f32 v90, v92, v93
    v_cvt_pk_bf16_f32 v91, v94, v95
    v_cvt_pk_bf16_f32 v92, v96, v97
    v_cvt_pk_bf16_f32 v93, v98, v99
    v_cvt_pk_bf16_f32 v94, v100, v101
    v_cvt_pk_bf16_f32 v95, v102, v103
    v_pk_fma_f32 v[104:105], v[104:105], v[212:213], v[214:215] op_sel_hi:[1,0,0]
    v_pk_fma_f32 v[106:107], v[106:107], v[212:213], v[214:215] op_sel_hi:[1,0,0]
    v_pk_fma_f32 v[108:109], v[108:109], v[212:213], v[214:215] op_sel_hi:[1,0,0]
    v_pk_fma_f32 v[110:111], v[110:111], v[212:213], v[214:215] op_sel_hi:[1,0,0]
    v_pk_fma_f32 v[112:113], v[112:113], v[212:213], v[214:215] op_sel_hi:[1,0,0]
    v_pk_fma_f32 v[114:115], v[114:115], v[212:213], v[214:215] op_sel_hi:[1,0,0]
    v_pk_fma_f32 v[116:117], v[116:117], v[212:213], v[214:215] op_sel_hi:[1,0,0]
    v_pk_fma_f32 v[118:119], v[118:119], v[212:213], v[214:215] op_sel_hi:[1,0,0]
    v_mfma_f32_32x32x16_bf16 v[184:199], a[160:163], v[88:91], v[184:199]
    v_exp_f32 v104, v104
    v_exp_f32 v105, v105
    v_exp_f32 v106, v106
    v_exp_f32 v107, v107
    v_exp_f32 v108, v108
    v_exp_f32 v109, v109
    v_exp_f32 v110, v110
    v_exp_f32 v111, v111
    v_mfma_f32_32x32x16_bf16 v[184:199], a[164:167], v[92:95], v[184:199]
    v_exp_f32 v112, v112
    v_exp_f32 v113, v113
    v_exp_f32 v114, v114
    v_exp_f32 v115, v115
    v_exp_f32 v116, v116
    v_exp_f32 v117, v117
    v_exp_f32 v118, v118
    v_exp_f32 v119, v119
    v_pk_add_f32 v[208:209], v[208:209], v[104:105]
    v_pk_add_f32 v[210:211], v[210:211], v[106:107]
    v_pk_add_f32 v[208:209], v[208:209], v[108:109]
    v_pk_add_f32 v[210:211], v[210:211], v[110:111]
    v_pk_add_f32 v[208:209], v[208:209], v[112:113]
    v_pk_add_f32 v[210:211], v[210:211], v[114:115]
    v_pk_add_f32 v[208:209], v[208:209], v[116:117]
    v_pk_add_f32 v[210:211], v[210:211], v[118:119]
    v_cvt_pk_bf16_f32 v104, v104, v105
    v_cvt_pk_bf16_f32 v105, v106, v107
    v_cvt_pk_bf16_f32 v106, v108, v109
    v_cvt_pk_bf16_f32 v107, v110, v111
    v_cvt_pk_bf16_f32 v108, v112, v113
    v_cvt_pk_bf16_f32 v109, v114, v115
    v_cvt_pk_bf16_f32 v110, v116, v117
    v_cvt_pk_bf16_f32 v111, v118, v119
    v_pk_fma_f32 v[120:121], v[120:121], v[212:213], v[214:215] op_sel_hi:[1,0,0]
    v_pk_fma_f32 v[122:123], v[122:123], v[212:213], v[214:215] op_sel_hi:[1,0,0]
    v_pk_fma_f32 v[124:125], v[124:125], v[212:213], v[214:215] op_sel_hi:[1,0,0]
    v_pk_fma_f32 v[126:127], v[126:127], v[212:213], v[214:215] op_sel_hi:[1,0,0]
    v_pk_fma_f32 v[128:129], v[128:129], v[212:213], v[214:215] op_sel_hi:[1,0,0]
    v_pk_fma_f32 v[130:131], v[130:131], v[212:213], v[214:215] op_sel_hi:[1,0,0]
    v_pk_fma_f32 v[132:133], v[132:133], v[212:213], v[214:215] op_sel_hi:[1,0,0]
    v_pk_fma_f32 v[134:135], v[134:135], v[212:213], v[214:215] op_sel_hi:[1,0,0]
    v_mfma_f32_32x32x16_bf16 v[184:199], a[168:171], v[104:107], v[184:199]
    v_exp_f32 v120, v120
    v_exp_f32 v121, v121
    v_exp_f32 v122, v122
    v_exp_f32 v123, v123
    v_exp_f32 v124, v124
    v_exp_f32 v125, v125
    v_exp_f32 v126, v126
    v_exp_f32 v127, v127
    v_mfma_f32_32x32x16_bf16 v[184:199], a[172:175], v[108:111], v[184:199]
    v_exp_f32 v128, v128
    v_exp_f32 v129, v129
    v_exp_f32 v130, v130
    v_exp_f32 v131, v131
    v_exp_f32 v132, v132
    v_exp_f32 v133, v133
    v_exp_f32 v134, v134
    v_exp_f32 v135, v135
    v_pk_add_f32 v[208:209], v[208:209], v[120:121]
    v_pk_add_f32 v[210:211], v[210:211], v[122:123]
    v_pk_add_f32 v[208:209], v[208:209], v[124:125]
    v_pk_add_f32 v[210:211], v[210:211], v[126:127]
    v_pk_add_f32 v[208:209], v[208:209], v[128:129]
    v_pk_add_f32 v[210:211], v[210:211], v[130:131]
    v_pk_add_f32 v[208:209], v[208:209], v[132:133]
    v_pk_add_f32 v[210:211], v[210:211], v[134:135]
    v_cvt_pk_bf16_f32 v120, v120, v121
    v_cvt_pk_bf16_f32 v121, v122, v123
    v_cvt_pk_bf16_f32 v122, v124, v125
    v_cvt_pk_bf16_f32 v123, v126, v127
    v_cvt_pk_bf16_f32 v124, v128, v129
    v_cvt_pk_bf16_f32 v125, v130, v131
    v_cvt_pk_bf16_f32 v126, v132, v133
    v_cvt_pk_bf16_f32 v127, v134, v135
    v_pk_fma_f32 v[136:137], v[136:137], v[212:213], v[214:215] op_sel_hi:[1,0,0]
    v_pk_fma_f32 v[138:139], v[138:139], v[212:213], v[214:215] op_sel_hi:[1,0,0]
    v_pk_fma_f32 v[140:141], v[140:141], v[212:213], v[214:215] op_sel_hi:[1,0,0]
    v_pk_fma_f32 v[142:143], v[142:143], v[212:213], v[214:215] op_sel_hi:[1,0,0]
    v_pk_fma_f32 v[144:145], v[144:145], v[212:213], v[214:215] op_sel_hi:[1,0,0]
    v_pk_fma_f32 v[146:147], v[146:147], v[212:213], v[214:215] op_sel_hi:[1,0,0]
    v_pk_fma_f32 v[148:149], v[148:149], v[212:213], v[214:215] op_sel_hi:[1,0,0]
    v_pk_fma_f32 v[150:151], v[150:151], v[212:213], v[214:215] op_sel_hi:[1,0,0]
    v_mfma_f32_32x32x16_bf16 v[184:199], a[176:179], v[120:123], v[184:199]
    v_exp_f32 v136, v136
    v_exp_f32 v137, v137
    v_exp_f32 v138, v138
    v_exp_f32 v139, v139
    v_exp_f32 v140, v140
    v_exp_f32 v141, v141
    v_exp_f32 v142, v142
    v_exp_f32 v143, v143
    v_mfma_f32_32x32x16_bf16 v[184:199], a[180:183], v[124:127], v[184:199]
    v_exp_f32 v144, v144
    v_exp_f32 v145, v145
    v_exp_f32 v146, v146
    v_exp_f32 v147, v147
    v_exp_f32 v148, v148
    v_exp_f32 v149, v149
    v_exp_f32 v150, v150
    v_exp_f32 v151, v151
    v_pk_add_f32 v[208:209], v[208:209], v[136:137]
    v_pk_add_f32 v[210:211], v[210:211], v[138:139]
    v_pk_add_f32 v[208:209], v[208:209], v[140:141]
    v_pk_add_f32 v[210:211], v[210:211], v[142:143]
    v_pk_add_f32 v[208:209], v[208:209], v[144:145]
    v_pk_add_f32 v[210:211], v[210:211], v[146:147]
    v_pk_add_f32 v[208:209], v[208:209], v[148:149]
    v_pk_add_f32 v[210:211], v[210:211], v[150:151]
    v_cvt_pk_bf16_f32 v136, v136, v137
    v_cvt_pk_bf16_f32 v137, v138, v139
    v_cvt_pk_bf16_f32 v138, v140, v141
    v_cvt_pk_bf16_f32 v139, v142, v143
    v_cvt_pk_bf16_f32 v140, v144, v145
    v_cvt_pk_bf16_f32 v141, v146, v147
    v_cvt_pk_bf16_f32 v142, v148, v149
    v_cvt_pk_bf16_f32 v143, v150, v151
    s_waitcnt vmcnt(6)
    v_pk_add_f32 v[208:209], v[208:209], v[210:211]
    v_mfma_f32_32x32x16_bf16 v[184:199], a[184:187], v[136:139], v[184:199]
    v_mfma_f32_32x32x16_bf16 v[184:199], a[188:191], v[140:143], v[184:199]
    v_add_f32 v208, v208, v209
    v_mov_b32 v209, v208
    s_nop 1
    v_permlane32_swap_b32 v208, v209
    v_add_f32 v208, v208, v209
    v_rcp_f32 v208, v208
    s_add_u32 s52, s49, 196608
    s_nop 3
    v_pk_mul_f32 v[184:185], v[184:185], v[208:209] op_sel_hi:[1,0]
    v_pk_mul_f32 v[186:187], v[186:187], v[208:209] op_sel_hi:[1,0]
    v_pk_mul_f32 v[188:189], v[188:189], v[208:209] op_sel_hi:[1,0]
    v_pk_mul_f32 v[190:191], v[190:191], v[208:209] op_sel_hi:[1,0]
    v_pk_mul_f32 v[192:193], v[192:193], v[208:209] op_sel_hi:[1,0]
    v_pk_mul_f32 v[194:195], v[194:195], v[208:209] op_sel_hi:[1,0]
    v_pk_mul_f32 v[196:197], v[196:197], v[208:209] op_sel_hi:[1,0]
    v_pk_mul_f32 v[198:199], v[198:199], v[208:209] op_sel_hi:[1,0]
    v_cvt_pk_bf16_f32 v200, v184, v185
    v_cvt_pk_bf16_f32 v201, v186, v187
    v_cvt_pk_bf16_f32 v202, v188, v189
    v_cvt_pk_bf16_f32 v203, v190, v191
    v_cvt_pk_bf16_f32 v204, v192, v193
    v_cvt_pk_bf16_f32 v205, v194, v195
    v_cvt_pk_bf16_f32 v206, v196, v197
    v_cvt_pk_bf16_f32 v207, v198, v199
    buffer_store_dwordx4 v[200:203], v222, s[32:35], s52 offen offset:0 sc1
    buffer_store_dwordx4 v[204:207], v222, s[32:35], s52 offen offset:1024 sc1
mega_kernel_wdone:
    s_cmp_lg_u32 s69, 0
    s_cbranch_scc1 q0_225
    v_cmp_gt_u32 vcc, 8, v1
    v_lshlrev_b32 v4, 2, v1
    v_mov_b32 v5, 52
    v_cndmask_b32 v4, v5, v4, vcc
    buffer_load_dword v5, v4, s[36:39], 0 offen sc1
    v_cndmask_b32 v4, 1, 32, vcc
    s_waitcnt vmcnt(0)
    v_cmp_ne_u32 vcc, v4, v5
    s_nop 0
    s_cbranch_vccnz q0_225
    s_mov_b32 s69, 1
q0_225:
    s_waitcnt vmcnt(0)
    v_mov_b32 v4, 131136
    s_cmp_lg_u32 s44, 0
    s_cbranch_scc1 d1_226
    s_mov_b64 exec, 1
    ds_write_b32 v4, v7
    s_mov_b64 exec, -1
    s_waitcnt lgkmcnt(0)
d1_226:
    s_barrier
    s_cmp_lg_u32 s69, 0
    s_cbranch_scc1 ck_229
    s_cmp_lg_u32 s100, 0
    s_cbranch_scc1 pcd_231
    v_and_b32 v4, 7, v1
    v_lshlrev_b32 v4, 2, v4
    s_mov_b32 s52, 0
pcw_230:
    buffer_load_dword v5, v4, s[36:39], 0 offen sc1
    s_add_u32 s52, s52, 1
    s_waitcnt vmcnt(0)
    v_cmp_ne_u32 vcc, 32, v5
    s_nop 0
    s_cbranch_vccz pcd_231
    v_cmp_lt_u32 vcc, 32, v5
    s_nop 0
    s_cbranch_vccnz pcb_232
    s_sleep 8
    s_cmp_lt_u32 s52, 200000
    s_cbranch_scc1 pcw_230
    s_branch pcd_231
pcb_232:
    s_mov_b32 s100, 1
    s_waitcnt vmcnt(0) lgkmcnt(0)
    s_barrier
    s_branch mega_kernel_restart
pcd_231:
ck_229:
    s_cmp_lg_u32 s44, 0
    s_cbranch_scc1 d2_227
    s_cmp_lg_u32 s57, 0
    s_cbranch_scc1 sig_228
d2_227:
    s_cmp_eq_u32 s75, 0
    s_cbranch_scc1 mega_kernel_wnext
    s_mov_b32 s75, 0
    v_mov_b32 v4, 131136
    ds_read_b32 v5, v4
    s_waitcnt lgkmcnt(0)
    v_readfirstlane_b32 s47, v5
    s_barrier
    s_branch gotjob_137
sig_228:
    s_cmp_lg_u32 s69, 0
    s_cbranch_scc1 id_234
    s_mov_b32 s69, 1
    v_mov_b32 v4, 52
    s_mov_b32 s52, 0
iw_233:
    buffer_load_dword v5, v4, s[36:39], 0 offen sc1
    s_add_u32 s52, s52, 1
    s_waitcnt vmcnt(0)
    v_cmp_ne_u32 vcc, 0, v5
    s_nop 0
    s_cbranch_vccnz id_234
    s_sleep 4
    s_cmp_lt_u32 s52, 200000
    s_cbranch_scc1 iw_233
id_234:
    s_add_u32 s49, s56, s45
    s_lshl_b32 s49, s49, 7
    s_add_u32 s49, s49, 0x6400000
    v_mov_b32 v4, s49
    v_mov_b32 v5, s57
    s_mov_b64 exec, 1
    buffer_atomic_add v5, v4, s[32:35], 0 offen sc1
    s_cmp_lg_u32 s56, 80
    s_cbranch_scc1 k0_235
    s_cmp_lg_u32 s58, 0
    s_cbranch_scc1 k0_235
    v_add_u32 v4, -3072, v4
    v_mov_b32 v5, 2
    buffer_atomic_add v5, v4, s[32:35], 0 offen sc1
k0_235:
    s_mov_b64 exec, -1
    s_branch d2_227
mega_kernel_end:
    s_endpgm
.section .rodata,"a"
.p2align 6
.amdhsa_kernel mega_kernel
  .amdhsa_next_free_vgpr 512
  .amdhsa_next_free_sgpr 102
  .amdhsa_accum_offset 256
  .amdhsa_group_segment_fixed_size 0
  .amdhsa_kernarg_size 104
  .amdhsa_user_sgpr_count 2
  .amdhsa_user_sgpr_kernarg_segment_ptr 1
  .amdhsa_system_sgpr_workgroup_id_x 1
  .amdhsa_float_denorm_mode_32 3
.end_amdhsa_kernel
```
